```python
import torch

def _softmax(x, axis=-1):
    return torch.softmax(x, dim=axis)

def _gelu(x):
    return torch.nn.functional.gelu(x, approximate='tanh')

def _silu(x):
    return torch.nn.functional.silu(x)

def _sigmoid(x):
    return torch.sigmoid(x)

def _layernorm(x, axis=-1, eps=1e-05):
    m = x.mean(dim=axis, keepdim=True)
    v = x.var(dim=axis, keepdim=True, unbiased=False)
    return (x - m) / torch.sqrt(v + eps)

def _scatter_add(tgt, idx, src, axis=0):
    return tgt.clone().index_add_(axis, idx, src)

def _segment_sum(src, seg, n):
    out = torch.zeros((n,) + src.shape[1:], dtype=src.dtype)
    return out.index_add_(0, seg, src)

def _pad(x, pw):
    flat = tuple((v for pair in reversed(pw) for v in pair))
    return torch.nn.functional.pad(x, flat)
kernel_name = 'parallel_sum__memory_aug_recurrent_mem_tr__mixer_channel_mlp__prompt'

def setup_inputs():

    _w = lambda a: (lambda t: t.to(torch.bfloat16) if t.is_floating_point() else t)(torch.as_tensor(a))

    def _A_setup():
        B, S, Dm = (1, 2048, 640)
        H, Dh = (32, 128)
        M, seg = (8, 32)
        seg = min(seg, S)
        S = S // seg * seg
        return {'x': _w((lambda *s: torch.randn(*s, dtype=torch.bfloat16) * 0.05)(B, S, Dm)), 'mem0': _w((lambda *s: torch.randn(*s, dtype=torch.bfloat16) * 0.2)(B, M, Dm)), 'Wq': _w((lambda *s: torch.randn(*s, dtype=torch.bfloat16) * 1.6)(Dm, H, Dh) * Dm ** (-0.5)), 'Wk': _w((lambda *s: torch.randn(*s, dtype=torch.bfloat16) * 1.6)(Dm, H, Dh) * Dm ** (-0.5)), 'Wv': _w((lambda *s: torch.randn(*s, dtype=torch.bfloat16) * 0.2)(Dm, H, Dh) * Dm ** (-0.5)), 'Wo': _w((lambda *s: torch.randn(*s, dtype=torch.bfloat16) * 0.2)(H, Dh, Dm) * (H * Dh) ** (-0.5)), 'seg_len': seg}
    _A_in = _A_setup()

    def _B_setup():
        B, S, D, F = (1, 2048, 640, 1728)
        return {'x': _w((lambda *s: torch.randn(*s, dtype=torch.bfloat16) * 0.05)(B, S, D)), 'w1': _w((lambda *s: torch.randn(*s, dtype=torch.bfloat16) * 0.8)(D, F) * D ** (-0.5)), 'b1': _w((lambda *s: torch.randn(*s, dtype=torch.bfloat16) * 0.4)(F)), 'w2': _w((lambda *s: torch.randn(*s, dtype=torch.bfloat16) * 0.05)(F, D) * F ** (-0.5)), 'b2': _w((lambda *s: torch.randn(*s, dtype=torch.bfloat16) * 0.05)(D))}
    _B_in = _B_setup()
    return {'A_x': _A_in['x'], 'A_mem0': _A_in['mem0'], 'A_Wq': _A_in['Wq'], 'A_Wk': _A_in['Wk'], 'A_Wv': _A_in['Wv'], 'A_Wo': _A_in['Wo'], 'A_seg_len': _A_in['seg_len'], 'B_x': _B_in['x'], 'B_w1': _B_in['w1'], 'B_b1': _B_in['b1'], 'B_w2': _B_in['w2'], 'B_b2': _B_in['b2']}

def reference(A_x, A_mem0, A_Wq, A_Wk, A_Wv, A_Wo, A_seg_len, B_x, B_w1, B_b1, B_w2, B_b2):

    def _A_ref(x, mem0, Wq, Wk, Wv, Wo, seg_len):
        B, S, Dm = x.shape
        H, Dh = (Wq.shape[1], Wq.shape[2])
        M = mem0.shape[1]
        scale = Dh ** (-0.5)
        n_seg = S // seg_len
        L = M + seg_len
        idx = torch.arange(L)
        mask = (idx[:, None] < M) | (idx[:, None] >= idx[None, :])
        mem = mem0
        outs = []
        for s in range(n_seg):
            xs = x[:, s * seg_len:(s + 1) * seg_len, :].clone()
            h = torch.concatenate([mem, xs], axis=1)
            q = torch.einsum('btd,dhe->bhte', h, Wq)
            k = torch.einsum('btd,dhe->bhte', h, Wk)
            v = torch.einsum('btd,dhe->bhte', h, Wv)
            scores = torch.einsum('bhqe,bhke->bhqk', q, k) * scale
            scores = torch.where(mask[None, None], scores, -1000000000.0)
            p = _softmax(scores, axis=-1)
            o = torch.einsum('bhqk,bhke->bhqe', p, v)
            o = torch.einsum('bhte,hed->btd', o, Wo)
            mem = o[:, :M, :].clone()
            outs.append(o[:, M:, :])
        return torch.concatenate(outs, axis=1)

    def _B_ref(x, w1, b1, w2, b2):
        y = _layernorm(x, axis=-1)
        h = _gelu(torch.einsum('bsd,df->bsf', y, w1) + b1)
        return torch.einsum('bsf,fd->bsd', h, w2) + b2
    x = A_x
    xn = _layernorm(x, axis=-1)
    return x + _A_ref(xn, A_mem0, A_Wq, A_Wk, A_Wv, A_Wo, A_seg_len) + _B_ref(xn, B_w1, B_b1, B_w2, B_b2)
```

```asm
; @launch grid=(256,1,1) block=(256,1,1) lds=163840
.amdgcn_target "amdgcn-amd-amdhsa--gfx950"
.text
.globl parallel_sum__memory_aug_recurrent_mem_tr__mixer_channel_mlp__prompt_kernel
.p2align 8
.type parallel_sum__memory_aug_recurrent_mem_tr__mixer_channel_mlp__prompt_kernel,@function
parallel_sum__memory_aug_recurrent_mem_tr__mixer_channel_mlp__prompt_kernel:
    s_cmp_ge_u32 s2, 256
    s_cbranch_scc1 L_exit
    s_load_dwordx2 s[50:51], s[0:1], 104
    s_load_dwordx2 s[4:5], s[0:1], 112
    s_getreg_b32 s52, hwreg(HW_REG_XCC_ID, 0, 4)
    v_lshrrev_b32 v1, 6, v0
    s_nop 0
    v_readfirstlane_b32 s13, v1
    v_and_b32 v0, 63, v0
    s_mov_b32 s6, 268435456
    s_mov_b32 s7, 0x20000
    s_xor_b32 s64, s52, 3
    s_and_b32 s64, s64, 7
    s_waitcnt lgkmcnt(0)
    s_cmp_eq_u32 s13, 0
    s_cbranch_scc0 L_gotrole
    s_mov_b64 exec, 1
    v_mov_b32 v2, 1
    s_mov_b32 s42, 0
L_ticket:
    s_lshl_b32 s43, s64, 2
    s_add_u32 s43, s43, 128
    s_cmp_eq_u32 s64, 0
    s_cselect_b32 s43, 0, s43
    v_mov_b32 v1, s43
    global_atomic_add v3, v1, v2, s[50:51] sc0
    s_waitcnt vmcnt(0)
    v_readfirstlane_b32 s65, v3
    s_nop 3
    s_cmp_lt_u32 s65, 32
    s_cbranch_scc1 L_ticketok
    s_add_u32 s64, s64, 1
    s_and_b32 s64, s64, 7
    s_add_u32 s42, s42, 1
    s_cmp_lt_u32 s42, 8
    s_cbranch_scc1 L_ticket
    s_mov_b32 s64, 8
L_ticketok:
    s_lshl_b32 s43, s64, 5
    s_add_u32 s43, s43, s65
    v_mov_b32 v3, s43
    v_mov_b32 v1, 23552
    ds_write_b32 v1, v3
    s_waitcnt lgkmcnt(0)
    s_mov_b64 exec, -1
L_gotrole:
    s_barrier
    v_mov_b32 v1, 23552
    ds_read_b32 v3, v1
    s_waitcnt lgkmcnt(0)
    v_readfirstlane_b32 s43, v3
    s_nop 3
    s_lshr_b32 s64, s43, 5
    s_and_b32 s65, s43, 31
    s_barrier
    s_cmp_ge_u32 s64, 8
    s_cbranch_scc1 L_exit
    s_cmp_eq_u32 s64, 0
    s_cbranch_scc0 L_worker
    s_mov_b32 s12, s65
    s_load_dwordx2 s[54:55], s[0:1], 16
    s_load_dwordx2 s[56:57], s[0:1], 24
    s_load_dwordx2 s[58:59], s[0:1], 32
    s_load_dwordx2 s[60:61], s[0:1], 40
    s_load_dwordx2 s[62:63], s[0:1], 8
    s_mov_b32 s40, 0x05040100
    s_mov_b32 s41, 0x07060302
    v_mov_b32 v15, v0
    v_lshlrev_b32 v0, 4, v0
    s_mov_b32 s11, 0x20000
    v_lshrrev_b32 v4, 4, v15
    v_lshlrev_b32 v4, 2, v4
    v_and_b32 v5, 15, v15
    v_lshlrev_b32 v5, 2, v5
    s_lshl_b32 s42, s12, 8
    s_lshl_b32 s43, s13, 6
    s_add_u32 s42, s42, s43
    v_lshl_add_u32 v1, v4, 13, v5
    v_add_u32 v1, s42, v1
    v_mul_u32_u24 v2, 1280, v4
    v_add_u32 v2, v2, v5
    s_mul_i32 s42, s12, 163840
    s_add_u32 s42, s42, s43
    v_add_u32 v2, s42, v2
    v_add_u32 v14, v2, v5
    v_add_u32 v14, s43, v14
    v_lshrrev_b32 v12, 4, v15
    s_lshl_b32 s42, s13, 4
    v_add_u32 v1, s42, v12
    v_lshlrev_b32 v1, 13, v1
    v_and_b32 v13, 15, v15
    v_lshl_add_u32 v1, v13, 4, v1
    s_lshl_b32 s42, s12, 8
    v_add_u32 v1, s42, v1
    v_lshlrev_b32 v13, 10, v12
    v_add_u32 v13, v13, v5
    v_add_u32 v13, s43, v13
    s_mul_i32 s42, s13, 34816
    s_add_u32 s42, s42, 24576
    v_add_u32 v3, s42, v0
    s_lshl_b32 s42, s12, 2
    s_add_u32 s42, s42, s13
    s_lshl_b32 s42, s42, 14
    s_add_u32 s24, s42, 524288
    s_add_u32 s36, s24, 4096
    s_add_u32 s37, s24, 8192
    s_add_u32 s38, s24, 12288
    s_mov_b32 s10, 5242880
    s_mov_b32 s11, 0x20000
    s_lshl_b32 s43, s13, 12
    s_waitcnt lgkmcnt(0)
    s_mov_b32 s8, s54
    s_mov_b32 s9, s55
    s_add_u32 m0, s43, 43008
    s_mov_b32 s42, 0
    buffer_load_dwordx4 v1, s[8:11], s42 offen  lds
    s_add_u32 m0, s43, 44032
    s_mov_b32 s42, 32768
    buffer_load_dwordx4 v1, s[8:11], s42 offen  lds
    s_add_u32 m0, s43, 45056
    s_mov_b32 s42, 65536
    buffer_load_dwordx4 v1, s[8:11], s42 offen  lds
    s_add_u32 m0, s43, 46080
    s_mov_b32 s42, 98304
    buffer_load_dwordx4 v1, s[8:11], s42 offen  lds
    s_add_u32 m0, s43, 77824
    s_mov_b32 s42, 524288
    buffer_load_dwordx4 v1, s[8:11], s42 offen  lds
    s_add_u32 m0, s43, 78848
    s_mov_b32 s42, 557056
    buffer_load_dwordx4 v1, s[8:11], s42 offen  lds
    s_add_u32 m0, s43, 79872
    s_mov_b32 s42, 589824
    buffer_load_dwordx4 v1, s[8:11], s42 offen  lds
    s_add_u32 m0, s43, 80896
    s_mov_b32 s42, 622592
    buffer_load_dwordx4 v1, s[8:11], s42 offen  lds
    v_bfe_u32 v12, v15, 1, 3
    v_lshlrev_b32 v1, 6, v12
    v_lshrrev_b32 v12, 4, v15
    v_lshl_add_u32 v1, v12, 4, v1
    v_and_b32 v12, 1, v15
    v_mov_b32 v13, 0xaaaa
    v_mul_u32_u24 v2, v12, v13
    v_add_u32 v2, 0x4444, v2
    s_lshl_b32 s46, s13, 5
    s_add_u32 s46, s46, s12
    s_lshl_b32 s42, s46, 7
    v_lshrrev_b32 v12, 3, v15
    v_mul_u32_u24 v4, 10240, v12
    v_and_b32 v12, 7, v15
    v_lshl_add_u32 v4, v12, 4, v4
    v_add_u32 v4, s42, v4
    s_and_b32 s43, s46, 1
    s_lshl_b32 s43, s43, 2
    s_bfe_u32 s53, s46, 0x20001
    s_or_b32 s43, s43, s53
    s_andn2_b32 s53, s46, 7
    s_or_b32 s43, s43, s53
    s_cmp_lt_u32 s46, 64
    s_cselect_b32 s53, s43, s46
    s_lshl_b32 s42, s53, 7
    v_lshrrev_b32 v12, 4, v15
    v_lshlrev_b32 v5, 6, v12
    v_and_b32 v12, 15, v15
    v_lshl_add_u32 v5, v12, 3, v5
    v_add_u32 v5, s42, v5
    v_and_b32 v12, 0x28, v15
    v_cmp_eq_u32 vcc, 0, v12
    v_mov_b32 v13, 0x7ff00000
    s_nop 0
    v_cndmask_b32 v5, v13, v5, vcc
    v_lshrrev_b32 v12, 5, v15
    v_lshlrev_b32 v12, 2, v12
    v_and_b32 v13, 15, v15
    v_xor_b32 v12, v12, v13
    v_lshlrev_b32 v6, 3, v12
    v_lshrrev_b32 v12, 4, v15
    v_lshl_add_u32 v6, v12, 7, v6
    s_lshl_b32 s42, s13, 10
    s_add_u32 s42, s42, 10240
    v_add_u32 v6, s42, v6
    v_bfe_u32 v12, v15, 3, 1
    v_lshlrev_b32 v7, 3, v12
    v_lshrrev_b32 v12, 4, v15
    v_lshl_add_u32 v7, v12, 1, v7
    v_bfe_u32 v12, v15, 2, 1
    v_add_u32 v7, v7, v12
    v_bfe_u32 v12, v15, 1, 1
    v_lshlrev_b32 v12, 2, v12
    v_xor_b32 v7, v7, v12
    v_lshlrev_b32 v7, 3, v7
    v_and_b32 v12, 3, v15
    v_lshl_add_u32 v7, v12, 7, v7
    v_add_u32 v7, 10240, v7
    v_bfe_u32 v12, v15, 2, 2
    v_lshlrev_b32 v8, 7, v12
    v_and_b32 v12, 1, v15
    v_lshl_add_u32 v8, v12, 6, v8
    v_lshrrev_b32 v12, 4, v15
    v_lshl_add_u32 v8, v12, 4, v8
    s_lshl_b32 s42, s13, 9
    v_add_u32 v8, s42, v8
    v_and_b32 v12, 2, v15
    v_lshl_add_u32 v8, v12, 17, v8
    v_lshlrev_b32 v9, 3, v15
    s_mul_i32 s42, s12, 10240
    s_add_u32 s42, s42, 131072
    s_lshl_b32 s43, s13, 10
    s_add_u32 s25, s42, s43
    s_add_u32 s26, s25, 4096
    s_lshl_b32 s43, s13, 9
    s_add_u32 s27, s42, s43
    s_add_u32 s27, s27, 8192
    s_mov_b32 s28, 131072
    s_mov_b32 s29, 212992
    s_mov_b32 s30, 294912
    s_mov_b32 s31, 376832
    s_lshl_b32 s42, s12, 13
    s_add_u32 s20, s42, 20971520
    s_add_u32 s35, s20, 4096
    s_lshl_b32 s43, s13, 11
    s_add_u32 s21, s42, 37748736
    s_add_u32 s48, s21, 262144
    s_add_u32 s21, s21, s43
    s_add_u32 s47, s20, 262144
    s_mul_i32 s22, s12, 320
    s_add_u32 s23, s22, 4200448
    s_mov_b32 s33, 0x3e0293ee
    s_mov_b32 s96, s33
    s_mov_b32 s97, s33
    s_mov_b32 s98, 0x3f803f80
    s_mov_b32 s99, 0x3f803f80
    s_mov_b32 s100, 0x3f003f00
    s_mov_b32 s101, 0x3f003f00
    s_lshl_b32 s88, s13, 7
    s_add_u32 s88, s88, s12
    s_add_u32 s88, s88, 40960
    s_cmp_lt_u32 s13, 2
    s_cselect_b32 s42, 3, 2
    s_lshr_b32 s42, s12, s42
    s_and_b32 s42, s42, 3
    s_lshl_b32 s43, s13, 2
    s_add_u32 s42, s42, s43
    s_lshl_b32 s42, s42, 7
    s_add_u32 s89, s42, 40960
    s_mov_b32 s34, 0xfffffffe
    s_mov_b32 s44, 0x33333333
    s_mov_b32 s45, 0x33333333
    s_lshl_b32 s42, s13, 12
    s_add_u32 s15, s42, 65536
    s_and_b32 s42, s12, 1
    s_lshl_b32 s42, s42, 8
    s_lshl_b32 s43, s13, 5
    s_add_u32 s42, s42, s43
    s_add_u32 s49, s42, 32768
    s_mov_b32 s39, 0
    s_mov_b32 s16, 81920
    s_mov_b32 s17, 114688
    s_mov_b32 s14, 0
    s_mov_b32 s18, 1
    s_mov_b32 s19, -1
    s_mov_b32 s32, 0
    v_mov_b64 v[56:57], 0
    v_mov_b64 v[58:59], 0
    v_mov_b64 v[60:61], -1
    buffer_store_dwordx4 v[56:59], v0, s[4:7], s25 offen sc1
    buffer_store_dwordx4 v[56:59], v0, s[4:7], s26 offen sc1
    buffer_store_dwordx2 v[56:57], v9, s[4:7], s27 offen sc1
    s_cmp_ge_u32 s46, 80
    s_cbranch_scc1 C_noM
    s_mov_b32 s8, s62
    s_mov_b32 s9, s63
    s_mov_b32 s10, 10240
    s_and_b32 s42, s53, 3
    s_mul_i32 s42, s42, 2560
    s_lshr_b32 s43, s53, 2
    s_lshl_b32 s43, s43, 6
    s_add_u32 s42, s42, s43
    v_bfe_u32 v12, v15, 4, 1
    v_mul_u32_u24 v12, 1280, v12
    v_and_b32 v13, 7, v15
    v_lshl_add_u32 v12, v13, 3, v12
    buffer_load_dwordx2 v[62:63], v12, s[8:11], s42 offen
    s_mov_b32 s43, 81920
    buffer_store_dwordx2 v[60:61], v5, s[4:7], s43 offen sc1
    s_mov_b32 s43, 98304
    buffer_store_dwordx2 v[60:61], v5, s[4:7], s43 offen sc1
    s_mov_b32 s43, 114688
    buffer_store_dwordx2 v[60:61], v5, s[4:7], s43 offen sc1
    s_waitcnt vmcnt(0)
    v_min_u32 v62, s34, v62
    s_mov_b32 s43, 65536
    buffer_store_dwordx2 v[62:63], v5, s[4:7], s43 offen sc1
C_noM:
    s_mov_b32 s8, s4
    s_mov_b32 s9, s5
    s_mov_b32 s10, 0
    s_cmp_eq_u32 s13, 3
    s_cbranch_scc1 C_noF
    s_add_u32 s8, s4, 32768
    s_addc_u32 s9, s5, 0
    s_mov_b32 s10, 512
    v_lshlrev_b32 v12, 4, v0
    v_mov_b32 v13, 0
    buffer_store_byte v13, v12, s[8:11], s46 offen sc1
C_noF:
    s_cmp_eq_u32 s13, 3
    s_cbranch_scc0 C_noZ
    s_lshl_b32 s42, s12, 10
    buffer_store_dwordx4 v[56:59], v0, s[4:7], s42 offen sc1
    s_add_u32 s42, s42, 3145728
    buffer_store_dwordx4 v[56:59], v0, s[4:7], s42 offen sc1
    s_mov_b64 exec, 1
    s_lshl_b32 s42, 1, s52
    v_mov_b32 v12, 8
    v_mov_b32 v13, s42
    global_atomic_or v12, v13, s[50:51]
    s_mov_b64 exec, -1
C_noZ:
    v_and_b32 v12, 15, v15
    v_and_b32 v52, 0xff, v0
    v_mov_b32 v48, 0
    v_mov_b32 v13, 0x3f80
    v_cmp_eq_u32 vcc, 0, v12
    s_nop 1
    v_cndmask_b32 v48, v48, v13, vcc
    v_mov_b32 v13, 0x3f800000
    v_cmp_eq_u32 vcc, 1, v12
    s_nop 1
    v_cndmask_b32 v48, v48, v13, vcc
    v_mov_b32 v49, 0
    v_mov_b32 v13, 0x3f80
    v_cmp_eq_u32 vcc, 4, v12
    s_nop 1
    v_cndmask_b32 v49, v49, v13, vcc
    v_mov_b32 v13, 0x3f800000
    v_cmp_eq_u32 vcc, 5, v12
    s_nop 1
    v_cndmask_b32 v49, v49, v13, vcc
    v_mov_b32 v50, 0
    v_mov_b32 v13, 0x3f80
    v_cmp_eq_u32 vcc, 2, v12
    s_nop 1
    v_cndmask_b32 v50, v50, v13, vcc
    v_mov_b32 v13, 0x3f800000
    v_cmp_eq_u32 vcc, 3, v12
    s_nop 1
    v_cndmask_b32 v50, v50, v13, vcc
    v_mov_b32 v51, 0
    v_mov_b32 v13, 0x3f80
    v_cmp_eq_u32 vcc, 6, v12
    s_nop 1
    v_cndmask_b32 v51, v51, v13, vcc
    v_mov_b32 v13, 0x3f800000
    v_cmp_eq_u32 vcc, 7, v12
    s_nop 1
    v_cndmask_b32 v51, v51, v13, vcc
    ds_write_b128 v52, v[48:51] offset:22528
    s_waitcnt lgkmcnt(0)
    v_lshrrev_b32 v4, 4, v15
    v_lshlrev_b32 v4, 2, v4
    v_and_b32 v5, 15, v15
    v_lshlrev_b32 v5, 2, v5
    s_lshl_b32 s42, s12, 8
    s_lshl_b32 s43, s13, 6
    s_add_u32 s42, s42, s43
    v_lshl_add_u32 v1, v4, 13, v5
    v_add_u32 v1, s42, v1
    v_mul_u32_u24 v2, 1280, v4
    v_add_u32 v2, v2, v5
    s_mul_i32 s42, s12, 163840
    s_add_u32 s42, s42, s43
    v_add_u32 v2, s42, v2
    v_add_u32 v14, v2, v5
    v_add_u32 v14, s43, v14
    v_lshrrev_b32 v12, 4, v15
    s_lshl_b32 s42, s13, 4
    v_add_u32 v1, s42, v12
    v_lshlrev_b32 v1, 13, v1
    v_and_b32 v13, 15, v15
    v_lshl_add_u32 v1, v13, 4, v1
    s_lshl_b32 s42, s12, 8
    v_add_u32 v1, s42, v1
    v_lshlrev_b32 v13, 10, v12
    v_add_u32 v13, v13, v5
    v_add_u32 v13, s43, v13
    s_mul_i32 s42, s13, 34816
    s_add_u32 s42, s42, 24576
    v_add_u32 v3, s42, v0
    s_lshl_b32 s42, s12, 2
    s_add_u32 s42, s42, s13
    s_lshl_b32 s42, s42, 14
    s_add_u32 s24, s42, 524288
    s_add_u32 s36, s24, 4096
    s_add_u32 s37, s24, 8192
    s_add_u32 s38, s24, 12288
    s_mov_b32 s10, 5242880
    s_mov_b32 s11, 0x20000
    s_lshl_b32 s43, s13, 12
    s_mov_b32 s8, s54
    s_mov_b32 s9, s55
    s_add_u32 m0, s43, 112640
    s_mov_b32 s42, 1048576
    buffer_load_dwordx4 v1, s[8:11], s42 offen  lds
    s_add_u32 m0, s43, 113664
    s_mov_b32 s42, 1081344
    buffer_load_dwordx4 v1, s[8:11], s42 offen  lds
    s_add_u32 m0, s43, 114688
    s_mov_b32 s42, 1114112
    buffer_load_dwordx4 v1, s[8:11], s42 offen  lds
    s_add_u32 m0, s43, 115712
    s_mov_b32 s42, 1146880
    buffer_load_dwordx4 v1, s[8:11], s42 offen  lds
    s_waitcnt vmcnt(8)
    s_barrier
    s_add_u32 m0, s43, 147456
    s_mov_b32 s42, 1572864
    buffer_load_dwordx4 v1, s[8:11], s42 offen  lds
    s_add_u32 m0, s43, 148480
    s_mov_b32 s42, 1605632
    buffer_load_dwordx4 v1, s[8:11], s42 offen  lds
    s_add_u32 m0, s43, 149504
    s_mov_b32 s42, 1638400
    buffer_load_dwordx4 v1, s[8:11], s42 offen  lds
    s_add_u32 m0, s43, 150528
    s_mov_b32 s42, 1671168
    buffer_load_dwordx4 v1, s[8:11], s42 offen  lds
    v_add_u32 v12, 43008, v13
    ds_read2st64_b32 v[16:17], v12 offset0:0 offset1:1
    ds_read2st64_b32 v[18:19], v12 offset0:2 offset1:3
    ds_read2st64_b32 v[20:21], v12 offset0:16 offset1:17
    ds_read2st64_b32 v[22:23], v12 offset0:18 offset1:19
    ds_read2st64_b32 v[24:25], v12 offset0:32 offset1:33
    ds_read2st64_b32 v[26:27], v12 offset0:34 offset1:35
    ds_read2st64_b32 v[28:29], v12 offset0:48 offset1:49
    ds_read2st64_b32 v[30:31], v12 offset0:50 offset1:51
    s_waitcnt lgkmcnt(0)
    v_perm_b32 v4, v17, v16, s40
    v_perm_b32 v5, v17, v16, s41
    v_perm_b32 v6, v19, v18, s40
    v_perm_b32 v7, v19, v18, s41
    ds_write_b128 v3, v[4:7] offset:0
    v_perm_b32 v8, v21, v20, s40
    v_perm_b32 v9, v21, v20, s41
    v_perm_b32 v10, v23, v22, s40
    v_perm_b32 v11, v23, v22, s41
    ds_write_b128 v3, v[8:11] offset:1024
    v_perm_b32 v4, v25, v24, s40
    v_perm_b32 v5, v25, v24, s41
    v_perm_b32 v6, v27, v26, s40
    v_perm_b32 v7, v27, v26, s41
    v_accvgpr_write_b32 a0, v4
    v_accvgpr_write_b32 a1, v5
    v_accvgpr_write_b32 a2, v6
    v_accvgpr_write_b32 a3, v7
    v_perm_b32 v8, v29, v28, s40
    v_perm_b32 v9, v29, v28, s41
    v_perm_b32 v10, v31, v30, s40
    v_perm_b32 v11, v31, v30, s41
    v_accvgpr_write_b32 a4, v8
    v_accvgpr_write_b32 a5, v9
    v_accvgpr_write_b32 a6, v10
    v_accvgpr_write_b32 a7, v11
    s_waitcnt vmcnt(8)
    s_barrier
    s_add_u32 m0, s43, 43008
    s_mov_b32 s42, 2097152
    buffer_load_dwordx4 v1, s[8:11], s42 offen  lds
    s_add_u32 m0, s43, 44032
    s_mov_b32 s42, 2129920
    buffer_load_dwordx4 v1, s[8:11], s42 offen  lds
    s_add_u32 m0, s43, 45056
    s_mov_b32 s42, 2162688
    buffer_load_dwordx4 v1, s[8:11], s42 offen  lds
    s_add_u32 m0, s43, 46080
    s_mov_b32 s42, 2195456
    buffer_load_dwordx4 v1, s[8:11], s42 offen  lds
    v_add_u32 v12, 77824, v13
    ds_read2st64_b32 v[16:17], v12 offset0:0 offset1:1
    ds_read2st64_b32 v[18:19], v12 offset0:2 offset1:3
    ds_read2st64_b32 v[20:21], v12 offset0:16 offset1:17
    ds_read2st64_b32 v[22:23], v12 offset0:18 offset1:19
    ds_read2st64_b32 v[24:25], v12 offset0:32 offset1:33
    ds_read2st64_b32 v[26:27], v12 offset0:34 offset1:35
    ds_read2st64_b32 v[28:29], v12 offset0:48 offset1:49
    ds_read2st64_b32 v[30:31], v12 offset0:50 offset1:51
    s_waitcnt lgkmcnt(0)
    v_perm_b32 v4, v17, v16, s40
    v_perm_b32 v5, v17, v16, s41
    v_perm_b32 v6, v19, v18, s40
    v_perm_b32 v7, v19, v18, s41
    v_accvgpr_write_b32 a8, v4
    v_accvgpr_write_b32 a9, v5
    v_accvgpr_write_b32 a10, v6
    v_accvgpr_write_b32 a11, v7
    v_perm_b32 v8, v21, v20, s40
    v_perm_b32 v9, v21, v20, s41
    v_perm_b32 v10, v23, v22, s40
    v_perm_b32 v11, v23, v22, s41
    v_accvgpr_write_b32 a12, v8
    v_accvgpr_write_b32 a13, v9
    v_accvgpr_write_b32 a14, v10
    v_accvgpr_write_b32 a15, v11
    v_perm_b32 v4, v25, v24, s40
    v_perm_b32 v5, v25, v24, s41
    v_perm_b32 v6, v27, v26, s40
    v_perm_b32 v7, v27, v26, s41
    v_accvgpr_write_b32 a16, v4
    v_accvgpr_write_b32 a17, v5
    v_accvgpr_write_b32 a18, v6
    v_accvgpr_write_b32 a19, v7
    v_perm_b32 v8, v29, v28, s40
    v_perm_b32 v9, v29, v28, s41
    v_perm_b32 v10, v31, v30, s40
    v_perm_b32 v11, v31, v30, s41
    v_accvgpr_write_b32 a20, v8
    v_accvgpr_write_b32 a21, v9
    v_accvgpr_write_b32 a22, v10
    v_accvgpr_write_b32 a23, v11
    s_waitcnt vmcnt(8)
    s_barrier
    s_add_u32 m0, s43, 77824
    s_mov_b32 s42, 2621440
    buffer_load_dwordx4 v1, s[8:11], s42 offen  lds
    s_add_u32 m0, s43, 78848
    s_mov_b32 s42, 2654208
    buffer_load_dwordx4 v1, s[8:11], s42 offen  lds
    s_add_u32 m0, s43, 79872
    s_mov_b32 s42, 2686976
    buffer_load_dwordx4 v1, s[8:11], s42 offen  lds
    s_add_u32 m0, s43, 80896
    s_mov_b32 s42, 2719744
    buffer_load_dwordx4 v1, s[8:11], s42 offen  lds
    v_add_u32 v12, 112640, v13
    ds_read2st64_b32 v[16:17], v12 offset0:0 offset1:1
    ds_read2st64_b32 v[18:19], v12 offset0:2 offset1:3
    ds_read2st64_b32 v[20:21], v12 offset0:16 offset1:17
    ds_read2st64_b32 v[22:23], v12 offset0:18 offset1:19
    ds_read2st64_b32 v[24:25], v12 offset0:32 offset1:33
    ds_read2st64_b32 v[26:27], v12 offset0:34 offset1:35
    ds_read2st64_b32 v[28:29], v12 offset0:48 offset1:49
    ds_read2st64_b32 v[30:31], v12 offset0:50 offset1:51
    s_waitcnt lgkmcnt(0)
    v_perm_b32 v4, v17, v16, s40
    v_perm_b32 v5, v17, v16, s41
    v_perm_b32 v6, v19, v18, s40
    v_perm_b32 v7, v19, v18, s41
    v_accvgpr_write_b32 a24, v4
    v_accvgpr_write_b32 a25, v5
    v_accvgpr_write_b32 a26, v6
    v_accvgpr_write_b32 a27, v7
    v_perm_b32 v8, v21, v20, s40
    v_perm_b32 v9, v21, v20, s41
    v_perm_b32 v10, v23, v22, s40
    v_perm_b32 v11, v23, v22, s41
    v_accvgpr_write_b32 a28, v8
    v_accvgpr_write_b32 a29, v9
    v_accvgpr_write_b32 a30, v10
    v_accvgpr_write_b32 a31, v11
    v_perm_b32 v4, v25, v24, s40
    v_perm_b32 v5, v25, v24, s41
    v_perm_b32 v6, v27, v26, s40
    v_perm_b32 v7, v27, v26, s41
    v_accvgpr_write_b32 a32, v4
    v_accvgpr_write_b32 a33, v5
    v_accvgpr_write_b32 a34, v6
    v_accvgpr_write_b32 a35, v7
    v_perm_b32 v8, v29, v28, s40
    v_perm_b32 v9, v29, v28, s41
    v_perm_b32 v10, v31, v30, s40
    v_perm_b32 v11, v31, v30, s41
    v_accvgpr_write_b32 a36, v8
    v_accvgpr_write_b32 a37, v9
    v_accvgpr_write_b32 a38, v10
    v_accvgpr_write_b32 a39, v11
    s_cmp_eq_u32 s13, 3
    s_cbranch_scc0 C_noA
    s_mov_b64 exec, 1
    v_mov_b32 v4, 4
    v_mov_b32 v5, 1
    global_atomic_add v4, v5, s[50:51]
    s_mov_b64 exec, -1
C_noA:
    s_waitcnt vmcnt(8)
    s_barrier
    s_add_u32 m0, s43, 112640
    s_mov_b32 s42, 3145728
    buffer_load_dwordx4 v1, s[8:11], s42 offen  lds
    s_add_u32 m0, s43, 113664
    s_mov_b32 s42, 3178496
    buffer_load_dwordx4 v1, s[8:11], s42 offen  lds
    s_add_u32 m0, s43, 114688
    s_mov_b32 s42, 3211264
    buffer_load_dwordx4 v1, s[8:11], s42 offen  lds
    s_add_u32 m0, s43, 115712
    s_mov_b32 s42, 3244032
    buffer_load_dwordx4 v1, s[8:11], s42 offen  lds
    v_add_u32 v12, 147456, v13
    ds_read2st64_b32 v[16:17], v12 offset0:0 offset1:1
    ds_read2st64_b32 v[18:19], v12 offset0:2 offset1:3
    ds_read2st64_b32 v[20:21], v12 offset0:16 offset1:17
    ds_read2st64_b32 v[22:23], v12 offset0:18 offset1:19
    ds_read2st64_b32 v[24:25], v12 offset0:32 offset1:33
    ds_read2st64_b32 v[26:27], v12 offset0:34 offset1:35
    ds_read2st64_b32 v[28:29], v12 offset0:48 offset1:49
    ds_read2st64_b32 v[30:31], v12 offset0:50 offset1:51
    s_waitcnt lgkmcnt(0)
    v_perm_b32 v4, v17, v16, s40
    v_perm_b32 v5, v17, v16, s41
    v_perm_b32 v6, v19, v18, s40
    v_perm_b32 v7, v19, v18, s41
    v_accvgpr_write_b32 a40, v4
    v_accvgpr_write_b32 a41, v5
    v_accvgpr_write_b32 a42, v6
    v_accvgpr_write_b32 a43, v7
    v_perm_b32 v8, v21, v20, s40
    v_perm_b32 v9, v21, v20, s41
    v_perm_b32 v10, v23, v22, s40
    v_perm_b32 v11, v23, v22, s41
    v_accvgpr_write_b32 a44, v8
    v_accvgpr_write_b32 a45, v9
    v_accvgpr_write_b32 a46, v10
    v_accvgpr_write_b32 a47, v11
    v_perm_b32 v4, v25, v24, s40
    v_perm_b32 v5, v25, v24, s41
    v_perm_b32 v6, v27, v26, s40
    v_perm_b32 v7, v27, v26, s41
    v_accvgpr_write_b32 a48, v4
    v_accvgpr_write_b32 a49, v5
    v_accvgpr_write_b32 a50, v6
    v_accvgpr_write_b32 a51, v7
    v_perm_b32 v8, v29, v28, s40
    v_perm_b32 v9, v29, v28, s41
    v_perm_b32 v10, v31, v30, s40
    v_perm_b32 v11, v31, v30, s41
    v_accvgpr_write_b32 a52, v8
    v_accvgpr_write_b32 a53, v9
    v_accvgpr_write_b32 a54, v10
    v_accvgpr_write_b32 a55, v11
    s_mov_b32 s8, s60
    s_mov_b32 s9, s61
    s_mov_b32 s42, 0
    buffer_load_dwordx2 v[32:33], v14, s[8:11], s42 offen
    s_mov_b32 s42, 1280
    buffer_load_dwordx2 v[34:35], v14, s[8:11], s42 offen
    s_mov_b32 s42, 2560
    buffer_load_dwordx2 v[36:37], v14, s[8:11], s42 offen
    s_mov_b32 s42, 3840
    buffer_load_dwordx2 v[38:39], v14, s[8:11], s42 offen
    s_mov_b32 s42, 20480
    buffer_load_dwordx2 v[40:41], v14, s[8:11], s42 offen
    s_mov_b32 s42, 21760
    buffer_load_dwordx2 v[42:43], v14, s[8:11], s42 offen
    s_mov_b32 s42, 23040
    buffer_load_dwordx2 v[44:45], v14, s[8:11], s42 offen
    s_mov_b32 s42, 24320
    buffer_load_dwordx2 v[46:47], v14, s[8:11], s42 offen
    s_waitcnt vmcnt(16)
    s_barrier
    s_mov_b32 s8, s54
    s_mov_b32 s9, s55
    s_add_u32 m0, s43, 147456
    s_mov_b32 s42, 3670016
    buffer_load_dwordx4 v1, s[8:11], s42 offen  lds
    s_add_u32 m0, s43, 148480
    s_mov_b32 s42, 3702784
    buffer_load_dwordx4 v1, s[8:11], s42 offen  lds
    s_add_u32 m0, s43, 149504
    s_mov_b32 s42, 3735552
    buffer_load_dwordx4 v1, s[8:11], s42 offen  lds
    s_add_u32 m0, s43, 150528
    s_mov_b32 s42, 3768320
    buffer_load_dwordx4 v1, s[8:11], s42 offen  lds
    v_add_u32 v12, 43008, v13
    ds_read2st64_b32 v[16:17], v12 offset0:0 offset1:1
    ds_read2st64_b32 v[18:19], v12 offset0:2 offset1:3
    ds_read2st64_b32 v[20:21], v12 offset0:16 offset1:17
    ds_read2st64_b32 v[22:23], v12 offset0:18 offset1:19
    ds_read2st64_b32 v[24:25], v12 offset0:32 offset1:33
    ds_read2st64_b32 v[26:27], v12 offset0:34 offset1:35
    ds_read2st64_b32 v[28:29], v12 offset0:48 offset1:49
    ds_read2st64_b32 v[30:31], v12 offset0:50 offset1:51
    s_waitcnt lgkmcnt(0)
    v_perm_b32 v4, v17, v16, s40
    v_perm_b32 v5, v17, v16, s41
    v_perm_b32 v6, v19, v18, s40
    v_perm_b32 v7, v19, v18, s41
    v_accvgpr_write_b32 a56, v4
    v_accvgpr_write_b32 a57, v5
    v_accvgpr_write_b32 a58, v6
    v_accvgpr_write_b32 a59, v7
    v_perm_b32 v8, v21, v20, s40
    v_perm_b32 v9, v21, v20, s41
    v_perm_b32 v10, v23, v22, s40
    v_perm_b32 v11, v23, v22, s41
    v_accvgpr_write_b32 a60, v8
    v_accvgpr_write_b32 a61, v9
    v_accvgpr_write_b32 a62, v10
    v_accvgpr_write_b32 a63, v11
    v_perm_b32 v4, v25, v24, s40
    v_perm_b32 v5, v25, v24, s41
    v_perm_b32 v6, v27, v26, s40
    v_perm_b32 v7, v27, v26, s41
    v_accvgpr_write_b32 a64, v4
    v_accvgpr_write_b32 a65, v5
    v_accvgpr_write_b32 a66, v6
    v_accvgpr_write_b32 a67, v7
    v_perm_b32 v8, v29, v28, s40
    v_perm_b32 v9, v29, v28, s41
    v_perm_b32 v10, v31, v30, s40
    v_perm_b32 v11, v31, v30, s41
    v_accvgpr_write_b32 a68, v8
    v_accvgpr_write_b32 a69, v9
    v_accvgpr_write_b32 a70, v10
    v_accvgpr_write_b32 a71, v11
    s_waitcnt vmcnt(16)
    s_barrier
    s_add_u32 m0, s43, 43008
    s_mov_b32 s42, 4194304
    buffer_load_dwordx4 v1, s[8:11], s42 offen  lds
    s_add_u32 m0, s43, 44032
    s_mov_b32 s42, 4227072
    buffer_load_dwordx4 v1, s[8:11], s42 offen  lds
    s_add_u32 m0, s43, 45056
    s_mov_b32 s42, 4259840
    buffer_load_dwordx4 v1, s[8:11], s42 offen  lds
    s_add_u32 m0, s43, 46080
    s_mov_b32 s42, 4292608
    buffer_load_dwordx4 v1, s[8:11], s42 offen  lds
    v_add_u32 v12, 77824, v13
    ds_read2st64_b32 v[16:17], v12 offset0:0 offset1:1
    ds_read2st64_b32 v[18:19], v12 offset0:2 offset1:3
    ds_read2st64_b32 v[20:21], v12 offset0:16 offset1:17
    ds_read2st64_b32 v[22:23], v12 offset0:18 offset1:19
    ds_read2st64_b32 v[24:25], v12 offset0:32 offset1:33
    ds_read2st64_b32 v[26:27], v12 offset0:34 offset1:35
    ds_read2st64_b32 v[28:29], v12 offset0:48 offset1:49
    ds_read2st64_b32 v[30:31], v12 offset0:50 offset1:51
    s_waitcnt lgkmcnt(0)
    v_perm_b32 v4, v17, v16, s40
    v_perm_b32 v5, v17, v16, s41
    v_perm_b32 v6, v19, v18, s40
    v_perm_b32 v7, v19, v18, s41
    v_accvgpr_write_b32 a72, v4
    v_accvgpr_write_b32 a73, v5
    v_accvgpr_write_b32 a74, v6
    v_accvgpr_write_b32 a75, v7
    v_perm_b32 v8, v21, v20, s40
    v_perm_b32 v9, v21, v20, s41
    v_perm_b32 v10, v23, v22, s40
    v_perm_b32 v11, v23, v22, s41
    v_accvgpr_write_b32 a76, v8
    v_accvgpr_write_b32 a77, v9
    v_accvgpr_write_b32 a78, v10
    v_accvgpr_write_b32 a79, v11
    v_perm_b32 v4, v25, v24, s40
    v_perm_b32 v5, v25, v24, s41
    v_perm_b32 v6, v27, v26, s40
    v_perm_b32 v7, v27, v26, s41
    buffer_store_dwordx4 v[4:7], v0, s[4:7], s24 offen offset:0
    v_perm_b32 v8, v29, v28, s40
    v_perm_b32 v9, v29, v28, s41
    v_perm_b32 v10, v31, v30, s40
    v_perm_b32 v11, v31, v30, s41
    buffer_store_dwordx4 v[8:11], v0, s[4:7], s24 offen offset:1024
    s_waitcnt vmcnt(18)
    s_barrier
    s_add_u32 m0, s43, 77824
    s_mov_b32 s42, 4718592
    buffer_load_dwordx4 v1, s[8:11], s42 offen  lds
    s_add_u32 m0, s43, 78848
    s_mov_b32 s42, 4751360
    buffer_load_dwordx4 v1, s[8:11], s42 offen  lds
    s_add_u32 m0, s43, 79872
    s_mov_b32 s42, 4784128
    buffer_load_dwordx4 v1, s[8:11], s42 offen  lds
    s_add_u32 m0, s43, 80896
    s_mov_b32 s42, 4816896
    buffer_load_dwordx4 v1, s[8:11], s42 offen  lds
    v_add_u32 v12, 112640, v13
    ds_read2st64_b32 v[16:17], v12 offset0:0 offset1:1
    ds_read2st64_b32 v[18:19], v12 offset0:2 offset1:3
    ds_read2st64_b32 v[20:21], v12 offset0:16 offset1:17
    ds_read2st64_b32 v[22:23], v12 offset0:18 offset1:19
    ds_read2st64_b32 v[24:25], v12 offset0:32 offset1:33
    ds_read2st64_b32 v[26:27], v12 offset0:34 offset1:35
    ds_read2st64_b32 v[28:29], v12 offset0:48 offset1:49
    ds_read2st64_b32 v[30:31], v12 offset0:50 offset1:51
    s_waitcnt lgkmcnt(0)
    v_perm_b32 v4, v17, v16, s40
    v_perm_b32 v5, v17, v16, s41
    v_perm_b32 v6, v19, v18, s40
    v_perm_b32 v7, v19, v18, s41
    v_accvgpr_write_b32 a80, v4
    v_accvgpr_write_b32 a81, v5
    v_accvgpr_write_b32 a82, v6
    v_accvgpr_write_b32 a83, v7
    v_perm_b32 v8, v21, v20, s40
    v_perm_b32 v9, v21, v20, s41
    v_perm_b32 v10, v23, v22, s40
    v_perm_b32 v11, v23, v22, s41
    v_accvgpr_write_b32 a84, v8
    v_accvgpr_write_b32 a85, v9
    v_accvgpr_write_b32 a86, v10
    v_accvgpr_write_b32 a87, v11
    v_perm_b32 v4, v25, v24, s40
    v_perm_b32 v5, v25, v24, s41
    v_perm_b32 v6, v27, v26, s40
    v_perm_b32 v7, v27, v26, s41
    v_accvgpr_write_b32 a88, v4
    v_accvgpr_write_b32 a89, v5
    v_accvgpr_write_b32 a90, v6
    v_accvgpr_write_b32 a91, v7
    v_perm_b32 v8, v29, v28, s40
    v_perm_b32 v9, v29, v28, s41
    v_perm_b32 v10, v31, v30, s40
    v_perm_b32 v11, v31, v30, s41
    v_accvgpr_write_b32 a92, v8
    v_accvgpr_write_b32 a93, v9
    v_accvgpr_write_b32 a94, v10
    v_accvgpr_write_b32 a95, v11
    s_waitcnt vmcnt(10)
    s_barrier
    s_mov_b32 s8, s56
    s_mov_b32 s9, s57
    s_add_u32 m0, s43, 112640
    s_mov_b32 s42, 0
    buffer_load_dwordx4 v1, s[8:11], s42 offen  lds
    s_add_u32 m0, s43, 113664
    s_mov_b32 s42, 32768
    buffer_load_dwordx4 v1, s[8:11], s42 offen  lds
    s_add_u32 m0, s43, 114688
    s_mov_b32 s42, 65536
    buffer_load_dwordx4 v1, s[8:11], s42 offen  lds
    s_add_u32 m0, s43, 115712
    s_mov_b32 s42, 98304
    buffer_load_dwordx4 v1, s[8:11], s42 offen  lds
    v_add_u32 v12, 147456, v13
    ds_read2st64_b32 v[16:17], v12 offset0:0 offset1:1
    ds_read2st64_b32 v[18:19], v12 offset0:2 offset1:3
    ds_read2st64_b32 v[20:21], v12 offset0:16 offset1:17
    ds_read2st64_b32 v[22:23], v12 offset0:18 offset1:19
    ds_read2st64_b32 v[24:25], v12 offset0:32 offset1:33
    ds_read2st64_b32 v[26:27], v12 offset0:34 offset1:35
    ds_read2st64_b32 v[28:29], v12 offset0:48 offset1:49
    ds_read2st64_b32 v[30:31], v12 offset0:50 offset1:51
    s_waitcnt lgkmcnt(0)
    v_perm_b32 v4, v17, v16, s40
    v_perm_b32 v5, v17, v16, s41
    v_perm_b32 v6, v19, v18, s40
    v_perm_b32 v7, v19, v18, s41
    v_accvgpr_write_b32 a96, v4
    v_accvgpr_write_b32 a97, v5
    v_accvgpr_write_b32 a98, v6
    v_accvgpr_write_b32 a99, v7
    v_perm_b32 v8, v21, v20, s40
    v_perm_b32 v9, v21, v20, s41
    v_perm_b32 v10, v23, v22, s40
    v_perm_b32 v11, v23, v22, s41
    v_accvgpr_write_b32 a100, v8
    v_accvgpr_write_b32 a101, v9
    v_accvgpr_write_b32 a102, v10
    v_accvgpr_write_b32 a103, v11
    v_perm_b32 v4, v25, v24, s40
    v_perm_b32 v5, v25, v24, s41
    v_perm_b32 v6, v27, v26, s40
    v_perm_b32 v7, v27, v26, s41
    v_accvgpr_write_b32 a104, v4
    v_accvgpr_write_b32 a105, v5
    v_accvgpr_write_b32 a106, v6
    v_accvgpr_write_b32 a107, v7
    v_perm_b32 v8, v29, v28, s40
    v_perm_b32 v9, v29, v28, s41
    v_perm_b32 v10, v31, v30, s40
    v_perm_b32 v11, v31, v30, s41
    v_accvgpr_write_b32 a108, v8
    v_accvgpr_write_b32 a109, v9
    v_accvgpr_write_b32 a110, v10
    v_accvgpr_write_b32 a111, v11
    s_waitcnt vmcnt(10)
    s_barrier
    s_add_u32 m0, s43, 147456
    s_mov_b32 s42, 524288
    buffer_load_dwordx4 v1, s[8:11], s42 offen  lds
    s_add_u32 m0, s43, 148480
    s_mov_b32 s42, 557056
    buffer_load_dwordx4 v1, s[8:11], s42 offen  lds
    s_add_u32 m0, s43, 149504
    s_mov_b32 s42, 589824
    buffer_load_dwordx4 v1, s[8:11], s42 offen  lds
    s_add_u32 m0, s43, 150528
    s_mov_b32 s42, 622592
    buffer_load_dwordx4 v1, s[8:11], s42 offen  lds
    v_add_u32 v12, 43008, v13
    ds_read2st64_b32 v[16:17], v12 offset0:0 offset1:1
    ds_read2st64_b32 v[18:19], v12 offset0:2 offset1:3
    ds_read2st64_b32 v[20:21], v12 offset0:16 offset1:17
    ds_read2st64_b32 v[22:23], v12 offset0:18 offset1:19
    ds_read2st64_b32 v[24:25], v12 offset0:32 offset1:33
    ds_read2st64_b32 v[26:27], v12 offset0:34 offset1:35
    ds_read2st64_b32 v[28:29], v12 offset0:48 offset1:49
    ds_read2st64_b32 v[30:31], v12 offset0:50 offset1:51
    s_waitcnt lgkmcnt(0)
    v_perm_b32 v4, v17, v16, s40
    v_perm_b32 v5, v17, v16, s41
    v_perm_b32 v6, v19, v18, s40
    v_perm_b32 v7, v19, v18, s41
    v_accvgpr_write_b32 a112, v4
    v_accvgpr_write_b32 a113, v5
    v_accvgpr_write_b32 a114, v6
    v_accvgpr_write_b32 a115, v7
    v_perm_b32 v8, v21, v20, s40
    v_perm_b32 v9, v21, v20, s41
    v_perm_b32 v10, v23, v22, s40
    v_perm_b32 v11, v23, v22, s41
    v_accvgpr_write_b32 a116, v8
    v_accvgpr_write_b32 a117, v9
    v_accvgpr_write_b32 a118, v10
    v_accvgpr_write_b32 a119, v11
    v_perm_b32 v4, v25, v24, s40
    v_perm_b32 v5, v25, v24, s41
    v_perm_b32 v6, v27, v26, s40
    v_perm_b32 v7, v27, v26, s41
    v_accvgpr_write_b32 a120, v4
    v_accvgpr_write_b32 a121, v5
    v_accvgpr_write_b32 a122, v6
    v_accvgpr_write_b32 a123, v7
    v_perm_b32 v8, v29, v28, s40
    v_perm_b32 v9, v29, v28, s41
    v_perm_b32 v10, v31, v30, s40
    v_perm_b32 v11, v31, v30, s41
    v_accvgpr_write_b32 a124, v8
    v_accvgpr_write_b32 a125, v9
    v_accvgpr_write_b32 a126, v10
    v_accvgpr_write_b32 a127, v11
    s_mov_b32 s8, s60
    s_mov_b32 s9, s61
    s_mov_b32 s42, 40960
    buffer_load_dwordx2 v[48:49], v14, s[8:11], s42 offen
    s_mov_b32 s42, 42240
    buffer_load_dwordx2 v[50:51], v14, s[8:11], s42 offen
    s_mov_b32 s42, 43520
    buffer_load_dwordx2 v[52:53], v14, s[8:11], s42 offen
    s_mov_b32 s42, 44800
    buffer_load_dwordx2 v[54:55], v14, s[8:11], s42 offen
    s_mov_b32 s42, 61440
    buffer_load_dwordx2 v[56:57], v14, s[8:11], s42 offen
    s_mov_b32 s42, 62720
    buffer_load_dwordx2 v[58:59], v14, s[8:11], s42 offen
    s_mov_b32 s42, 64000
    buffer_load_dwordx2 v[60:61], v14, s[8:11], s42 offen
    s_mov_b32 s42, 65280
    buffer_load_dwordx2 v[62:63], v14, s[8:11], s42 offen
    s_waitcnt vmcnt(16)
    s_barrier
    s_mov_b32 s8, s56
    s_mov_b32 s9, s57
    s_add_u32 m0, s43, 43008
    s_mov_b32 s42, 1048576
    buffer_load_dwordx4 v1, s[8:11], s42 offen  lds
    s_add_u32 m0, s43, 44032
    s_mov_b32 s42, 1081344
    buffer_load_dwordx4 v1, s[8:11], s42 offen  lds
    s_add_u32 m0, s43, 45056
    s_mov_b32 s42, 1114112
    buffer_load_dwordx4 v1, s[8:11], s42 offen  lds
    s_add_u32 m0, s43, 46080
    s_mov_b32 s42, 1146880
    buffer_load_dwordx4 v1, s[8:11], s42 offen  lds
    v_add_u32 v12, 77824, v13
    ds_read2st64_b32 v[16:17], v12 offset0:0 offset1:1
    ds_read2st64_b32 v[18:19], v12 offset0:2 offset1:3
    ds_read2st64_b32 v[20:21], v12 offset0:16 offset1:17
    ds_read2st64_b32 v[22:23], v12 offset0:18 offset1:19
    ds_read2st64_b32 v[24:25], v12 offset0:32 offset1:33
    ds_read2st64_b32 v[26:27], v12 offset0:34 offset1:35
    ds_read2st64_b32 v[28:29], v12 offset0:48 offset1:49
    ds_read2st64_b32 v[30:31], v12 offset0:50 offset1:51
    s_waitcnt lgkmcnt(0)
    v_perm_b32 v4, v17, v16, s40
    v_perm_b32 v5, v17, v16, s41
    v_perm_b32 v6, v19, v18, s40
    v_perm_b32 v7, v19, v18, s41
    v_accvgpr_write_b32 a128, v4
    v_accvgpr_write_b32 a129, v5
    v_accvgpr_write_b32 a130, v6
    v_accvgpr_write_b32 a131, v7
    v_perm_b32 v8, v21, v20, s40
    v_perm_b32 v9, v21, v20, s41
    v_perm_b32 v10, v23, v22, s40
    v_perm_b32 v11, v23, v22, s41
    v_accvgpr_write_b32 a132, v8
    v_accvgpr_write_b32 a133, v9
    v_accvgpr_write_b32 a134, v10
    v_accvgpr_write_b32 a135, v11
    v_perm_b32 v4, v25, v24, s40
    v_perm_b32 v5, v25, v24, s41
    v_perm_b32 v6, v27, v26, s40
    v_perm_b32 v7, v27, v26, s41
    v_accvgpr_write_b32 a136, v4
    v_accvgpr_write_b32 a137, v5
    v_accvgpr_write_b32 a138, v6
    v_accvgpr_write_b32 a139, v7
    v_perm_b32 v8, v29, v28, s40
    v_perm_b32 v9, v29, v28, s41
    v_perm_b32 v10, v31, v30, s40
    v_perm_b32 v11, v31, v30, s41
    v_accvgpr_write_b32 a140, v8
    v_accvgpr_write_b32 a141, v9
    v_accvgpr_write_b32 a142, v10
    v_accvgpr_write_b32 a143, v11
    v_perm_b32 v4, v34, v32, s40
    v_perm_b32 v5, v34, v32, s41
    v_perm_b32 v6, v38, v36, s40
    v_perm_b32 v7, v38, v36, s41
    buffer_store_dwordx4 v[4:7], v0, s[4:7], s36 offen offset:2048
    v_perm_b32 v8, v42, v40, s40
    v_perm_b32 v9, v42, v40, s41
    v_perm_b32 v10, v46, v44, s40
    v_perm_b32 v11, v46, v44, s41
    buffer_store_dwordx4 v[8:11], v0, s[4:7], s36 offen offset:3072
    v_perm_b32 v200, v35, v33, s40
    v_perm_b32 v201, v35, v33, s41
    v_perm_b32 v202, v39, v37, s40
    v_perm_b32 v203, v39, v37, s41
    v_perm_b32 v204, v43, v41, s40
    v_perm_b32 v205, v43, v41, s41
    v_perm_b32 v206, v47, v45, s40
    v_perm_b32 v207, v47, v45, s41
    s_waitcnt vmcnt(18)
    s_barrier
    s_add_u32 m0, s43, 77824
    s_mov_b32 s42, 1572864
    buffer_load_dwordx4 v1, s[8:11], s42 offen  lds
    s_add_u32 m0, s43, 78848
    s_mov_b32 s42, 1605632
    buffer_load_dwordx4 v1, s[8:11], s42 offen  lds
    s_add_u32 m0, s43, 79872
    s_mov_b32 s42, 1638400
    buffer_load_dwordx4 v1, s[8:11], s42 offen  lds
    s_add_u32 m0, s43, 80896
    s_mov_b32 s42, 1671168
    buffer_load_dwordx4 v1, s[8:11], s42 offen  lds
    v_add_u32 v12, 112640, v13
    ds_read2st64_b32 v[16:17], v12 offset0:0 offset1:1
    ds_read2st64_b32 v[18:19], v12 offset0:2 offset1:3
    ds_read2st64_b32 v[20:21], v12 offset0:16 offset1:17
    ds_read2st64_b32 v[22:23], v12 offset0:18 offset1:19
    ds_read2st64_b32 v[24:25], v12 offset0:32 offset1:33
    ds_read2st64_b32 v[26:27], v12 offset0:34 offset1:35
    ds_read2st64_b32 v[28:29], v12 offset0:48 offset1:49
    ds_read2st64_b32 v[30:31], v12 offset0:50 offset1:51
    s_waitcnt lgkmcnt(0)
    v_perm_b32 v4, v17, v16, s40
    v_perm_b32 v5, v17, v16, s41
    v_perm_b32 v6, v19, v18, s40
    v_perm_b32 v7, v19, v18, s41
    ds_write_b128 v3, v[4:7] offset:2048
    v_perm_b32 v8, v21, v20, s40
    v_perm_b32 v9, v21, v20, s41
    v_perm_b32 v10, v23, v22, s40
    v_perm_b32 v11, v23, v22, s41
    ds_write_b128 v3, v[8:11] offset:3072
    v_perm_b32 v4, v25, v24, s40
    v_perm_b32 v5, v25, v24, s41
    v_perm_b32 v6, v27, v26, s40
    v_perm_b32 v7, v27, v26, s41
    v_accvgpr_write_b32 a144, v4
    v_accvgpr_write_b32 a145, v5
    v_accvgpr_write_b32 a146, v6
    v_accvgpr_write_b32 a147, v7
    v_perm_b32 v8, v29, v28, s40
    v_perm_b32 v9, v29, v28, s41
    v_perm_b32 v10, v31, v30, s40
    v_perm_b32 v11, v31, v30, s41
    v_accvgpr_write_b32 a148, v8
    v_accvgpr_write_b32 a149, v9
    v_accvgpr_write_b32 a150, v10
    v_accvgpr_write_b32 a151, v11
    s_waitcnt vmcnt(18)
    s_barrier
    s_add_u32 m0, s43, 112640
    s_mov_b32 s42, 2097152
    buffer_load_dwordx4 v1, s[8:11], s42 offen  lds
    s_add_u32 m0, s43, 113664
    s_mov_b32 s42, 2129920
    buffer_load_dwordx4 v1, s[8:11], s42 offen  lds
    s_add_u32 m0, s43, 114688
    s_mov_b32 s42, 2162688
    buffer_load_dwordx4 v1, s[8:11], s42 offen  lds
    s_add_u32 m0, s43, 115712
    s_mov_b32 s42, 2195456
    buffer_load_dwordx4 v1, s[8:11], s42 offen  lds
    v_add_u32 v12, 147456, v13
    ds_read2st64_b32 v[16:17], v12 offset0:0 offset1:1
    ds_read2st64_b32 v[18:19], v12 offset0:2 offset1:3
    ds_read2st64_b32 v[20:21], v12 offset0:16 offset1:17
    ds_read2st64_b32 v[22:23], v12 offset0:18 offset1:19
    ds_read2st64_b32 v[24:25], v12 offset0:32 offset1:33
    ds_read2st64_b32 v[26:27], v12 offset0:34 offset1:35
    ds_read2st64_b32 v[28:29], v12 offset0:48 offset1:49
    ds_read2st64_b32 v[30:31], v12 offset0:50 offset1:51
    s_waitcnt lgkmcnt(0)
    v_perm_b32 v4, v17, v16, s40
    v_perm_b32 v5, v17, v16, s41
    v_perm_b32 v6, v19, v18, s40
    v_perm_b32 v7, v19, v18, s41
    v_accvgpr_write_b32 a152, v4
    v_accvgpr_write_b32 a153, v5
    v_accvgpr_write_b32 a154, v6
    v_accvgpr_write_b32 a155, v7
    v_perm_b32 v8, v21, v20, s40
    v_perm_b32 v9, v21, v20, s41
    v_perm_b32 v10, v23, v22, s40
    v_perm_b32 v11, v23, v22, s41
    v_accvgpr_write_b32 a156, v8
    v_accvgpr_write_b32 a157, v9
    v_accvgpr_write_b32 a158, v10
    v_accvgpr_write_b32 a159, v11
    v_perm_b32 v4, v25, v24, s40
    v_perm_b32 v5, v25, v24, s41
    v_perm_b32 v6, v27, v26, s40
    v_perm_b32 v7, v27, v26, s41
    v_accvgpr_write_b32 a160, v4
    v_accvgpr_write_b32 a161, v5
    v_accvgpr_write_b32 a162, v6
    v_accvgpr_write_b32 a163, v7
    v_perm_b32 v8, v29, v28, s40
    v_perm_b32 v9, v29, v28, s41
    v_perm_b32 v10, v31, v30, s40
    v_perm_b32 v11, v31, v30, s41
    v_accvgpr_write_b32 a164, v8
    v_accvgpr_write_b32 a165, v9
    v_accvgpr_write_b32 a166, v10
    v_accvgpr_write_b32 a167, v11
    s_waitcnt vmcnt(10)
    s_barrier
    s_add_u32 m0, s43, 147456
    s_mov_b32 s42, 2621440
    buffer_load_dwordx4 v1, s[8:11], s42 offen  lds
    s_add_u32 m0, s43, 148480
    s_mov_b32 s42, 2654208
    buffer_load_dwordx4 v1, s[8:11], s42 offen  lds
    s_add_u32 m0, s43, 149504
    s_mov_b32 s42, 2686976
    buffer_load_dwordx4 v1, s[8:11], s42 offen  lds
    s_add_u32 m0, s43, 150528
    s_mov_b32 s42, 2719744
    buffer_load_dwordx4 v1, s[8:11], s42 offen  lds
    v_add_u32 v12, 43008, v13
    ds_read2st64_b32 v[16:17], v12 offset0:0 offset1:1
    ds_read2st64_b32 v[18:19], v12 offset0:2 offset1:3
    ds_read2st64_b32 v[20:21], v12 offset0:16 offset1:17
    ds_read2st64_b32 v[22:23], v12 offset0:18 offset1:19
    ds_read2st64_b32 v[24:25], v12 offset0:32 offset1:33
    ds_read2st64_b32 v[26:27], v12 offset0:34 offset1:35
    ds_read2st64_b32 v[28:29], v12 offset0:48 offset1:49
    ds_read2st64_b32 v[30:31], v12 offset0:50 offset1:51
    s_waitcnt lgkmcnt(0)
    v_perm_b32 v4, v17, v16, s40
    v_perm_b32 v5, v17, v16, s41
    v_perm_b32 v6, v19, v18, s40
    v_perm_b32 v7, v19, v18, s41
    v_accvgpr_write_b32 a168, v4
    v_accvgpr_write_b32 a169, v5
    v_accvgpr_write_b32 a170, v6
    v_accvgpr_write_b32 a171, v7
    v_perm_b32 v8, v21, v20, s40
    v_perm_b32 v9, v21, v20, s41
    v_perm_b32 v10, v23, v22, s40
    v_perm_b32 v11, v23, v22, s41
    v_accvgpr_write_b32 a172, v8
    v_accvgpr_write_b32 a173, v9
    v_accvgpr_write_b32 a174, v10
    v_accvgpr_write_b32 a175, v11
    v_perm_b32 v4, v25, v24, s40
    v_perm_b32 v5, v25, v24, s41
    v_perm_b32 v6, v27, v26, s40
    v_perm_b32 v7, v27, v26, s41
    v_accvgpr_write_b32 a176, v4
    v_accvgpr_write_b32 a177, v5
    v_accvgpr_write_b32 a178, v6
    v_accvgpr_write_b32 a179, v7
    v_perm_b32 v8, v29, v28, s40
    v_perm_b32 v9, v29, v28, s41
    v_perm_b32 v10, v31, v30, s40
    v_perm_b32 v11, v31, v30, s41
    v_accvgpr_write_b32 a180, v8
    v_accvgpr_write_b32 a181, v9
    v_accvgpr_write_b32 a182, v10
    v_accvgpr_write_b32 a183, v11
    s_waitcnt vmcnt(8)
    s_barrier
    s_add_u32 m0, s43, 43008
    s_mov_b32 s42, 3145728
    buffer_load_dwordx4 v1, s[8:11], s42 offen  lds
    s_add_u32 m0, s43, 44032
    s_mov_b32 s42, 3178496
    buffer_load_dwordx4 v1, s[8:11], s42 offen  lds
    s_add_u32 m0, s43, 45056
    s_mov_b32 s42, 3211264
    buffer_load_dwordx4 v1, s[8:11], s42 offen  lds
    s_add_u32 m0, s43, 46080
    s_mov_b32 s42, 3244032
    buffer_load_dwordx4 v1, s[8:11], s42 offen  lds
    v_add_u32 v12, 77824, v13
    ds_read2st64_b32 v[16:17], v12 offset0:0 offset1:1
    ds_read2st64_b32 v[18:19], v12 offset0:2 offset1:3
    ds_read2st64_b32 v[20:21], v12 offset0:16 offset1:17
    ds_read2st64_b32 v[22:23], v12 offset0:18 offset1:19
    ds_read2st64_b32 v[24:25], v12 offset0:32 offset1:33
    ds_read2st64_b32 v[26:27], v12 offset0:34 offset1:35
    ds_read2st64_b32 v[28:29], v12 offset0:48 offset1:49
    ds_read2st64_b32 v[30:31], v12 offset0:50 offset1:51
    s_waitcnt lgkmcnt(0)
    v_perm_b32 v4, v17, v16, s40
    v_perm_b32 v5, v17, v16, s41
    v_perm_b32 v6, v19, v18, s40
    v_perm_b32 v7, v19, v18, s41
    v_accvgpr_write_b32 a184, v4
    v_accvgpr_write_b32 a185, v5
    v_accvgpr_write_b32 a186, v6
    v_accvgpr_write_b32 a187, v7
    v_perm_b32 v8, v21, v20, s40
    v_perm_b32 v9, v21, v20, s41
    v_perm_b32 v10, v23, v22, s40
    v_perm_b32 v11, v23, v22, s41
    v_accvgpr_write_b32 a188, v8
    v_accvgpr_write_b32 a189, v9
    v_accvgpr_write_b32 a190, v10
    v_accvgpr_write_b32 a191, v11
    v_perm_b32 v4, v25, v24, s40
    v_perm_b32 v5, v25, v24, s41
    v_perm_b32 v6, v27, v26, s40
    v_perm_b32 v7, v27, v26, s41
    v_accvgpr_write_b32 a192, v4
    v_accvgpr_write_b32 a193, v5
    v_accvgpr_write_b32 a194, v6
    v_accvgpr_write_b32 a195, v7
    v_perm_b32 v8, v29, v28, s40
    v_perm_b32 v9, v29, v28, s41
    v_perm_b32 v10, v31, v30, s40
    v_perm_b32 v11, v31, v30, s41
    v_accvgpr_write_b32 a196, v8
    v_accvgpr_write_b32 a197, v9
    v_accvgpr_write_b32 a198, v10
    v_accvgpr_write_b32 a199, v11
    s_mov_b32 s8, s60
    s_mov_b32 s9, s61
    s_mov_b32 s42, 122880
    buffer_load_dwordx2 v[32:33], v14, s[8:11], s42 offen
    s_mov_b32 s42, 124160
    buffer_load_dwordx2 v[34:35], v14, s[8:11], s42 offen
    s_mov_b32 s42, 125440
    buffer_load_dwordx2 v[36:37], v14, s[8:11], s42 offen
    s_mov_b32 s42, 126720
    buffer_load_dwordx2 v[38:39], v14, s[8:11], s42 offen
    s_mov_b32 s42, 143360
    buffer_load_dwordx2 v[40:41], v14, s[8:11], s42 offen
    s_mov_b32 s42, 144640
    buffer_load_dwordx2 v[42:43], v14, s[8:11], s42 offen
    s_mov_b32 s42, 145920
    buffer_load_dwordx2 v[44:45], v14, s[8:11], s42 offen
    s_mov_b32 s42, 147200
    buffer_load_dwordx2 v[46:47], v14, s[8:11], s42 offen
    s_waitcnt vmcnt(16)
    s_barrier
    s_mov_b32 s8, s56
    s_mov_b32 s9, s57
    s_add_u32 m0, s43, 77824
    s_mov_b32 s42, 3670016
    buffer_load_dwordx4 v1, s[8:11], s42 offen  lds
    s_add_u32 m0, s43, 78848
    s_mov_b32 s42, 3702784
    buffer_load_dwordx4 v1, s[8:11], s42 offen  lds
    s_add_u32 m0, s43, 79872
    s_mov_b32 s42, 3735552
    buffer_load_dwordx4 v1, s[8:11], s42 offen  lds
    s_add_u32 m0, s43, 80896
    s_mov_b32 s42, 3768320
    buffer_load_dwordx4 v1, s[8:11], s42 offen  lds
    v_add_u32 v12, 112640, v13
    ds_read2st64_b32 v[16:17], v12 offset0:0 offset1:1
    ds_read2st64_b32 v[18:19], v12 offset0:2 offset1:3
    ds_read2st64_b32 v[20:21], v12 offset0:16 offset1:17
    ds_read2st64_b32 v[22:23], v12 offset0:18 offset1:19
    ds_read2st64_b32 v[24:25], v12 offset0:32 offset1:33
    ds_read2st64_b32 v[26:27], v12 offset0:34 offset1:35
    ds_read2st64_b32 v[28:29], v12 offset0:48 offset1:49
    ds_read2st64_b32 v[30:31], v12 offset0:50 offset1:51
    s_waitcnt lgkmcnt(0)
    v_perm_b32 v4, v17, v16, s40
    v_perm_b32 v5, v17, v16, s41
    v_perm_b32 v6, v19, v18, s40
    v_perm_b32 v7, v19, v18, s41
    buffer_store_dwordx4 v[4:7], v0, s[4:7], s24 offen offset:2048
    v_perm_b32 v8, v21, v20, s40
    v_perm_b32 v9, v21, v20, s41
    v_perm_b32 v10, v23, v22, s40
    v_perm_b32 v11, v23, v22, s41
    buffer_store_dwordx4 v[8:11], v0, s[4:7], s24 offen offset:3072
    v_perm_b32 v4, v25, v24, s40
    v_perm_b32 v5, v25, v24, s41
    v_perm_b32 v6, v27, v26, s40
    v_perm_b32 v7, v27, v26, s41
    v_accvgpr_write_b32 a200, v4
    v_accvgpr_write_b32 a201, v5
    v_accvgpr_write_b32 a202, v6
    v_accvgpr_write_b32 a203, v7
    v_perm_b32 v8, v29, v28, s40
    v_perm_b32 v9, v29, v28, s41
    v_perm_b32 v10, v31, v30, s40
    v_perm_b32 v11, v31, v30, s41
    v_accvgpr_write_b32 a204, v8
    v_accvgpr_write_b32 a205, v9
    v_accvgpr_write_b32 a206, v10
    v_accvgpr_write_b32 a207, v11
    v_perm_b32 v4, v50, v48, s40
    v_perm_b32 v5, v50, v48, s41
    v_perm_b32 v6, v54, v52, s40
    v_perm_b32 v7, v54, v52, s41
    buffer_store_dwordx4 v[4:7], v0, s[4:7], s37 offen offset:0
    v_perm_b32 v8, v58, v56, s40
    v_perm_b32 v9, v58, v56, s41
    v_perm_b32 v10, v62, v60, s40
    v_perm_b32 v11, v62, v60, s41
    buffer_store_dwordx4 v[8:11], v0, s[4:7], s37 offen offset:1024
    v_perm_b32 v208, v51, v49, s40
    v_perm_b32 v209, v51, v49, s41
    v_perm_b32 v210, v55, v53, s40
    v_perm_b32 v211, v55, v53, s41
    v_perm_b32 v212, v59, v57, s40
    v_perm_b32 v213, v59, v57, s41
    v_perm_b32 v214, v63, v61, s40
    v_perm_b32 v215, v63, v61, s41
    s_waitcnt vmcnt(20)
    s_barrier
    s_add_u32 m0, s43, 112640
    s_mov_b32 s42, 4194304
    buffer_load_dwordx4 v1, s[8:11], s42 offen  lds
    s_add_u32 m0, s43, 113664
    s_mov_b32 s42, 4227072
    buffer_load_dwordx4 v1, s[8:11], s42 offen  lds
    s_add_u32 m0, s43, 114688
    s_mov_b32 s42, 4259840
    buffer_load_dwordx4 v1, s[8:11], s42 offen  lds
    s_add_u32 m0, s43, 115712
    s_mov_b32 s42, 4292608
    buffer_load_dwordx4 v1, s[8:11], s42 offen  lds
    v_add_u32 v12, 147456, v13
    ds_read2st64_b32 v[16:17], v12 offset0:0 offset1:1
    ds_read2st64_b32 v[18:19], v12 offset0:2 offset1:3
    ds_read2st64_b32 v[20:21], v12 offset0:16 offset1:17
    ds_read2st64_b32 v[22:23], v12 offset0:18 offset1:19
    ds_read2st64_b32 v[24:25], v12 offset0:32 offset1:33
    ds_read2st64_b32 v[26:27], v12 offset0:34 offset1:35
    ds_read2st64_b32 v[28:29], v12 offset0:48 offset1:49
    ds_read2st64_b32 v[30:31], v12 offset0:50 offset1:51
    s_waitcnt lgkmcnt(0)
    v_perm_b32 v4, v17, v16, s40
    v_perm_b32 v5, v17, v16, s41
    v_perm_b32 v6, v19, v18, s40
    v_perm_b32 v7, v19, v18, s41
    ds_write_b128 v3, v[4:7] offset:4096
    v_perm_b32 v8, v21, v20, s40
    v_perm_b32 v9, v21, v20, s41
    v_perm_b32 v10, v23, v22, s40
    v_perm_b32 v11, v23, v22, s41
    ds_write_b128 v3, v[8:11] offset:5120
    v_perm_b32 v4, v25, v24, s40
    v_perm_b32 v5, v25, v24, s41
    v_perm_b32 v6, v27, v26, s40
    v_perm_b32 v7, v27, v26, s41
    v_accvgpr_write_b32 a208, v4
    v_accvgpr_write_b32 a209, v5
    v_accvgpr_write_b32 a210, v6
    v_accvgpr_write_b32 a211, v7
    v_perm_b32 v8, v29, v28, s40
    v_perm_b32 v9, v29, v28, s41
    v_perm_b32 v10, v31, v30, s40
    v_perm_b32 v11, v31, v30, s41
    v_accvgpr_write_b32 a212, v8
    v_accvgpr_write_b32 a213, v9
    v_accvgpr_write_b32 a214, v10
    v_accvgpr_write_b32 a215, v11
    s_waitcnt vmcnt(20)
    s_barrier
    s_add_u32 m0, s43, 147456
    s_mov_b32 s42, 4718592
    buffer_load_dwordx4 v1, s[8:11], s42 offen  lds
    s_add_u32 m0, s43, 148480
    s_mov_b32 s42, 4751360
    buffer_load_dwordx4 v1, s[8:11], s42 offen  lds
    s_add_u32 m0, s43, 149504
    s_mov_b32 s42, 4784128
    buffer_load_dwordx4 v1, s[8:11], s42 offen  lds
    s_add_u32 m0, s43, 150528
    s_mov_b32 s42, 4816896
    buffer_load_dwordx4 v1, s[8:11], s42 offen  lds
    v_add_u32 v12, 43008, v13
    ds_read2st64_b32 v[16:17], v12 offset0:0 offset1:1
    ds_read2st64_b32 v[18:19], v12 offset0:2 offset1:3
    ds_read2st64_b32 v[20:21], v12 offset0:16 offset1:17
    ds_read2st64_b32 v[22:23], v12 offset0:18 offset1:19
    ds_read2st64_b32 v[24:25], v12 offset0:32 offset1:33
    ds_read2st64_b32 v[26:27], v12 offset0:34 offset1:35
    ds_read2st64_b32 v[28:29], v12 offset0:48 offset1:49
    ds_read2st64_b32 v[30:31], v12 offset0:50 offset1:51
    s_waitcnt lgkmcnt(0)
    v_perm_b32 v4, v17, v16, s40
    v_perm_b32 v5, v17, v16, s41
    v_perm_b32 v6, v19, v18, s40
    v_perm_b32 v7, v19, v18, s41
    ds_write_b128 v3, v[4:7] offset:6144
    v_perm_b32 v8, v21, v20, s40
    v_perm_b32 v9, v21, v20, s41
    v_perm_b32 v10, v23, v22, s40
    v_perm_b32 v11, v23, v22, s41
    ds_write_b128 v3, v[8:11] offset:7168
    v_perm_b32 v4, v25, v24, s40
    v_perm_b32 v5, v25, v24, s41
    v_perm_b32 v6, v27, v26, s40
    v_perm_b32 v7, v27, v26, s41
    ds_write_b128 v3, v[4:7] offset:8192
    v_perm_b32 v8, v29, v28, s40
    v_perm_b32 v9, v29, v28, s41
    v_perm_b32 v10, v31, v30, s40
    v_perm_b32 v11, v31, v30, s41
    ds_write_b128 v3, v[8:11] offset:9216
    s_waitcnt vmcnt(12)
    s_barrier
    s_mov_b32 s8, s58
    s_mov_b32 s9, s59
    s_add_u32 m0, s43, 43008
    s_mov_b32 s42, 0
    buffer_load_dwordx4 v1, s[8:11], s42 offen  lds
    s_add_u32 m0, s43, 44032
    s_mov_b32 s42, 32768
    buffer_load_dwordx4 v1, s[8:11], s42 offen  lds
    s_add_u32 m0, s43, 45056
    s_mov_b32 s42, 65536
    buffer_load_dwordx4 v1, s[8:11], s42 offen  lds
    s_add_u32 m0, s43, 46080
    s_mov_b32 s42, 98304
    buffer_load_dwordx4 v1, s[8:11], s42 offen  lds
    v_add_u32 v12, 77824, v13
    ds_read2st64_b32 v[16:17], v12 offset0:0 offset1:1
    ds_read2st64_b32 v[18:19], v12 offset0:2 offset1:3
    ds_read2st64_b32 v[20:21], v12 offset0:16 offset1:17
    ds_read2st64_b32 v[22:23], v12 offset0:18 offset1:19
    ds_read2st64_b32 v[24:25], v12 offset0:32 offset1:33
    ds_read2st64_b32 v[26:27], v12 offset0:34 offset1:35
    ds_read2st64_b32 v[28:29], v12 offset0:48 offset1:49
    ds_read2st64_b32 v[30:31], v12 offset0:50 offset1:51
    s_waitcnt lgkmcnt(0)
    v_perm_b32 v4, v17, v16, s40
    v_perm_b32 v5, v17, v16, s41
    v_perm_b32 v6, v19, v18, s40
    v_perm_b32 v7, v19, v18, s41
    ds_write_b128 v3, v[4:7] offset:10240
    v_perm_b32 v8, v21, v20, s40
    v_perm_b32 v9, v21, v20, s41
    v_perm_b32 v10, v23, v22, s40
    v_perm_b32 v11, v23, v22, s41
    ds_write_b128 v3, v[8:11] offset:11264
    v_perm_b32 v4, v25, v24, s40
    v_perm_b32 v5, v25, v24, s41
    v_perm_b32 v6, v27, v26, s40
    v_perm_b32 v7, v27, v26, s41
    ds_write_b128 v3, v[4:7] offset:12288
    v_perm_b32 v8, v29, v28, s40
    v_perm_b32 v9, v29, v28, s41
    v_perm_b32 v10, v31, v30, s40
    v_perm_b32 v11, v31, v30, s41
    ds_write_b128 v3, v[8:11] offset:13312
    s_waitcnt vmcnt(8)
    s_barrier
    s_add_u32 m0, s43, 77824
    s_mov_b32 s42, 524288
    buffer_load_dwordx4 v1, s[8:11], s42 offen  lds
    s_add_u32 m0, s43, 78848
    s_mov_b32 s42, 557056
    buffer_load_dwordx4 v1, s[8:11], s42 offen  lds
    s_add_u32 m0, s43, 79872
    s_mov_b32 s42, 589824
    buffer_load_dwordx4 v1, s[8:11], s42 offen  lds
    s_add_u32 m0, s43, 80896
    s_mov_b32 s42, 622592
    buffer_load_dwordx4 v1, s[8:11], s42 offen  lds
    v_add_u32 v12, 112640, v13
    ds_read2st64_b32 v[16:17], v12 offset0:0 offset1:1
    ds_read2st64_b32 v[18:19], v12 offset0:2 offset1:3
    ds_read2st64_b32 v[20:21], v12 offset0:16 offset1:17
    ds_read2st64_b32 v[22:23], v12 offset0:18 offset1:19
    ds_read2st64_b32 v[24:25], v12 offset0:32 offset1:33
    ds_read2st64_b32 v[26:27], v12 offset0:34 offset1:35
    ds_read2st64_b32 v[28:29], v12 offset0:48 offset1:49
    ds_read2st64_b32 v[30:31], v12 offset0:50 offset1:51
    s_waitcnt lgkmcnt(0)
    v_perm_b32 v4, v17, v16, s40
    v_perm_b32 v5, v17, v16, s41
    v_perm_b32 v6, v19, v18, s40
    v_perm_b32 v7, v19, v18, s41
    v_accvgpr_write_b32 a216, v4
    v_accvgpr_write_b32 a217, v5
    v_accvgpr_write_b32 a218, v6
    v_accvgpr_write_b32 a219, v7
    v_perm_b32 v8, v21, v20, s40
    v_perm_b32 v9, v21, v20, s41
    v_perm_b32 v10, v23, v22, s40
    v_perm_b32 v11, v23, v22, s41
    v_accvgpr_write_b32 a220, v8
    v_accvgpr_write_b32 a221, v9
    v_accvgpr_write_b32 a222, v10
    v_accvgpr_write_b32 a223, v11
    v_perm_b32 v4, v25, v24, s40
    v_perm_b32 v5, v25, v24, s41
    v_perm_b32 v6, v27, v26, s40
    v_perm_b32 v7, v27, v26, s41
    ds_write_b128 v3, v[4:7] offset:14336
    v_perm_b32 v8, v29, v28, s40
    v_perm_b32 v9, v29, v28, s41
    v_perm_b32 v10, v31, v30, s40
    v_perm_b32 v11, v31, v30, s41
    ds_write_b128 v3, v[8:11] offset:15360
    s_waitcnt vmcnt(8)
    s_barrier
    s_add_u32 m0, s43, 112640
    s_mov_b32 s42, 1048576
    buffer_load_dwordx4 v1, s[8:11], s42 offen  lds
    s_add_u32 m0, s43, 113664
    s_mov_b32 s42, 1081344
    buffer_load_dwordx4 v1, s[8:11], s42 offen  lds
    s_add_u32 m0, s43, 114688
    s_mov_b32 s42, 1114112
    buffer_load_dwordx4 v1, s[8:11], s42 offen  lds
    s_add_u32 m0, s43, 115712
    s_mov_b32 s42, 1146880
    buffer_load_dwordx4 v1, s[8:11], s42 offen  lds
    v_add_u32 v12, 147456, v13
    ds_read2st64_b32 v[16:17], v12 offset0:0 offset1:1
    ds_read2st64_b32 v[18:19], v12 offset0:2 offset1:3
    ds_read2st64_b32 v[20:21], v12 offset0:16 offset1:17
    ds_read2st64_b32 v[22:23], v12 offset0:18 offset1:19
    ds_read2st64_b32 v[24:25], v12 offset0:32 offset1:33
    ds_read2st64_b32 v[26:27], v12 offset0:34 offset1:35
    ds_read2st64_b32 v[28:29], v12 offset0:48 offset1:49
    ds_read2st64_b32 v[30:31], v12 offset0:50 offset1:51
    s_waitcnt lgkmcnt(0)
    v_perm_b32 v4, v17, v16, s40
    v_perm_b32 v5, v17, v16, s41
    v_perm_b32 v6, v19, v18, s40
    v_perm_b32 v7, v19, v18, s41
    v_accvgpr_write_b32 a224, v4
    v_accvgpr_write_b32 a225, v5
    v_accvgpr_write_b32 a226, v6
    v_accvgpr_write_b32 a227, v7
    v_perm_b32 v8, v21, v20, s40
    v_perm_b32 v9, v21, v20, s41
    v_perm_b32 v10, v23, v22, s40
    v_perm_b32 v11, v23, v22, s41
    v_accvgpr_write_b32 a228, v8
    v_accvgpr_write_b32 a229, v9
    v_accvgpr_write_b32 a230, v10
    v_accvgpr_write_b32 a231, v11
    v_perm_b32 v4, v25, v24, s40
    v_perm_b32 v5, v25, v24, s41
    v_perm_b32 v6, v27, v26, s40
    v_perm_b32 v7, v27, v26, s41
    v_accvgpr_write_b32 a232, v4
    v_accvgpr_write_b32 a233, v5
    v_accvgpr_write_b32 a234, v6
    v_accvgpr_write_b32 a235, v7
    v_perm_b32 v8, v29, v28, s40
    v_perm_b32 v9, v29, v28, s41
    v_perm_b32 v10, v31, v30, s40
    v_perm_b32 v11, v31, v30, s41
    v_accvgpr_write_b32 a236, v8
    v_accvgpr_write_b32 a237, v9
    v_accvgpr_write_b32 a238, v10
    v_accvgpr_write_b32 a239, v11
    v_perm_b32 v192, v34, v32, s40
    v_perm_b32 v193, v34, v32, s41
    v_perm_b32 v194, v38, v36, s40
    v_perm_b32 v195, v38, v36, s41
    v_perm_b32 v196, v42, v40, s40
    v_perm_b32 v197, v42, v40, s41
    v_perm_b32 v198, v46, v44, s40
    v_perm_b32 v199, v46, v44, s41
    v_perm_b32 v216, v35, v33, s40
    v_perm_b32 v217, v35, v33, s41
    v_perm_b32 v218, v39, v37, s40
    v_perm_b32 v219, v39, v37, s41
    v_perm_b32 v220, v43, v41, s40
    v_perm_b32 v221, v43, v41, s41
    v_perm_b32 v222, v47, v45, s40
    v_perm_b32 v223, v47, v45, s41
    s_waitcnt vmcnt(8)
    s_barrier
    s_add_u32 m0, s43, 147456
    s_mov_b32 s42, 1572864
    buffer_load_dwordx4 v1, s[8:11], s42 offen  lds
    s_add_u32 m0, s43, 148480
    s_mov_b32 s42, 1605632
    buffer_load_dwordx4 v1, s[8:11], s42 offen  lds
    s_add_u32 m0, s43, 149504
    s_mov_b32 s42, 1638400
    buffer_load_dwordx4 v1, s[8:11], s42 offen  lds
    s_add_u32 m0, s43, 150528
    s_mov_b32 s42, 1671168
    buffer_load_dwordx4 v1, s[8:11], s42 offen  lds
    v_add_u32 v12, 43008, v13
    ds_read2st64_b32 v[16:17], v12 offset0:0 offset1:1
    ds_read2st64_b32 v[18:19], v12 offset0:2 offset1:3
    ds_read2st64_b32 v[20:21], v12 offset0:16 offset1:17
    ds_read2st64_b32 v[22:23], v12 offset0:18 offset1:19
    ds_read2st64_b32 v[24:25], v12 offset0:32 offset1:33
    ds_read2st64_b32 v[26:27], v12 offset0:34 offset1:35
    ds_read2st64_b32 v[28:29], v12 offset0:48 offset1:49
    ds_read2st64_b32 v[30:31], v12 offset0:50 offset1:51
    s_waitcnt lgkmcnt(0)
    v_perm_b32 v4, v17, v16, s40
    v_perm_b32 v5, v17, v16, s41
    v_perm_b32 v6, v19, v18, s40
    v_perm_b32 v7, v19, v18, s41
    v_accvgpr_write_b32 a240, v4
    v_accvgpr_write_b32 a241, v5
    v_accvgpr_write_b32 a242, v6
    v_accvgpr_write_b32 a243, v7
    v_perm_b32 v8, v21, v20, s40
    v_perm_b32 v9, v21, v20, s41
    v_perm_b32 v10, v23, v22, s40
    v_perm_b32 v11, v23, v22, s41
    v_accvgpr_write_b32 a244, v8
    v_accvgpr_write_b32 a245, v9
    v_accvgpr_write_b32 a246, v10
    v_accvgpr_write_b32 a247, v11
    v_perm_b32 v4, v25, v24, s40
    v_perm_b32 v5, v25, v24, s41
    v_perm_b32 v6, v27, v26, s40
    v_perm_b32 v7, v27, v26, s41
    v_accvgpr_write_b32 a248, v4
    v_accvgpr_write_b32 a249, v5
    v_accvgpr_write_b32 a250, v6
    v_accvgpr_write_b32 a251, v7
    v_perm_b32 v8, v29, v28, s40
    v_perm_b32 v9, v29, v28, s41
    v_perm_b32 v10, v31, v30, s40
    v_perm_b32 v11, v31, v30, s41
    v_accvgpr_write_b32 a252, v8
    v_accvgpr_write_b32 a253, v9
    v_accvgpr_write_b32 a254, v10
    v_accvgpr_write_b32 a255, v11
    s_waitcnt vmcnt(8)
    s_barrier
    s_add_u32 m0, s43, 43008
    s_mov_b32 s42, 2097152
    buffer_load_dwordx4 v1, s[8:11], s42 offen  lds
    s_add_u32 m0, s43, 44032
    s_mov_b32 s42, 2129920
    buffer_load_dwordx4 v1, s[8:11], s42 offen  lds
    s_add_u32 m0, s43, 45056
    s_mov_b32 s42, 2162688
    buffer_load_dwordx4 v1, s[8:11], s42 offen  lds
    s_add_u32 m0, s43, 46080
    s_mov_b32 s42, 2195456
    buffer_load_dwordx4 v1, s[8:11], s42 offen  lds
    v_add_u32 v12, 77824, v13
    ds_read2st64_b32 v[16:17], v12 offset0:0 offset1:1
    ds_read2st64_b32 v[18:19], v12 offset0:2 offset1:3
    ds_read2st64_b32 v[20:21], v12 offset0:16 offset1:17
    ds_read2st64_b32 v[22:23], v12 offset0:18 offset1:19
    ds_read2st64_b32 v[24:25], v12 offset0:32 offset1:33
    ds_read2st64_b32 v[26:27], v12 offset0:34 offset1:35
    ds_read2st64_b32 v[28:29], v12 offset0:48 offset1:49
    ds_read2st64_b32 v[30:31], v12 offset0:50 offset1:51
    s_waitcnt lgkmcnt(0)
    v_perm_b32 v64, v17, v16, s40
    v_perm_b32 v65, v17, v16, s41
    v_perm_b32 v66, v19, v18, s40
    v_perm_b32 v67, v19, v18, s41
    v_perm_b32 v68, v21, v20, s40
    v_perm_b32 v69, v21, v20, s41
    v_perm_b32 v70, v23, v22, s40
    v_perm_b32 v71, v23, v22, s41
    v_perm_b32 v72, v25, v24, s40
    v_perm_b32 v73, v25, v24, s41
    v_perm_b32 v74, v27, v26, s40
    v_perm_b32 v75, v27, v26, s41
    v_perm_b32 v76, v29, v28, s40
    v_perm_b32 v77, v29, v28, s41
    v_perm_b32 v78, v31, v30, s40
    v_perm_b32 v79, v31, v30, s41
    s_waitcnt vmcnt(8)
    s_barrier
    s_add_u32 m0, s43, 77824
    s_mov_b32 s42, 2621440
    buffer_load_dwordx4 v1, s[8:11], s42 offen  lds
    s_add_u32 m0, s43, 78848
    s_mov_b32 s42, 2654208
    buffer_load_dwordx4 v1, s[8:11], s42 offen  lds
    s_add_u32 m0, s43, 79872
    s_mov_b32 s42, 2686976
    buffer_load_dwordx4 v1, s[8:11], s42 offen  lds
    s_add_u32 m0, s43, 80896
    s_mov_b32 s42, 2719744
    buffer_load_dwordx4 v1, s[8:11], s42 offen  lds
    v_add_u32 v12, 112640, v13
    ds_read2st64_b32 v[16:17], v12 offset0:0 offset1:1
    ds_read2st64_b32 v[18:19], v12 offset0:2 offset1:3
    ds_read2st64_b32 v[20:21], v12 offset0:16 offset1:17
    ds_read2st64_b32 v[22:23], v12 offset0:18 offset1:19
    ds_read2st64_b32 v[24:25], v12 offset0:32 offset1:33
    ds_read2st64_b32 v[26:27], v12 offset0:34 offset1:35
    ds_read2st64_b32 v[28:29], v12 offset0:48 offset1:49
    ds_read2st64_b32 v[30:31], v12 offset0:50 offset1:51
    s_waitcnt lgkmcnt(0)
    v_perm_b32 v80, v17, v16, s40
    v_perm_b32 v81, v17, v16, s41
    v_perm_b32 v82, v19, v18, s40
    v_perm_b32 v83, v19, v18, s41
    v_perm_b32 v84, v21, v20, s40
    v_perm_b32 v85, v21, v20, s41
    v_perm_b32 v86, v23, v22, s40
    v_perm_b32 v87, v23, v22, s41
    v_perm_b32 v88, v25, v24, s40
    v_perm_b32 v89, v25, v24, s41
    v_perm_b32 v90, v27, v26, s40
    v_perm_b32 v91, v27, v26, s41
    v_perm_b32 v92, v29, v28, s40
    v_perm_b32 v93, v29, v28, s41
    v_perm_b32 v94, v31, v30, s40
    v_perm_b32 v95, v31, v30, s41
    s_waitcnt vmcnt(8)
    s_barrier
    s_add_u32 m0, s43, 112640
    s_mov_b32 s42, 3145728
    buffer_load_dwordx4 v1, s[8:11], s42 offen  lds
    s_add_u32 m0, s43, 113664
    s_mov_b32 s42, 3178496
    buffer_load_dwordx4 v1, s[8:11], s42 offen  lds
    s_add_u32 m0, s43, 114688
    s_mov_b32 s42, 3211264
    buffer_load_dwordx4 v1, s[8:11], s42 offen  lds
    s_add_u32 m0, s43, 115712
    s_mov_b32 s42, 3244032
    buffer_load_dwordx4 v1, s[8:11], s42 offen  lds
    v_add_u32 v12, 147456, v13
    ds_read2st64_b32 v[16:17], v12 offset0:0 offset1:1
    ds_read2st64_b32 v[18:19], v12 offset0:2 offset1:3
    ds_read2st64_b32 v[20:21], v12 offset0:16 offset1:17
    ds_read2st64_b32 v[22:23], v12 offset0:18 offset1:19
    ds_read2st64_b32 v[24:25], v12 offset0:32 offset1:33
    ds_read2st64_b32 v[26:27], v12 offset0:34 offset1:35
    ds_read2st64_b32 v[28:29], v12 offset0:48 offset1:49
    ds_read2st64_b32 v[30:31], v12 offset0:50 offset1:51
    s_waitcnt lgkmcnt(0)
    v_perm_b32 v96, v17, v16, s40
    v_perm_b32 v97, v17, v16, s41
    v_perm_b32 v98, v19, v18, s40
    v_perm_b32 v99, v19, v18, s41
    v_perm_b32 v100, v21, v20, s40
    v_perm_b32 v101, v21, v20, s41
    v_perm_b32 v102, v23, v22, s40
    v_perm_b32 v103, v23, v22, s41
    v_perm_b32 v104, v25, v24, s40
    v_perm_b32 v105, v25, v24, s41
    v_perm_b32 v106, v27, v26, s40
    v_perm_b32 v107, v27, v26, s41
    v_perm_b32 v108, v29, v28, s40
    v_perm_b32 v109, v29, v28, s41
    v_perm_b32 v110, v31, v30, s40
    v_perm_b32 v111, v31, v30, s41
    s_waitcnt vmcnt(8)
    s_barrier
    s_add_u32 m0, s43, 147456
    s_mov_b32 s42, 3670016
    buffer_load_dwordx4 v1, s[8:11], s42 offen  lds
    s_add_u32 m0, s43, 148480
    s_mov_b32 s42, 3702784
    buffer_load_dwordx4 v1, s[8:11], s42 offen  lds
    s_add_u32 m0, s43, 149504
    s_mov_b32 s42, 3735552
    buffer_load_dwordx4 v1, s[8:11], s42 offen  lds
    s_add_u32 m0, s43, 150528
    s_mov_b32 s42, 3768320
    buffer_load_dwordx4 v1, s[8:11], s42 offen  lds
    v_add_u32 v12, 43008, v13
    ds_read2st64_b32 v[16:17], v12 offset0:0 offset1:1
    ds_read2st64_b32 v[18:19], v12 offset0:2 offset1:3
    ds_read2st64_b32 v[20:21], v12 offset0:16 offset1:17
    ds_read2st64_b32 v[22:23], v12 offset0:18 offset1:19
    ds_read2st64_b32 v[24:25], v12 offset0:32 offset1:33
    ds_read2st64_b32 v[26:27], v12 offset0:34 offset1:35
    ds_read2st64_b32 v[28:29], v12 offset0:48 offset1:49
    ds_read2st64_b32 v[30:31], v12 offset0:50 offset1:51
    s_waitcnt lgkmcnt(0)
    v_perm_b32 v112, v17, v16, s40
    v_perm_b32 v113, v17, v16, s41
    v_perm_b32 v114, v19, v18, s40
    v_perm_b32 v115, v19, v18, s41
    v_perm_b32 v116, v21, v20, s40
    v_perm_b32 v117, v21, v20, s41
    v_perm_b32 v118, v23, v22, s40
    v_perm_b32 v119, v23, v22, s41
    v_perm_b32 v4, v25, v24, s40
    v_perm_b32 v5, v25, v24, s41
    v_perm_b32 v6, v27, v26, s40
    v_perm_b32 v7, v27, v26, s41
    buffer_store_dwordx4 v[4:7], v0, s[4:7], s36 offen offset:0
    v_perm_b32 v8, v29, v28, s40
    v_perm_b32 v9, v29, v28, s41
    v_perm_b32 v10, v31, v30, s40
    v_perm_b32 v11, v31, v30, s41
    buffer_store_dwordx4 v[8:11], v0, s[4:7], s36 offen offset:1024
    s_waitcnt vmcnt(10)
    s_barrier
    s_add_u32 m0, s43, 43008
    s_mov_b32 s42, 4194304
    buffer_load_dwordx4 v1, s[8:11], s42 offen  lds
    s_add_u32 m0, s43, 44032
    s_mov_b32 s42, 4227072
    buffer_load_dwordx4 v1, s[8:11], s42 offen  lds
    s_add_u32 m0, s43, 45056
    s_mov_b32 s42, 4259840
    buffer_load_dwordx4 v1, s[8:11], s42 offen  lds
    s_add_u32 m0, s43, 46080
    s_mov_b32 s42, 4292608
    buffer_load_dwordx4 v1, s[8:11], s42 offen  lds
    v_add_u32 v12, 77824, v13
    ds_read2st64_b32 v[16:17], v12 offset0:0 offset1:1
    ds_read2st64_b32 v[18:19], v12 offset0:2 offset1:3
    ds_read2st64_b32 v[20:21], v12 offset0:16 offset1:17
    ds_read2st64_b32 v[22:23], v12 offset0:18 offset1:19
    ds_read2st64_b32 v[24:25], v12 offset0:32 offset1:33
    ds_read2st64_b32 v[26:27], v12 offset0:34 offset1:35
    ds_read2st64_b32 v[28:29], v12 offset0:48 offset1:49
    ds_read2st64_b32 v[30:31], v12 offset0:50 offset1:51
    s_waitcnt lgkmcnt(0)
    v_perm_b32 v120, v17, v16, s40
    v_perm_b32 v121, v17, v16, s41
    v_perm_b32 v122, v19, v18, s40
    v_perm_b32 v123, v19, v18, s41
    v_perm_b32 v124, v21, v20, s40
    v_perm_b32 v125, v21, v20, s41
    v_perm_b32 v126, v23, v22, s40
    v_perm_b32 v127, v23, v22, s41
    v_perm_b32 v4, v25, v24, s40
    v_perm_b32 v5, v25, v24, s41
    v_perm_b32 v6, v27, v26, s40
    v_perm_b32 v7, v27, v26, s41
    ds_write_b128 v3, v[4:7] offset:16384
    v_perm_b32 v8, v29, v28, s40
    v_perm_b32 v9, v29, v28, s41
    v_perm_b32 v10, v31, v30, s40
    v_perm_b32 v11, v31, v30, s41
    ds_write_b128 v3, v[8:11] offset:17408
    s_waitcnt vmcnt(10)
    s_barrier
    s_add_u32 m0, s43, 77824
    s_mov_b32 s42, 4718592
    buffer_load_dwordx4 v1, s[8:11], s42 offen  lds
    s_add_u32 m0, s43, 78848
    s_mov_b32 s42, 4751360
    buffer_load_dwordx4 v1, s[8:11], s42 offen  lds
    s_add_u32 m0, s43, 79872
    s_mov_b32 s42, 4784128
    buffer_load_dwordx4 v1, s[8:11], s42 offen  lds
    s_add_u32 m0, s43, 80896
    s_mov_b32 s42, 4816896
    buffer_load_dwordx4 v1, s[8:11], s42 offen  lds
    v_add_u32 v12, 112640, v13
    ds_read2st64_b32 v[16:17], v12 offset0:0 offset1:1
    ds_read2st64_b32 v[18:19], v12 offset0:2 offset1:3
    ds_read2st64_b32 v[20:21], v12 offset0:16 offset1:17
    ds_read2st64_b32 v[22:23], v12 offset0:18 offset1:19
    ds_read2st64_b32 v[24:25], v12 offset0:32 offset1:33
    ds_read2st64_b32 v[26:27], v12 offset0:34 offset1:35
    ds_read2st64_b32 v[28:29], v12 offset0:48 offset1:49
    ds_read2st64_b32 v[30:31], v12 offset0:50 offset1:51
    s_waitcnt lgkmcnt(0)
    v_perm_b32 v128, v17, v16, s40
    v_perm_b32 v129, v17, v16, s41
    v_perm_b32 v130, v19, v18, s40
    v_perm_b32 v131, v19, v18, s41
    v_perm_b32 v132, v21, v20, s40
    v_perm_b32 v133, v21, v20, s41
    v_perm_b32 v134, v23, v22, s40
    v_perm_b32 v135, v23, v22, s41
    v_perm_b32 v136, v25, v24, s40
    v_perm_b32 v137, v25, v24, s41
    v_perm_b32 v138, v27, v26, s40
    v_perm_b32 v139, v27, v26, s41
    v_perm_b32 v140, v29, v28, s40
    v_perm_b32 v141, v29, v28, s41
    v_perm_b32 v142, v31, v30, s40
    v_perm_b32 v143, v31, v30, s41
    s_waitcnt vmcnt(10)
    s_barrier
    s_mov_b32 s8, s60
    s_mov_b32 s9, s61
    s_mov_b32 s42, 81920
    buffer_load_dwordx2 v[32:33], v14, s[8:11], s42 offen
    s_mov_b32 s42, 83200
    buffer_load_dwordx2 v[34:35], v14, s[8:11], s42 offen
    s_mov_b32 s42, 84480
    buffer_load_dwordx2 v[36:37], v14, s[8:11], s42 offen
    s_mov_b32 s42, 85760
    buffer_load_dwordx2 v[38:39], v14, s[8:11], s42 offen
    s_mov_b32 s42, 102400
    buffer_load_dwordx2 v[40:41], v14, s[8:11], s42 offen
    s_mov_b32 s42, 103680
    buffer_load_dwordx2 v[42:43], v14, s[8:11], s42 offen
    s_mov_b32 s42, 104960
    buffer_load_dwordx2 v[44:45], v14, s[8:11], s42 offen
    s_mov_b32 s42, 106240
    buffer_load_dwordx2 v[46:47], v14, s[8:11], s42 offen
    v_add_u32 v12, 147456, v13
    ds_read2st64_b32 v[16:17], v12 offset0:0 offset1:1
    ds_read2st64_b32 v[18:19], v12 offset0:2 offset1:3
    ds_read2st64_b32 v[20:21], v12 offset0:16 offset1:17
    ds_read2st64_b32 v[22:23], v12 offset0:18 offset1:19
    ds_read2st64_b32 v[24:25], v12 offset0:32 offset1:33
    ds_read2st64_b32 v[26:27], v12 offset0:34 offset1:35
    ds_read2st64_b32 v[28:29], v12 offset0:48 offset1:49
    ds_read2st64_b32 v[30:31], v12 offset0:50 offset1:51
    s_waitcnt lgkmcnt(0)
    v_perm_b32 v144, v17, v16, s40
    v_perm_b32 v145, v17, v16, s41
    v_perm_b32 v146, v19, v18, s40
    v_perm_b32 v147, v19, v18, s41
    v_perm_b32 v148, v21, v20, s40
    v_perm_b32 v149, v21, v20, s41
    v_perm_b32 v150, v23, v22, s40
    v_perm_b32 v151, v23, v22, s41
    v_perm_b32 v152, v25, v24, s40
    v_perm_b32 v153, v25, v24, s41
    v_perm_b32 v154, v27, v26, s40
    v_perm_b32 v155, v27, v26, s41
    v_perm_b32 v156, v29, v28, s40
    v_perm_b32 v157, v29, v28, s41
    v_perm_b32 v158, v31, v30, s40
    v_perm_b32 v159, v31, v30, s41
    s_waitcnt vmcnt(12)
    s_barrier
    s_mov_b32 s42, 512
    buffer_load_dwordx2 v[48:49], v14, s[8:11], s42 offen
    s_mov_b32 s42, 1792
    buffer_load_dwordx2 v[50:51], v14, s[8:11], s42 offen
    s_mov_b32 s42, 3072
    buffer_load_dwordx2 v[52:53], v14, s[8:11], s42 offen
    s_mov_b32 s42, 4352
    buffer_load_dwordx2 v[54:55], v14, s[8:11], s42 offen
    s_mov_b32 s42, 20992
    buffer_load_dwordx2 v[56:57], v14, s[8:11], s42 offen
    s_mov_b32 s42, 22272
    buffer_load_dwordx2 v[58:59], v14, s[8:11], s42 offen
    s_mov_b32 s42, 23552
    buffer_load_dwordx2 v[60:61], v14, s[8:11], s42 offen
    s_mov_b32 s42, 24832
    buffer_load_dwordx2 v[62:63], v14, s[8:11], s42 offen
    v_add_u32 v12, 43008, v13
    ds_read2st64_b32 v[16:17], v12 offset0:0 offset1:1
    ds_read2st64_b32 v[18:19], v12 offset0:2 offset1:3
    ds_read2st64_b32 v[20:21], v12 offset0:16 offset1:17
    ds_read2st64_b32 v[22:23], v12 offset0:18 offset1:19
    ds_read2st64_b32 v[24:25], v12 offset0:32 offset1:33
    ds_read2st64_b32 v[26:27], v12 offset0:34 offset1:35
    ds_read2st64_b32 v[28:29], v12 offset0:48 offset1:49
    ds_read2st64_b32 v[30:31], v12 offset0:50 offset1:51
    s_waitcnt lgkmcnt(0)
    v_perm_b32 v160, v17, v16, s40
    v_perm_b32 v161, v17, v16, s41
    v_perm_b32 v162, v19, v18, s40
    v_perm_b32 v163, v19, v18, s41
    v_perm_b32 v164, v21, v20, s40
    v_perm_b32 v165, v21, v20, s41
    v_perm_b32 v166, v23, v22, s40
    v_perm_b32 v167, v23, v22, s41
    v_perm_b32 v168, v25, v24, s40
    v_perm_b32 v169, v25, v24, s41
    v_perm_b32 v170, v27, v26, s40
    v_perm_b32 v171, v27, v26, s41
    v_perm_b32 v172, v29, v28, s40
    v_perm_b32 v173, v29, v28, s41
    v_perm_b32 v174, v31, v30, s40
    v_perm_b32 v175, v31, v30, s41
    s_waitcnt vmcnt(16)
    s_barrier
    v_add_u32 v12, 77824, v13
    ds_read2st64_b32 v[16:17], v12 offset0:0 offset1:1
    ds_read2st64_b32 v[18:19], v12 offset0:2 offset1:3
    ds_read2st64_b32 v[20:21], v12 offset0:16 offset1:17
    ds_read2st64_b32 v[22:23], v12 offset0:18 offset1:19
    ds_read2st64_b32 v[24:25], v12 offset0:32 offset1:33
    ds_read2st64_b32 v[26:27], v12 offset0:34 offset1:35
    ds_read2st64_b32 v[28:29], v12 offset0:48 offset1:49
    ds_read2st64_b32 v[30:31], v12 offset0:50 offset1:51
    s_waitcnt lgkmcnt(0)
    s_barrier
    v_perm_b32 v176, v17, v16, s40
    v_perm_b32 v177, v17, v16, s41
    v_perm_b32 v178, v19, v18, s40
    v_perm_b32 v179, v19, v18, s41
    v_perm_b32 v180, v21, v20, s40
    v_perm_b32 v181, v21, v20, s41
    v_perm_b32 v182, v23, v22, s40
    v_perm_b32 v183, v23, v22, s41
    v_perm_b32 v184, v25, v24, s40
    v_perm_b32 v185, v25, v24, s41
    v_perm_b32 v186, v27, v26, s40
    v_perm_b32 v187, v27, v26, s41
    v_perm_b32 v188, v29, v28, s40
    v_perm_b32 v189, v29, v28, s41
    v_perm_b32 v190, v31, v30, s40
    v_perm_b32 v191, v31, v30, s41
    s_mov_b32 s42, 41472
    buffer_load_dwordx2 v[16:17], v14, s[8:11], s42 offen
    s_mov_b32 s42, 42752
    buffer_load_dwordx2 v[18:19], v14, s[8:11], s42 offen
    s_mov_b32 s42, 44032
    buffer_load_dwordx2 v[20:21], v14, s[8:11], s42 offen
    s_mov_b32 s42, 45312
    buffer_load_dwordx2 v[22:23], v14, s[8:11], s42 offen
    s_mov_b32 s42, 61952
    buffer_load_dwordx2 v[24:25], v14, s[8:11], s42 offen
    s_mov_b32 s42, 63232
    buffer_load_dwordx2 v[26:27], v14, s[8:11], s42 offen
    s_mov_b32 s42, 64512
    buffer_load_dwordx2 v[28:29], v14, s[8:11], s42 offen
    s_mov_b32 s42, 65792
    buffer_load_dwordx2 v[30:31], v14, s[8:11], s42 offen
    s_waitcnt vmcnt(16)
    v_perm_b32 v4, v34, v32, s40
    v_perm_b32 v5, v34, v32, s41
    v_perm_b32 v6, v38, v36, s40
    v_perm_b32 v7, v38, v36, s41
    ds_write_b128 v3, v[4:7] offset:18432
    v_perm_b32 v8, v42, v40, s40
    v_perm_b32 v9, v42, v40, s41
    v_perm_b32 v10, v46, v44, s40
    v_perm_b32 v11, v46, v44, s41
    ds_write_b128 v3, v[8:11] offset:19456
    v_perm_b32 v4, v35, v33, s40
    v_perm_b32 v5, v35, v33, s41
    v_perm_b32 v6, v39, v37, s40
    v_perm_b32 v7, v39, v37, s41
    ds_write_b128 v3, v[4:7] offset:20480
    v_perm_b32 v8, v43, v41, s40
    v_perm_b32 v9, v43, v41, s41
    v_perm_b32 v10, v47, v45, s40
    v_perm_b32 v11, v47, v45, s41
    ds_write_b128 v3, v[8:11] offset:21504
    s_mov_b32 s42, 82432
    buffer_load_dwordx2 v[32:33], v14, s[8:11], s42 offen
    s_mov_b32 s42, 83712
    buffer_load_dwordx2 v[34:35], v14, s[8:11], s42 offen
    s_mov_b32 s42, 84992
    buffer_load_dwordx2 v[36:37], v14, s[8:11], s42 offen
    s_mov_b32 s42, 86272
    buffer_load_dwordx2 v[38:39], v14, s[8:11], s42 offen
    s_mov_b32 s42, 102912
    buffer_load_dwordx2 v[40:41], v14, s[8:11], s42 offen
    s_mov_b32 s42, 104192
    buffer_load_dwordx2 v[42:43], v14, s[8:11], s42 offen
    s_mov_b32 s42, 105472
    buffer_load_dwordx2 v[44:45], v14, s[8:11], s42 offen
    s_mov_b32 s42, 106752
    buffer_load_dwordx2 v[46:47], v14, s[8:11], s42 offen
    s_waitcnt vmcnt(16)
    v_perm_b32 v224, v50, v48, s40
    v_perm_b32 v225, v50, v48, s41
    v_perm_b32 v226, v54, v52, s40
    v_perm_b32 v227, v54, v52, s41
    v_perm_b32 v228, v58, v56, s40
    v_perm_b32 v229, v58, v56, s41
    v_perm_b32 v230, v62, v60, s40
    v_perm_b32 v231, v62, v60, s41
    v_perm_b32 v4, v51, v49, s40
    v_perm_b32 v5, v51, v49, s41
    v_perm_b32 v6, v55, v53, s40
    v_perm_b32 v7, v55, v53, s41
    ds_write_b128 v3, v[4:7] offset:24576
    v_perm_b32 v8, v59, v57, s40
    v_perm_b32 v9, v59, v57, s41
    v_perm_b32 v10, v63, v61, s40
    v_perm_b32 v11, v63, v61, s41
    ds_write_b128 v3, v[8:11] offset:25600
    s_mov_b32 s42, 123392
    buffer_load_dwordx2 v[48:49], v14, s[8:11], s42 offen
    s_mov_b32 s42, 124672
    buffer_load_dwordx2 v[50:51], v14, s[8:11], s42 offen
    s_mov_b32 s42, 125952
    buffer_load_dwordx2 v[52:53], v14, s[8:11], s42 offen
    s_mov_b32 s42, 127232
    buffer_load_dwordx2 v[54:55], v14, s[8:11], s42 offen
    s_mov_b32 s42, 143872
    buffer_load_dwordx2 v[56:57], v14, s[8:11], s42 offen
    s_mov_b32 s42, 145152
    buffer_load_dwordx2 v[58:59], v14, s[8:11], s42 offen
    s_mov_b32 s42, 146432
    buffer_load_dwordx2 v[60:61], v14, s[8:11], s42 offen
    s_mov_b32 s42, 147712
    buffer_load_dwordx2 v[62:63], v14, s[8:11], s42 offen
    s_waitcnt vmcnt(16)
    v_perm_b32 v4, v18, v16, s40
    v_perm_b32 v5, v18, v16, s41
    v_perm_b32 v6, v22, v20, s40
    v_perm_b32 v7, v22, v20, s41
    buffer_store_dwordx4 v[4:7], v0, s[4:7], s37 offen offset:2048
    v_perm_b32 v8, v26, v24, s40
    v_perm_b32 v9, v26, v24, s41
    v_perm_b32 v10, v30, v28, s40
    v_perm_b32 v11, v30, v28, s41
    buffer_store_dwordx4 v[8:11], v0, s[4:7], s37 offen offset:3072
    v_perm_b32 v4, v19, v17, s40
    v_perm_b32 v5, v19, v17, s41
    v_perm_b32 v6, v23, v21, s40
    v_perm_b32 v7, v23, v21, s41
    ds_write_b128 v3, v[4:7] offset:26624
    v_perm_b32 v8, v27, v25, s40
    v_perm_b32 v9, v27, v25, s41
    v_perm_b32 v10, v31, v29, s40
    v_perm_b32 v11, v31, v29, s41
    ds_write_b128 v3, v[8:11] offset:27648
    s_mov_b32 s8, s60
    s_mov_b32 s9, s61
    s_mov_b32 s42, 1024
    buffer_load_dword v16, v2, s[8:11], s42 offen
    s_mov_b32 s42, 2304
    buffer_load_dword v17, v2, s[8:11], s42 offen
    s_mov_b32 s42, 3584
    buffer_load_dword v18, v2, s[8:11], s42 offen
    s_mov_b32 s42, 4864
    buffer_load_dword v19, v2, s[8:11], s42 offen
    s_mov_b32 s42, 21504
    buffer_load_dword v20, v2, s[8:11], s42 offen
    s_mov_b32 s42, 22784
    buffer_load_dword v21, v2, s[8:11], s42 offen
    s_mov_b32 s42, 24064
    buffer_load_dword v22, v2, s[8:11], s42 offen
    s_mov_b32 s42, 25344
    buffer_load_dword v23, v2, s[8:11], s42 offen
    s_mov_b32 s42, 41984
    buffer_load_dword v24, v2, s[8:11], s42 offen
    s_mov_b32 s42, 43264
    buffer_load_dword v25, v2, s[8:11], s42 offen
    s_mov_b32 s42, 44544
    buffer_load_dword v26, v2, s[8:11], s42 offen
    s_mov_b32 s42, 45824
    buffer_load_dword v27, v2, s[8:11], s42 offen
    s_mov_b32 s42, 62464
    buffer_load_dword v28, v2, s[8:11], s42 offen
    s_mov_b32 s42, 63744
    buffer_load_dword v29, v2, s[8:11], s42 offen
    s_mov_b32 s42, 65024
    buffer_load_dword v30, v2, s[8:11], s42 offen
    s_mov_b32 s42, 66304
    buffer_load_dword v31, v2, s[8:11], s42 offen
    s_waitcnt vmcnt(26)
    v_perm_b32 v4, v34, v32, s40
    v_perm_b32 v5, v34, v32, s41
    v_perm_b32 v6, v38, v36, s40
    v_perm_b32 v7, v38, v36, s41
    ds_write_b128 v3, v[4:7] offset:22528
    v_perm_b32 v8, v42, v40, s40
    v_perm_b32 v9, v42, v40, s41
    v_perm_b32 v10, v46, v44, s40
    v_perm_b32 v11, v46, v44, s41
    ds_write_b128 v3, v[8:11] offset:23552
    v_perm_b32 v240, v35, v33, s40
    v_perm_b32 v241, v35, v33, s41
    v_perm_b32 v242, v39, v37, s40
    v_perm_b32 v243, v39, v37, s41
    v_perm_b32 v244, v43, v41, s40
    v_perm_b32 v245, v43, v41, s41
    v_perm_b32 v246, v47, v45, s40
    v_perm_b32 v247, v47, v45, s41
    s_mov_b32 s42, 82944
    buffer_load_dword v32, v2, s[8:11], s42 offen
    s_mov_b32 s42, 84224
    buffer_load_dword v33, v2, s[8:11], s42 offen
    s_mov_b32 s42, 85504
    buffer_load_dword v34, v2, s[8:11], s42 offen
    s_mov_b32 s42, 86784
    buffer_load_dword v35, v2, s[8:11], s42 offen
    s_mov_b32 s42, 103424
    buffer_load_dword v36, v2, s[8:11], s42 offen
    s_mov_b32 s42, 104704
    buffer_load_dword v37, v2, s[8:11], s42 offen
    s_mov_b32 s42, 105984
    buffer_load_dword v38, v2, s[8:11], s42 offen
    s_mov_b32 s42, 107264
    buffer_load_dword v39, v2, s[8:11], s42 offen
    s_mov_b32 s42, 123904
    buffer_load_dword v40, v2, s[8:11], s42 offen
    s_mov_b32 s42, 125184
    buffer_load_dword v41, v2, s[8:11], s42 offen
    s_mov_b32 s42, 126464
    buffer_load_dword v42, v2, s[8:11], s42 offen
    s_mov_b32 s42, 127744
    buffer_load_dword v43, v2, s[8:11], s42 offen
    s_mov_b32 s42, 144384
    buffer_load_dword v44, v2, s[8:11], s42 offen
    s_mov_b32 s42, 145664
    buffer_load_dword v45, v2, s[8:11], s42 offen
    s_mov_b32 s42, 146944
    buffer_load_dword v46, v2, s[8:11], s42 offen
    s_mov_b32 s42, 148224
    buffer_load_dword v47, v2, s[8:11], s42 offen
    s_waitcnt vmcnt(34)
    v_perm_b32 v232, v50, v48, s40
    v_perm_b32 v233, v50, v48, s41
    v_perm_b32 v234, v54, v52, s40
    v_perm_b32 v235, v54, v52, s41
    v_perm_b32 v236, v58, v56, s40
    v_perm_b32 v237, v58, v56, s41
    v_perm_b32 v238, v62, v60, s40
    v_perm_b32 v239, v62, v60, s41
    v_perm_b32 v4, v51, v49, s40
    v_perm_b32 v5, v51, v49, s41
    v_perm_b32 v6, v55, v53, s40
    v_perm_b32 v7, v55, v53, s41
    ds_write_b128 v3, v[4:7] offset:28672
    v_perm_b32 v8, v59, v57, s40
    v_perm_b32 v9, v59, v57, s41
    v_perm_b32 v10, v63, v61, s40
    v_perm_b32 v11, v63, v61, s41
    ds_write_b128 v3, v[8:11] offset:29696
    s_cmp_eq_u32 s13, 0
    s_cbranch_scc0 C_arrived
    s_mov_b64 exec, 7
    v_lshlrev_b32 v8, 3, v0
    v_add_u32 v8, 8192, v8
    v_mov_b32 v4, 4
    s_mov_b32 s66, 0
C_poll:
    global_load_dwordx2 v[6:7], v4, s[50:51] sc1
    s_add_u32 s66, s66, 1
    s_cmp_gt_u32 s66, 0x100000
    s_cbranch_scc1 C_polled
    s_waitcnt vmcnt(0)
    v_cmp_gt_u32 vcc, 32, v6
    s_cbranch_vccnz C_poll
C_pollkv:
    buffer_load_dword v9, v8, s[4:7], 0 offen sc1
    s_add_u32 s66, s66, 1
    s_cmp_gt_u32 s66, 0x100000
    s_cbranch_scc1 C_polled
    s_waitcnt vmcnt(0)
    v_cmp_gt_u32 vcc, 32, v9
    s_cbranch_vccz C_polled
    s_sleep 4
    s_branch C_pollkv
C_polled:
    s_waitcnt vmcnt(0)
    s_mov_b64 exec, 1
    v_mov_b32 v4, 23552
    ds_write_b32 v4, v7
    s_waitcnt lgkmcnt(0)
    s_mov_b64 exec, -1
    v_lshlrev_b32 v4, 3, v0
    s_mov_b32 m0, 23808
    s_sub_u32 s66, s48, 262144
    buffer_load_dword v4, s[4:7], s20 offen sc1 lds
    buffer_load_dword v4, s[4:7], s66 offen sc1 lds
C_arrived:
    s_waitcnt vmcnt(16)
    v_perm_b32 v4, v17, v16, s40
    v_perm_b32 v5, v17, v16, s41
    v_perm_b32 v6, v19, v18, s40
    v_perm_b32 v7, v19, v18, s41
    ds_write_b128 v3, v[4:7] offset:30720
    v_perm_b32 v8, v21, v20, s40
    v_perm_b32 v9, v21, v20, s41
    v_perm_b32 v10, v23, v22, s40
    v_perm_b32 v11, v23, v22, s41
    ds_write_b128 v3, v[8:11] offset:31744
    v_perm_b32 v248, v25, v24, s40
    v_perm_b32 v249, v25, v24, s41
    v_perm_b32 v250, v27, v26, s40
    v_perm_b32 v251, v27, v26, s41
    v_perm_b32 v252, v29, v28, s40
    v_perm_b32 v253, v29, v28, s41
    v_perm_b32 v254, v31, v30, s40
    v_perm_b32 v255, v31, v30, s41
    s_waitcnt vmcnt(0)
    v_perm_b32 v4, v33, v32, s40
    v_perm_b32 v5, v33, v32, s41
    v_perm_b32 v6, v35, v34, s40
    v_perm_b32 v7, v35, v34, s41
    ds_write_b128 v3, v[4:7] offset:32768
    v_perm_b32 v8, v37, v36, s40
    v_perm_b32 v9, v37, v36, s41
    v_perm_b32 v10, v39, v38, s40
    v_perm_b32 v11, v39, v38, s41
    ds_write_b128 v3, v[8:11] offset:33792
    v_perm_b32 v4, v41, v40, s40
    v_perm_b32 v5, v41, v40, s41
    v_perm_b32 v6, v43, v42, s40
    v_perm_b32 v7, v43, v42, s41
    buffer_store_dwordx4 v[4:7], v0, s[4:7], s38 offen offset:0
    v_perm_b32 v8, v45, v44, s40
    v_perm_b32 v9, v45, v44, s41
    v_perm_b32 v10, v47, v46, s40
    v_perm_b32 v11, v47, v46, s41
    buffer_store_dwordx4 v[8:11], v0, s[4:7], s38 offen offset:1024
    s_waitcnt vmcnt(0) lgkmcnt(0)
    v_bfe_u32 v12, v15, 1, 3
    v_lshlrev_b32 v1, 6, v12
    v_lshrrev_b32 v12, 4, v15
    v_lshl_add_u32 v1, v12, 4, v1
    v_and_b32 v12, 1, v15
    v_mov_b32 v13, 0xaaaa
    v_mul_u32_u24 v2, v12, v13
    v_add_u32 v2, 0x4444, v2
    s_lshl_b32 s46, s13, 5
    s_add_u32 s46, s46, s12
    s_lshl_b32 s42, s46, 7
    v_lshrrev_b32 v12, 3, v15
    v_mul_u32_u24 v4, 10240, v12
    v_and_b32 v12, 7, v15
    v_lshl_add_u32 v4, v12, 4, v4
    v_add_u32 v4, s42, v4
    s_and_b32 s43, s46, 1
    s_lshl_b32 s43, s43, 2
    s_bfe_u32 s53, s46, 0x20001
    s_or_b32 s43, s43, s53
    s_andn2_b32 s53, s46, 7
    s_or_b32 s43, s43, s53
    s_cmp_lt_u32 s46, 64
    s_cselect_b32 s53, s43, s46
    s_lshl_b32 s42, s53, 7
    v_lshrrev_b32 v12, 4, v15
    v_lshlrev_b32 v5, 6, v12
    v_and_b32 v12, 15, v15
    v_lshl_add_u32 v5, v12, 3, v5
    v_add_u32 v5, s42, v5
    v_and_b32 v12, 0x28, v15
    v_cmp_eq_u32 vcc, 0, v12
    v_mov_b32 v13, 0x7ff00000
    s_nop 0
    v_cndmask_b32 v5, v13, v5, vcc
    v_lshrrev_b32 v12, 5, v15
    v_lshlrev_b32 v12, 2, v12
    v_and_b32 v13, 15, v15
    v_xor_b32 v12, v12, v13
    v_lshlrev_b32 v6, 3, v12
    v_lshrrev_b32 v12, 4, v15
    v_lshl_add_u32 v6, v12, 7, v6
    s_lshl_b32 s42, s13, 10
    s_add_u32 s42, s42, 10240
    v_add_u32 v6, s42, v6
    v_bfe_u32 v12, v15, 3, 1
    v_lshlrev_b32 v7, 3, v12
    v_lshrrev_b32 v12, 4, v15
    v_lshl_add_u32 v7, v12, 1, v7
    v_bfe_u32 v12, v15, 2, 1
    v_add_u32 v7, v7, v12
    v_bfe_u32 v12, v15, 1, 1
    v_lshlrev_b32 v12, 2, v12
    v_xor_b32 v7, v7, v12
    v_lshlrev_b32 v7, 3, v7
    v_and_b32 v12, 3, v15
    v_lshl_add_u32 v7, v12, 7, v7
    v_add_u32 v7, 10240, v7
    v_bfe_u32 v12, v15, 2, 2
    v_lshlrev_b32 v8, 7, v12
    v_and_b32 v12, 1, v15
    v_lshl_add_u32 v8, v12, 6, v8
    v_lshrrev_b32 v12, 4, v15
    v_lshl_add_u32 v8, v12, 4, v8
    s_lshl_b32 s42, s13, 9
    v_add_u32 v8, s42, v8
    v_and_b32 v12, 2, v15
    v_lshl_add_u32 v8, v12, 17, v8
    v_lshlrev_b32 v9, 3, v15
    s_mov_b32 s8, s4
    s_mov_b32 s9, s5
    s_mov_b32 s10, 0
    s_cmp_eq_u32 s13, 3
    s_cbranch_scc1 C_noF2
    s_add_u32 s8, s4, 32768
    s_addc_u32 s9, s5, 0
    s_mov_b32 s10, 512
C_noF2:
    s_barrier
    v_mov_b32 v12, 23552
    ds_read_b32 v13, v12
    s_waitcnt lgkmcnt(0)
    v_readfirstlane_b32 s42, v13
    s_nop 3
    s_bcnt1_i32_b32 s87, s42
    s_cmp_eq_u32 s87, 1
    s_cbranch_scc0 C_slow
    s_cmp_eq_u32 s13, 1
    s_cbranch_scc1 CF_w1
    s_cmp_eq_u32 s13, 2
    s_cbranch_scc1 CF_w2
    s_cmp_eq_u32 s13, 3
    s_cbranch_scc1 CF_w3
CF_w0:
    v_lshlrev_b32 v11, 3, v0
    s_mov_b32 s42, 65536
    buffer_load_dwordx2 v[12:13], v5, s[4:7], s42 offen sc1
    s_mov_b32 s42, 81920
    buffer_load_dwordx2 v[12:13], v5, s[4:7], s42 offen sc1
    s_mov_b32 s42, 98304
    buffer_load_dwordx2 v[12:13], v5, s[4:7], s42 offen sc1
    s_mov_b32 s42, 114688
    buffer_load_dwordx2 v[12:13], v5, s[4:7], s42 offen sc1
    buffer_load_dword v14, v11, s[4:7], s25 offen sc1
CF0_rec:
    s_waitcnt vmcnt(0) lgkmcnt(0)
    s_add_u32 s32, s32, 1
    s_cmp_gt_u32 s32, 0x40000
    s_cbranch_scc1 L_abort
    s_barrier
    ds_read_b128 v[40:43], v3 offset:0
    ds_read_b128 v[44:47], v3 offset:1024
    ds_read_b128 v[48:51], v3 offset:2048
    ds_read_b128 v[52:55], v3 offset:3072
    s_mov_b32 m0, 14336
    s_nop 0
    buffer_load_dwordx4 v0, s[4:7], s20 offen offset:0 sc1 lds
    buffer_load_dwordx4 v0, s[4:7], s20 offen offset:1024 sc1 lds
    buffer_load_dwordx4 v0, s[4:7], s20 offen offset:2048 sc1 lds
    buffer_load_dwordx4 v0, s[4:7], s20 offen offset:3072 sc1 lds
    s_mov_b32 m0, 0
    s_nop 0
    buffer_load_dwordx4 v0, s[4:7], s15 offen offset:0 sc1 lds
    buffer_load_dwordx4 v0, s[4:7], s15 offen offset:1024 sc1 lds
    buffer_load_dwordx4 v0, s[4:7], s15 offen offset:2048 sc1 lds
    buffer_load_dwordx4 v0, s[4:7], s15 offen offset:3072 sc1 lds
    buffer_load_dwordx4 v[56:59], v0, s[4:7], s24 offen offset:2048
    buffer_load_dwordx4 v[60:63], v0, s[4:7], s24 offen offset:3072
    v_mov_b64 v[28:29], 0
    v_mov_b64 v[30:31], 0
    v_mov_b64 v[32:33], 0
    v_mov_b64 v[34:35], 0
    v_mov_b64 v[36:37], 0
    v_mov_b64 v[38:39], 0
    s_waitcnt vmcnt(0) lgkmcnt(0)
    s_branch HZ_CF0_top
.p2align 6
CF0_pretop:
    s_waitcnt vmcnt(4)
HZ_CF0_top:
    s_barrier
    ds_read_b128 v[12:15], v1 offset:0
    ds_read_b128 v[16:19], v1 offset:512
    ds_read_b128 v[20:23], v1 offset:1024
    ds_read_b128 v[24:27], v1 offset:1536
    s_waitcnt lgkmcnt(3)
    v_smfmac_f32_16x16x64_bf16 v[28:31], v[12:15], v[40:47], v2
    v_smfmac_f32_16x16x64_bf16 v[32:35], v[12:15], v[48:55], v2
    v_smfmac_f32_16x16x64_bf16 v[36:39], v[12:15], a[240:247], v2
    s_waitcnt vmcnt(2)
    s_barrier
    ds_read_b128 v[12:15], v1 offset:2048
    buffer_load_dwordx4 v[40:43], v0, s[4:7], s36 offen offset:0
    s_waitcnt lgkmcnt(3)
    v_smfmac_f32_16x16x64_bf16 v[28:31], v[16:19], a[0:7], v2
    buffer_load_dwordx4 v[44:47], v0, s[4:7], s36 offen offset:1024
    v_smfmac_f32_16x16x64_bf16 v[32:35], v[16:19], a[144:151], v2
    buffer_load_dwordx4 v[48:51], v0, s[4:7], s24 offen offset:0
    v_smfmac_f32_16x16x64_bf16 v[36:39], v[16:19], a[248:255], v2
    ds_read_b128 v[16:19], v1 offset:2560
    buffer_load_dwordx4 v[52:55], v0, s[4:7], s24 offen offset:1024
    s_waitcnt lgkmcnt(3)
    v_smfmac_f32_16x16x64_bf16 v[28:31], v[20:23], a[8:15], v2
    v_smfmac_f32_16x16x64_bf16 v[32:35], v[20:23], a[152:159], v2
    v_smfmac_f32_16x16x64_bf16 v[36:39], v[20:23], v[64:71], v2
    ds_read_b128 v[20:23], v1 offset:3072
    s_waitcnt lgkmcnt(3)
    v_smfmac_f32_16x16x64_bf16 v[28:31], v[24:27], a[16:23], v2
    v_smfmac_f32_16x16x64_bf16 v[32:35], v[24:27], a[160:167], v2
    s_barrier
    v_smfmac_f32_16x16x64_bf16 v[36:39], v[24:27], v[72:79], v2
    ds_read_b128 v[24:27], v1 offset:3584
    v_lshlrev_b32 v10, 3, v0
    s_mov_b32 m0, 23552
    s_nop 0
    buffer_load_dword v10, s[4:7], s47 offen sc1 lds
    buffer_load_dword v10, s[4:7], s48 offen sc1 lds
    s_waitcnt lgkmcnt(3)
    v_smfmac_f32_16x16x64_bf16 v[28:31], v[12:15], a[24:31], v2
    v_smfmac_f32_16x16x64_bf16 v[32:35], v[12:15], a[168:175], v2
    v_smfmac_f32_16x16x64_bf16 v[36:39], v[12:15], v[80:87], v2
    ds_read_b128 v[12:15], v1 offset:4096
    s_waitcnt lgkmcnt(3)
    v_smfmac_f32_16x16x64_bf16 v[28:31], v[16:19], a[32:39], v2
    v_smfmac_f32_16x16x64_bf16 v[32:35], v[16:19], a[176:183], v2
    v_smfmac_f32_16x16x64_bf16 v[36:39], v[16:19], v[88:95], v2
    ds_read_b128 v[16:19], v1 offset:4608
    s_waitcnt lgkmcnt(3)
    v_smfmac_f32_16x16x64_bf16 v[28:31], v[20:23], a[40:47], v2
    v_smfmac_f32_16x16x64_bf16 v[32:35], v[20:23], a[184:191], v2
    v_smfmac_f32_16x16x64_bf16 v[36:39], v[20:23], v[96:103], v2
    ds_read_b128 v[20:23], v1 offset:5120
    s_waitcnt lgkmcnt(3)
    v_smfmac_f32_16x16x64_bf16 v[28:31], v[24:27], a[48:55], v2
    v_smfmac_f32_16x16x64_bf16 v[32:35], v[24:27], a[192:199], v2
    v_smfmac_f32_16x16x64_bf16 v[36:39], v[24:27], v[104:111], v2
    ds_read_b128 v[24:27], v1 offset:5632
    s_waitcnt lgkmcnt(3)
    v_smfmac_f32_16x16x64_bf16 v[28:31], v[12:15], a[56:63], v2
    s_waitcnt vmcnt(6)
    v_smfmac_f32_16x16x64_bf16 v[32:35], v[12:15], v[56:63], v2
    ds_read_b128 v[56:59], v3 offset:4096
    ds_read_b128 v[60:63], v3 offset:5120
    v_smfmac_f32_16x16x64_bf16 v[36:39], v[12:15], v[112:119], v2
    ds_read_b128 v[12:15], v1 offset:6144
    s_waitcnt lgkmcnt(5)
    v_smfmac_f32_16x16x64_bf16 v[28:31], v[16:19], a[64:71], v2
    v_smfmac_f32_16x16x64_bf16 v[32:35], v[16:19], a[200:207], v2
    s_waitcnt vmcnt(4)
    v_smfmac_f32_16x16x64_bf16 v[36:39], v[16:19], v[40:47], v2
    ds_read_b128 v[40:43], v3 offset:16384
    ds_read_b128 v[44:47], v3 offset:17408
    ds_read_b128 v[16:19], v1 offset:6656
    s_waitcnt lgkmcnt(7)
    v_smfmac_f32_16x16x64_bf16 v[28:31], v[20:23], a[72:79], v2
    s_waitcnt lgkmcnt(4)
    v_smfmac_f32_16x16x64_bf16 v[32:35], v[20:23], v[56:63], v2
    ds_read_b128 v[56:59], v3 offset:6144
    ds_read_b128 v[60:63], v3 offset:7168
    v_smfmac_f32_16x16x64_bf16 v[36:39], v[20:23], v[120:127], v2
    ds_read_b128 v[20:23], v1 offset:7168
    s_waitcnt vmcnt(2)
    v_smfmac_f32_16x16x64_bf16 v[28:31], v[24:27], v[48:55], v2
    ds_read_b128 v[48:51], v3 offset:8192
    ds_read_b128 v[52:55], v3 offset:9216
    v_smfmac_f32_16x16x64_bf16 v[32:35], v[24:27], a[208:215], v2
    s_waitcnt lgkmcnt(6)
    v_smfmac_f32_16x16x64_bf16 v[36:39], v[24:27], v[40:47], v2
    ds_read_b128 v[40:43], v3 offset:10240
    ds_read_b128 v[44:47], v3 offset:11264
    ds_read_b128 v[24:27], v1 offset:7680
    s_barrier
    v_smfmac_f32_16x16x64_bf16 v[28:31], v[12:15], a[80:87], v2
    s_waitcnt lgkmcnt(6)
    v_smfmac_f32_16x16x64_bf16 v[32:35], v[12:15], v[56:63], v2
    ds_read_b128 v[56:59], v3 offset:12288
    ds_read_b128 v[60:63], v3 offset:13312
    ds_read_b128 v[12:15], v1 offset:8192
    v_smfmac_f32_16x16x64_bf16 v[28:31], v[16:19], a[88:95], v2
    s_waitcnt lgkmcnt(6)
    v_smfmac_f32_16x16x64_bf16 v[32:35], v[16:19], v[48:55], v2
    ds_read_b128 v[16:19], v1 offset:8704
    v_smfmac_f32_16x16x64_bf16 v[28:31], v[20:23], a[96:103], v2
    s_waitcnt lgkmcnt(5)
    v_smfmac_f32_16x16x64_bf16 v[32:35], v[20:23], v[40:47], v2
    ds_read_b128 v[40:43], v3 offset:14336
    ds_read_b128 v[44:47], v3 offset:15360
    ds_read_b128 v[20:23], v1 offset:9216
    s_waitcnt lgkmcnt(7)
    v_smfmac_f32_16x16x64_bf16 v[28:31], v[24:27], a[104:111], v2
    s_waitcnt lgkmcnt(5)
    v_smfmac_f32_16x16x64_bf16 v[32:35], v[24:27], v[56:63], v2
    ds_read_b128 v[24:27], v1 offset:9728
    s_waitcnt lgkmcnt(5)
    v_smfmac_f32_16x16x64_bf16 v[28:31], v[12:15], a[112:119], v2
    v_smfmac_f32_16x16x64_bf16 v[32:35], v[12:15], a[216:223], v2
    s_waitcnt lgkmcnt(4)
    v_smfmac_f32_16x16x64_bf16 v[28:31], v[16:19], a[120:127], v2
    s_waitcnt lgkmcnt(2)
    v_smfmac_f32_16x16x64_bf16 v[32:35], v[16:19], v[40:47], v2
    ds_read_b128 v[56:59], v0 offset:14336
    ds_read_b128 v[60:63], v0 offset:18432
    s_waitcnt lgkmcnt(3)
    v_smfmac_f32_16x16x64_bf16 v[28:31], v[20:23], a[128:135], v2
    s_waitcnt lgkmcnt(2)
    v_smfmac_f32_16x16x64_bf16 v[28:31], v[24:27], a[136:143], v2
    ds_read_b128 v[48:51], v0 offset:15360
    ds_read_b128 v[52:55], v0 offset:19456
    v_smfmac_f32_16x16x64_bf16 v[32:35], v[20:23], a[224:231], v2
    v_smfmac_f32_16x16x64_bf16 v[32:35], v[24:27], a[232:239], v2
    s_nop 3
    v_cmp_u_f32 vcc, v28, v30
    v_cvt_pk_bf16_f32 v28, v28, v30
    v_cvt_pk_bf16_f32 v30, v29, v31
    v_smfmac_f32_16x16x64_bf16 v[36:39], v[12:15], v[160:167], v2
    ds_read_b128 v[12:15], v1 offset:6144
    v_smfmac_f32_16x16x64_bf16 v[36:39], v[16:19], v[168:175], v2
    ds_read_b128 v[16:19], v1 offset:6656
    s_cbranch_vccnz CF0_scan
CF0_scanned:
    v_cvt_pk_bf16_f32 v29, v32, v34
    v_cvt_pk_bf16_f32 v31, v33, v35
    ds_write_b64 v6, v[28:29]
    ds_write_b64 v6, v[30:31] offset:512
    v_smfmac_f32_16x16x64_bf16 v[36:39], v[20:23], v[176:183], v2
    ds_read_b128 v[20:23], v1 offset:7168
    v_smfmac_f32_16x16x64_bf16 v[36:39], v[24:27], v[184:191], v2
    ds_read_b128 v[24:27], v1 offset:7680
    s_waitcnt lgkmcnt(5)
    v_smfmac_f32_16x16x64_bf16 v[36:39], v[12:15], v[128:135], v2
    s_waitcnt lgkmcnt(4)
    v_smfmac_f32_16x16x64_bf16 v[36:39], v[16:19], v[136:143], v2
    s_waitcnt lgkmcnt(2)
    s_barrier
    ds_read_b64_tr_b16 v[28:29], v7 offset:0
    ds_read_b64_tr_b16 v[30:31], v7 offset:512
    s_waitcnt lgkmcnt(3)
    v_smfmac_f32_16x16x64_bf16 v[36:39], v[20:23], v[144:151], v2
    ds_read_b64_tr_b16 v[32:33], v7 offset:1024
    ds_read_b64_tr_b16 v[34:35], v7 offset:1536
    s_waitcnt lgkmcnt(4)
    v_smfmac_f32_16x16x64_bf16 v[36:39], v[24:27], v[152:159], v2
    s_waitcnt lgkmcnt(2)
    v_mfma_f32_16x16x32_bf16 v[12:15], v[56:59], v[28:31], 0
    ds_read_b64_tr_b16 v[40:41], v7 offset:2048
    ds_read_b64_tr_b16 v[42:43], v7 offset:2560
    v_mfma_f32_16x16x32_bf16 v[20:23], v[60:63], v[28:31], 0
    ds_read_b128 v[56:59], v0 offset:16384
    ds_read_b128 v[60:63], v0 offset:20480
    s_waitcnt lgkmcnt(4)
    v_mfma_f32_16x16x32_bf16 v[12:15], v[48:51], v[32:35], v[12:15]
    ds_read_b64_tr_b16 v[44:45], v7 offset:3072
    ds_read_b64_tr_b16 v[46:47], v7 offset:3584
    v_mfma_f32_16x16x32_bf16 v[20:23], v[52:55], v[32:35], v[20:23]
    ds_read_b128 v[48:51], v0 offset:17408
    ds_read_b128 v[52:55], v0 offset:21504
    v_mfma_f32_16x16x32_bf16 v[16:19], v[28:31], v[28:31], 0
    v_mov_b64 v[24:25], s[98:99]
    v_mov_b64 v[26:27], s[98:99]
    v_mfma_f32_16x16x32_bf16 v[16:19], v[32:35], v[32:35], v[16:19]
    s_waitcnt lgkmcnt(4)
    v_mfma_f32_16x16x32_bf16 v[12:15], v[56:59], v[40:43], v[12:15]
    v_mfma_f32_16x16x32_bf16 v[20:23], v[60:63], v[40:43], v[20:23]
    buffer_load_dwordx4 v[56:59], v0, s[4:7], s21 offen sc1
    v_cvt_pk_bf16_f32 v36, v36, v38
    s_waitcnt lgkmcnt(0)
    v_mfma_f32_16x16x32_bf16 v[12:15], v[48:51], v[44:47], v[12:15]
    v_cvt_pk_bf16_f32 v37, v37, v39
    v_mfma_f32_16x16x32_bf16 v[20:23], v[52:55], v[44:47], v[20:23]
    buffer_load_dwordx4 v[60:63], v0, s[4:7], s21 offen offset:1024 sc1
    v_mfma_f32_16x16x32_bf16 v[16:19], v[40:43], v[40:43], v[16:19]
    v_mov_b32 v53, 0
    v_mov_b32 v54, 0
    v_mfma_f32_16x16x32_bf16 v[16:19], v[44:47], v[44:47], v[16:19]
    s_nop 0
    v_max3_f32 v11, v12, v13, v14
    s_nop 0
    v_max3_f32 v10, v15, v20, v21
    v_max3_f32 v11, v11, v22, v23
    v_max_f32 v11, v11, v10
    buffer_load_dwordx4 v[28:31], v0, s[4:7], s36 offen offset:2048
    s_nop 0
    v_max3_f32 v10, v11, v18, v19
    v_max3_f32 v11, v11, v18, v19
    s_nop 1
    v_permlane32_swap_b32 v10, v11
    v_max_f32 v16, v10, v11
    v_max_f32 v10, v10, v11
    buffer_load_dwordx4 v[32:35], v0, s[4:7], s36 offen offset:3072
    s_nop 0
    v_permlane16_swap_b32 v10, v16
    v_max_f32 v10, v10, v16
    v_mul_f32 v10, s33, v10
    v_pk_fma_f32 v[12:13], v[12:13], s[96:97], v[10:11] op_sel_hi:[1,1,0] neg_lo:[0,0,1] neg_hi:[0,0,1]
    v_pk_fma_f32 v[14:15], v[14:15], s[96:97], v[10:11] op_sel_hi:[1,1,0] neg_lo:[0,0,1] neg_hi:[0,0,1]
    v_pk_fma_f32 v[20:21], v[20:21], s[96:97], v[10:11] op_sel_hi:[1,1,0] neg_lo:[0,0,1] neg_hi:[0,0,1]
    v_pk_fma_f32 v[22:23], v[22:23], s[96:97], v[10:11] op_sel_hi:[1,1,0] neg_lo:[0,0,1] neg_hi:[0,0,1]
    v_pk_fma_f32 v[18:19], v[18:19], s[96:97], v[10:11] op_sel_hi:[1,1,0] neg_lo:[0,0,1] neg_hi:[0,0,1]
    v_exp_f32 v12, v12
    v_exp_f32 v13, v13
    v_exp_f32 v14, v14
    v_cvt_pk_bf16_f32 v48, v12, v13
    v_exp_f32 v15, v15
    v_exp_f32 v20, v20
    v_cvt_pk_bf16_f32 v49, v14, v15
    v_exp_f32 v21, v21
    v_exp_f32 v22, v22
    v_cvt_pk_bf16_f32 v50, v20, v21
    v_exp_f32 v23, v23
    v_exp_f32 v18, v18
    v_cvt_pk_bf16_f32 v51, v22, v23
    v_exp_f32 v19, v19
    s_nop 0
    v_mfma_f32_16x16x32_bf16 v[20:23], v[24:27], v[48:51], 0
    v_cvt_pk_bf16_f32 v52, v18, v19
    v_cvt_pk_bf16_f32 v55, v18, v19
    s_waitcnt vmcnt(2)
    v_mfma_f32_16x16x32_bf16 v[12:15], v[60:63], v[48:51], 0
    buffer_load_dwordx4 v[40:43], v0, s[4:7], s37 offen offset:0
    s_nop 0
    v_mfma_f32_16x16x16_bf16 v[20:23], v[24:25], v[52:53], v[20:23]
    buffer_load_dwordx4 v[44:47], v0, s[4:7], s37 offen offset:1024
    v_mfma_f32_16x16x32_bf16 v[24:27], v[56:59], v[48:51], 0
    ds_read_b128 v[56:59], v3 offset:18432
    ds_read_b128 v[60:63], v3 offset:19456
    v_mfma_f32_16x16x16_bf16 v[12:15], v[36:37], v[54:55], v[12:15]
    s_nop 2
    v_rcp_f32 v10, v20
    v_mfma_f32_16x16x16_bf16 v[24:27], v[36:37], v[52:53], v[24:27]
    s_add_u32 s14, s14, 1
    s_add_u32 s21, s21, 262144
    s_mov_b32 m0, 0
    s_add_u32 s35, s35, 262144
    s_add_u32 s20, s20, 262144
    s_add_u32 s47, s47, 262144
    s_add_u32 s48, s48, 262144
    v_pk_mul_f32 v[12:13], v[12:13], v[10:11] op_sel_hi:[1,0]
    v_pk_mul_f32 v[14:15], v[14:15], v[10:11] op_sel_hi:[1,0]
    v_pk_mul_f32 v[24:25], v[24:25], v[10:11] op_sel_hi:[1,0]
    v_cvt_pk_bf16_f32 v48, v24, v12
    v_cvt_pk_bf16_f32 v49, v25, v13
    v_pk_mul_f32 v[26:27], v[26:27], v[10:11] op_sel_hi:[1,0]
    v_cvt_pk_bf16_f32 v50, v26, v14
    v_cvt_pk_bf16_f32 v51, v27, v15
    ds_write_b128 v8, v[48:51]
    v_mov_b64 v[36:37], 0
    v_mov_b64 v[38:39], 0
    s_waitcnt lgkmcnt(0)
    buffer_load_dwordx4 v[48:51], v0, s[4:7], s37 offen offset:2048
    buffer_load_dwordx4 v[52:55], v0, s[4:7], s37 offen offset:3072
    s_barrier
    ds_read_b128 v[12:15], v1 offset:0
    ds_read_b128 v[16:19], v1 offset:512
    ds_read_b128 v[20:23], v1 offset:1024
    ds_read_b128 v[24:27], v1 offset:1536
    s_waitcnt lgkmcnt(3)
    s_waitcnt vmcnt(4)
    v_smfmac_f32_16x16x64_bf16 v[36:39], v[12:15], v[28:35], v2
    s_waitcnt lgkmcnt(2)
    s_waitcnt vmcnt(2)
    v_smfmac_f32_16x16x64_bf16 v[36:39], v[16:19], v[40:47], v2
    buffer_load_dwordx4 v[40:43], v0, s[4:7], s38 offen offset:0
    v_mov_b64 v[28:29], 0
    s_waitcnt lgkmcnt(1)
    v_smfmac_f32_16x16x64_bf16 v[36:39], v[20:23], v[56:63], v2
    ds_read_b128 v[56:59], v3 offset:20480
    ds_read_b128 v[60:63], v3 offset:21504
    v_mov_b64 v[30:31], 0
    s_waitcnt lgkmcnt(2)
    v_smfmac_f32_16x16x64_bf16 v[36:39], v[24:27], v[192:199], v2
    buffer_load_dwordx4 v[44:47], v0, s[4:7], s38 offen offset:1024
    v_mov_b64 v[32:33], 0
    v_smfmac_f32_16x16x64_bf16 v[28:31], v[12:15], v[200:207], v2
    v_mov_b64 v[34:35], 0
    v_smfmac_f32_16x16x64_bf16 v[28:31], v[16:19], v[208:215], v2
    s_nop 2
    v_cvt_pk_bf16_f32 v36, v36, v37
    s_waitcnt lgkmcnt(0)
    v_smfmac_f32_16x16x64_bf16 v[28:31], v[20:23], v[56:63], v2
    ds_read_b128 v[56:59], v3 offset:22528
    ds_read_b128 v[60:63], v3 offset:23552
    v_cvt_pk_bf16_f32 v37, v38, v39
    v_smfmac_f32_16x16x64_bf16 v[28:31], v[24:27], v[216:223], v2
    v_and_or_b32 v36, v36, -2, s18
    v_smfmac_f32_16x16x64_bf16 v[32:35], v[12:15], v[224:231], v2
    s_waitcnt vmcnt(2)
    v_smfmac_f32_16x16x64_bf16 v[32:35], v[16:19], v[48:55], v2
    ds_read_b128 v[48:51], v3 offset:24576
    ds_read_b128 v[52:55], v3 offset:25600
    s_nop 1
    v_cvt_pk_bf16_f32 v38, v28, v29
    v_cvt_pk_bf16_f32 v39, v30, v31
    buffer_store_dwordx4 v[36:39], v0, s[4:7], s25 offen
    s_waitcnt lgkmcnt(2)
    v_smfmac_f32_16x16x64_bf16 v[32:35], v[20:23], v[56:63], v2
    ds_read_b128 v[56:59], v3 offset:26624
    ds_read_b128 v[60:63], v3 offset:27648
    v_mov_b64 v[36:37], 0
    v_mov_b64 v[38:39], 0
    v_smfmac_f32_16x16x64_bf16 v[32:35], v[24:27], v[232:239], v2
    s_waitcnt lgkmcnt(2)
    v_smfmac_f32_16x16x64_bf16 v[36:39], v[12:15], v[48:55], v2
    ds_read_b128 v[48:51], v3 offset:28672
    ds_read_b128 v[52:55], v3 offset:29696
    v_mov_b64 v[28:29], 0
    s_waitcnt lgkmcnt(2)
    v_smfmac_f32_16x16x64_bf16 v[36:39], v[16:19], v[56:63], v2
    ds_read_b128 v[56:59], v3 offset:30720
    ds_read_b128 v[60:63], v3 offset:31744
    v_mov_b64 v[30:31], 0
    v_cvt_pk_bf16_f32 v32, v32, v33
    v_smfmac_f32_16x16x64_bf16 v[36:39], v[20:23], v[240:247], v2
    v_cvt_pk_bf16_f32 v33, v34, v35
    s_waitcnt lgkmcnt(2)
    v_smfmac_f32_16x16x64_bf16 v[36:39], v[24:27], v[48:55], v2
    ds_read_b128 v[48:51], v3 offset:32768
    ds_read_b128 v[52:55], v3 offset:33792
    v_and_or_b32 v32, v32, -2, s18
    s_waitcnt lgkmcnt(2)
    v_smfmac_f32_16x16x64_bf16 v[28:31], v[12:15], v[56:63], v2
    v_smfmac_f32_16x16x64_bf16 v[28:31], v[16:19], v[248:255], v2
    s_nop 1
    v_cvt_pk_bf16_f32 v34, v36, v37
    v_cvt_pk_bf16_f32 v35, v38, v39
    buffer_store_dwordx4 v[32:35], v0, s[4:7], s26 offen
    s_waitcnt lgkmcnt(0)
    v_smfmac_f32_16x16x64_bf16 v[28:31], v[20:23], v[48:55], v2
    s_waitcnt vmcnt(2)
    v_smfmac_f32_16x16x64_bf16 v[28:31], v[24:27], v[40:47], v2
    v_and_b32 v16, 0xff, v0
    ds_read_b128 v[12:15], v16 offset:22528
    s_nop 5
    v_cvt_pk_bf16_f32 v28, v28, v29
    v_cvt_pk_bf16_f32 v29, v30, v31
    v_and_or_b32 v28, v28, -2, s18
    buffer_store_dwordx2 v[28:29], v9, s[4:7], s27 offen
    v_mov_b32 v20, s14
    v_lshlrev_b32 v21, 4, v0
    v_mov_b32 v22, -1
    v_mov_b64 v[28:29], 0
    v_mov_b64 v[30:31], 0
    v_mov_b64 v[32:33], 0
    v_mov_b64 v[34:35], 0
    v_mov_b64 v[36:37], 0
    v_mov_b64 v[38:39], 0
    v_bfe_u32 v23, v0, 2, 5
    ds_read_b128 v[40:43], v3 offset:0
    ds_read_b128 v[44:47], v3 offset:1024
    s_waitcnt lgkmcnt(0)
    s_waitcnt vmcnt(2)
    buffer_load_dwordx4 v[48:51], v4, s[4:7], s28 offen sc1
    buffer_load_dwordx4 v[52:55], v4, s[4:7], s29 offen sc1
    buffer_load_dwordx4 v[56:59], v4, s[4:7], s30 offen sc1
    buffer_load_dwordx4 v[60:63], v4, s[4:7], s31 offen sc1
CF0_red:
    s_waitcnt vmcnt(3)
    v_mfma_f32_16x16x32_bf16 v[16:19], v[12:15], v[48:51], 0
    s_waitcnt vmcnt(2)
    v_mfma_f32_16x16x32_bf16 v[16:19], v[12:15], v[52:55], v[16:19]
    v_bitop3_b32 v10, v48, v52, s19 bitop3:0x7e
    s_waitcnt vmcnt(1)
    v_mfma_f32_16x16x32_bf16 v[16:19], v[12:15], v[56:59], v[16:19]
    s_waitcnt vmcnt(0)
    v_bitop3_b32 v11, v56, v60, s19 bitop3:0x7e
    v_bitop3_b32 v10, v10, v11, 1 bitop3:0xa8
    v_cmp_ne_u32 vcc, 0, v10
    v_mfma_f32_16x16x32_bf16 v[16:19], v[12:15], v[60:63], v[16:19]
    s_cmp_eq_u32 s14, 63
    s_cbranch_vccnz CF0_redo
    s_nop 5
    v_add_f32_dpp v16, v16, v16 row_ror:8 row_mask:0xf bank_mask:0xf
    v_add_f32_dpp v17, v17, v17 row_ror:8 row_mask:0xf bank_mask:0xf
    v_add_f32_dpp v18, v18, v18 row_ror:8 row_mask:0xf bank_mask:0xf
    v_add_f32_dpp v19, v19, v19 row_ror:8 row_mask:0xf bank_mask:0xf
    v_cvt_pk_bf16_f32 v10, v16, v17
    v_cvt_pk_bf16_f32 v11, v18, v19
    v_min_u32 v10, s34, v10
    s_cbranch_scc1 CF0_last
    buffer_store_dwordx2 v[10:11], v5, s[4:7], s16 offen
    buffer_store_byte v20, v21, s[8:11], s46 offen
    buffer_store_dword v22, v5, s[4:7], s17 offen
    ds_read_b128 v[48:51], v3 offset:2048
    ds_read_b128 v[52:55], v3 offset:3072
    s_add_u32 s15, s16, 0
    s_add_u32 s39, s39, 0x01010101
    s_add_u32 s16, s16, 16384
    s_and_b32 s16, s16, 0xffff
    s_or_b32 s16, s16, 65536
    s_add_u32 s17, s17, 16384
    s_and_b32 s17, s17, 0xffff
    s_or_b32 s17, s17, 65536
    s_xor_b32 s18, s18, 1
    s_not_b32 s19, s19
    buffer_load_dword v10, v23, s[4:7], s49 offen sc1
    buffer_load_dword v10, v23, s[4:7], s49 offen sc1
    buffer_load_dword v10, v23, s[4:7], s49 offen sc1
    buffer_load_dword v10, v23, s[4:7], s49 offen sc1
    buffer_load_dword v10, v23, s[4:7], s49 offen sc1
CF0_m0:
    s_waitcnt vmcnt(4)
    v_cmp_ne_u32 vcc, s39, v10
    buffer_load_dword v10, v23, s[4:7], s49 offen sc1
    s_cbranch_vccz CF0_m0ok
    s_waitcnt vmcnt(4)
    v_cmp_ne_u32 vcc, s39, v10
    buffer_load_dword v10, v23, s[4:7], s49 offen sc1
    s_cbranch_vccz CF0_m0ok
    s_waitcnt vmcnt(4)
    v_cmp_ne_u32 vcc, s39, v10
    buffer_load_dword v10, v23, s[4:7], s49 offen sc1
    s_cbranch_vccz CF0_m0ok
    s_waitcnt vmcnt(4)
    v_cmp_ne_u32 vcc, s39, v10
    buffer_load_dword v10, v23, s[4:7], s49 offen sc1
    s_cbranch_vccz CF0_m0ok
    s_add_u32 s32, s32, 1
    s_cmp_gt_u32 s32, 0x40000
    s_cbranch_scc1 L_abort
    s_branch CF0_m0
CF0_m0ok:
    buffer_load_dwordx4 v0, s[4:7], s15 offen offset:0 sc1 lds
    buffer_load_dwordx4 v0, s[4:7], s15 offen offset:1024 sc1 lds
    buffer_load_dwordx4 v0, s[4:7], s15 offen offset:2048 sc1 lds
    buffer_load_dwordx4 v0, s[4:7], s15 offen offset:3072 sc1 lds
    s_barrier
    buffer_load_dwordx4 v[56:59], v0, s[4:7], s24 offen offset:2048
    buffer_load_dwordx4 v[60:63], v0, s[4:7], s24 offen offset:3072
    s_waitcnt lgkmcnt(0)
    s_branch CF0_pretop
CF0_redo:
    s_mov_b64 exec, vcc
CF0_redo2:
    buffer_load_dwordx4 v[48:51], v4, s[4:7], s28 offen sc1
    buffer_load_dwordx4 v[52:55], v4, s[4:7], s29 offen sc1
    buffer_load_dwordx4 v[56:59], v4, s[4:7], s30 offen sc1
    buffer_load_dwordx4 v[60:63], v4, s[4:7], s31 offen sc1
    s_add_u32 s32, s32, 1
    s_cmp_gt_u32 s32, 0x40000
    s_cbranch_scc1 L_abort
    s_waitcnt vmcnt(0)
    v_bitop3_b32 v10, v48, v52, s19 bitop3:0x7e
    v_bitop3_b32 v11, v56, v60, s19 bitop3:0x7e
    v_bitop3_b32 v10, v10, v11, 1 bitop3:0xa8
    v_cmp_ne_u32 vcc, 0, v10
    s_cbranch_vccnz CF0_redo2
    s_mov_b64 exec, -1
    s_nop 1
    s_branch CF0_red
CF0_last:
    s_mov_b32 s42, 4855808
    buffer_store_dwordx2 v[10:11], v5, s[4:7], s42 offen sc1
    s_branch CF0_done
CF0_scan:
    v_mov_b32 v10, 0
    ds_read_b32 v11, v0 offset:0
    s_waitcnt lgkmcnt(0)
    v_max_u32 v10, v10, v11
    ds_read_b32 v11, v0 offset:1024
    s_waitcnt lgkmcnt(0)
    v_max_u32 v10, v10, v11
    ds_read_b32 v11, v0 offset:2048
    s_waitcnt lgkmcnt(0)
    v_max_u32 v10, v10, v11
    ds_read_b32 v11, v0 offset:3072
    s_waitcnt lgkmcnt(0)
    v_max_u32 v10, v10, v11
    ds_read_b32 v11, v0 offset:4096
    s_waitcnt lgkmcnt(0)
    v_max_u32 v10, v10, v11
    ds_read_b32 v11, v0 offset:5120
    s_waitcnt lgkmcnt(0)
    v_max_u32 v10, v10, v11
    ds_read_b32 v11, v0 offset:6144
    s_waitcnt lgkmcnt(0)
    v_max_u32 v10, v10, v11
    ds_read_b32 v11, v0 offset:7168
    s_waitcnt lgkmcnt(0)
    v_max_u32 v10, v10, v11
    ds_read_b32 v11, v0 offset:8192
    s_waitcnt lgkmcnt(0)
    v_max_u32 v10, v10, v11
    ds_read_b32 v11, v0 offset:9216
    s_waitcnt lgkmcnt(0)
    v_max_u32 v10, v10, v11
    v_cmp_eq_u32 vcc, -1, v10
    s_cbranch_vccnz CF0_rec
    s_branch CF0_scanned
CF0_done:
    s_waitcnt vmcnt(0) lgkmcnt(0)
    s_endpgm
CF_w1:
    v_lshlrev_b32 v11, 3, v0
    s_mov_b32 s42, 65536
    buffer_load_dwordx2 v[12:13], v5, s[4:7], s42 offen sc1
    s_mov_b32 s42, 81920
    buffer_load_dwordx2 v[12:13], v5, s[4:7], s42 offen sc1
    s_mov_b32 s42, 98304
    buffer_load_dwordx2 v[12:13], v5, s[4:7], s42 offen sc1
    s_mov_b32 s42, 114688
    buffer_load_dwordx2 v[12:13], v5, s[4:7], s42 offen sc1
CF1_rec:
    s_waitcnt vmcnt(0) lgkmcnt(0)
    s_add_u32 s32, s32, 1
    s_cmp_gt_u32 s32, 0x40000
    s_cbranch_scc1 L_abort
    s_barrier
    ds_read_b128 v[40:43], v3 offset:0
    ds_read_b128 v[44:47], v3 offset:1024
    ds_read_b128 v[48:51], v3 offset:2048
    ds_read_b128 v[52:55], v3 offset:3072
    s_mov_b32 m0, 4096
    v_bfe_u32 v11, v0, 2, 5
    buffer_load_dword v11, v11, s[4:7], s49 offen sc1
    buffer_load_dwordx4 v0, s[4:7], s15 offen offset:0 sc1 lds
    buffer_load_dwordx4 v0, s[4:7], s15 offen offset:1024 sc1 lds
    buffer_load_dwordx4 v0, s[4:7], s15 offen offset:2048 sc1 lds
    buffer_load_dwordx4 v0, s[4:7], s15 offen offset:3072 sc1 lds
    buffer_load_dwordx4 v[56:59], v0, s[4:7], s24 offen offset:2048
    buffer_load_dwordx4 v[60:63], v0, s[4:7], s24 offen offset:3072
    v_mov_b64 v[28:29], 0
    v_mov_b64 v[30:31], 0
    v_mov_b64 v[32:33], 0
    v_mov_b64 v[34:35], 0
    v_mov_b64 v[36:37], 0
    v_mov_b64 v[38:39], 0
    s_waitcnt vmcnt(0) lgkmcnt(0)
    s_branch HZ_CF1_top
.p2align 6
HZ_CF1_top:
    s_barrier
    ds_read_b128 v[12:15], v1 offset:0
    ds_read_b128 v[16:19], v1 offset:512
    ds_read_b128 v[20:23], v1 offset:1024
    ds_read_b128 v[24:27], v1 offset:1536
    s_waitcnt lgkmcnt(3)
    v_smfmac_f32_16x16x64_bf16 v[28:31], v[12:15], v[40:47], v2
    v_smfmac_f32_16x16x64_bf16 v[32:35], v[12:15], v[48:55], v2
    v_smfmac_f32_16x16x64_bf16 v[36:39], v[12:15], a[240:247], v2
    s_barrier
    ds_read_b128 v[12:15], v1 offset:2048
    buffer_load_dwordx4 v[40:43], v0, s[4:7], s36 offen offset:0
    s_waitcnt lgkmcnt(3)
    v_smfmac_f32_16x16x64_bf16 v[28:31], v[16:19], a[0:7], v2
    buffer_load_dwordx4 v[44:47], v0, s[4:7], s36 offen offset:1024
    v_smfmac_f32_16x16x64_bf16 v[32:35], v[16:19], a[144:151], v2
    buffer_load_dwordx4 v[48:51], v0, s[4:7], s24 offen offset:0
    v_smfmac_f32_16x16x64_bf16 v[36:39], v[16:19], a[248:255], v2
    ds_read_b128 v[16:19], v1 offset:2560
    buffer_load_dwordx4 v[52:55], v0, s[4:7], s24 offen offset:1024
    s_waitcnt lgkmcnt(3)
    v_smfmac_f32_16x16x64_bf16 v[28:31], v[20:23], a[8:15], v2
    v_smfmac_f32_16x16x64_bf16 v[32:35], v[20:23], a[152:159], v2
    v_smfmac_f32_16x16x64_bf16 v[36:39], v[20:23], v[64:71], v2
    ds_read_b128 v[20:23], v1 offset:3072
    s_waitcnt lgkmcnt(3)
    v_smfmac_f32_16x16x64_bf16 v[28:31], v[24:27], a[16:23], v2
    s_waitcnt vmcnt(10)
    v_cmp_ne_u32 vcc, s39, v11
    v_smfmac_f32_16x16x64_bf16 v[32:35], v[24:27], a[160:167], v2
    s_cbranch_vccnz CF1_mr
    s_waitcnt vmcnt(6)
CF1_mok:
    s_barrier
    v_smfmac_f32_16x16x64_bf16 v[36:39], v[24:27], v[72:79], v2
    ds_read_b128 v[24:27], v1 offset:3584
    s_waitcnt lgkmcnt(3)
    v_smfmac_f32_16x16x64_bf16 v[28:31], v[12:15], a[24:31], v2
    v_smfmac_f32_16x16x64_bf16 v[32:35], v[12:15], a[168:175], v2
    v_smfmac_f32_16x16x64_bf16 v[36:39], v[12:15], v[80:87], v2
    ds_read_b128 v[12:15], v1 offset:4096
    s_waitcnt lgkmcnt(3)
    v_smfmac_f32_16x16x64_bf16 v[28:31], v[16:19], a[32:39], v2
    v_smfmac_f32_16x16x64_bf16 v[32:35], v[16:19], a[176:183], v2
    v_smfmac_f32_16x16x64_bf16 v[36:39], v[16:19], v[88:95], v2
    ds_read_b128 v[16:19], v1 offset:4608
    s_waitcnt lgkmcnt(3)
    v_smfmac_f32_16x16x64_bf16 v[28:31], v[20:23], a[40:47], v2
    v_smfmac_f32_16x16x64_bf16 v[32:35], v[20:23], a[184:191], v2
    v_smfmac_f32_16x16x64_bf16 v[36:39], v[20:23], v[96:103], v2
    ds_read_b128 v[20:23], v1 offset:5120
    s_waitcnt lgkmcnt(3)
    v_smfmac_f32_16x16x64_bf16 v[28:31], v[24:27], a[48:55], v2
    v_smfmac_f32_16x16x64_bf16 v[32:35], v[24:27], a[192:199], v2
    v_smfmac_f32_16x16x64_bf16 v[36:39], v[24:27], v[104:111], v2
    ds_read_b128 v[24:27], v1 offset:5632
    s_waitcnt lgkmcnt(3)
    v_smfmac_f32_16x16x64_bf16 v[28:31], v[12:15], a[56:63], v2
    s_waitcnt vmcnt(4)
    v_smfmac_f32_16x16x64_bf16 v[32:35], v[12:15], v[56:63], v2
    ds_read_b128 v[56:59], v3 offset:4096
    ds_read_b128 v[60:63], v3 offset:5120
    v_smfmac_f32_16x16x64_bf16 v[36:39], v[12:15], v[112:119], v2
    ds_read_b128 v[12:15], v1 offset:6144
    s_waitcnt lgkmcnt(5)
    v_smfmac_f32_16x16x64_bf16 v[28:31], v[16:19], a[64:71], v2
    v_smfmac_f32_16x16x64_bf16 v[32:35], v[16:19], a[200:207], v2
    s_waitcnt vmcnt(2)
    v_smfmac_f32_16x16x64_bf16 v[36:39], v[16:19], v[40:47], v2
    ds_read_b128 v[40:43], v3 offset:16384
    ds_read_b128 v[44:47], v3 offset:17408
    ds_read_b128 v[16:19], v1 offset:6656
    s_waitcnt lgkmcnt(7)
    v_smfmac_f32_16x16x64_bf16 v[28:31], v[20:23], a[72:79], v2
    s_waitcnt lgkmcnt(4)
    v_smfmac_f32_16x16x64_bf16 v[32:35], v[20:23], v[56:63], v2
    ds_read_b128 v[56:59], v3 offset:6144
    ds_read_b128 v[60:63], v3 offset:7168
    v_smfmac_f32_16x16x64_bf16 v[36:39], v[20:23], v[120:127], v2
    ds_read_b128 v[20:23], v1 offset:7168
    s_waitcnt vmcnt(0)
    v_smfmac_f32_16x16x64_bf16 v[28:31], v[24:27], v[48:55], v2
    ds_read_b128 v[48:51], v3 offset:8192
    ds_read_b128 v[52:55], v3 offset:9216
    v_smfmac_f32_16x16x64_bf16 v[32:35], v[24:27], a[208:215], v2
    s_waitcnt lgkmcnt(6)
    v_smfmac_f32_16x16x64_bf16 v[36:39], v[24:27], v[40:47], v2
    ds_read_b128 v[40:43], v3 offset:10240
    ds_read_b128 v[44:47], v3 offset:11264
    ds_read_b128 v[24:27], v1 offset:7680
    s_barrier
    v_smfmac_f32_16x16x64_bf16 v[28:31], v[12:15], a[80:87], v2
    s_waitcnt lgkmcnt(6)
    v_smfmac_f32_16x16x64_bf16 v[32:35], v[12:15], v[56:63], v2
    ds_read_b128 v[56:59], v3 offset:12288
    ds_read_b128 v[60:63], v3 offset:13312
    ds_read_b128 v[12:15], v1 offset:8192
    v_smfmac_f32_16x16x64_bf16 v[28:31], v[16:19], a[88:95], v2
    s_waitcnt lgkmcnt(6)
    v_smfmac_f32_16x16x64_bf16 v[32:35], v[16:19], v[48:55], v2
    ds_read_b128 v[16:19], v1 offset:8704
    v_smfmac_f32_16x16x64_bf16 v[28:31], v[20:23], a[96:103], v2
    s_waitcnt lgkmcnt(5)
    v_smfmac_f32_16x16x64_bf16 v[32:35], v[20:23], v[40:47], v2
    ds_read_b128 v[40:43], v3 offset:14336
    ds_read_b128 v[44:47], v3 offset:15360
    ds_read_b128 v[20:23], v1 offset:9216
    s_waitcnt lgkmcnt(7)
    v_smfmac_f32_16x16x64_bf16 v[28:31], v[24:27], a[104:111], v2
    s_waitcnt lgkmcnt(5)
    v_smfmac_f32_16x16x64_bf16 v[32:35], v[24:27], v[56:63], v2
    ds_read_b128 v[24:27], v1 offset:9728
    s_waitcnt lgkmcnt(5)
    v_smfmac_f32_16x16x64_bf16 v[28:31], v[12:15], a[112:119], v2
    v_smfmac_f32_16x16x64_bf16 v[32:35], v[12:15], a[216:223], v2
    s_waitcnt lgkmcnt(4)
    v_smfmac_f32_16x16x64_bf16 v[28:31], v[16:19], a[120:127], v2
    s_waitcnt lgkmcnt(2)
    v_smfmac_f32_16x16x64_bf16 v[32:35], v[16:19], v[40:47], v2
    ds_read_b128 v[56:59], v0 offset:14336
    ds_read_b128 v[60:63], v0 offset:18432
    s_waitcnt lgkmcnt(3)
    v_smfmac_f32_16x16x64_bf16 v[28:31], v[20:23], a[128:135], v2
    s_waitcnt lgkmcnt(2)
    v_smfmac_f32_16x16x64_bf16 v[28:31], v[24:27], a[136:143], v2
    ds_read_b128 v[48:51], v0 offset:15360
    ds_read_b128 v[52:55], v0 offset:19456
    v_smfmac_f32_16x16x64_bf16 v[32:35], v[20:23], a[224:231], v2
    v_smfmac_f32_16x16x64_bf16 v[32:35], v[24:27], a[232:239], v2
    s_nop 3
    v_cmp_u_f32 vcc, v28, v30
    v_cvt_pk_bf16_f32 v28, v28, v30
    v_cvt_pk_bf16_f32 v30, v29, v31
    v_smfmac_f32_16x16x64_bf16 v[36:39], v[12:15], v[160:167], v2
    ds_read_b128 v[12:15], v1 offset:6144
    v_smfmac_f32_16x16x64_bf16 v[36:39], v[16:19], v[168:175], v2
    ds_read_b128 v[16:19], v1 offset:6656
    s_cbranch_vccnz CF1_scan
CF1_scanned:
    v_cvt_pk_bf16_f32 v29, v32, v34
    v_cvt_pk_bf16_f32 v31, v33, v35
    ds_write_b64 v6, v[28:29]
    ds_write_b64 v6, v[30:31] offset:512
    v_smfmac_f32_16x16x64_bf16 v[36:39], v[20:23], v[176:183], v2
    ds_read_b128 v[20:23], v1 offset:7168
    v_smfmac_f32_16x16x64_bf16 v[36:39], v[24:27], v[184:191], v2
    ds_read_b128 v[24:27], v1 offset:7680
    s_waitcnt lgkmcnt(5)
    v_smfmac_f32_16x16x64_bf16 v[36:39], v[12:15], v[128:135], v2
    s_waitcnt lgkmcnt(4)
    v_smfmac_f32_16x16x64_bf16 v[36:39], v[16:19], v[136:143], v2
    s_waitcnt lgkmcnt(2)
    s_barrier
    ds_read_b64_tr_b16 v[28:29], v7 offset:0
    ds_read_b64_tr_b16 v[30:31], v7 offset:512
    s_waitcnt lgkmcnt(3)
    v_smfmac_f32_16x16x64_bf16 v[36:39], v[20:23], v[144:151], v2
    ds_read_b64_tr_b16 v[32:33], v7 offset:1024
    ds_read_b64_tr_b16 v[34:35], v7 offset:1536
    s_waitcnt lgkmcnt(4)
    v_smfmac_f32_16x16x64_bf16 v[36:39], v[24:27], v[152:159], v2
    s_waitcnt lgkmcnt(2)
    v_mfma_f32_16x16x32_bf16 v[12:15], v[56:59], v[28:31], 0
    ds_read_b64_tr_b16 v[40:41], v7 offset:2048
    ds_read_b64_tr_b16 v[42:43], v7 offset:2560
    v_mfma_f32_16x16x32_bf16 v[20:23], v[60:63], v[28:31], 0
    ds_read_b128 v[56:59], v0 offset:16384
    ds_read_b128 v[60:63], v0 offset:20480
    s_waitcnt lgkmcnt(4)
    v_mfma_f32_16x16x32_bf16 v[12:15], v[48:51], v[32:35], v[12:15]
    ds_read_b64_tr_b16 v[44:45], v7 offset:3072
    ds_read_b64_tr_b16 v[46:47], v7 offset:3584
    v_mfma_f32_16x16x32_bf16 v[20:23], v[52:55], v[32:35], v[20:23]
    ds_read_b128 v[48:51], v0 offset:17408
    ds_read_b128 v[52:55], v0 offset:21504
    v_mfma_f32_16x16x32_bf16 v[16:19], v[28:31], v[28:31], 0
    v_mov_b64 v[24:25], s[98:99]
    v_mov_b64 v[26:27], s[98:99]
    v_mfma_f32_16x16x32_bf16 v[16:19], v[32:35], v[32:35], v[16:19]
    s_waitcnt lgkmcnt(4)
    v_mfma_f32_16x16x32_bf16 v[12:15], v[56:59], v[40:43], v[12:15]
    v_mfma_f32_16x16x32_bf16 v[20:23], v[60:63], v[40:43], v[20:23]
    buffer_load_dwordx4 v[56:59], v0, s[4:7], s21 offen sc1
    v_cvt_pk_bf16_f32 v36, v36, v38
    s_waitcnt lgkmcnt(0)
    v_mfma_f32_16x16x32_bf16 v[12:15], v[48:51], v[44:47], v[12:15]
    v_cvt_pk_bf16_f32 v37, v37, v39
    v_mfma_f32_16x16x32_bf16 v[20:23], v[52:55], v[44:47], v[20:23]
    buffer_load_dwordx4 v[60:63], v0, s[4:7], s21 offen offset:1024 sc1
    v_mfma_f32_16x16x32_bf16 v[16:19], v[40:43], v[40:43], v[16:19]
    v_mov_b32 v53, 0
    v_mov_b32 v54, 0
    v_mfma_f32_16x16x32_bf16 v[16:19], v[44:47], v[44:47], v[16:19]
    s_nop 0
    v_max3_f32 v11, v12, v13, v14
    s_nop 0
    v_max3_f32 v10, v15, v20, v21
    v_max3_f32 v11, v11, v22, v23
    v_max_f32 v11, v11, v10
    buffer_load_dwordx4 v[28:31], v0, s[4:7], s36 offen offset:2048
    s_nop 0
    v_max3_f32 v10, v11, v18, v19
    v_max3_f32 v11, v11, v18, v19
    s_nop 1
    v_permlane32_swap_b32 v10, v11
    v_max_f32 v16, v10, v11
    v_max_f32 v10, v10, v11
    buffer_load_dwordx4 v[32:35], v0, s[4:7], s36 offen offset:3072
    s_nop 0
    v_permlane16_swap_b32 v10, v16
    v_max_f32 v10, v10, v16
    v_mul_f32 v10, s33, v10
    v_pk_fma_f32 v[12:13], v[12:13], s[96:97], v[10:11] op_sel_hi:[1,1,0] neg_lo:[0,0,1] neg_hi:[0,0,1]
    v_pk_fma_f32 v[14:15], v[14:15], s[96:97], v[10:11] op_sel_hi:[1,1,0] neg_lo:[0,0,1] neg_hi:[0,0,1]
    v_pk_fma_f32 v[20:21], v[20:21], s[96:97], v[10:11] op_sel_hi:[1,1,0] neg_lo:[0,0,1] neg_hi:[0,0,1]
    v_pk_fma_f32 v[22:23], v[22:23], s[96:97], v[10:11] op_sel_hi:[1,1,0] neg_lo:[0,0,1] neg_hi:[0,0,1]
    v_pk_fma_f32 v[18:19], v[18:19], s[96:97], v[10:11] op_sel_hi:[1,1,0] neg_lo:[0,0,1] neg_hi:[0,0,1]
    v_exp_f32 v12, v12
    v_exp_f32 v13, v13
    v_exp_f32 v14, v14
    v_cvt_pk_bf16_f32 v48, v12, v13
    v_exp_f32 v15, v15
    v_exp_f32 v20, v20
    v_cvt_pk_bf16_f32 v49, v14, v15
    v_exp_f32 v21, v21
    v_exp_f32 v22, v22
    v_cvt_pk_bf16_f32 v50, v20, v21
    v_exp_f32 v23, v23
    v_exp_f32 v18, v18
    v_cvt_pk_bf16_f32 v51, v22, v23
    v_exp_f32 v19, v19
    s_nop 0
    v_mfma_f32_16x16x32_bf16 v[20:23], v[24:27], v[48:51], 0
    v_cvt_pk_bf16_f32 v52, v18, v19
    v_cvt_pk_bf16_f32 v55, v18, v19
    s_waitcnt vmcnt(2)
    v_mfma_f32_16x16x32_bf16 v[12:15], v[60:63], v[48:51], 0
    buffer_load_dwordx4 v[40:43], v0, s[4:7], s37 offen offset:0
    s_nop 0
    v_mfma_f32_16x16x16_bf16 v[20:23], v[24:25], v[52:53], v[20:23]
    buffer_load_dwordx4 v[44:47], v0, s[4:7], s37 offen offset:1024
    v_mfma_f32_16x16x32_bf16 v[24:27], v[56:59], v[48:51], 0
    ds_read_b128 v[56:59], v3 offset:18432
    ds_read_b128 v[60:63], v3 offset:19456
    v_mfma_f32_16x16x16_bf16 v[12:15], v[36:37], v[54:55], v[12:15]
    s_nop 2
    v_rcp_f32 v10, v20
    v_mfma_f32_16x16x16_bf16 v[24:27], v[36:37], v[52:53], v[24:27]
    s_add_u32 s14, s14, 1
    s_add_u32 s21, s21, 262144
    s_add_u32 s35, s35, 262144
    s_add_u32 s20, s20, 262144
    v_pk_mul_f32 v[12:13], v[12:13], v[10:11] op_sel_hi:[1,0]
    v_pk_mul_f32 v[14:15], v[14:15], v[10:11] op_sel_hi:[1,0]
    s_nop 1
    v_pk_mul_f32 v[24:25], v[24:25], v[10:11] op_sel_hi:[1,0]
    v_cvt_pk_bf16_f32 v48, v24, v12
    v_cvt_pk_bf16_f32 v49, v25, v13
    v_pk_mul_f32 v[26:27], v[26:27], v[10:11] op_sel_hi:[1,0]
    v_cvt_pk_bf16_f32 v50, v26, v14
    v_cvt_pk_bf16_f32 v51, v27, v15
    ds_write_b128 v8, v[48:51]
    v_mov_b64 v[36:37], 0
    v_mov_b64 v[38:39], 0
    s_waitcnt lgkmcnt(0)
    buffer_load_dwordx4 v[48:51], v0, s[4:7], s37 offen offset:2048
    buffer_load_dwordx4 v[52:55], v0, s[4:7], s37 offen offset:3072
    s_barrier
    ds_read_b128 v[12:15], v1 offset:0
    ds_read_b128 v[16:19], v1 offset:512
    ds_read_b128 v[20:23], v1 offset:1024
    ds_read_b128 v[24:27], v1 offset:1536
    s_waitcnt lgkmcnt(3)
    s_waitcnt vmcnt(4)
    v_smfmac_f32_16x16x64_bf16 v[36:39], v[12:15], v[28:35], v2
    s_waitcnt lgkmcnt(2)
    s_waitcnt vmcnt(2)
    v_smfmac_f32_16x16x64_bf16 v[36:39], v[16:19], v[40:47], v2
    buffer_load_dwordx4 v[40:43], v0, s[4:7], s38 offen offset:0
    v_mov_b64 v[28:29], 0
    s_waitcnt lgkmcnt(1)
    v_smfmac_f32_16x16x64_bf16 v[36:39], v[20:23], v[56:63], v2
    ds_read_b128 v[56:59], v3 offset:20480
    ds_read_b128 v[60:63], v3 offset:21504
    v_mov_b64 v[30:31], 0
    s_waitcnt lgkmcnt(2)
    v_smfmac_f32_16x16x64_bf16 v[36:39], v[24:27], v[192:199], v2
    buffer_load_dwordx4 v[44:47], v0, s[4:7], s38 offen offset:1024
    v_mov_b64 v[32:33], 0
    v_smfmac_f32_16x16x64_bf16 v[28:31], v[12:15], v[200:207], v2
    v_mov_b64 v[34:35], 0
    v_smfmac_f32_16x16x64_bf16 v[28:31], v[16:19], v[208:215], v2
    s_nop 2
    v_cvt_pk_bf16_f32 v36, v36, v37
    s_waitcnt lgkmcnt(0)
    v_smfmac_f32_16x16x64_bf16 v[28:31], v[20:23], v[56:63], v2
    ds_read_b128 v[56:59], v3 offset:22528
    ds_read_b128 v[60:63], v3 offset:23552
    v_cvt_pk_bf16_f32 v37, v38, v39
    v_smfmac_f32_16x16x64_bf16 v[28:31], v[24:27], v[216:223], v2
    v_and_or_b32 v36, v36, -2, s18
    v_smfmac_f32_16x16x64_bf16 v[32:35], v[12:15], v[224:231], v2
    s_waitcnt vmcnt(2)
    v_smfmac_f32_16x16x64_bf16 v[32:35], v[16:19], v[48:55], v2
    ds_read_b128 v[48:51], v3 offset:24576
    ds_read_b128 v[52:55], v3 offset:25600
    s_nop 1
    v_cvt_pk_bf16_f32 v38, v28, v29
    v_cvt_pk_bf16_f32 v39, v30, v31
    buffer_store_dwordx4 v[36:39], v0, s[4:7], s25 offen
    s_waitcnt lgkmcnt(2)
    v_smfmac_f32_16x16x64_bf16 v[32:35], v[20:23], v[56:63], v2
    ds_read_b128 v[56:59], v3 offset:26624
    ds_read_b128 v[60:63], v3 offset:27648
    v_mov_b64 v[36:37], 0
    v_mov_b64 v[38:39], 0
    v_smfmac_f32_16x16x64_bf16 v[32:35], v[24:27], v[232:239], v2
    s_waitcnt lgkmcnt(2)
    v_smfmac_f32_16x16x64_bf16 v[36:39], v[12:15], v[48:55], v2
    ds_read_b128 v[48:51], v3 offset:28672
    ds_read_b128 v[52:55], v3 offset:29696
    v_mov_b64 v[28:29], 0
    s_waitcnt lgkmcnt(2)
    v_smfmac_f32_16x16x64_bf16 v[36:39], v[16:19], v[56:63], v2
    ds_read_b128 v[56:59], v3 offset:30720
    ds_read_b128 v[60:63], v3 offset:31744
    v_mov_b64 v[30:31], 0
    v_cvt_pk_bf16_f32 v32, v32, v33
    v_smfmac_f32_16x16x64_bf16 v[36:39], v[20:23], v[240:247], v2
    v_cvt_pk_bf16_f32 v33, v34, v35
    s_waitcnt lgkmcnt(2)
    v_smfmac_f32_16x16x64_bf16 v[36:39], v[24:27], v[48:55], v2
    ds_read_b128 v[48:51], v3 offset:32768
    ds_read_b128 v[52:55], v3 offset:33792
    v_and_or_b32 v32, v32, -2, s18
    s_waitcnt lgkmcnt(2)
    v_smfmac_f32_16x16x64_bf16 v[28:31], v[12:15], v[56:63], v2
    v_smfmac_f32_16x16x64_bf16 v[28:31], v[16:19], v[248:255], v2
    s_nop 1
    v_cvt_pk_bf16_f32 v34, v36, v37
    v_cvt_pk_bf16_f32 v35, v38, v39
    buffer_store_dwordx4 v[32:35], v0, s[4:7], s26 offen
    s_waitcnt lgkmcnt(0)
    v_smfmac_f32_16x16x64_bf16 v[28:31], v[20:23], v[48:55], v2
    s_waitcnt vmcnt(2)
    v_smfmac_f32_16x16x64_bf16 v[28:31], v[24:27], v[40:47], v2
    v_and_b32 v16, 0xff, v0
    ds_read_b128 v[12:15], v16 offset:22528
    s_nop 5
    v_cvt_pk_bf16_f32 v28, v28, v29
    v_cvt_pk_bf16_f32 v29, v30, v31
    v_and_or_b32 v28, v28, -2, s18
    buffer_store_dwordx2 v[28:29], v9, s[4:7], s27 offen
    v_mov_b32 v20, s14
    v_lshlrev_b32 v21, 4, v0
    v_mov_b32 v22, -1
    v_mov_b64 v[28:29], 0
    v_mov_b64 v[30:31], 0
    v_mov_b64 v[32:33], 0
    v_mov_b64 v[34:35], 0
    v_mov_b64 v[36:37], 0
    v_mov_b64 v[38:39], 0
    s_waitcnt lgkmcnt(0)
    s_waitcnt vmcnt(0)
    buffer_load_dwordx4 v[48:51], v4, s[4:7], s28 offen sc1
    buffer_load_dwordx4 v[52:55], v4, s[4:7], s29 offen sc1
    buffer_load_dwordx4 v[56:59], v4, s[4:7], s30 offen sc1
    buffer_load_dwordx4 v[60:63], v4, s[4:7], s31 offen sc1
CF1_red:
    s_waitcnt vmcnt(3)
    v_mfma_f32_16x16x32_bf16 v[16:19], v[12:15], v[48:51], 0
    s_waitcnt vmcnt(2)
    v_mfma_f32_16x16x32_bf16 v[16:19], v[12:15], v[52:55], v[16:19]
    v_bitop3_b32 v10, v48, v52, s19 bitop3:0x7e
    s_waitcnt vmcnt(1)
    v_mfma_f32_16x16x32_bf16 v[16:19], v[12:15], v[56:59], v[16:19]
    s_waitcnt vmcnt(0)
    v_bitop3_b32 v11, v56, v60, s19 bitop3:0x7e
    v_bitop3_b32 v10, v10, v11, 1 bitop3:0xa8
    v_cmp_ne_u32 vcc, 0, v10
    v_mfma_f32_16x16x32_bf16 v[16:19], v[12:15], v[60:63], v[16:19]
    s_cmp_eq_u32 s14, 63
    s_cbranch_vccnz CF1_redo
    s_nop 5
    v_add_f32_dpp v16, v16, v16 row_ror:8 row_mask:0xf bank_mask:0xf
    v_add_f32_dpp v17, v17, v17 row_ror:8 row_mask:0xf bank_mask:0xf
    v_add_f32_dpp v18, v18, v18 row_ror:8 row_mask:0xf bank_mask:0xf
    v_add_f32_dpp v19, v19, v19 row_ror:8 row_mask:0xf bank_mask:0xf
    v_cvt_pk_bf16_f32 v10, v16, v17
    v_cvt_pk_bf16_f32 v11, v18, v19
    v_min_u32 v10, s34, v10
    s_cbranch_scc1 CF1_last
    buffer_store_dwordx2 v[10:11], v5, s[4:7], s16 offen
    buffer_store_byte v20, v21, s[8:11], s46 offen
    buffer_store_dword v22, v5, s[4:7], s17 offen
    ds_read_b128 v[40:43], v3 offset:0
    ds_read_b128 v[44:47], v3 offset:1024
    ds_read_b128 v[48:51], v3 offset:2048
    ds_read_b128 v[52:55], v3 offset:3072
    s_add_u32 s15, s16, 4096
    s_add_u32 s39, s39, 0x01010101
    s_add_u32 s16, s16, 16384
    s_and_b32 s16, s16, 0xffff
    s_or_b32 s16, s16, 65536
    s_add_u32 s17, s17, 16384
    s_and_b32 s17, s17, 0xffff
    s_or_b32 s17, s17, 65536
    s_xor_b32 s18, s18, 1
    s_not_b32 s19, s19
    s_waitcnt lgkmcnt(0)
    s_barrier
    v_bfe_u32 v11, v0, 2, 5
    buffer_load_dword v11, v11, s[4:7], s49 offen sc1
    buffer_load_dwordx4 v0, s[4:7], s15 offen offset:0 sc1 lds
    buffer_load_dwordx4 v0, s[4:7], s15 offen offset:1024 sc1 lds
    buffer_load_dwordx4 v0, s[4:7], s15 offen offset:2048 sc1 lds
    buffer_load_dwordx4 v0, s[4:7], s15 offen offset:3072 sc1 lds
    buffer_load_dwordx4 v[56:59], v0, s[4:7], s24 offen offset:2048
    buffer_load_dwordx4 v[60:63], v0, s[4:7], s24 offen offset:3072
    s_branch HZ_CF1_top
CF1_redo:
    s_mov_b64 exec, vcc
CF1_redo2:
    buffer_load_dwordx4 v[48:51], v4, s[4:7], s28 offen sc1
    buffer_load_dwordx4 v[52:55], v4, s[4:7], s29 offen sc1
    buffer_load_dwordx4 v[56:59], v4, s[4:7], s30 offen sc1
    buffer_load_dwordx4 v[60:63], v4, s[4:7], s31 offen sc1
    s_add_u32 s32, s32, 1
    s_cmp_gt_u32 s32, 0x40000
    s_cbranch_scc1 L_abort
    s_waitcnt vmcnt(0)
    v_bitop3_b32 v10, v48, v52, s19 bitop3:0x7e
    v_bitop3_b32 v11, v56, v60, s19 bitop3:0x7e
    v_bitop3_b32 v10, v10, v11, 1 bitop3:0xa8
    v_cmp_ne_u32 vcc, 0, v10
    s_cbranch_vccnz CF1_redo2
    s_mov_b64 exec, -1
    s_nop 1
    s_branch CF1_red
CF1_last:
    s_mov_b32 s42, 4855808
    buffer_store_dwordx2 v[10:11], v5, s[4:7], s42 offen sc1
    s_branch CF1_done
CF1_scan:
    v_mov_b32 v10, 0
    ds_read_b32 v11, v0 offset:0
    s_waitcnt lgkmcnt(0)
    v_max_u32 v10, v10, v11
    ds_read_b32 v11, v0 offset:1024
    s_waitcnt lgkmcnt(0)
    v_max_u32 v10, v10, v11
    ds_read_b32 v11, v0 offset:2048
    s_waitcnt lgkmcnt(0)
    v_max_u32 v10, v10, v11
    ds_read_b32 v11, v0 offset:3072
    s_waitcnt lgkmcnt(0)
    v_max_u32 v10, v10, v11
    ds_read_b32 v11, v0 offset:4096
    s_waitcnt lgkmcnt(0)
    v_max_u32 v10, v10, v11
    ds_read_b32 v11, v0 offset:5120
    s_waitcnt lgkmcnt(0)
    v_max_u32 v10, v10, v11
    ds_read_b32 v11, v0 offset:6144
    s_waitcnt lgkmcnt(0)
    v_max_u32 v10, v10, v11
    ds_read_b32 v11, v0 offset:7168
    s_waitcnt lgkmcnt(0)
    v_max_u32 v10, v10, v11
    ds_read_b32 v11, v0 offset:8192
    s_waitcnt lgkmcnt(0)
    v_max_u32 v10, v10, v11
    ds_read_b32 v11, v0 offset:9216
    s_waitcnt lgkmcnt(0)
    v_max_u32 v10, v10, v11
    v_cmp_eq_u32 vcc, -1, v10
    s_cbranch_vccnz CF1_rec
    s_branch CF1_scanned
CF1_mr:
    s_add_u32 s32, s32, 1
    s_cmp_gt_u32 s32, 0x40000
    s_cbranch_scc1 L_abort
    v_bfe_u32 v11, v0, 2, 5
    buffer_load_dword v11, v11, s[4:7], s49 offen sc1
    buffer_load_dwordx4 v0, s[4:7], s15 offen offset:0 sc1 lds
    buffer_load_dwordx4 v0, s[4:7], s15 offen offset:1024 sc1 lds
    buffer_load_dwordx4 v0, s[4:7], s15 offen offset:2048 sc1 lds
    buffer_load_dwordx4 v0, s[4:7], s15 offen offset:3072 sc1 lds
    s_waitcnt vmcnt(4)
    v_cmp_ne_u32 vcc, s39, v11
    s_cbranch_vccnz CF1_mr
    s_waitcnt vmcnt(0)
    s_branch CF1_mok
CF1_done:
    s_waitcnt vmcnt(0) lgkmcnt(0)
    s_endpgm
CF_w2:
    v_lshlrev_b32 v11, 3, v0
    s_mov_b32 s42, 65536
    buffer_load_dwordx2 v[12:13], v5, s[4:7], s42 offen sc1
    s_mov_b32 s42, 81920
    buffer_load_dwordx2 v[12:13], v5, s[4:7], s42 offen sc1
    s_mov_b32 s42, 98304
    buffer_load_dwordx2 v[12:13], v5, s[4:7], s42 offen sc1
    s_mov_b32 s42, 114688
    buffer_load_dwordx2 v[12:13], v5, s[4:7], s42 offen sc1
CF2_rec:
    s_waitcnt vmcnt(0) lgkmcnt(0)
    s_add_u32 s32, s32, 1
    s_cmp_gt_u32 s32, 0x40000
    s_cbranch_scc1 L_abort
    s_barrier
    ds_read_b128 v[40:43], v3 offset:0
    ds_read_b128 v[44:47], v3 offset:1024
    ds_read_b128 v[48:51], v3 offset:2048
    ds_read_b128 v[52:55], v3 offset:3072
    s_mov_b32 m0, 8192
    buffer_load_dwordx4 v[56:59], v0, s[4:7], s24 offen offset:2048
    buffer_load_dwordx4 v[60:63], v0, s[4:7], s24 offen offset:3072
    v_mov_b64 v[28:29], 0
    v_mov_b64 v[30:31], 0
    v_mov_b64 v[32:33], 0
    v_mov_b64 v[34:35], 0
    v_mov_b64 v[36:37], 0
    v_mov_b64 v[38:39], 0
    s_waitcnt vmcnt(0) lgkmcnt(0)
    s_branch HZ_CF2_top
.p2align 6
HZ_CF2_top:
    s_barrier
    ds_read_b128 v[12:15], v1 offset:0
    ds_read_b128 v[16:19], v1 offset:512
    ds_read_b128 v[20:23], v1 offset:1024
    ds_read_b128 v[24:27], v1 offset:1536
    v_bfe_u32 v11, v0, 2, 4
    buffer_load_dword v11, v11, s[4:7], s49 offen sc1
    buffer_load_dwordx4 v0, s[4:7], s15 offen offset:0 sc1 lds
    buffer_load_dwordx4 v0, s[4:7], s15 offen offset:1024 sc1 lds
    s_waitcnt lgkmcnt(3)
    v_smfmac_f32_16x16x64_bf16 v[28:31], v[12:15], v[40:47], v2
    v_smfmac_f32_16x16x64_bf16 v[32:35], v[12:15], v[48:55], v2
    v_smfmac_f32_16x16x64_bf16 v[36:39], v[12:15], a[240:247], v2
    s_barrier
    ds_read_b128 v[12:15], v1 offset:2048
    buffer_load_dwordx4 v[40:43], v0, s[4:7], s36 offen offset:0
    s_waitcnt lgkmcnt(3)
    v_smfmac_f32_16x16x64_bf16 v[28:31], v[16:19], a[0:7], v2
    buffer_load_dwordx4 v[44:47], v0, s[4:7], s36 offen offset:1024
    v_smfmac_f32_16x16x64_bf16 v[32:35], v[16:19], a[144:151], v2
    buffer_load_dwordx4 v[48:51], v0, s[4:7], s24 offen offset:0
    v_smfmac_f32_16x16x64_bf16 v[36:39], v[16:19], a[248:255], v2
    ds_read_b128 v[16:19], v1 offset:2560
    buffer_load_dwordx4 v[52:55], v0, s[4:7], s24 offen offset:1024
    s_waitcnt lgkmcnt(3)
    v_smfmac_f32_16x16x64_bf16 v[28:31], v[20:23], a[8:15], v2
    v_smfmac_f32_16x16x64_bf16 v[32:35], v[20:23], a[152:159], v2
    v_smfmac_f32_16x16x64_bf16 v[36:39], v[20:23], v[64:71], v2
    ds_read_b128 v[20:23], v1 offset:3072
    s_waitcnt lgkmcnt(3)
    v_smfmac_f32_16x16x64_bf16 v[28:31], v[24:27], a[16:23], v2
    s_waitcnt vmcnt(6)
    v_cmp_ne_u32 vcc, s39, v11
    v_smfmac_f32_16x16x64_bf16 v[32:35], v[24:27], a[160:167], v2
    s_cbranch_vccnz CF2_mr
CF2_mok:
    s_barrier
    v_smfmac_f32_16x16x64_bf16 v[36:39], v[24:27], v[72:79], v2
    ds_read_b128 v[24:27], v1 offset:3584
    s_waitcnt lgkmcnt(3)
    v_smfmac_f32_16x16x64_bf16 v[28:31], v[12:15], a[24:31], v2
    v_smfmac_f32_16x16x64_bf16 v[32:35], v[12:15], a[168:175], v2
    v_smfmac_f32_16x16x64_bf16 v[36:39], v[12:15], v[80:87], v2
    ds_read_b128 v[12:15], v1 offset:4096
    s_waitcnt lgkmcnt(3)
    v_smfmac_f32_16x16x64_bf16 v[28:31], v[16:19], a[32:39], v2
    v_smfmac_f32_16x16x64_bf16 v[32:35], v[16:19], a[176:183], v2
    v_smfmac_f32_16x16x64_bf16 v[36:39], v[16:19], v[88:95], v2
    ds_read_b128 v[16:19], v1 offset:4608
    s_waitcnt lgkmcnt(3)
    v_smfmac_f32_16x16x64_bf16 v[28:31], v[20:23], a[40:47], v2
    v_smfmac_f32_16x16x64_bf16 v[32:35], v[20:23], a[184:191], v2
    v_smfmac_f32_16x16x64_bf16 v[36:39], v[20:23], v[96:103], v2
    ds_read_b128 v[20:23], v1 offset:5120
    s_waitcnt lgkmcnt(3)
    v_smfmac_f32_16x16x64_bf16 v[28:31], v[24:27], a[48:55], v2
    v_smfmac_f32_16x16x64_bf16 v[32:35], v[24:27], a[192:199], v2
    v_smfmac_f32_16x16x64_bf16 v[36:39], v[24:27], v[104:111], v2
    ds_read_b128 v[24:27], v1 offset:5632
    s_waitcnt lgkmcnt(3)
    v_smfmac_f32_16x16x64_bf16 v[28:31], v[12:15], a[56:63], v2
    v_smfmac_f32_16x16x64_bf16 v[32:35], v[12:15], v[56:63], v2
    ds_read_b128 v[56:59], v3 offset:4096
    ds_read_b128 v[60:63], v3 offset:5120
    v_smfmac_f32_16x16x64_bf16 v[36:39], v[12:15], v[112:119], v2
    ds_read_b128 v[12:15], v1 offset:6144
    s_waitcnt lgkmcnt(5)
    v_smfmac_f32_16x16x64_bf16 v[28:31], v[16:19], a[64:71], v2
    v_smfmac_f32_16x16x64_bf16 v[32:35], v[16:19], a[200:207], v2
    s_waitcnt vmcnt(2)
    v_smfmac_f32_16x16x64_bf16 v[36:39], v[16:19], v[40:47], v2
    ds_read_b128 v[40:43], v3 offset:16384
    ds_read_b128 v[44:47], v3 offset:17408
    ds_read_b128 v[16:19], v1 offset:6656
    s_waitcnt lgkmcnt(7)
    v_smfmac_f32_16x16x64_bf16 v[28:31], v[20:23], a[72:79], v2
    s_waitcnt lgkmcnt(4)
    v_smfmac_f32_16x16x64_bf16 v[32:35], v[20:23], v[56:63], v2
    ds_read_b128 v[56:59], v3 offset:6144
    ds_read_b128 v[60:63], v3 offset:7168
    v_smfmac_f32_16x16x64_bf16 v[36:39], v[20:23], v[120:127], v2
    ds_read_b128 v[20:23], v1 offset:7168
    s_waitcnt vmcnt(0)
    v_smfmac_f32_16x16x64_bf16 v[28:31], v[24:27], v[48:55], v2
    ds_read_b128 v[48:51], v3 offset:8192
    ds_read_b128 v[52:55], v3 offset:9216
    v_smfmac_f32_16x16x64_bf16 v[32:35], v[24:27], a[208:215], v2
    s_waitcnt lgkmcnt(6)
    v_smfmac_f32_16x16x64_bf16 v[36:39], v[24:27], v[40:47], v2
    ds_read_b128 v[40:43], v3 offset:10240
    ds_read_b128 v[44:47], v3 offset:11264
    ds_read_b128 v[24:27], v1 offset:7680
    s_barrier
    v_smfmac_f32_16x16x64_bf16 v[28:31], v[12:15], a[80:87], v2
    s_waitcnt lgkmcnt(6)
    v_smfmac_f32_16x16x64_bf16 v[32:35], v[12:15], v[56:63], v2
    ds_read_b128 v[56:59], v3 offset:12288
    ds_read_b128 v[60:63], v3 offset:13312
    ds_read_b128 v[12:15], v1 offset:8192
    v_smfmac_f32_16x16x64_bf16 v[28:31], v[16:19], a[88:95], v2
    s_waitcnt lgkmcnt(6)
    v_smfmac_f32_16x16x64_bf16 v[32:35], v[16:19], v[48:55], v2
    ds_read_b128 v[16:19], v1 offset:8704
    v_smfmac_f32_16x16x64_bf16 v[28:31], v[20:23], a[96:103], v2
    s_waitcnt lgkmcnt(5)
    v_smfmac_f32_16x16x64_bf16 v[32:35], v[20:23], v[40:47], v2
    ds_read_b128 v[40:43], v3 offset:14336
    ds_read_b128 v[44:47], v3 offset:15360
    ds_read_b128 v[20:23], v1 offset:9216
    s_waitcnt lgkmcnt(7)
    v_smfmac_f32_16x16x64_bf16 v[28:31], v[24:27], a[104:111], v2
    s_waitcnt lgkmcnt(5)
    v_smfmac_f32_16x16x64_bf16 v[32:35], v[24:27], v[56:63], v2
    ds_read_b128 v[24:27], v1 offset:9728
    s_waitcnt lgkmcnt(5)
    v_smfmac_f32_16x16x64_bf16 v[28:31], v[12:15], a[112:119], v2
    v_smfmac_f32_16x16x64_bf16 v[32:35], v[12:15], a[216:223], v2
    s_waitcnt lgkmcnt(4)
    v_smfmac_f32_16x16x64_bf16 v[28:31], v[16:19], a[120:127], v2
    s_waitcnt lgkmcnt(2)
    v_smfmac_f32_16x16x64_bf16 v[32:35], v[16:19], v[40:47], v2
    ds_read_b128 v[56:59], v0 offset:14336
    ds_read_b128 v[60:63], v0 offset:18432
    s_waitcnt lgkmcnt(3)
    v_smfmac_f32_16x16x64_bf16 v[28:31], v[20:23], a[128:135], v2
    s_waitcnt lgkmcnt(2)
    v_smfmac_f32_16x16x64_bf16 v[28:31], v[24:27], a[136:143], v2
    ds_read_b128 v[48:51], v0 offset:15360
    ds_read_b128 v[52:55], v0 offset:19456
    v_smfmac_f32_16x16x64_bf16 v[32:35], v[20:23], a[224:231], v2
    v_smfmac_f32_16x16x64_bf16 v[32:35], v[24:27], a[232:239], v2
    s_nop 3
    v_cmp_u_f32 vcc, v28, v30
    v_cvt_pk_bf16_f32 v28, v28, v30
    v_cvt_pk_bf16_f32 v30, v29, v31
    v_smfmac_f32_16x16x64_bf16 v[36:39], v[12:15], v[160:167], v2
    ds_read_b128 v[12:15], v1 offset:6144
    v_smfmac_f32_16x16x64_bf16 v[36:39], v[16:19], v[168:175], v2
    ds_read_b128 v[16:19], v1 offset:6656
    s_cbranch_vccnz CF2_scan
CF2_scanned:
    v_cvt_pk_bf16_f32 v29, v32, v34
    v_cvt_pk_bf16_f32 v31, v33, v35
    ds_write_b64 v6, v[28:29]
    ds_write_b64 v6, v[30:31] offset:512
    v_smfmac_f32_16x16x64_bf16 v[36:39], v[20:23], v[176:183], v2
    ds_read_b128 v[20:23], v1 offset:7168
    v_smfmac_f32_16x16x64_bf16 v[36:39], v[24:27], v[184:191], v2
    ds_read_b128 v[24:27], v1 offset:7680
    s_waitcnt lgkmcnt(5)
    v_smfmac_f32_16x16x64_bf16 v[36:39], v[12:15], v[128:135], v2
    s_waitcnt lgkmcnt(4)
    v_smfmac_f32_16x16x64_bf16 v[36:39], v[16:19], v[136:143], v2
    s_waitcnt lgkmcnt(2)
    s_barrier
    ds_read_b64_tr_b16 v[28:29], v7 offset:0
    ds_read_b64_tr_b16 v[30:31], v7 offset:512
    s_waitcnt lgkmcnt(3)
    v_smfmac_f32_16x16x64_bf16 v[36:39], v[20:23], v[144:151], v2
    ds_read_b64_tr_b16 v[32:33], v7 offset:1024
    ds_read_b64_tr_b16 v[34:35], v7 offset:1536
    s_waitcnt lgkmcnt(4)
    v_smfmac_f32_16x16x64_bf16 v[36:39], v[24:27], v[152:159], v2
    s_waitcnt lgkmcnt(2)
    v_mfma_f32_16x16x32_bf16 v[12:15], v[56:59], v[28:31], 0
    ds_read_b64_tr_b16 v[40:41], v7 offset:2048
    ds_read_b64_tr_b16 v[42:43], v7 offset:2560
    v_mfma_f32_16x16x32_bf16 v[20:23], v[60:63], v[28:31], 0
    ds_read_b128 v[56:59], v0 offset:16384
    ds_read_b128 v[60:63], v0 offset:20480
    s_waitcnt lgkmcnt(4)
    v_mfma_f32_16x16x32_bf16 v[12:15], v[48:51], v[32:35], v[12:15]
    ds_read_b64_tr_b16 v[44:45], v7 offset:3072
    ds_read_b64_tr_b16 v[46:47], v7 offset:3584
    v_mfma_f32_16x16x32_bf16 v[20:23], v[52:55], v[32:35], v[20:23]
    ds_read_b128 v[48:51], v0 offset:17408
    ds_read_b128 v[52:55], v0 offset:21504
    v_mfma_f32_16x16x32_bf16 v[16:19], v[28:31], v[28:31], 0
    v_mov_b64 v[24:25], s[98:99]
    v_mov_b64 v[26:27], s[98:99]
    v_mfma_f32_16x16x32_bf16 v[16:19], v[32:35], v[32:35], v[16:19]
    s_waitcnt lgkmcnt(4)
    v_mfma_f32_16x16x32_bf16 v[12:15], v[56:59], v[40:43], v[12:15]
    v_mfma_f32_16x16x32_bf16 v[20:23], v[60:63], v[40:43], v[20:23]
    buffer_load_dwordx4 v[56:59], v0, s[4:7], s21 offen sc1
    v_cvt_pk_bf16_f32 v36, v36, v38
    s_waitcnt lgkmcnt(0)
    v_mfma_f32_16x16x32_bf16 v[12:15], v[48:51], v[44:47], v[12:15]
    v_cvt_pk_bf16_f32 v37, v37, v39
    v_mfma_f32_16x16x32_bf16 v[20:23], v[52:55], v[44:47], v[20:23]
    buffer_load_dwordx4 v[60:63], v0, s[4:7], s21 offen offset:1024 sc1
    v_mfma_f32_16x16x32_bf16 v[16:19], v[40:43], v[40:43], v[16:19]
    v_mov_b32 v53, 0
    v_mov_b32 v54, 0
    v_mfma_f32_16x16x32_bf16 v[16:19], v[44:47], v[44:47], v[16:19]
    s_nop 0
    v_max3_f32 v11, v12, v13, v14
    s_nop 0
    v_max3_f32 v10, v15, v20, v21
    v_max3_f32 v11, v11, v22, v23
    v_max_f32 v11, v11, v10
    buffer_load_dwordx4 v[28:31], v0, s[4:7], s36 offen offset:2048
    s_nop 0
    v_max3_f32 v10, v11, v18, v19
    v_max3_f32 v11, v11, v18, v19
    s_nop 1
    v_permlane32_swap_b32 v10, v11
    v_max_f32 v16, v10, v11
    v_max_f32 v10, v10, v11
    buffer_load_dwordx4 v[32:35], v0, s[4:7], s36 offen offset:3072
    s_nop 0
    v_permlane16_swap_b32 v10, v16
    v_max_f32 v10, v10, v16
    v_mul_f32 v10, s33, v10
    v_pk_fma_f32 v[12:13], v[12:13], s[96:97], v[10:11] op_sel_hi:[1,1,0] neg_lo:[0,0,1] neg_hi:[0,0,1]
    v_pk_fma_f32 v[14:15], v[14:15], s[96:97], v[10:11] op_sel_hi:[1,1,0] neg_lo:[0,0,1] neg_hi:[0,0,1]
    v_pk_fma_f32 v[20:21], v[20:21], s[96:97], v[10:11] op_sel_hi:[1,1,0] neg_lo:[0,0,1] neg_hi:[0,0,1]
    v_pk_fma_f32 v[22:23], v[22:23], s[96:97], v[10:11] op_sel_hi:[1,1,0] neg_lo:[0,0,1] neg_hi:[0,0,1]
    v_pk_fma_f32 v[18:19], v[18:19], s[96:97], v[10:11] op_sel_hi:[1,1,0] neg_lo:[0,0,1] neg_hi:[0,0,1]
    v_exp_f32 v12, v12
    v_exp_f32 v13, v13
    v_exp_f32 v14, v14
    v_cvt_pk_bf16_f32 v48, v12, v13
    v_exp_f32 v15, v15
    v_exp_f32 v20, v20
    v_cvt_pk_bf16_f32 v49, v14, v15
    v_exp_f32 v21, v21
    v_exp_f32 v22, v22
    v_cvt_pk_bf16_f32 v50, v20, v21
    v_exp_f32 v23, v23
    v_exp_f32 v18, v18
    v_cvt_pk_bf16_f32 v51, v22, v23
    v_exp_f32 v19, v19
    s_nop 0
    v_mfma_f32_16x16x32_bf16 v[20:23], v[24:27], v[48:51], 0
    v_cvt_pk_bf16_f32 v52, v18, v19
    v_cvt_pk_bf16_f32 v55, v18, v19
    s_waitcnt vmcnt(2)
    v_mfma_f32_16x16x32_bf16 v[12:15], v[60:63], v[48:51], 0
    buffer_load_dwordx4 v[40:43], v0, s[4:7], s37 offen offset:0
    s_nop 0
    v_mfma_f32_16x16x16_bf16 v[20:23], v[24:25], v[52:53], v[20:23]
    buffer_load_dwordx4 v[44:47], v0, s[4:7], s37 offen offset:1024
    v_mfma_f32_16x16x32_bf16 v[24:27], v[56:59], v[48:51], 0
    ds_read_b128 v[56:59], v3 offset:18432
    ds_read_b128 v[60:63], v3 offset:19456
    v_mfma_f32_16x16x16_bf16 v[12:15], v[36:37], v[54:55], v[12:15]
    s_nop 2
    v_rcp_f32 v10, v20
    v_mfma_f32_16x16x16_bf16 v[24:27], v[36:37], v[52:53], v[24:27]
    s_add_u32 s14, s14, 1
    s_add_u32 s21, s21, 262144
    s_add_u32 s35, s35, 262144
    s_add_u32 s20, s20, 262144
    v_pk_mul_f32 v[12:13], v[12:13], v[10:11] op_sel_hi:[1,0]
    v_pk_mul_f32 v[14:15], v[14:15], v[10:11] op_sel_hi:[1,0]
    s_nop 1
    v_pk_mul_f32 v[24:25], v[24:25], v[10:11] op_sel_hi:[1,0]
    v_cvt_pk_bf16_f32 v48, v24, v12
    v_cvt_pk_bf16_f32 v49, v25, v13
    v_pk_mul_f32 v[26:27], v[26:27], v[10:11] op_sel_hi:[1,0]
    v_cvt_pk_bf16_f32 v50, v26, v14
    v_cvt_pk_bf16_f32 v51, v27, v15
    ds_write_b128 v8, v[48:51]
    v_mov_b64 v[36:37], 0
    v_mov_b64 v[38:39], 0
    s_waitcnt lgkmcnt(0)
    buffer_load_dwordx4 v[48:51], v0, s[4:7], s37 offen offset:2048
    buffer_load_dwordx4 v[52:55], v0, s[4:7], s37 offen offset:3072
    s_barrier
    ds_read_b128 v[12:15], v1 offset:0
    ds_read_b128 v[16:19], v1 offset:512
    ds_read_b128 v[20:23], v1 offset:1024
    ds_read_b128 v[24:27], v1 offset:1536
    s_waitcnt lgkmcnt(3)
    s_waitcnt vmcnt(4)
    v_smfmac_f32_16x16x64_bf16 v[36:39], v[12:15], v[28:35], v2
    s_waitcnt lgkmcnt(2)
    s_waitcnt vmcnt(2)
    v_smfmac_f32_16x16x64_bf16 v[36:39], v[16:19], v[40:47], v2
    buffer_load_dwordx4 v[40:43], v0, s[4:7], s38 offen offset:0
    v_mov_b64 v[28:29], 0
    s_waitcnt lgkmcnt(1)
    v_smfmac_f32_16x16x64_bf16 v[36:39], v[20:23], v[56:63], v2
    ds_read_b128 v[56:59], v3 offset:20480
    ds_read_b128 v[60:63], v3 offset:21504
    v_mov_b64 v[30:31], 0
    s_waitcnt lgkmcnt(2)
    v_smfmac_f32_16x16x64_bf16 v[36:39], v[24:27], v[192:199], v2
    buffer_load_dwordx4 v[44:47], v0, s[4:7], s38 offen offset:1024
    v_mov_b64 v[32:33], 0
    v_smfmac_f32_16x16x64_bf16 v[28:31], v[12:15], v[200:207], v2
    v_mov_b64 v[34:35], 0
    v_smfmac_f32_16x16x64_bf16 v[28:31], v[16:19], v[208:215], v2
    s_nop 2
    v_cvt_pk_bf16_f32 v36, v36, v37
    s_waitcnt lgkmcnt(0)
    v_smfmac_f32_16x16x64_bf16 v[28:31], v[20:23], v[56:63], v2
    ds_read_b128 v[56:59], v3 offset:22528
    ds_read_b128 v[60:63], v3 offset:23552
    v_cvt_pk_bf16_f32 v37, v38, v39
    v_smfmac_f32_16x16x64_bf16 v[28:31], v[24:27], v[216:223], v2
    v_and_or_b32 v36, v36, -2, s18
    v_smfmac_f32_16x16x64_bf16 v[32:35], v[12:15], v[224:231], v2
    s_waitcnt vmcnt(2)
    v_smfmac_f32_16x16x64_bf16 v[32:35], v[16:19], v[48:55], v2
    ds_read_b128 v[48:51], v3 offset:24576
    ds_read_b128 v[52:55], v3 offset:25600
    s_nop 1
    v_cvt_pk_bf16_f32 v38, v28, v29
    v_cvt_pk_bf16_f32 v39, v30, v31
    buffer_store_dwordx4 v[36:39], v0, s[4:7], s25 offen
    s_waitcnt lgkmcnt(2)
    v_smfmac_f32_16x16x64_bf16 v[32:35], v[20:23], v[56:63], v2
    ds_read_b128 v[56:59], v3 offset:26624
    ds_read_b128 v[60:63], v3 offset:27648
    s_mov_b32 m0, 14336
    v_mov_b64 v[36:37], 0
    v_mov_b64 v[38:39], 0
    v_smfmac_f32_16x16x64_bf16 v[32:35], v[24:27], v[232:239], v2
    buffer_load_dwordx4 v0, s[4:7], s20 offen offset:0 sc1 lds
    s_waitcnt lgkmcnt(2)
    v_smfmac_f32_16x16x64_bf16 v[36:39], v[12:15], v[48:55], v2
    ds_read_b128 v[48:51], v3 offset:28672
    ds_read_b128 v[52:55], v3 offset:29696
    buffer_load_dwordx4 v0, s[4:7], s20 offen offset:1024 sc1 lds
    v_mov_b64 v[28:29], 0
    s_waitcnt lgkmcnt(2)
    v_smfmac_f32_16x16x64_bf16 v[36:39], v[16:19], v[56:63], v2
    ds_read_b128 v[56:59], v3 offset:30720
    ds_read_b128 v[60:63], v3 offset:31744
    buffer_load_dwordx4 v0, s[4:7], s20 offen offset:2048 sc1 lds
    v_mov_b64 v[30:31], 0
    v_cvt_pk_bf16_f32 v32, v32, v33
    v_smfmac_f32_16x16x64_bf16 v[36:39], v[20:23], v[240:247], v2
    buffer_load_dwordx4 v0, s[4:7], s20 offen offset:3072 sc1 lds
    v_cvt_pk_bf16_f32 v33, v34, v35
    s_waitcnt lgkmcnt(2)
    v_smfmac_f32_16x16x64_bf16 v[36:39], v[24:27], v[48:55], v2
    ds_read_b128 v[48:51], v3 offset:32768
    ds_read_b128 v[52:55], v3 offset:33792
    s_mov_b32 m0, 8192
    v_and_or_b32 v32, v32, -2, s18
    s_waitcnt lgkmcnt(2)
    v_smfmac_f32_16x16x64_bf16 v[28:31], v[12:15], v[56:63], v2
    v_smfmac_f32_16x16x64_bf16 v[28:31], v[16:19], v[248:255], v2
    s_nop 0
    v_cvt_pk_bf16_f32 v34, v36, v37
    v_cvt_pk_bf16_f32 v35, v38, v39
    buffer_store_dwordx4 v[32:35], v0, s[4:7], s26 offen
    s_waitcnt lgkmcnt(0)
    v_smfmac_f32_16x16x64_bf16 v[28:31], v[20:23], v[48:55], v2
    s_waitcnt vmcnt(6)
    v_smfmac_f32_16x16x64_bf16 v[28:31], v[24:27], v[40:47], v2
    v_and_b32 v16, 0xff, v0
    ds_read_b128 v[12:15], v16 offset:22528
    s_nop 5
    v_cvt_pk_bf16_f32 v28, v28, v29
    v_cvt_pk_bf16_f32 v29, v30, v31
    v_and_or_b32 v28, v28, -2, s18
    buffer_store_dwordx2 v[28:29], v9, s[4:7], s27 offen
    v_mov_b32 v20, s14
    v_lshlrev_b32 v21, 4, v0
    v_mov_b32 v22, -1
    s_waitcnt lgkmcnt(0)
    s_waitcnt vmcnt(0)
    v_mov_b64 v[28:29], 0
    v_mov_b64 v[30:31], 0
    v_mov_b64 v[32:33], 0
    v_mov_b64 v[34:35], 0
    v_mov_b64 v[36:37], 0
    v_mov_b64 v[38:39], 0
    s_cmp_ge_u32 s46, 80
    s_cbranch_scc1 CF2_nored
    buffer_load_dwordx4 v[48:51], v4, s[4:7], s28 offen sc1
    buffer_load_dwordx4 v[52:55], v4, s[4:7], s29 offen sc1
    buffer_load_dwordx4 v[56:59], v4, s[4:7], s30 offen sc1
    buffer_load_dwordx4 v[60:63], v4, s[4:7], s31 offen sc1
CF2_red:
    s_waitcnt vmcnt(3)
    v_mfma_f32_16x16x32_bf16 v[16:19], v[12:15], v[48:51], 0
    s_waitcnt vmcnt(2)
    v_mfma_f32_16x16x32_bf16 v[16:19], v[12:15], v[52:55], v[16:19]
    v_bitop3_b32 v10, v48, v52, s19 bitop3:0x7e
    s_waitcnt vmcnt(1)
    v_mfma_f32_16x16x32_bf16 v[16:19], v[12:15], v[56:59], v[16:19]
    s_waitcnt vmcnt(0)
    v_bitop3_b32 v11, v56, v60, s19 bitop3:0x7e
    v_bitop3_b32 v10, v10, v11, 1 bitop3:0xa8
    v_cmp_ne_u32 vcc, 0, v10
    v_mfma_f32_16x16x32_bf16 v[16:19], v[12:15], v[60:63], v[16:19]
    s_cmp_eq_u32 s14, 63
    s_cbranch_vccnz CF2_redo
    s_nop 5
    v_add_f32_dpp v16, v16, v16 row_ror:8 row_mask:0xf bank_mask:0xf
    v_add_f32_dpp v17, v17, v17 row_ror:8 row_mask:0xf bank_mask:0xf
    v_add_f32_dpp v18, v18, v18 row_ror:8 row_mask:0xf bank_mask:0xf
    v_add_f32_dpp v19, v19, v19 row_ror:8 row_mask:0xf bank_mask:0xf
    v_cvt_pk_bf16_f32 v10, v16, v17
    v_cvt_pk_bf16_f32 v11, v18, v19
    v_min_u32 v10, s34, v10
    s_cbranch_scc1 CF2_last
    buffer_store_dwordx2 v[10:11], v5, s[4:7], s16 offen
    buffer_store_byte v20, v21, s[8:11], s46 offen
    buffer_store_dword v22, v5, s[4:7], s17 offen
CF2_nored2:
    ds_read_b128 v[40:43], v3 offset:0
    ds_read_b128 v[44:47], v3 offset:1024
    ds_read_b128 v[48:51], v3 offset:2048
    ds_read_b128 v[52:55], v3 offset:3072
    s_add_u32 s15, s16, 8192
    s_add_u32 s39, s39, 0x01010101
    s_add_u32 s16, s16, 16384
    s_and_b32 s16, s16, 0xffff
    s_or_b32 s16, s16, 65536
    s_add_u32 s17, s17, 16384
    s_and_b32 s17, s17, 0xffff
    s_or_b32 s17, s17, 65536
    s_xor_b32 s18, s18, 1
    s_not_b32 s19, s19
    s_waitcnt lgkmcnt(0)
    s_barrier
    buffer_load_dwordx4 v[56:59], v0, s[4:7], s24 offen offset:2048
    buffer_load_dwordx4 v[60:63], v0, s[4:7], s24 offen offset:3072
    s_branch HZ_CF2_top
CF2_redo:
    s_mov_b64 exec, vcc
CF2_redo2:
    buffer_load_dwordx4 v[48:51], v4, s[4:7], s28 offen sc1
    buffer_load_dwordx4 v[52:55], v4, s[4:7], s29 offen sc1
    buffer_load_dwordx4 v[56:59], v4, s[4:7], s30 offen sc1
    buffer_load_dwordx4 v[60:63], v4, s[4:7], s31 offen sc1
    s_add_u32 s32, s32, 1
    s_cmp_gt_u32 s32, 0x40000
    s_cbranch_scc1 L_abort
    s_waitcnt vmcnt(0)
    v_bitop3_b32 v10, v48, v52, s19 bitop3:0x7e
    v_bitop3_b32 v11, v56, v60, s19 bitop3:0x7e
    v_bitop3_b32 v10, v10, v11, 1 bitop3:0xa8
    v_cmp_ne_u32 vcc, 0, v10
    s_cbranch_vccnz CF2_redo2
    s_mov_b64 exec, -1
    s_nop 1
    s_branch CF2_red
CF2_last:
    s_mov_b32 s42, 4855808
    buffer_store_dwordx2 v[10:11], v5, s[4:7], s42 offen sc1
    s_branch CF2_done
CF2_scan:
    v_mov_b32 v10, 0
    ds_read_b32 v11, v0 offset:0
    s_waitcnt lgkmcnt(0)
    v_max_u32 v10, v10, v11
    ds_read_b32 v11, v0 offset:1024
    s_waitcnt lgkmcnt(0)
    v_max_u32 v10, v10, v11
    ds_read_b32 v11, v0 offset:2048
    s_waitcnt lgkmcnt(0)
    v_max_u32 v10, v10, v11
    ds_read_b32 v11, v0 offset:3072
    s_waitcnt lgkmcnt(0)
    v_max_u32 v10, v10, v11
    ds_read_b32 v11, v0 offset:4096
    s_waitcnt lgkmcnt(0)
    v_max_u32 v10, v10, v11
    ds_read_b32 v11, v0 offset:5120
    s_waitcnt lgkmcnt(0)
    v_max_u32 v10, v10, v11
    ds_read_b32 v11, v0 offset:6144
    s_waitcnt lgkmcnt(0)
    v_max_u32 v10, v10, v11
    ds_read_b32 v11, v0 offset:7168
    s_waitcnt lgkmcnt(0)
    v_max_u32 v10, v10, v11
    ds_read_b32 v11, v0 offset:8192
    s_waitcnt lgkmcnt(0)
    v_max_u32 v10, v10, v11
    ds_read_b32 v11, v0 offset:9216
    s_waitcnt lgkmcnt(0)
    v_max_u32 v10, v10, v11
    v_cmp_eq_u32 vcc, -1, v10
    s_cbranch_vccnz CF2_rec
    s_branch CF2_scanned
CF2_nored:
    s_waitcnt vmcnt(0)
    s_cmp_eq_u32 s14, 63
    s_cbranch_scc1 CF2_done
    s_branch CF2_nored2
CF2_mr:
    s_add_u32 s32, s32, 1
    s_cmp_gt_u32 s32, 0x40000
    s_cbranch_scc1 L_abort
    v_bfe_u32 v11, v0, 2, 4
    buffer_load_dword v11, v11, s[4:7], s49 offen sc1
    buffer_load_dwordx4 v0, s[4:7], s15 offen offset:0 sc1 lds
    buffer_load_dwordx4 v0, s[4:7], s15 offen offset:1024 sc1 lds
    s_waitcnt vmcnt(2)
    v_cmp_ne_u32 vcc, s39, v11
    s_cbranch_vccnz CF2_mr
    s_waitcnt vmcnt(0)
    s_branch CF2_mok
CF2_done:
    s_waitcnt vmcnt(0) lgkmcnt(0)
    s_endpgm
CF_w3:
    s_cmp_eq_u32 s12, 0
    s_cselect_b32 s31, 0, 1
    v_lshlrev_b32 v11, 3, v0
    s_sub_u32 s42, s48, 262144
    buffer_load_dword v14, v11, s[4:7], s42 offen sc1
CF3_rec:
    s_waitcnt vmcnt(0) lgkmcnt(0)
    s_add_u32 s32, s32, 1
    s_cmp_gt_u32 s32, 0x40000
    s_cbranch_scc1 L_abort
    s_barrier
    ds_read_b128 v[40:43], v3 offset:0
    ds_read_b128 v[44:47], v3 offset:1024
    ds_read_b128 v[48:51], v3 offset:2048
    ds_read_b128 v[52:55], v3 offset:3072
    s_mov_b32 m0, 18432
    s_nop 0
    buffer_load_dwordx4 v0, s[4:7], s35 offen offset:0 sc1 lds
    buffer_load_dwordx4 v0, s[4:7], s35 offen offset:1024 sc1 lds
    buffer_load_dwordx4 v0, s[4:7], s35 offen offset:2048 sc1 lds
    buffer_load_dwordx4 v0, s[4:7], s35 offen offset:3072 sc1 lds
    buffer_load_dwordx4 v[56:59], v0, s[4:7], s24 offen offset:2048
    buffer_load_dwordx4 v[60:63], v0, s[4:7], s24 offen offset:3072
    v_mov_b64 v[28:29], 0
    v_mov_b64 v[30:31], 0
    v_mov_b64 v[32:33], 0
    v_mov_b64 v[34:35], 0
    v_mov_b64 v[36:37], 0
    v_mov_b64 v[38:39], 0
    s_waitcnt vmcnt(0) lgkmcnt(0)
    s_branch HZ_CF3_top
.p2align 6
HZ_CF3_top:
    s_barrier
    ds_read_b128 v[12:15], v1 offset:0
    ds_read_b128 v[16:19], v1 offset:512
    ds_read_b128 v[20:23], v1 offset:1024
    ds_read_b128 v[24:27], v1 offset:1536
    s_waitcnt lgkmcnt(3)
    v_smfmac_f32_16x16x64_bf16 v[28:31], v[12:15], v[40:47], v2
    v_smfmac_f32_16x16x64_bf16 v[32:35], v[12:15], v[48:55], v2
    v_smfmac_f32_16x16x64_bf16 v[36:39], v[12:15], a[240:247], v2
    s_barrier
    ds_read_b128 v[12:15], v1 offset:2048
    buffer_load_dwordx4 v[40:43], v0, s[4:7], s36 offen offset:0
    s_waitcnt lgkmcnt(3)
    v_smfmac_f32_16x16x64_bf16 v[28:31], v[16:19], a[0:7], v2
    buffer_load_dwordx4 v[44:47], v0, s[4:7], s36 offen offset:1024
    v_smfmac_f32_16x16x64_bf16 v[32:35], v[16:19], a[144:151], v2
    buffer_load_dwordx4 v[48:51], v0, s[4:7], s24 offen offset:0
    v_smfmac_f32_16x16x64_bf16 v[36:39], v[16:19], a[248:255], v2
    ds_read_b128 v[16:19], v1 offset:2560
    buffer_load_dwordx4 v[52:55], v0, s[4:7], s24 offen offset:1024
    s_waitcnt lgkmcnt(3)
    v_smfmac_f32_16x16x64_bf16 v[28:31], v[20:23], a[8:15], v2
    v_smfmac_f32_16x16x64_bf16 v[32:35], v[20:23], a[152:159], v2
    v_smfmac_f32_16x16x64_bf16 v[36:39], v[20:23], v[64:71], v2
    ds_read_b128 v[20:23], v1 offset:3072
    s_waitcnt lgkmcnt(3)
    v_smfmac_f32_16x16x64_bf16 v[28:31], v[24:27], a[16:23], v2
    v_smfmac_f32_16x16x64_bf16 v[32:35], v[24:27], a[160:167], v2
    s_barrier
    v_smfmac_f32_16x16x64_bf16 v[36:39], v[24:27], v[72:79], v2
    ds_read_b128 v[24:27], v1 offset:3584
    buffer_store_dwordx2 v[4:5], v9, s[8:11], s23 offen sc1
    s_mov_b32 s10, 0
    s_waitcnt lgkmcnt(3)
    v_smfmac_f32_16x16x64_bf16 v[28:31], v[12:15], a[24:31], v2
    v_smfmac_f32_16x16x64_bf16 v[32:35], v[12:15], a[168:175], v2
    v_smfmac_f32_16x16x64_bf16 v[36:39], v[12:15], v[80:87], v2
    ds_read_b128 v[12:15], v1 offset:4096
    s_waitcnt lgkmcnt(3)
    v_smfmac_f32_16x16x64_bf16 v[28:31], v[16:19], a[32:39], v2
    v_smfmac_f32_16x16x64_bf16 v[32:35], v[16:19], a[176:183], v2
    v_smfmac_f32_16x16x64_bf16 v[36:39], v[16:19], v[88:95], v2
    ds_read_b128 v[16:19], v1 offset:4608
    s_waitcnt lgkmcnt(3)
    v_smfmac_f32_16x16x64_bf16 v[28:31], v[20:23], a[40:47], v2
    v_smfmac_f32_16x16x64_bf16 v[32:35], v[20:23], a[184:191], v2
    v_smfmac_f32_16x16x64_bf16 v[36:39], v[20:23], v[96:103], v2
    ds_read_b128 v[20:23], v1 offset:5120
    s_waitcnt lgkmcnt(3)
    v_smfmac_f32_16x16x64_bf16 v[28:31], v[24:27], a[48:55], v2
    v_smfmac_f32_16x16x64_bf16 v[32:35], v[24:27], a[192:199], v2
    v_smfmac_f32_16x16x64_bf16 v[36:39], v[24:27], v[104:111], v2
    ds_read_b128 v[24:27], v1 offset:5632
    s_waitcnt lgkmcnt(3)
    v_smfmac_f32_16x16x64_bf16 v[28:31], v[12:15], a[56:63], v2
    s_waitcnt vmcnt(5)
    v_smfmac_f32_16x16x64_bf16 v[32:35], v[12:15], v[56:63], v2
    ds_read_b128 v[56:59], v3 offset:4096
    ds_read_b128 v[60:63], v3 offset:5120
    v_smfmac_f32_16x16x64_bf16 v[36:39], v[12:15], v[112:119], v2
    ds_read_b128 v[12:15], v1 offset:6144
    s_waitcnt lgkmcnt(5)
    v_smfmac_f32_16x16x64_bf16 v[28:31], v[16:19], a[64:71], v2
    v_smfmac_f32_16x16x64_bf16 v[32:35], v[16:19], a[200:207], v2
    s_waitcnt vmcnt(3)
    v_smfmac_f32_16x16x64_bf16 v[36:39], v[16:19], v[40:47], v2
    ds_read_b128 v[40:43], v3 offset:16384
    ds_read_b128 v[44:47], v3 offset:17408
    ds_read_b128 v[16:19], v1 offset:6656
    s_waitcnt lgkmcnt(7)
    v_smfmac_f32_16x16x64_bf16 v[28:31], v[20:23], a[72:79], v2
    s_waitcnt lgkmcnt(4)
    v_smfmac_f32_16x16x64_bf16 v[32:35], v[20:23], v[56:63], v2
    ds_read_b128 v[56:59], v3 offset:6144
    ds_read_b128 v[60:63], v3 offset:7168
    v_smfmac_f32_16x16x64_bf16 v[36:39], v[20:23], v[120:127], v2
    ds_read_b128 v[20:23], v1 offset:7168
    s_waitcnt vmcnt(1)
    v_smfmac_f32_16x16x64_bf16 v[28:31], v[24:27], v[48:55], v2
    ds_read_b128 v[48:51], v3 offset:8192
    ds_read_b128 v[52:55], v3 offset:9216
    v_smfmac_f32_16x16x64_bf16 v[32:35], v[24:27], a[208:215], v2
    s_waitcnt lgkmcnt(6)
    v_smfmac_f32_16x16x64_bf16 v[36:39], v[24:27], v[40:47], v2
    ds_read_b128 v[40:43], v3 offset:10240
    ds_read_b128 v[44:47], v3 offset:11264
    ds_read_b128 v[24:27], v1 offset:7680
    s_barrier
    v_smfmac_f32_16x16x64_bf16 v[28:31], v[12:15], a[80:87], v2
    s_waitcnt lgkmcnt(6)
    v_smfmac_f32_16x16x64_bf16 v[32:35], v[12:15], v[56:63], v2
    ds_read_b128 v[56:59], v3 offset:12288
    ds_read_b128 v[60:63], v3 offset:13312
    ds_read_b128 v[12:15], v1 offset:8192
    v_smfmac_f32_16x16x64_bf16 v[28:31], v[16:19], a[88:95], v2
    s_waitcnt lgkmcnt(6)
    v_smfmac_f32_16x16x64_bf16 v[32:35], v[16:19], v[48:55], v2
    ds_read_b128 v[16:19], v1 offset:8704
    v_smfmac_f32_16x16x64_bf16 v[28:31], v[20:23], a[96:103], v2
    s_waitcnt lgkmcnt(5)
    v_smfmac_f32_16x16x64_bf16 v[32:35], v[20:23], v[40:47], v2
    ds_read_b128 v[40:43], v3 offset:14336
    ds_read_b128 v[44:47], v3 offset:15360
    ds_read_b128 v[20:23], v1 offset:9216
    s_waitcnt lgkmcnt(7)
    v_smfmac_f32_16x16x64_bf16 v[28:31], v[24:27], a[104:111], v2
    s_waitcnt lgkmcnt(5)
    v_smfmac_f32_16x16x64_bf16 v[32:35], v[24:27], v[56:63], v2
    ds_read_b128 v[24:27], v1 offset:9728
    s_waitcnt lgkmcnt(5)
    v_smfmac_f32_16x16x64_bf16 v[28:31], v[12:15], a[112:119], v2
    v_smfmac_f32_16x16x64_bf16 v[32:35], v[12:15], a[216:223], v2
    s_waitcnt lgkmcnt(4)
    v_smfmac_f32_16x16x64_bf16 v[28:31], v[16:19], a[120:127], v2
    s_waitcnt lgkmcnt(2)
    v_smfmac_f32_16x16x64_bf16 v[32:35], v[16:19], v[40:47], v2
    ds_read_b128 v[56:59], v0 offset:14336
    ds_read_b128 v[60:63], v0 offset:18432
    s_waitcnt lgkmcnt(3)
    v_smfmac_f32_16x16x64_bf16 v[28:31], v[20:23], a[128:135], v2
    s_waitcnt lgkmcnt(2)
    v_smfmac_f32_16x16x64_bf16 v[28:31], v[24:27], a[136:143], v2
    ds_read_b128 v[48:51], v0 offset:15360
    ds_read_b128 v[52:55], v0 offset:19456
    v_smfmac_f32_16x16x64_bf16 v[32:35], v[20:23], a[224:231], v2
    v_smfmac_f32_16x16x64_bf16 v[32:35], v[24:27], a[232:239], v2
    s_nop 3
    v_cmp_u_f32 vcc, v28, v30
    v_cvt_pk_bf16_f32 v28, v28, v30
    v_cvt_pk_bf16_f32 v30, v29, v31
    v_smfmac_f32_16x16x64_bf16 v[36:39], v[12:15], v[160:167], v2
    ds_read_b128 v[12:15], v1 offset:6144
    v_smfmac_f32_16x16x64_bf16 v[36:39], v[16:19], v[168:175], v2
    ds_read_b128 v[16:19], v1 offset:6656
    s_cbranch_vccnz CF3_scan
CF3_scanned:
    v_cvt_pk_bf16_f32 v29, v32, v34
    v_cvt_pk_bf16_f32 v31, v33, v35
    ds_write_b64 v6, v[28:29]
    ds_write_b64 v6, v[30:31] offset:512
    v_smfmac_f32_16x16x64_bf16 v[36:39], v[20:23], v[176:183], v2
    ds_read_b128 v[20:23], v1 offset:7168
    v_smfmac_f32_16x16x64_bf16 v[36:39], v[24:27], v[184:191], v2
    ds_read_b128 v[24:27], v1 offset:7680
    s_waitcnt lgkmcnt(5)
    v_smfmac_f32_16x16x64_bf16 v[36:39], v[12:15], v[128:135], v2
    s_waitcnt lgkmcnt(4)
    v_smfmac_f32_16x16x64_bf16 v[36:39], v[16:19], v[136:143], v2
    s_cmp_ge_u32 s14, 61
    s_cbranch_scc1 CF3_pub62
CF3_pub62b:
    s_waitcnt lgkmcnt(2)
    s_barrier
    ds_read_b64_tr_b16 v[28:29], v7 offset:0
    ds_read_b64_tr_b16 v[30:31], v7 offset:512
    s_waitcnt lgkmcnt(3)
    v_smfmac_f32_16x16x64_bf16 v[36:39], v[20:23], v[144:151], v2
    ds_read_b64_tr_b16 v[32:33], v7 offset:1024
    ds_read_b64_tr_b16 v[34:35], v7 offset:1536
    s_waitcnt lgkmcnt(4)
    v_smfmac_f32_16x16x64_bf16 v[36:39], v[24:27], v[152:159], v2
    s_waitcnt lgkmcnt(2)
    v_mfma_f32_16x16x32_bf16 v[12:15], v[56:59], v[28:31], 0
    ds_read_b64_tr_b16 v[40:41], v7 offset:2048
    ds_read_b64_tr_b16 v[42:43], v7 offset:2560
    v_mfma_f32_16x16x32_bf16 v[20:23], v[60:63], v[28:31], 0
    ds_read_b128 v[56:59], v0 offset:16384
    ds_read_b128 v[60:63], v0 offset:20480
    s_waitcnt lgkmcnt(4)
    v_mfma_f32_16x16x32_bf16 v[12:15], v[48:51], v[32:35], v[12:15]
    ds_read_b64_tr_b16 v[44:45], v7 offset:3072
    ds_read_b64_tr_b16 v[46:47], v7 offset:3584
    v_mfma_f32_16x16x32_bf16 v[20:23], v[52:55], v[32:35], v[20:23]
    ds_read_b128 v[48:51], v0 offset:17408
    ds_read_b128 v[52:55], v0 offset:21504
    v_mfma_f32_16x16x32_bf16 v[16:19], v[28:31], v[28:31], 0
    v_mov_b64 v[24:25], s[98:99]
    v_mov_b64 v[26:27], s[98:99]
    v_mfma_f32_16x16x32_bf16 v[16:19], v[32:35], v[32:35], v[16:19]
    s_waitcnt lgkmcnt(4)
    v_mfma_f32_16x16x32_bf16 v[12:15], v[56:59], v[40:43], v[12:15]
    v_mfma_f32_16x16x32_bf16 v[20:23], v[60:63], v[40:43], v[20:23]
    buffer_load_dwordx4 v[56:59], v0, s[4:7], s21 offen sc1
    v_cvt_pk_bf16_f32 v36, v36, v38
    s_waitcnt lgkmcnt(0)
    v_mfma_f32_16x16x32_bf16 v[12:15], v[48:51], v[44:47], v[12:15]
    v_cvt_pk_bf16_f32 v37, v37, v39
    v_mfma_f32_16x16x32_bf16 v[20:23], v[52:55], v[44:47], v[20:23]
    buffer_load_dwordx4 v[60:63], v0, s[4:7], s21 offen offset:1024 sc1
    v_mfma_f32_16x16x32_bf16 v[16:19], v[40:43], v[40:43], v[16:19]
    v_mov_b32 v53, 0
    v_mov_b32 v54, 0
    v_mfma_f32_16x16x32_bf16 v[16:19], v[44:47], v[44:47], v[16:19]
    s_nop 0
    v_max3_f32 v11, v12, v13, v14
    s_nop 0
    v_max3_f32 v10, v15, v20, v21
    v_max3_f32 v11, v11, v22, v23
    v_max_f32 v11, v11, v10
    buffer_load_dwordx4 v[28:31], v0, s[4:7], s36 offen offset:2048
    s_nop 0
    v_max3_f32 v10, v11, v18, v19
    v_max3_f32 v11, v11, v18, v19
    s_nop 1
    v_permlane32_swap_b32 v10, v11
    v_max_f32 v16, v10, v11
    v_max_f32 v10, v10, v11
    buffer_load_dwordx4 v[32:35], v0, s[4:7], s36 offen offset:3072
    s_nop 0
    v_permlane16_swap_b32 v10, v16
    v_max_f32 v10, v10, v16
    v_mul_f32 v10, s33, v10
    v_pk_fma_f32 v[12:13], v[12:13], s[96:97], v[10:11] op_sel_hi:[1,1,0] neg_lo:[0,0,1] neg_hi:[0,0,1]
    v_pk_fma_f32 v[14:15], v[14:15], s[96:97], v[10:11] op_sel_hi:[1,1,0] neg_lo:[0,0,1] neg_hi:[0,0,1]
    v_pk_fma_f32 v[20:21], v[20:21], s[96:97], v[10:11] op_sel_hi:[1,1,0] neg_lo:[0,0,1] neg_hi:[0,0,1]
    v_pk_fma_f32 v[22:23], v[22:23], s[96:97], v[10:11] op_sel_hi:[1,1,0] neg_lo:[0,0,1] neg_hi:[0,0,1]
    v_pk_fma_f32 v[18:19], v[18:19], s[96:97], v[10:11] op_sel_hi:[1,1,0] neg_lo:[0,0,1] neg_hi:[0,0,1]
    v_exp_f32 v12, v12
    v_exp_f32 v13, v13
    v_exp_f32 v14, v14
    v_cvt_pk_bf16_f32 v48, v12, v13
    v_exp_f32 v15, v15
    v_exp_f32 v20, v20
    v_cvt_pk_bf16_f32 v49, v14, v15
    v_exp_f32 v21, v21
    v_exp_f32 v22, v22
    v_cvt_pk_bf16_f32 v50, v20, v21
    v_exp_f32 v23, v23
    v_exp_f32 v18, v18
    v_cvt_pk_bf16_f32 v51, v22, v23
    v_exp_f32 v19, v19
    s_nop 0
    v_mfma_f32_16x16x32_bf16 v[20:23], v[24:27], v[48:51], 0
    v_cvt_pk_bf16_f32 v52, v18, v19
    v_cvt_pk_bf16_f32 v55, v18, v19
    s_waitcnt vmcnt(2)
    v_mfma_f32_16x16x32_bf16 v[12:15], v[60:63], v[48:51], 0
    buffer_load_dwordx4 v[40:43], v0, s[4:7], s37 offen offset:0
    s_nop 0
    v_mfma_f32_16x16x16_bf16 v[20:23], v[24:25], v[52:53], v[20:23]
    buffer_load_dwordx4 v[44:47], v0, s[4:7], s37 offen offset:1024
    v_mfma_f32_16x16x32_bf16 v[24:27], v[56:59], v[48:51], 0
    ds_read_b128 v[56:59], v3 offset:18432
    ds_read_b128 v[60:63], v3 offset:19456
    v_mfma_f32_16x16x16_bf16 v[12:15], v[36:37], v[54:55], v[12:15]
    s_nop 2
    v_rcp_f32 v10, v20
    v_mfma_f32_16x16x16_bf16 v[24:27], v[36:37], v[52:53], v[24:27]
    s_add_u32 s14, s14, 1
    s_add_u32 s21, s21, 262144
    s_add_u32 s35, s35, 262144
    s_add_u32 s20, s20, 262144
    v_pk_mul_f32 v[12:13], v[12:13], v[10:11] op_sel_hi:[1,0]
    v_pk_mul_f32 v[14:15], v[14:15], v[10:11] op_sel_hi:[1,0]
    s_nop 1
    v_pk_mul_f32 v[24:25], v[24:25], v[10:11] op_sel_hi:[1,0]
    v_cvt_pk_bf16_f32 v48, v24, v12
    v_cvt_pk_bf16_f32 v49, v25, v13
    v_pk_mul_f32 v[26:27], v[26:27], v[10:11] op_sel_hi:[1,0]
    v_cvt_pk_bf16_f32 v50, v26, v14
    v_cvt_pk_bf16_f32 v51, v27, v15
    ds_write_b128 v8, v[48:51]
    v_mov_b64 v[36:37], 0
    v_mov_b64 v[38:39], 0
    s_waitcnt lgkmcnt(0)
    buffer_load_dwordx4 v[48:51], v0, s[4:7], s37 offen offset:2048
    buffer_load_dwordx4 v[52:55], v0, s[4:7], s37 offen offset:3072
    s_barrier
    ds_read_b128 v[12:15], v1 offset:0
    ds_read_b128 v[16:19], v1 offset:512
    ds_read_b128 v[20:23], v1 offset:1024
    ds_read_b128 v[24:27], v1 offset:1536
    s_waitcnt lgkmcnt(3)
    s_waitcnt vmcnt(4)
    v_smfmac_f32_16x16x64_bf16 v[36:39], v[12:15], v[28:35], v2
    s_waitcnt lgkmcnt(2)
    s_waitcnt vmcnt(2)
    v_smfmac_f32_16x16x64_bf16 v[36:39], v[16:19], v[40:47], v2
    buffer_load_dwordx4 v[40:43], v0, s[4:7], s38 offen offset:0
    v_mov_b64 v[28:29], 0
    s_waitcnt lgkmcnt(1)
    v_smfmac_f32_16x16x64_bf16 v[36:39], v[20:23], v[56:63], v2
    ds_read_b128 v[56:59], v3 offset:20480
    ds_read_b128 v[60:63], v3 offset:21504
    v_mov_b64 v[30:31], 0
    s_waitcnt lgkmcnt(2)
    v_smfmac_f32_16x16x64_bf16 v[36:39], v[24:27], v[192:199], v2
    buffer_load_dwordx4 v[44:47], v0, s[4:7], s38 offen offset:1024
    v_mov_b64 v[32:33], 0
    v_smfmac_f32_16x16x64_bf16 v[28:31], v[12:15], v[200:207], v2
    v_mov_b64 v[34:35], 0
    v_smfmac_f32_16x16x64_bf16 v[28:31], v[16:19], v[208:215], v2
    s_nop 2
    v_cvt_pk_bf16_f32 v36, v36, v37
    s_waitcnt lgkmcnt(0)
    v_smfmac_f32_16x16x64_bf16 v[28:31], v[20:23], v[56:63], v2
    ds_read_b128 v[56:59], v3 offset:22528
    ds_read_b128 v[60:63], v3 offset:23552
    v_cvt_pk_bf16_f32 v37, v38, v39
    v_smfmac_f32_16x16x64_bf16 v[28:31], v[24:27], v[216:223], v2
    v_and_or_b32 v36, v36, -2, s18
    v_smfmac_f32_16x16x64_bf16 v[32:35], v[12:15], v[224:231], v2
    s_waitcnt vmcnt(2)
    v_smfmac_f32_16x16x64_bf16 v[32:35], v[16:19], v[48:55], v2
    ds_read_b128 v[48:51], v3 offset:24576
    ds_read_b128 v[52:55], v3 offset:25600
    s_nop 1
    v_cvt_pk_bf16_f32 v38, v28, v29
    v_cvt_pk_bf16_f32 v39, v30, v31
    buffer_store_dwordx4 v[36:39], v0, s[4:7], s25 offen
    s_waitcnt lgkmcnt(2)
    v_smfmac_f32_16x16x64_bf16 v[32:35], v[20:23], v[56:63], v2
    ds_read_b128 v[56:59], v3 offset:26624
    ds_read_b128 v[60:63], v3 offset:27648
    s_mov_b32 m0, 18432
    v_mov_b64 v[36:37], 0
    v_mov_b64 v[38:39], 0
    v_smfmac_f32_16x16x64_bf16 v[32:35], v[24:27], v[232:239], v2
    buffer_load_dwordx4 v0, s[4:7], s35 offen offset:0 sc1 lds
    s_waitcnt lgkmcnt(2)
    v_smfmac_f32_16x16x64_bf16 v[36:39], v[12:15], v[48:55], v2
    ds_read_b128 v[48:51], v3 offset:28672
    ds_read_b128 v[52:55], v3 offset:29696
    buffer_load_dwordx4 v0, s[4:7], s35 offen offset:1024 sc1 lds
    v_mov_b64 v[28:29], 0
    s_waitcnt lgkmcnt(2)
    v_smfmac_f32_16x16x64_bf16 v[36:39], v[16:19], v[56:63], v2
    ds_read_b128 v[56:59], v3 offset:30720
    ds_read_b128 v[60:63], v3 offset:31744
    buffer_load_dwordx4 v0, s[4:7], s35 offen offset:2048 sc1 lds
    v_mov_b64 v[30:31], 0
    v_cvt_pk_bf16_f32 v32, v32, v33
    v_smfmac_f32_16x16x64_bf16 v[36:39], v[20:23], v[240:247], v2
    buffer_load_dwordx4 v0, s[4:7], s35 offen offset:3072 sc1 lds
    v_cvt_pk_bf16_f32 v33, v34, v35
    s_waitcnt lgkmcnt(2)
    v_smfmac_f32_16x16x64_bf16 v[36:39], v[24:27], v[48:55], v2
    ds_read_b128 v[48:51], v3 offset:32768
    ds_read_b128 v[52:55], v3 offset:33792
    v_and_or_b32 v32, v32, -2, s18
    s_waitcnt lgkmcnt(2)
    v_smfmac_f32_16x16x64_bf16 v[28:31], v[12:15], v[56:63], v2
    v_smfmac_f32_16x16x64_bf16 v[28:31], v[16:19], v[248:255], v2
    s_nop 1
    v_cvt_pk_bf16_f32 v34, v36, v37
    v_cvt_pk_bf16_f32 v35, v38, v39
    buffer_store_dwordx4 v[32:35], v0, s[4:7], s26 offen
    s_waitcnt lgkmcnt(0)
    v_smfmac_f32_16x16x64_bf16 v[28:31], v[20:23], v[48:55], v2
    s_waitcnt vmcnt(6)
    v_smfmac_f32_16x16x64_bf16 v[28:31], v[24:27], v[40:47], v2
    s_nop 7
    v_cvt_pk_bf16_f32 v28, v28, v29
    v_cvt_pk_bf16_f32 v29, v30, v31
    v_and_or_b32 v28, v28, -2, s18
    buffer_store_dwordx2 v[28:29], v9, s[4:7], s27 offen
    ds_read_b128 v[40:43], v3 offset:0
    ds_read_b128 v[44:47], v3 offset:1024
    ds_read_b128 v[48:51], v3 offset:2048
    ds_read_b128 v[52:55], v3 offset:3072
    s_add_u32 s42, s15, s22
    s_sub_u32 s42, s42, 12288
    s_add_u32 s10, s42, 320
    s_cmp_lt_u32 s22, 10240
    s_cselect_b32 s10, s10, 0
    buffer_load_dwordx2 v[4:5], v9, s[8:11], s42 offen sc1
    s_add_u32 s23, s23, 10240
    s_add_u32 s10, s23, 320
    s_cmp_lt_u32 s22, 10240
    s_cselect_b32 s10, s10, 0
    s_cmp_eq_u32 s14, 63
    s_cbranch_scc1 CF3_last
    s_cmp_eq_u32 s31, 1
    s_cbranch_scc1 CF3_kvok
    s_lshl_b32 s42, s14, 7
    s_add_u32 s42, s42, 8448
    s_min_u32 s42, s42, 16256
    s_load_dword s28, s[4:5], s42 glc
    s_load_dword s29, s[4:5], 16256 glc
    s_waitcnt lgkmcnt(0)
    s_cmp_ge_u32 s29, 32
    s_cselect_b32 s31, 1, 0
    s_cmp_ge_u32 s28, 32
    s_cbranch_scc0 CF3_kvw
CF3_kvok:
    s_add_u32 s15, s16, 12288
    s_add_u32 s16, s16, 16384
    s_and_b32 s16, s16, 0xffff
    s_or_b32 s16, s16, 65536
    s_add_u32 s17, s17, 16384
    s_and_b32 s17, s17, 0xffff
    s_or_b32 s17, s17, 65536
    s_xor_b32 s18, s18, 1
    s_not_b32 s19, s19
    v_mov_b64 v[28:29], 0
    v_mov_b64 v[30:31], 0
    v_mov_b64 v[32:33], 0
    v_mov_b64 v[34:35], 0
    v_mov_b64 v[36:37], 0
    v_mov_b64 v[38:39], 0
    s_waitcnt vmcnt(0) lgkmcnt(0)
    s_barrier
    buffer_load_dwordx4 v[56:59], v0, s[4:7], s24 offen offset:2048
    buffer_load_dwordx4 v[60:63], v0, s[4:7], s24 offen offset:3072
    s_branch HZ_CF3_top
CF3_scan:
    v_mov_b32 v10, 0
    ds_read_b32 v11, v0 offset:0
    s_waitcnt lgkmcnt(0)
    v_max_u32 v10, v10, v11
    ds_read_b32 v11, v0 offset:1024
    s_waitcnt lgkmcnt(0)
    v_max_u32 v10, v10, v11
    ds_read_b32 v11, v0 offset:2048
    s_waitcnt lgkmcnt(0)
    v_max_u32 v10, v10, v11
    ds_read_b32 v11, v0 offset:3072
    s_waitcnt lgkmcnt(0)
    v_max_u32 v10, v10, v11
    ds_read_b32 v11, v0 offset:4096
    s_waitcnt lgkmcnt(0)
    v_max_u32 v10, v10, v11
    ds_read_b32 v11, v0 offset:5120
    s_waitcnt lgkmcnt(0)
    v_max_u32 v10, v10, v11
    ds_read_b32 v11, v0 offset:6144
    s_waitcnt lgkmcnt(0)
    v_max_u32 v10, v10, v11
    ds_read_b32 v11, v0 offset:7168
    s_waitcnt lgkmcnt(0)
    v_max_u32 v10, v10, v11
    ds_read_b32 v11, v0 offset:8192
    s_waitcnt lgkmcnt(0)
    v_max_u32 v10, v10, v11
    ds_read_b32 v11, v0 offset:9216
    s_waitcnt lgkmcnt(0)
    v_max_u32 v10, v10, v11
    v_cmp_eq_u32 vcc, -1, v10
    s_cbranch_vccnz CF3_rec
    s_branch CF3_scanned
CF3_kvw:
    v_mov_b32 v10, 0
CF3_kvw2:
    buffer_load_dword v11, v10, s[4:7], s42 offen sc1
    s_add_u32 s32, s32, 1
    s_cmp_gt_u32 s32, 0x40000
    s_cbranch_scc1 L_abort
    s_waitcnt vmcnt(0)
    v_cmp_gt_u32 vcc, 32, v11
    s_cbranch_vccnz CF3_kvw2
    s_branch CF3_kvok
CF3_pub62:
    v_add_u32 v11, s22, v9
    ds_read_b64 v[4:5], v11 offset:0
    s_add_u32 s42, s23, 10240
    s_add_u32 s10, s42, 320
    s_waitcnt lgkmcnt(0)
    buffer_store_dwordx2 v[4:5], v9, s[8:11], s42 offen sc1
    s_mov_b32 s10, 0
    s_branch CF3_pub62b
CF3_last:
    s_waitcnt vmcnt(0)
    s_branch CF3_done
CF3_done:
    s_waitcnt vmcnt(0) lgkmcnt(0)
    s_endpgm
C_slow:
    s_cmp_eq_u32 s13, 1
    s_cbranch_scc1 CS_w1
    s_cmp_eq_u32 s13, 2
    s_cbranch_scc1 CS_w2
    s_cmp_eq_u32 s13, 3
    s_cbranch_scc1 CS_w3
CS_w0:
    v_lshlrev_b32 v11, 3, v0
    s_mov_b32 s42, 65536
    buffer_load_dwordx2 v[12:13], v5, s[4:7], s42 offen sc1
    s_mov_b32 s42, 81920
    buffer_load_dwordx2 v[12:13], v5, s[4:7], s42 offen sc1
    s_mov_b32 s42, 98304
    buffer_load_dwordx2 v[12:13], v5, s[4:7], s42 offen sc1
    s_mov_b32 s42, 114688
    buffer_load_dwordx2 v[12:13], v5, s[4:7], s42 offen sc1
    buffer_load_dword v14, v11, s[4:7], s25 offen sc1
CS0_rec:
    s_waitcnt vmcnt(0) lgkmcnt(0)
    s_add_u32 s32, s32, 1
    s_cmp_gt_u32 s32, 0x40000
    s_cbranch_scc1 L_abort
    s_barrier
    ds_read_b128 v[40:43], v3 offset:0
    ds_read_b128 v[44:47], v3 offset:1024
    ds_read_b128 v[48:51], v3 offset:2048
    ds_read_b128 v[52:55], v3 offset:3072
    s_mov_b32 m0, 14336
    s_nop 0
    buffer_load_dwordx4 v0, s[4:7], s20 offen offset:0 sc1 lds
    buffer_load_dwordx4 v0, s[4:7], s20 offen offset:1024 sc1 lds
    buffer_load_dwordx4 v0, s[4:7], s20 offen offset:2048 sc1 lds
    buffer_load_dwordx4 v0, s[4:7], s20 offen offset:3072 sc1 lds
    s_mov_b32 m0, 0
    s_nop 0
    buffer_load_dwordx4 v0, s[4:7], s15 offen offset:0 sc1 lds
    buffer_load_dwordx4 v0, s[4:7], s15 offen offset:1024 sc1 lds
    buffer_load_dwordx4 v0, s[4:7], s15 offen offset:2048 sc1 lds
    buffer_load_dwordx4 v0, s[4:7], s15 offen offset:3072 sc1 lds
    buffer_load_dwordx4 v[56:59], v0, s[4:7], s24 offen offset:2048
    buffer_load_dwordx4 v[60:63], v0, s[4:7], s24 offen offset:3072
    v_mov_b64 v[28:29], 0
    v_mov_b64 v[30:31], 0
    v_mov_b64 v[32:33], 0
    v_mov_b64 v[34:35], 0
    v_mov_b64 v[36:37], 0
    v_mov_b64 v[38:39], 0
    s_waitcnt vmcnt(0) lgkmcnt(0)
    s_branch HZ_CS0_top
.p2align 6
CS0_pretop:
    s_waitcnt vmcnt(4)
HZ_CS0_top:
    s_barrier
    ds_read_b128 v[12:15], v1 offset:0
    ds_read_b128 v[16:19], v1 offset:512
    ds_read_b128 v[20:23], v1 offset:1024
    ds_read_b128 v[24:27], v1 offset:1536
    s_waitcnt lgkmcnt(3)
    v_smfmac_f32_16x16x64_bf16 v[28:31], v[12:15], v[40:47], v2
    v_smfmac_f32_16x16x64_bf16 v[32:35], v[12:15], v[48:55], v2
    v_smfmac_f32_16x16x64_bf16 v[36:39], v[12:15], a[240:247], v2
    s_waitcnt vmcnt(2)
    s_barrier
    ds_read_b128 v[12:15], v1 offset:2048
    buffer_load_dwordx4 v[40:43], v0, s[4:7], s36 offen offset:0
    s_waitcnt lgkmcnt(3)
    v_smfmac_f32_16x16x64_bf16 v[28:31], v[16:19], a[0:7], v2
    buffer_load_dwordx4 v[44:47], v0, s[4:7], s36 offen offset:1024
    v_smfmac_f32_16x16x64_bf16 v[32:35], v[16:19], a[144:151], v2
    buffer_load_dwordx4 v[48:51], v0, s[4:7], s24 offen offset:0
    v_smfmac_f32_16x16x64_bf16 v[36:39], v[16:19], a[248:255], v2
    ds_read_b128 v[16:19], v1 offset:2560
    buffer_load_dwordx4 v[52:55], v0, s[4:7], s24 offen offset:1024
    s_waitcnt lgkmcnt(3)
    v_smfmac_f32_16x16x64_bf16 v[28:31], v[20:23], a[8:15], v2
    v_smfmac_f32_16x16x64_bf16 v[32:35], v[20:23], a[152:159], v2
    v_smfmac_f32_16x16x64_bf16 v[36:39], v[20:23], v[64:71], v2
    ds_read_b128 v[20:23], v1 offset:3072
    s_waitcnt lgkmcnt(3)
    v_smfmac_f32_16x16x64_bf16 v[28:31], v[24:27], a[16:23], v2
    v_smfmac_f32_16x16x64_bf16 v[32:35], v[24:27], a[160:167], v2
    s_barrier
    v_smfmac_f32_16x16x64_bf16 v[36:39], v[24:27], v[72:79], v2
    ds_read_b128 v[24:27], v1 offset:3584
    v_lshlrev_b32 v10, 3, v0
    s_mov_b32 m0, 23552
    s_nop 0
    buffer_load_dword v10, s[4:7], s47 offen sc1 lds
    buffer_load_dword v10, s[4:7], s48 offen sc1 lds
    s_waitcnt lgkmcnt(3)
    v_smfmac_f32_16x16x64_bf16 v[28:31], v[12:15], a[24:31], v2
    v_smfmac_f32_16x16x64_bf16 v[32:35], v[12:15], a[168:175], v2
    v_smfmac_f32_16x16x64_bf16 v[36:39], v[12:15], v[80:87], v2
    ds_read_b128 v[12:15], v1 offset:4096
    s_waitcnt lgkmcnt(3)
    v_smfmac_f32_16x16x64_bf16 v[28:31], v[16:19], a[32:39], v2
    v_smfmac_f32_16x16x64_bf16 v[32:35], v[16:19], a[176:183], v2
    v_smfmac_f32_16x16x64_bf16 v[36:39], v[16:19], v[88:95], v2
    ds_read_b128 v[16:19], v1 offset:4608
    s_waitcnt lgkmcnt(3)
    v_smfmac_f32_16x16x64_bf16 v[28:31], v[20:23], a[40:47], v2
    v_smfmac_f32_16x16x64_bf16 v[32:35], v[20:23], a[184:191], v2
    v_smfmac_f32_16x16x64_bf16 v[36:39], v[20:23], v[96:103], v2
    ds_read_b128 v[20:23], v1 offset:5120
    s_waitcnt lgkmcnt(3)
    v_smfmac_f32_16x16x64_bf16 v[28:31], v[24:27], a[48:55], v2
    v_smfmac_f32_16x16x64_bf16 v[32:35], v[24:27], a[192:199], v2
    v_smfmac_f32_16x16x64_bf16 v[36:39], v[24:27], v[104:111], v2
    ds_read_b128 v[24:27], v1 offset:5632
    s_waitcnt lgkmcnt(3)
    v_smfmac_f32_16x16x64_bf16 v[28:31], v[12:15], a[56:63], v2
    s_waitcnt vmcnt(6)
    v_smfmac_f32_16x16x64_bf16 v[32:35], v[12:15], v[56:63], v2
    ds_read_b128 v[56:59], v3 offset:4096
    ds_read_b128 v[60:63], v3 offset:5120
    v_smfmac_f32_16x16x64_bf16 v[36:39], v[12:15], v[112:119], v2
    ds_read_b128 v[12:15], v1 offset:6144
    s_waitcnt lgkmcnt(5)
    v_smfmac_f32_16x16x64_bf16 v[28:31], v[16:19], a[64:71], v2
    v_smfmac_f32_16x16x64_bf16 v[32:35], v[16:19], a[200:207], v2
    s_waitcnt vmcnt(4)
    v_smfmac_f32_16x16x64_bf16 v[36:39], v[16:19], v[40:47], v2
    ds_read_b128 v[40:43], v3 offset:16384
    ds_read_b128 v[44:47], v3 offset:17408
    ds_read_b128 v[16:19], v1 offset:6656
    s_waitcnt lgkmcnt(7)
    v_smfmac_f32_16x16x64_bf16 v[28:31], v[20:23], a[72:79], v2
    s_waitcnt lgkmcnt(4)
    v_smfmac_f32_16x16x64_bf16 v[32:35], v[20:23], v[56:63], v2
    ds_read_b128 v[56:59], v3 offset:6144
    ds_read_b128 v[60:63], v3 offset:7168
    v_smfmac_f32_16x16x64_bf16 v[36:39], v[20:23], v[120:127], v2
    ds_read_b128 v[20:23], v1 offset:7168
    s_waitcnt vmcnt(2)
    v_smfmac_f32_16x16x64_bf16 v[28:31], v[24:27], v[48:55], v2
    ds_read_b128 v[48:51], v3 offset:8192
    ds_read_b128 v[52:55], v3 offset:9216
    v_smfmac_f32_16x16x64_bf16 v[32:35], v[24:27], a[208:215], v2
    s_waitcnt lgkmcnt(6)
    v_smfmac_f32_16x16x64_bf16 v[36:39], v[24:27], v[40:47], v2
    ds_read_b128 v[40:43], v3 offset:10240
    ds_read_b128 v[44:47], v3 offset:11264
    ds_read_b128 v[24:27], v1 offset:7680
    s_barrier
    v_smfmac_f32_16x16x64_bf16 v[28:31], v[12:15], a[80:87], v2
    s_waitcnt lgkmcnt(6)
    v_smfmac_f32_16x16x64_bf16 v[32:35], v[12:15], v[56:63], v2
    ds_read_b128 v[56:59], v3 offset:12288
    ds_read_b128 v[60:63], v3 offset:13312
    ds_read_b128 v[12:15], v1 offset:8192
    v_smfmac_f32_16x16x64_bf16 v[28:31], v[16:19], a[88:95], v2
    s_waitcnt lgkmcnt(6)
    v_smfmac_f32_16x16x64_bf16 v[32:35], v[16:19], v[48:55], v2
    ds_read_b128 v[16:19], v1 offset:8704
    v_smfmac_f32_16x16x64_bf16 v[28:31], v[20:23], a[96:103], v2
    s_waitcnt lgkmcnt(5)
    v_smfmac_f32_16x16x64_bf16 v[32:35], v[20:23], v[40:47], v2
    ds_read_b128 v[40:43], v3 offset:14336
    ds_read_b128 v[44:47], v3 offset:15360
    ds_read_b128 v[20:23], v1 offset:9216
    s_waitcnt lgkmcnt(7)
    v_smfmac_f32_16x16x64_bf16 v[28:31], v[24:27], a[104:111], v2
    s_waitcnt lgkmcnt(5)
    v_smfmac_f32_16x16x64_bf16 v[32:35], v[24:27], v[56:63], v2
    ds_read_b128 v[24:27], v1 offset:9728
    s_waitcnt lgkmcnt(5)
    v_smfmac_f32_16x16x64_bf16 v[28:31], v[12:15], a[112:119], v2
    v_smfmac_f32_16x16x64_bf16 v[32:35], v[12:15], a[216:223], v2
    s_waitcnt lgkmcnt(4)
    v_smfmac_f32_16x16x64_bf16 v[28:31], v[16:19], a[120:127], v2
    s_waitcnt lgkmcnt(2)
    v_smfmac_f32_16x16x64_bf16 v[32:35], v[16:19], v[40:47], v2
    ds_read_b128 v[56:59], v0 offset:14336
    ds_read_b128 v[60:63], v0 offset:18432
    s_waitcnt lgkmcnt(3)
    v_smfmac_f32_16x16x64_bf16 v[28:31], v[20:23], a[128:135], v2
    s_waitcnt lgkmcnt(2)
    v_smfmac_f32_16x16x64_bf16 v[28:31], v[24:27], a[136:143], v2
    ds_read_b128 v[48:51], v0 offset:15360
    ds_read_b128 v[52:55], v0 offset:19456
    v_smfmac_f32_16x16x64_bf16 v[32:35], v[20:23], a[224:231], v2
    v_smfmac_f32_16x16x64_bf16 v[32:35], v[24:27], a[232:239], v2
    s_nop 3
    v_cmp_u_f32 vcc, v28, v30
    v_cvt_pk_bf16_f32 v28, v28, v30
    v_cvt_pk_bf16_f32 v30, v29, v31
    v_smfmac_f32_16x16x64_bf16 v[36:39], v[12:15], v[160:167], v2
    ds_read_b128 v[12:15], v1 offset:6144
    v_smfmac_f32_16x16x64_bf16 v[36:39], v[16:19], v[168:175], v2
    ds_read_b128 v[16:19], v1 offset:6656
    s_cbranch_vccnz CS0_scan
CS0_scanned:
    v_cvt_pk_bf16_f32 v29, v32, v34
    v_cvt_pk_bf16_f32 v31, v33, v35
    ds_write_b64 v6, v[28:29]
    ds_write_b64 v6, v[30:31] offset:512
    v_smfmac_f32_16x16x64_bf16 v[36:39], v[20:23], v[176:183], v2
    ds_read_b128 v[20:23], v1 offset:7168
    v_smfmac_f32_16x16x64_bf16 v[36:39], v[24:27], v[184:191], v2
    ds_read_b128 v[24:27], v1 offset:7680
    s_waitcnt lgkmcnt(5)
    v_smfmac_f32_16x16x64_bf16 v[36:39], v[12:15], v[128:135], v2
    s_waitcnt lgkmcnt(4)
    v_smfmac_f32_16x16x64_bf16 v[36:39], v[16:19], v[136:143], v2
    s_waitcnt lgkmcnt(2)
    s_barrier
    ds_read_b64_tr_b16 v[28:29], v7 offset:0
    ds_read_b64_tr_b16 v[30:31], v7 offset:512
    s_waitcnt lgkmcnt(3)
    v_smfmac_f32_16x16x64_bf16 v[36:39], v[20:23], v[144:151], v2
    ds_read_b64_tr_b16 v[32:33], v7 offset:1024
    ds_read_b64_tr_b16 v[34:35], v7 offset:1536
    s_waitcnt lgkmcnt(4)
    v_smfmac_f32_16x16x64_bf16 v[36:39], v[24:27], v[152:159], v2
    s_waitcnt lgkmcnt(2)
    v_mfma_f32_16x16x32_bf16 v[12:15], v[56:59], v[28:31], 0
    ds_read_b64_tr_b16 v[40:41], v7 offset:2048
    ds_read_b64_tr_b16 v[42:43], v7 offset:2560
    v_mfma_f32_16x16x32_bf16 v[20:23], v[60:63], v[28:31], 0
    ds_read_b128 v[56:59], v0 offset:16384
    ds_read_b128 v[60:63], v0 offset:20480
    s_waitcnt lgkmcnt(4)
    v_mfma_f32_16x16x32_bf16 v[12:15], v[48:51], v[32:35], v[12:15]
    ds_read_b64_tr_b16 v[44:45], v7 offset:3072
    ds_read_b64_tr_b16 v[46:47], v7 offset:3584
    v_mfma_f32_16x16x32_bf16 v[20:23], v[52:55], v[32:35], v[20:23]
    ds_read_b128 v[48:51], v0 offset:17408
    ds_read_b128 v[52:55], v0 offset:21504
    v_mfma_f32_16x16x32_bf16 v[16:19], v[28:31], v[28:31], 0
    v_mov_b64 v[24:25], s[98:99]
    v_mov_b64 v[26:27], s[98:99]
    v_mfma_f32_16x16x32_bf16 v[16:19], v[32:35], v[32:35], v[16:19]
    s_waitcnt lgkmcnt(4)
    v_mfma_f32_16x16x32_bf16 v[12:15], v[56:59], v[40:43], v[12:15]
    v_mfma_f32_16x16x32_bf16 v[20:23], v[60:63], v[40:43], v[20:23]
    buffer_load_dwordx4 v[56:59], v0, s[4:7], s21 offen sc1
    v_cvt_pk_bf16_f32 v36, v36, v38
    s_waitcnt lgkmcnt(0)
    v_mfma_f32_16x16x32_bf16 v[12:15], v[48:51], v[44:47], v[12:15]
    v_cvt_pk_bf16_f32 v37, v37, v39
    v_mfma_f32_16x16x32_bf16 v[20:23], v[52:55], v[44:47], v[20:23]
    buffer_load_dwordx4 v[60:63], v0, s[4:7], s21 offen offset:1024 sc1
    v_mfma_f32_16x16x32_bf16 v[16:19], v[40:43], v[40:43], v[16:19]
    v_mov_b32 v53, 0
    v_mov_b32 v54, 0
    v_mfma_f32_16x16x32_bf16 v[16:19], v[44:47], v[44:47], v[16:19]
    s_nop 0
    v_max3_f32 v11, v12, v13, v14
    s_nop 0
    v_max3_f32 v10, v15, v20, v21
    v_max3_f32 v11, v11, v22, v23
    v_max_f32 v11, v11, v10
    buffer_load_dwordx4 v[28:31], v0, s[4:7], s36 offen offset:2048
    s_nop 0
    v_max3_f32 v10, v11, v18, v19
    v_max3_f32 v11, v11, v18, v19
    s_nop 1
    v_permlane32_swap_b32 v10, v11
    v_max_f32 v16, v10, v11
    v_max_f32 v10, v10, v11
    buffer_load_dwordx4 v[32:35], v0, s[4:7], s36 offen offset:3072
    s_nop 0
    v_permlane16_swap_b32 v10, v16
    v_max_f32 v10, v10, v16
    v_mul_f32 v10, s33, v10
    v_pk_fma_f32 v[12:13], v[12:13], s[96:97], v[10:11] op_sel_hi:[1,1,0] neg_lo:[0,0,1] neg_hi:[0,0,1]
    v_pk_fma_f32 v[14:15], v[14:15], s[96:97], v[10:11] op_sel_hi:[1,1,0] neg_lo:[0,0,1] neg_hi:[0,0,1]
    v_pk_fma_f32 v[20:21], v[20:21], s[96:97], v[10:11] op_sel_hi:[1,1,0] neg_lo:[0,0,1] neg_hi:[0,0,1]
    v_pk_fma_f32 v[22:23], v[22:23], s[96:97], v[10:11] op_sel_hi:[1,1,0] neg_lo:[0,0,1] neg_hi:[0,0,1]
    v_pk_fma_f32 v[18:19], v[18:19], s[96:97], v[10:11] op_sel_hi:[1,1,0] neg_lo:[0,0,1] neg_hi:[0,0,1]
    v_exp_f32 v12, v12
    v_exp_f32 v13, v13
    v_exp_f32 v14, v14
    v_cvt_pk_bf16_f32 v48, v12, v13
    v_exp_f32 v15, v15
    v_exp_f32 v20, v20
    v_cvt_pk_bf16_f32 v49, v14, v15
    v_exp_f32 v21, v21
    v_exp_f32 v22, v22
    v_cvt_pk_bf16_f32 v50, v20, v21
    v_exp_f32 v23, v23
    v_exp_f32 v18, v18
    v_cvt_pk_bf16_f32 v51, v22, v23
    v_exp_f32 v19, v19
    s_nop 0
    v_mfma_f32_16x16x32_bf16 v[20:23], v[24:27], v[48:51], 0
    v_cvt_pk_bf16_f32 v52, v18, v19
    v_cvt_pk_bf16_f32 v55, v18, v19
    s_waitcnt vmcnt(2)
    v_mfma_f32_16x16x32_bf16 v[12:15], v[60:63], v[48:51], 0
    buffer_load_dwordx4 v[40:43], v0, s[4:7], s37 offen offset:0
    s_nop 0
    v_mfma_f32_16x16x16_bf16 v[20:23], v[24:25], v[52:53], v[20:23]
    buffer_load_dwordx4 v[44:47], v0, s[4:7], s37 offen offset:1024
    v_mfma_f32_16x16x32_bf16 v[24:27], v[56:59], v[48:51], 0
    ds_read_b128 v[56:59], v3 offset:18432
    ds_read_b128 v[60:63], v3 offset:19456
    v_mfma_f32_16x16x16_bf16 v[12:15], v[36:37], v[54:55], v[12:15]
    s_nop 2
    v_rcp_f32 v10, v20
    v_mfma_f32_16x16x16_bf16 v[24:27], v[36:37], v[52:53], v[24:27]
    s_add_u32 s14, s14, 1
    s_add_u32 s21, s21, 262144
    s_mov_b32 m0, 0
    s_add_u32 s35, s35, 262144
    s_add_u32 s20, s20, 262144
    s_add_u32 s47, s47, 262144
    s_add_u32 s48, s48, 262144
    v_pk_mul_f32 v[12:13], v[12:13], v[10:11] op_sel_hi:[1,0]
    v_pk_mul_f32 v[14:15], v[14:15], v[10:11] op_sel_hi:[1,0]
    v_pk_mul_f32 v[24:25], v[24:25], v[10:11] op_sel_hi:[1,0]
    v_cvt_pk_bf16_f32 v48, v24, v12
    v_cvt_pk_bf16_f32 v49, v25, v13
    v_pk_mul_f32 v[26:27], v[26:27], v[10:11] op_sel_hi:[1,0]
    v_cvt_pk_bf16_f32 v50, v26, v14
    v_cvt_pk_bf16_f32 v51, v27, v15
    ds_write_b128 v8, v[48:51]
    v_mov_b64 v[36:37], 0
    v_mov_b64 v[38:39], 0
    s_waitcnt lgkmcnt(0)
    buffer_load_dwordx4 v[48:51], v0, s[4:7], s37 offen offset:2048
    buffer_load_dwordx4 v[52:55], v0, s[4:7], s37 offen offset:3072
    s_barrier
    ds_read_b128 v[12:15], v1 offset:0
    ds_read_b128 v[16:19], v1 offset:512
    ds_read_b128 v[20:23], v1 offset:1024
    ds_read_b128 v[24:27], v1 offset:1536
    s_waitcnt lgkmcnt(3)
    s_waitcnt vmcnt(4)
    v_smfmac_f32_16x16x64_bf16 v[36:39], v[12:15], v[28:35], v2
    s_waitcnt lgkmcnt(2)
    s_waitcnt vmcnt(2)
    v_smfmac_f32_16x16x64_bf16 v[36:39], v[16:19], v[40:47], v2
    buffer_load_dwordx4 v[40:43], v0, s[4:7], s38 offen offset:0
    v_mov_b64 v[28:29], 0
    s_waitcnt lgkmcnt(1)
    v_smfmac_f32_16x16x64_bf16 v[36:39], v[20:23], v[56:63], v2
    ds_read_b128 v[56:59], v3 offset:20480
    ds_read_b128 v[60:63], v3 offset:21504
    v_mov_b64 v[30:31], 0
    s_waitcnt lgkmcnt(2)
    v_smfmac_f32_16x16x64_bf16 v[36:39], v[24:27], v[192:199], v2
    buffer_load_dwordx4 v[44:47], v0, s[4:7], s38 offen offset:1024
    v_mov_b64 v[32:33], 0
    v_smfmac_f32_16x16x64_bf16 v[28:31], v[12:15], v[200:207], v2
    v_mov_b64 v[34:35], 0
    v_smfmac_f32_16x16x64_bf16 v[28:31], v[16:19], v[208:215], v2
    s_nop 2
    v_cvt_pk_bf16_f32 v36, v36, v37
    s_waitcnt lgkmcnt(0)
    v_smfmac_f32_16x16x64_bf16 v[28:31], v[20:23], v[56:63], v2
    ds_read_b128 v[56:59], v3 offset:22528
    ds_read_b128 v[60:63], v3 offset:23552
    v_cvt_pk_bf16_f32 v37, v38, v39
    v_smfmac_f32_16x16x64_bf16 v[28:31], v[24:27], v[216:223], v2
    v_and_or_b32 v36, v36, -2, s18
    v_smfmac_f32_16x16x64_bf16 v[32:35], v[12:15], v[224:231], v2
    s_waitcnt vmcnt(2)
    v_smfmac_f32_16x16x64_bf16 v[32:35], v[16:19], v[48:55], v2
    ds_read_b128 v[48:51], v3 offset:24576
    ds_read_b128 v[52:55], v3 offset:25600
    s_nop 1
    v_cvt_pk_bf16_f32 v38, v28, v29
    v_cvt_pk_bf16_f32 v39, v30, v31
    buffer_store_dwordx4 v[36:39], v0, s[4:7], s25 offen sc1
    s_waitcnt lgkmcnt(2)
    v_smfmac_f32_16x16x64_bf16 v[32:35], v[20:23], v[56:63], v2
    ds_read_b128 v[56:59], v3 offset:26624
    ds_read_b128 v[60:63], v3 offset:27648
    v_mov_b64 v[36:37], 0
    v_mov_b64 v[38:39], 0
    v_smfmac_f32_16x16x64_bf16 v[32:35], v[24:27], v[232:239], v2
    s_waitcnt lgkmcnt(2)
    v_smfmac_f32_16x16x64_bf16 v[36:39], v[12:15], v[48:55], v2
    ds_read_b128 v[48:51], v3 offset:28672
    ds_read_b128 v[52:55], v3 offset:29696
    v_mov_b64 v[28:29], 0
    s_waitcnt lgkmcnt(2)
    v_smfmac_f32_16x16x64_bf16 v[36:39], v[16:19], v[56:63], v2
    ds_read_b128 v[56:59], v3 offset:30720
    ds_read_b128 v[60:63], v3 offset:31744
    v_mov_b64 v[30:31], 0
    v_cvt_pk_bf16_f32 v32, v32, v33
    v_smfmac_f32_16x16x64_bf16 v[36:39], v[20:23], v[240:247], v2
    v_cvt_pk_bf16_f32 v33, v34, v35
    s_waitcnt lgkmcnt(2)
    v_smfmac_f32_16x16x64_bf16 v[36:39], v[24:27], v[48:55], v2
    ds_read_b128 v[48:51], v3 offset:32768
    ds_read_b128 v[52:55], v3 offset:33792
    v_and_or_b32 v32, v32, -2, s18
    s_waitcnt lgkmcnt(2)
    v_smfmac_f32_16x16x64_bf16 v[28:31], v[12:15], v[56:63], v2
    v_smfmac_f32_16x16x64_bf16 v[28:31], v[16:19], v[248:255], v2
    s_nop 1
    v_cvt_pk_bf16_f32 v34, v36, v37
    v_cvt_pk_bf16_f32 v35, v38, v39
    buffer_store_dwordx4 v[32:35], v0, s[4:7], s26 offen sc1
    s_waitcnt lgkmcnt(0)
    v_smfmac_f32_16x16x64_bf16 v[28:31], v[20:23], v[48:55], v2
    s_waitcnt vmcnt(2)
    v_smfmac_f32_16x16x64_bf16 v[28:31], v[24:27], v[40:47], v2
    v_and_b32 v16, 0xff, v0
    ds_read_b128 v[12:15], v16 offset:22528
    s_nop 5
    v_cvt_pk_bf16_f32 v28, v28, v29
    v_cvt_pk_bf16_f32 v29, v30, v31
    v_and_or_b32 v28, v28, -2, s18
    buffer_store_dwordx2 v[28:29], v9, s[4:7], s27 offen sc1
    v_mov_b32 v20, s14
    v_lshlrev_b32 v21, 4, v0
    v_mov_b32 v22, -1
    v_mov_b64 v[28:29], 0
    v_mov_b64 v[30:31], 0
    v_mov_b64 v[32:33], 0
    v_mov_b64 v[34:35], 0
    v_mov_b64 v[36:37], 0
    v_mov_b64 v[38:39], 0
    v_bfe_u32 v23, v0, 2, 5
    ds_read_b128 v[40:43], v3 offset:0
    ds_read_b128 v[44:47], v3 offset:1024
    s_waitcnt lgkmcnt(0)
    s_waitcnt vmcnt(2)
    buffer_load_dwordx4 v[48:51], v4, s[4:7], s28 offen sc1
    buffer_load_dwordx4 v[52:55], v4, s[4:7], s29 offen sc1
    buffer_load_dwordx4 v[56:59], v4, s[4:7], s30 offen sc1
    buffer_load_dwordx4 v[60:63], v4, s[4:7], s31 offen sc1
CS0_red:
    s_waitcnt vmcnt(3)
    v_mfma_f32_16x16x32_bf16 v[16:19], v[12:15], v[48:51], 0
    s_waitcnt vmcnt(2)
    v_mfma_f32_16x16x32_bf16 v[16:19], v[12:15], v[52:55], v[16:19]
    v_bitop3_b32 v10, v48, v52, s19 bitop3:0x7e
    s_waitcnt vmcnt(1)
    v_mfma_f32_16x16x32_bf16 v[16:19], v[12:15], v[56:59], v[16:19]
    s_waitcnt vmcnt(0)
    v_bitop3_b32 v11, v56, v60, s19 bitop3:0x7e
    v_bitop3_b32 v10, v10, v11, 1 bitop3:0xa8
    v_cmp_ne_u32 vcc, 0, v10
    v_mfma_f32_16x16x32_bf16 v[16:19], v[12:15], v[60:63], v[16:19]
    s_cmp_eq_u32 s14, 63
    s_cbranch_vccnz CS0_redo
    s_nop 5
    v_add_f32_dpp v16, v16, v16 row_ror:8 row_mask:0xf bank_mask:0xf
    v_add_f32_dpp v17, v17, v17 row_ror:8 row_mask:0xf bank_mask:0xf
    v_add_f32_dpp v18, v18, v18 row_ror:8 row_mask:0xf bank_mask:0xf
    v_add_f32_dpp v19, v19, v19 row_ror:8 row_mask:0xf bank_mask:0xf
    v_cvt_pk_bf16_f32 v10, v16, v17
    v_cvt_pk_bf16_f32 v11, v18, v19
    v_min_u32 v10, s34, v10
    s_cbranch_scc1 CS0_last
    buffer_store_dwordx2 v[10:11], v5, s[4:7], s16 offen sc1
    buffer_store_byte v20, v21, s[8:11], s46 offen sc1
    buffer_store_dword v22, v5, s[4:7], s17 offen sc1
    ds_read_b128 v[48:51], v3 offset:2048
    ds_read_b128 v[52:55], v3 offset:3072
    s_add_u32 s15, s16, 0
    s_add_u32 s39, s39, 0x01010101
    s_add_u32 s16, s16, 16384
    s_and_b32 s16, s16, 0xffff
    s_or_b32 s16, s16, 65536
    s_add_u32 s17, s17, 16384
    s_and_b32 s17, s17, 0xffff
    s_or_b32 s17, s17, 65536
    s_xor_b32 s18, s18, 1
    s_not_b32 s19, s19
    buffer_load_dword v10, v23, s[4:7], s49 offen sc1
    buffer_load_dword v10, v23, s[4:7], s49 offen sc1
    buffer_load_dword v10, v23, s[4:7], s49 offen sc1
    buffer_load_dword v10, v23, s[4:7], s49 offen sc1
    buffer_load_dword v10, v23, s[4:7], s49 offen sc1
CS0_m0:
    s_waitcnt vmcnt(4)
    v_cmp_ne_u32 vcc, s39, v10
    buffer_load_dword v10, v23, s[4:7], s49 offen sc1
    s_cbranch_vccz CS0_m0ok
    s_waitcnt vmcnt(4)
    v_cmp_ne_u32 vcc, s39, v10
    buffer_load_dword v10, v23, s[4:7], s49 offen sc1
    s_cbranch_vccz CS0_m0ok
    s_waitcnt vmcnt(4)
    v_cmp_ne_u32 vcc, s39, v10
    buffer_load_dword v10, v23, s[4:7], s49 offen sc1
    s_cbranch_vccz CS0_m0ok
    s_waitcnt vmcnt(4)
    v_cmp_ne_u32 vcc, s39, v10
    buffer_load_dword v10, v23, s[4:7], s49 offen sc1
    s_cbranch_vccz CS0_m0ok
    s_add_u32 s32, s32, 1
    s_cmp_gt_u32 s32, 0x40000
    s_cbranch_scc1 L_abort
    s_branch CS0_m0
CS0_m0ok:
    buffer_load_dwordx4 v0, s[4:7], s15 offen offset:0 sc1 lds
    buffer_load_dwordx4 v0, s[4:7], s15 offen offset:1024 sc1 lds
    buffer_load_dwordx4 v0, s[4:7], s15 offen offset:2048 sc1 lds
    buffer_load_dwordx4 v0, s[4:7], s15 offen offset:3072 sc1 lds
    s_barrier
    buffer_load_dwordx4 v[56:59], v0, s[4:7], s24 offen offset:2048
    buffer_load_dwordx4 v[60:63], v0, s[4:7], s24 offen offset:3072
    s_waitcnt lgkmcnt(0)
    s_branch CS0_pretop
CS0_redo:
    s_mov_b64 exec, vcc
CS0_redo2:
    buffer_load_dwordx4 v[48:51], v4, s[4:7], s28 offen sc1
    buffer_load_dwordx4 v[52:55], v4, s[4:7], s29 offen sc1
    buffer_load_dwordx4 v[56:59], v4, s[4:7], s30 offen sc1
    buffer_load_dwordx4 v[60:63], v4, s[4:7], s31 offen sc1
    s_add_u32 s32, s32, 1
    s_cmp_gt_u32 s32, 0x40000
    s_cbranch_scc1 L_abort
    s_waitcnt vmcnt(0)
    v_bitop3_b32 v10, v48, v52, s19 bitop3:0x7e
    v_bitop3_b32 v11, v56, v60, s19 bitop3:0x7e
    v_bitop3_b32 v10, v10, v11, 1 bitop3:0xa8
    v_cmp_ne_u32 vcc, 0, v10
    s_cbranch_vccnz CS0_redo2
    s_mov_b64 exec, -1
    s_nop 1
    s_branch CS0_red
CS0_last:
    s_mov_b32 s42, 4855808
    buffer_store_dwordx2 v[10:11], v5, s[4:7], s42 offen sc1
    s_branch CS0_done
CS0_scan:
    v_mov_b32 v10, 0
    ds_read_b32 v11, v0 offset:0
    s_waitcnt lgkmcnt(0)
    v_max_u32 v10, v10, v11
    ds_read_b32 v11, v0 offset:1024
    s_waitcnt lgkmcnt(0)
    v_max_u32 v10, v10, v11
    ds_read_b32 v11, v0 offset:2048
    s_waitcnt lgkmcnt(0)
    v_max_u32 v10, v10, v11
    ds_read_b32 v11, v0 offset:3072
    s_waitcnt lgkmcnt(0)
    v_max_u32 v10, v10, v11
    ds_read_b32 v11, v0 offset:4096
    s_waitcnt lgkmcnt(0)
    v_max_u32 v10, v10, v11
    ds_read_b32 v11, v0 offset:5120
    s_waitcnt lgkmcnt(0)
    v_max_u32 v10, v10, v11
    ds_read_b32 v11, v0 offset:6144
    s_waitcnt lgkmcnt(0)
    v_max_u32 v10, v10, v11
    ds_read_b32 v11, v0 offset:7168
    s_waitcnt lgkmcnt(0)
    v_max_u32 v10, v10, v11
    ds_read_b32 v11, v0 offset:8192
    s_waitcnt lgkmcnt(0)
    v_max_u32 v10, v10, v11
    ds_read_b32 v11, v0 offset:9216
    s_waitcnt lgkmcnt(0)
    v_max_u32 v10, v10, v11
    v_cmp_eq_u32 vcc, -1, v10
    s_cbranch_vccnz CS0_rec
    s_branch CS0_scanned
CS0_done:
    s_waitcnt vmcnt(0) lgkmcnt(0)
    s_endpgm
CS_w1:
    v_lshlrev_b32 v11, 3, v0
    s_mov_b32 s42, 65536
    buffer_load_dwordx2 v[12:13], v5, s[4:7], s42 offen sc1
    s_mov_b32 s42, 81920
    buffer_load_dwordx2 v[12:13], v5, s[4:7], s42 offen sc1
    s_mov_b32 s42, 98304
    buffer_load_dwordx2 v[12:13], v5, s[4:7], s42 offen sc1
    s_mov_b32 s42, 114688
    buffer_load_dwordx2 v[12:13], v5, s[4:7], s42 offen sc1
CS1_rec:
    s_waitcnt vmcnt(0) lgkmcnt(0)
    s_add_u32 s32, s32, 1
    s_cmp_gt_u32 s32, 0x40000
    s_cbranch_scc1 L_abort
    s_barrier
    ds_read_b128 v[40:43], v3 offset:0
    ds_read_b128 v[44:47], v3 offset:1024
    ds_read_b128 v[48:51], v3 offset:2048
    ds_read_b128 v[52:55], v3 offset:3072
    s_mov_b32 m0, 4096
    v_bfe_u32 v11, v0, 2, 5
    buffer_load_dword v11, v11, s[4:7], s49 offen sc1
    buffer_load_dwordx4 v0, s[4:7], s15 offen offset:0 sc1 lds
    buffer_load_dwordx4 v0, s[4:7], s15 offen offset:1024 sc1 lds
    buffer_load_dwordx4 v0, s[4:7], s15 offen offset:2048 sc1 lds
    buffer_load_dwordx4 v0, s[4:7], s15 offen offset:3072 sc1 lds
    buffer_load_dwordx4 v[56:59], v0, s[4:7], s24 offen offset:2048
    buffer_load_dwordx4 v[60:63], v0, s[4:7], s24 offen offset:3072
    v_mov_b64 v[28:29], 0
    v_mov_b64 v[30:31], 0
    v_mov_b64 v[32:33], 0
    v_mov_b64 v[34:35], 0
    v_mov_b64 v[36:37], 0
    v_mov_b64 v[38:39], 0
    s_waitcnt vmcnt(0) lgkmcnt(0)
    s_branch HZ_CS1_top
.p2align 6
HZ_CS1_top:
    s_barrier
    ds_read_b128 v[12:15], v1 offset:0
    ds_read_b128 v[16:19], v1 offset:512
    ds_read_b128 v[20:23], v1 offset:1024
    ds_read_b128 v[24:27], v1 offset:1536
    s_waitcnt lgkmcnt(3)
    v_smfmac_f32_16x16x64_bf16 v[28:31], v[12:15], v[40:47], v2
    v_smfmac_f32_16x16x64_bf16 v[32:35], v[12:15], v[48:55], v2
    v_smfmac_f32_16x16x64_bf16 v[36:39], v[12:15], a[240:247], v2
    s_barrier
    ds_read_b128 v[12:15], v1 offset:2048
    buffer_load_dwordx4 v[40:43], v0, s[4:7], s36 offen offset:0
    s_waitcnt lgkmcnt(3)
    v_smfmac_f32_16x16x64_bf16 v[28:31], v[16:19], a[0:7], v2
    buffer_load_dwordx4 v[44:47], v0, s[4:7], s36 offen offset:1024
    v_smfmac_f32_16x16x64_bf16 v[32:35], v[16:19], a[144:151], v2
    buffer_load_dwordx4 v[48:51], v0, s[4:7], s24 offen offset:0
    v_smfmac_f32_16x16x64_bf16 v[36:39], v[16:19], a[248:255], v2
    ds_read_b128 v[16:19], v1 offset:2560
    buffer_load_dwordx4 v[52:55], v0, s[4:7], s24 offen offset:1024
    s_waitcnt lgkmcnt(3)
    v_smfmac_f32_16x16x64_bf16 v[28:31], v[20:23], a[8:15], v2
    v_smfmac_f32_16x16x64_bf16 v[32:35], v[20:23], a[152:159], v2
    v_smfmac_f32_16x16x64_bf16 v[36:39], v[20:23], v[64:71], v2
    ds_read_b128 v[20:23], v1 offset:3072
    s_waitcnt lgkmcnt(3)
    v_smfmac_f32_16x16x64_bf16 v[28:31], v[24:27], a[16:23], v2
    s_waitcnt vmcnt(10)
    v_cmp_ne_u32 vcc, s39, v11
    v_smfmac_f32_16x16x64_bf16 v[32:35], v[24:27], a[160:167], v2
    s_cbranch_vccnz CS1_mr
    s_waitcnt vmcnt(6)
CS1_mok:
    s_barrier
    v_smfmac_f32_16x16x64_bf16 v[36:39], v[24:27], v[72:79], v2
    ds_read_b128 v[24:27], v1 offset:3584
    s_waitcnt lgkmcnt(3)
    v_smfmac_f32_16x16x64_bf16 v[28:31], v[12:15], a[24:31], v2
    v_smfmac_f32_16x16x64_bf16 v[32:35], v[12:15], a[168:175], v2
    v_smfmac_f32_16x16x64_bf16 v[36:39], v[12:15], v[80:87], v2
    ds_read_b128 v[12:15], v1 offset:4096
    s_waitcnt lgkmcnt(3)
    v_smfmac_f32_16x16x64_bf16 v[28:31], v[16:19], a[32:39], v2
    v_smfmac_f32_16x16x64_bf16 v[32:35], v[16:19], a[176:183], v2
    v_smfmac_f32_16x16x64_bf16 v[36:39], v[16:19], v[88:95], v2
    ds_read_b128 v[16:19], v1 offset:4608
    s_waitcnt lgkmcnt(3)
    v_smfmac_f32_16x16x64_bf16 v[28:31], v[20:23], a[40:47], v2
    v_smfmac_f32_16x16x64_bf16 v[32:35], v[20:23], a[184:191], v2
    v_smfmac_f32_16x16x64_bf16 v[36:39], v[20:23], v[96:103], v2
    ds_read_b128 v[20:23], v1 offset:5120
    s_waitcnt lgkmcnt(3)
    v_smfmac_f32_16x16x64_bf16 v[28:31], v[24:27], a[48:55], v2
    v_smfmac_f32_16x16x64_bf16 v[32:35], v[24:27], a[192:199], v2
    v_smfmac_f32_16x16x64_bf16 v[36:39], v[24:27], v[104:111], v2
    ds_read_b128 v[24:27], v1 offset:5632
    s_waitcnt lgkmcnt(3)
    v_smfmac_f32_16x16x64_bf16 v[28:31], v[12:15], a[56:63], v2
    s_waitcnt vmcnt(4)
    v_smfmac_f32_16x16x64_bf16 v[32:35], v[12:15], v[56:63], v2
    ds_read_b128 v[56:59], v3 offset:4096
    ds_read_b128 v[60:63], v3 offset:5120
    v_smfmac_f32_16x16x64_bf16 v[36:39], v[12:15], v[112:119], v2
    ds_read_b128 v[12:15], v1 offset:6144
    s_waitcnt lgkmcnt(5)
    v_smfmac_f32_16x16x64_bf16 v[28:31], v[16:19], a[64:71], v2
    v_smfmac_f32_16x16x64_bf16 v[32:35], v[16:19], a[200:207], v2
    s_waitcnt vmcnt(2)
    v_smfmac_f32_16x16x64_bf16 v[36:39], v[16:19], v[40:47], v2
    ds_read_b128 v[40:43], v3 offset:16384
    ds_read_b128 v[44:47], v3 offset:17408
    ds_read_b128 v[16:19], v1 offset:6656
    s_waitcnt lgkmcnt(7)
    v_smfmac_f32_16x16x64_bf16 v[28:31], v[20:23], a[72:79], v2
    s_waitcnt lgkmcnt(4)
    v_smfmac_f32_16x16x64_bf16 v[32:35], v[20:23], v[56:63], v2
    ds_read_b128 v[56:59], v3 offset:6144
    ds_read_b128 v[60:63], v3 offset:7168
    v_smfmac_f32_16x16x64_bf16 v[36:39], v[20:23], v[120:127], v2
    ds_read_b128 v[20:23], v1 offset:7168
    s_waitcnt vmcnt(0)
    v_smfmac_f32_16x16x64_bf16 v[28:31], v[24:27], v[48:55], v2
    ds_read_b128 v[48:51], v3 offset:8192
    ds_read_b128 v[52:55], v3 offset:9216
    v_smfmac_f32_16x16x64_bf16 v[32:35], v[24:27], a[208:215], v2
    s_waitcnt lgkmcnt(6)
    v_smfmac_f32_16x16x64_bf16 v[36:39], v[24:27], v[40:47], v2
    ds_read_b128 v[40:43], v3 offset:10240
    ds_read_b128 v[44:47], v3 offset:11264
    ds_read_b128 v[24:27], v1 offset:7680
    s_barrier
    v_smfmac_f32_16x16x64_bf16 v[28:31], v[12:15], a[80:87], v2
    s_waitcnt lgkmcnt(6)
    v_smfmac_f32_16x16x64_bf16 v[32:35], v[12:15], v[56:63], v2
    ds_read_b128 v[56:59], v3 offset:12288
    ds_read_b128 v[60:63], v3 offset:13312
    ds_read_b128 v[12:15], v1 offset:8192
    v_smfmac_f32_16x16x64_bf16 v[28:31], v[16:19], a[88:95], v2
    s_waitcnt lgkmcnt(6)
    v_smfmac_f32_16x16x64_bf16 v[32:35], v[16:19], v[48:55], v2
    ds_read_b128 v[16:19], v1 offset:8704
    v_smfmac_f32_16x16x64_bf16 v[28:31], v[20:23], a[96:103], v2
    s_waitcnt lgkmcnt(5)
    v_smfmac_f32_16x16x64_bf16 v[32:35], v[20:23], v[40:47], v2
    ds_read_b128 v[40:43], v3 offset:14336
    ds_read_b128 v[44:47], v3 offset:15360
    ds_read_b128 v[20:23], v1 offset:9216
    s_waitcnt lgkmcnt(7)
    v_smfmac_f32_16x16x64_bf16 v[28:31], v[24:27], a[104:111], v2
    s_waitcnt lgkmcnt(5)
    v_smfmac_f32_16x16x64_bf16 v[32:35], v[24:27], v[56:63], v2
    ds_read_b128 v[24:27], v1 offset:9728
    s_waitcnt lgkmcnt(5)
    v_smfmac_f32_16x16x64_bf16 v[28:31], v[12:15], a[112:119], v2
    v_smfmac_f32_16x16x64_bf16 v[32:35], v[12:15], a[216:223], v2
    s_waitcnt lgkmcnt(4)
    v_smfmac_f32_16x16x64_bf16 v[28:31], v[16:19], a[120:127], v2
    s_waitcnt lgkmcnt(2)
    v_smfmac_f32_16x16x64_bf16 v[32:35], v[16:19], v[40:47], v2
    ds_read_b128 v[56:59], v0 offset:14336
    ds_read_b128 v[60:63], v0 offset:18432
    s_waitcnt lgkmcnt(3)
    v_smfmac_f32_16x16x64_bf16 v[28:31], v[20:23], a[128:135], v2
    s_waitcnt lgkmcnt(2)
    v_smfmac_f32_16x16x64_bf16 v[28:31], v[24:27], a[136:143], v2
    ds_read_b128 v[48:51], v0 offset:15360
    ds_read_b128 v[52:55], v0 offset:19456
    v_smfmac_f32_16x16x64_bf16 v[32:35], v[20:23], a[224:231], v2
    v_smfmac_f32_16x16x64_bf16 v[32:35], v[24:27], a[232:239], v2
    s_nop 3
    v_cmp_u_f32 vcc, v28, v30
    v_cvt_pk_bf16_f32 v28, v28, v30
    v_cvt_pk_bf16_f32 v30, v29, v31
    v_smfmac_f32_16x16x64_bf16 v[36:39], v[12:15], v[160:167], v2
    ds_read_b128 v[12:15], v1 offset:6144
    v_smfmac_f32_16x16x64_bf16 v[36:39], v[16:19], v[168:175], v2
    ds_read_b128 v[16:19], v1 offset:6656
    s_cbranch_vccnz CS1_scan
CS1_scanned:
    v_cvt_pk_bf16_f32 v29, v32, v34
    v_cvt_pk_bf16_f32 v31, v33, v35
    ds_write_b64 v6, v[28:29]
    ds_write_b64 v6, v[30:31] offset:512
    v_smfmac_f32_16x16x64_bf16 v[36:39], v[20:23], v[176:183], v2
    ds_read_b128 v[20:23], v1 offset:7168
    v_smfmac_f32_16x16x64_bf16 v[36:39], v[24:27], v[184:191], v2
    ds_read_b128 v[24:27], v1 offset:7680
    s_waitcnt lgkmcnt(5)
    v_smfmac_f32_16x16x64_bf16 v[36:39], v[12:15], v[128:135], v2
    s_waitcnt lgkmcnt(4)
    v_smfmac_f32_16x16x64_bf16 v[36:39], v[16:19], v[136:143], v2
    s_waitcnt lgkmcnt(2)
    s_barrier
    ds_read_b64_tr_b16 v[28:29], v7 offset:0
    ds_read_b64_tr_b16 v[30:31], v7 offset:512
    s_waitcnt lgkmcnt(3)
    v_smfmac_f32_16x16x64_bf16 v[36:39], v[20:23], v[144:151], v2
    ds_read_b64_tr_b16 v[32:33], v7 offset:1024
    ds_read_b64_tr_b16 v[34:35], v7 offset:1536
    s_waitcnt lgkmcnt(4)
    v_smfmac_f32_16x16x64_bf16 v[36:39], v[24:27], v[152:159], v2
    s_waitcnt lgkmcnt(2)
    v_mfma_f32_16x16x32_bf16 v[12:15], v[56:59], v[28:31], 0
    ds_read_b64_tr_b16 v[40:41], v7 offset:2048
    ds_read_b64_tr_b16 v[42:43], v7 offset:2560
    v_mfma_f32_16x16x32_bf16 v[20:23], v[60:63], v[28:31], 0
    ds_read_b128 v[56:59], v0 offset:16384
    ds_read_b128 v[60:63], v0 offset:20480
    s_waitcnt lgkmcnt(4)
    v_mfma_f32_16x16x32_bf16 v[12:15], v[48:51], v[32:35], v[12:15]
    ds_read_b64_tr_b16 v[44:45], v7 offset:3072
    ds_read_b64_tr_b16 v[46:47], v7 offset:3584
    v_mfma_f32_16x16x32_bf16 v[20:23], v[52:55], v[32:35], v[20:23]
    ds_read_b128 v[48:51], v0 offset:17408
    ds_read_b128 v[52:55], v0 offset:21504
    v_mfma_f32_16x16x32_bf16 v[16:19], v[28:31], v[28:31], 0
    v_mov_b64 v[24:25], s[98:99]
    v_mov_b64 v[26:27], s[98:99]
    v_mfma_f32_16x16x32_bf16 v[16:19], v[32:35], v[32:35], v[16:19]
    s_waitcnt lgkmcnt(4)
    v_mfma_f32_16x16x32_bf16 v[12:15], v[56:59], v[40:43], v[12:15]
    v_mfma_f32_16x16x32_bf16 v[20:23], v[60:63], v[40:43], v[20:23]
    buffer_load_dwordx4 v[56:59], v0, s[4:7], s21 offen sc1
    v_cvt_pk_bf16_f32 v36, v36, v38
    s_waitcnt lgkmcnt(0)
    v_mfma_f32_16x16x32_bf16 v[12:15], v[48:51], v[44:47], v[12:15]
    v_cvt_pk_bf16_f32 v37, v37, v39
    v_mfma_f32_16x16x32_bf16 v[20:23], v[52:55], v[44:47], v[20:23]
    buffer_load_dwordx4 v[60:63], v0, s[4:7], s21 offen offset:1024 sc1
    v_mfma_f32_16x16x32_bf16 v[16:19], v[40:43], v[40:43], v[16:19]
    v_mov_b32 v53, 0
    v_mov_b32 v54, 0
    v_mfma_f32_16x16x32_bf16 v[16:19], v[44:47], v[44:47], v[16:19]
    s_nop 0
    v_max3_f32 v11, v12, v13, v14
    s_nop 0
    v_max3_f32 v10, v15, v20, v21
    v_max3_f32 v11, v11, v22, v23
    v_max_f32 v11, v11, v10
    buffer_load_dwordx4 v[28:31], v0, s[4:7], s36 offen offset:2048
    s_nop 0
    v_max3_f32 v10, v11, v18, v19
    v_max3_f32 v11, v11, v18, v19
    s_nop 1
    v_permlane32_swap_b32 v10, v11
    v_max_f32 v16, v10, v11
    v_max_f32 v10, v10, v11
    buffer_load_dwordx4 v[32:35], v0, s[4:7], s36 offen offset:3072
    s_nop 0
    v_permlane16_swap_b32 v10, v16
    v_max_f32 v10, v10, v16
    v_mul_f32 v10, s33, v10
    v_pk_fma_f32 v[12:13], v[12:13], s[96:97], v[10:11] op_sel_hi:[1,1,0] neg_lo:[0,0,1] neg_hi:[0,0,1]
    v_pk_fma_f32 v[14:15], v[14:15], s[96:97], v[10:11] op_sel_hi:[1,1,0] neg_lo:[0,0,1] neg_hi:[0,0,1]
    v_pk_fma_f32 v[20:21], v[20:21], s[96:97], v[10:11] op_sel_hi:[1,1,0] neg_lo:[0,0,1] neg_hi:[0,0,1]
    v_pk_fma_f32 v[22:23], v[22:23], s[96:97], v[10:11] op_sel_hi:[1,1,0] neg_lo:[0,0,1] neg_hi:[0,0,1]
    v_pk_fma_f32 v[18:19], v[18:19], s[96:97], v[10:11] op_sel_hi:[1,1,0] neg_lo:[0,0,1] neg_hi:[0,0,1]
    v_exp_f32 v12, v12
    v_exp_f32 v13, v13
    v_exp_f32 v14, v14
    v_cvt_pk_bf16_f32 v48, v12, v13
    v_exp_f32 v15, v15
    v_exp_f32 v20, v20
    v_cvt_pk_bf16_f32 v49, v14, v15
    v_exp_f32 v21, v21
    v_exp_f32 v22, v22
    v_cvt_pk_bf16_f32 v50, v20, v21
    v_exp_f32 v23, v23
    v_exp_f32 v18, v18
    v_cvt_pk_bf16_f32 v51, v22, v23
    v_exp_f32 v19, v19
    s_nop 0
    v_mfma_f32_16x16x32_bf16 v[20:23], v[24:27], v[48:51], 0
    v_cvt_pk_bf16_f32 v52, v18, v19
    v_cvt_pk_bf16_f32 v55, v18, v19
    s_waitcnt vmcnt(2)
    v_mfma_f32_16x16x32_bf16 v[12:15], v[60:63], v[48:51], 0
    buffer_load_dwordx4 v[40:43], v0, s[4:7], s37 offen offset:0
    s_nop 0
    v_mfma_f32_16x16x16_bf16 v[20:23], v[24:25], v[52:53], v[20:23]
    buffer_load_dwordx4 v[44:47], v0, s[4:7], s37 offen offset:1024
    v_mfma_f32_16x16x32_bf16 v[24:27], v[56:59], v[48:51], 0
    ds_read_b128 v[56:59], v3 offset:18432
    ds_read_b128 v[60:63], v3 offset:19456
    v_mfma_f32_16x16x16_bf16 v[12:15], v[36:37], v[54:55], v[12:15]
    s_nop 2
    v_rcp_f32 v10, v20
    v_mfma_f32_16x16x16_bf16 v[24:27], v[36:37], v[52:53], v[24:27]
    s_add_u32 s14, s14, 1
    s_add_u32 s21, s21, 262144
    s_add_u32 s35, s35, 262144
    s_add_u32 s20, s20, 262144
    v_pk_mul_f32 v[12:13], v[12:13], v[10:11] op_sel_hi:[1,0]
    v_pk_mul_f32 v[14:15], v[14:15], v[10:11] op_sel_hi:[1,0]
    s_nop 1
    v_pk_mul_f32 v[24:25], v[24:25], v[10:11] op_sel_hi:[1,0]
    v_cvt_pk_bf16_f32 v48, v24, v12
    v_cvt_pk_bf16_f32 v49, v25, v13
    v_pk_mul_f32 v[26:27], v[26:27], v[10:11] op_sel_hi:[1,0]
    v_cvt_pk_bf16_f32 v50, v26, v14
    v_cvt_pk_bf16_f32 v51, v27, v15
    ds_write_b128 v8, v[48:51]
    v_mov_b64 v[36:37], 0
    v_mov_b64 v[38:39], 0
    s_waitcnt lgkmcnt(0)
    buffer_load_dwordx4 v[48:51], v0, s[4:7], s37 offen offset:2048
    buffer_load_dwordx4 v[52:55], v0, s[4:7], s37 offen offset:3072
    s_barrier
    ds_read_b128 v[12:15], v1 offset:0
    ds_read_b128 v[16:19], v1 offset:512
    ds_read_b128 v[20:23], v1 offset:1024
    ds_read_b128 v[24:27], v1 offset:1536
    s_waitcnt lgkmcnt(3)
    s_waitcnt vmcnt(4)
    v_smfmac_f32_16x16x64_bf16 v[36:39], v[12:15], v[28:35], v2
    s_waitcnt lgkmcnt(2)
    s_waitcnt vmcnt(2)
    v_smfmac_f32_16x16x64_bf16 v[36:39], v[16:19], v[40:47], v2
    buffer_load_dwordx4 v[40:43], v0, s[4:7], s38 offen offset:0
    v_mov_b64 v[28:29], 0
    s_waitcnt lgkmcnt(1)
    v_smfmac_f32_16x16x64_bf16 v[36:39], v[20:23], v[56:63], v2
    ds_read_b128 v[56:59], v3 offset:20480
    ds_read_b128 v[60:63], v3 offset:21504
    v_mov_b64 v[30:31], 0
    s_waitcnt lgkmcnt(2)
    v_smfmac_f32_16x16x64_bf16 v[36:39], v[24:27], v[192:199], v2
    buffer_load_dwordx4 v[44:47], v0, s[4:7], s38 offen offset:1024
    v_mov_b64 v[32:33], 0
    v_smfmac_f32_16x16x64_bf16 v[28:31], v[12:15], v[200:207], v2
    v_mov_b64 v[34:35], 0
    v_smfmac_f32_16x16x64_bf16 v[28:31], v[16:19], v[208:215], v2
    s_nop 2
    v_cvt_pk_bf16_f32 v36, v36, v37
    s_waitcnt lgkmcnt(0)
    v_smfmac_f32_16x16x64_bf16 v[28:31], v[20:23], v[56:63], v2
    ds_read_b128 v[56:59], v3 offset:22528
    ds_read_b128 v[60:63], v3 offset:23552
    v_cvt_pk_bf16_f32 v37, v38, v39
    v_smfmac_f32_16x16x64_bf16 v[28:31], v[24:27], v[216:223], v2
    v_and_or_b32 v36, v36, -2, s18
    v_smfmac_f32_16x16x64_bf16 v[32:35], v[12:15], v[224:231], v2
    s_waitcnt vmcnt(2)
    v_smfmac_f32_16x16x64_bf16 v[32:35], v[16:19], v[48:55], v2
    ds_read_b128 v[48:51], v3 offset:24576
    ds_read_b128 v[52:55], v3 offset:25600
    s_nop 1
    v_cvt_pk_bf16_f32 v38, v28, v29
    v_cvt_pk_bf16_f32 v39, v30, v31
    buffer_store_dwordx4 v[36:39], v0, s[4:7], s25 offen sc1
    s_waitcnt lgkmcnt(2)
    v_smfmac_f32_16x16x64_bf16 v[32:35], v[20:23], v[56:63], v2
    ds_read_b128 v[56:59], v3 offset:26624
    ds_read_b128 v[60:63], v3 offset:27648
    v_mov_b64 v[36:37], 0
    v_mov_b64 v[38:39], 0
    v_smfmac_f32_16x16x64_bf16 v[32:35], v[24:27], v[232:239], v2
    s_waitcnt lgkmcnt(2)
    v_smfmac_f32_16x16x64_bf16 v[36:39], v[12:15], v[48:55], v2
    ds_read_b128 v[48:51], v3 offset:28672
    ds_read_b128 v[52:55], v3 offset:29696
    v_mov_b64 v[28:29], 0
    s_waitcnt lgkmcnt(2)
    v_smfmac_f32_16x16x64_bf16 v[36:39], v[16:19], v[56:63], v2
    ds_read_b128 v[56:59], v3 offset:30720
    ds_read_b128 v[60:63], v3 offset:31744
    v_mov_b64 v[30:31], 0
    v_cvt_pk_bf16_f32 v32, v32, v33
    v_smfmac_f32_16x16x64_bf16 v[36:39], v[20:23], v[240:247], v2
    v_cvt_pk_bf16_f32 v33, v34, v35
    s_waitcnt lgkmcnt(2)
    v_smfmac_f32_16x16x64_bf16 v[36:39], v[24:27], v[48:55], v2
    ds_read_b128 v[48:51], v3 offset:32768
    ds_read_b128 v[52:55], v3 offset:33792
    v_and_or_b32 v32, v32, -2, s18
    s_waitcnt lgkmcnt(2)
    v_smfmac_f32_16x16x64_bf16 v[28:31], v[12:15], v[56:63], v2
    v_smfmac_f32_16x16x64_bf16 v[28:31], v[16:19], v[248:255], v2
    s_nop 1
    v_cvt_pk_bf16_f32 v34, v36, v37
    v_cvt_pk_bf16_f32 v35, v38, v39
    buffer_store_dwordx4 v[32:35], v0, s[4:7], s26 offen sc1
    s_waitcnt lgkmcnt(0)
    v_smfmac_f32_16x16x64_bf16 v[28:31], v[20:23], v[48:55], v2
    s_waitcnt vmcnt(2)
    v_smfmac_f32_16x16x64_bf16 v[28:31], v[24:27], v[40:47], v2
    v_and_b32 v16, 0xff, v0
    ds_read_b128 v[12:15], v16 offset:22528
    s_nop 5
    v_cvt_pk_bf16_f32 v28, v28, v29
    v_cvt_pk_bf16_f32 v29, v30, v31
    v_and_or_b32 v28, v28, -2, s18
    buffer_store_dwordx2 v[28:29], v9, s[4:7], s27 offen sc1
    v_mov_b32 v20, s14
    v_lshlrev_b32 v21, 4, v0
    v_mov_b32 v22, -1
    v_mov_b64 v[28:29], 0
    v_mov_b64 v[30:31], 0
    v_mov_b64 v[32:33], 0
    v_mov_b64 v[34:35], 0
    v_mov_b64 v[36:37], 0
    v_mov_b64 v[38:39], 0
    s_waitcnt lgkmcnt(0)
    s_waitcnt vmcnt(0)
    buffer_load_dwordx4 v[48:51], v4, s[4:7], s28 offen sc1
    buffer_load_dwordx4 v[52:55], v4, s[4:7], s29 offen sc1
    buffer_load_dwordx4 v[56:59], v4, s[4:7], s30 offen sc1
    buffer_load_dwordx4 v[60:63], v4, s[4:7], s31 offen sc1
CS1_red:
    s_waitcnt vmcnt(3)
    v_mfma_f32_16x16x32_bf16 v[16:19], v[12:15], v[48:51], 0
    s_waitcnt vmcnt(2)
    v_mfma_f32_16x16x32_bf16 v[16:19], v[12:15], v[52:55], v[16:19]
    v_bitop3_b32 v10, v48, v52, s19 bitop3:0x7e
    s_waitcnt vmcnt(1)
    v_mfma_f32_16x16x32_bf16 v[16:19], v[12:15], v[56:59], v[16:19]
    s_waitcnt vmcnt(0)
    v_bitop3_b32 v11, v56, v60, s19 bitop3:0x7e
    v_bitop3_b32 v10, v10, v11, 1 bitop3:0xa8
    v_cmp_ne_u32 vcc, 0, v10
    v_mfma_f32_16x16x32_bf16 v[16:19], v[12:15], v[60:63], v[16:19]
    s_cmp_eq_u32 s14, 63
    s_cbranch_vccnz CS1_redo
    s_nop 5
    v_add_f32_dpp v16, v16, v16 row_ror:8 row_mask:0xf bank_mask:0xf
    v_add_f32_dpp v17, v17, v17 row_ror:8 row_mask:0xf bank_mask:0xf
    v_add_f32_dpp v18, v18, v18 row_ror:8 row_mask:0xf bank_mask:0xf
    v_add_f32_dpp v19, v19, v19 row_ror:8 row_mask:0xf bank_mask:0xf
    v_cvt_pk_bf16_f32 v10, v16, v17
    v_cvt_pk_bf16_f32 v11, v18, v19
    v_min_u32 v10, s34, v10
    s_cbranch_scc1 CS1_last
    buffer_store_dwordx2 v[10:11], v5, s[4:7], s16 offen sc1
    buffer_store_byte v20, v21, s[8:11], s46 offen sc1
    buffer_store_dword v22, v5, s[4:7], s17 offen sc1
    ds_read_b128 v[40:43], v3 offset:0
    ds_read_b128 v[44:47], v3 offset:1024
    ds_read_b128 v[48:51], v3 offset:2048
    ds_read_b128 v[52:55], v3 offset:3072
    s_add_u32 s15, s16, 4096
    s_add_u32 s39, s39, 0x01010101
    s_add_u32 s16, s16, 16384
    s_and_b32 s16, s16, 0xffff
    s_or_b32 s16, s16, 65536
    s_add_u32 s17, s17, 16384
    s_and_b32 s17, s17, 0xffff
    s_or_b32 s17, s17, 65536
    s_xor_b32 s18, s18, 1
    s_not_b32 s19, s19
    s_waitcnt lgkmcnt(0)
    s_barrier
    v_bfe_u32 v11, v0, 2, 5
    buffer_load_dword v11, v11, s[4:7], s49 offen sc1
    buffer_load_dwordx4 v0, s[4:7], s15 offen offset:0 sc1 lds
    buffer_load_dwordx4 v0, s[4:7], s15 offen offset:1024 sc1 lds
    buffer_load_dwordx4 v0, s[4:7], s15 offen offset:2048 sc1 lds
    buffer_load_dwordx4 v0, s[4:7], s15 offen offset:3072 sc1 lds
    buffer_load_dwordx4 v[56:59], v0, s[4:7], s24 offen offset:2048
    buffer_load_dwordx4 v[60:63], v0, s[4:7], s24 offen offset:3072
    s_branch HZ_CS1_top
CS1_redo:
    s_mov_b64 exec, vcc
CS1_redo2:
    buffer_load_dwordx4 v[48:51], v4, s[4:7], s28 offen sc1
    buffer_load_dwordx4 v[52:55], v4, s[4:7], s29 offen sc1
    buffer_load_dwordx4 v[56:59], v4, s[4:7], s30 offen sc1
    buffer_load_dwordx4 v[60:63], v4, s[4:7], s31 offen sc1
    s_add_u32 s32, s32, 1
    s_cmp_gt_u32 s32, 0x40000
    s_cbranch_scc1 L_abort
    s_waitcnt vmcnt(0)
    v_bitop3_b32 v10, v48, v52, s19 bitop3:0x7e
    v_bitop3_b32 v11, v56, v60, s19 bitop3:0x7e
    v_bitop3_b32 v10, v10, v11, 1 bitop3:0xa8
    v_cmp_ne_u32 vcc, 0, v10
    s_cbranch_vccnz CS1_redo2
    s_mov_b64 exec, -1
    s_nop 1
    s_branch CS1_red
CS1_last:
    s_mov_b32 s42, 4855808
    buffer_store_dwordx2 v[10:11], v5, s[4:7], s42 offen sc1
    s_branch CS1_done
CS1_scan:
    v_mov_b32 v10, 0
    ds_read_b32 v11, v0 offset:0
    s_waitcnt lgkmcnt(0)
    v_max_u32 v10, v10, v11
    ds_read_b32 v11, v0 offset:1024
    s_waitcnt lgkmcnt(0)
    v_max_u32 v10, v10, v11
    ds_read_b32 v11, v0 offset:2048
    s_waitcnt lgkmcnt(0)
    v_max_u32 v10, v10, v11
    ds_read_b32 v11, v0 offset:3072
    s_waitcnt lgkmcnt(0)
    v_max_u32 v10, v10, v11
    ds_read_b32 v11, v0 offset:4096
    s_waitcnt lgkmcnt(0)
    v_max_u32 v10, v10, v11
    ds_read_b32 v11, v0 offset:5120
    s_waitcnt lgkmcnt(0)
    v_max_u32 v10, v10, v11
    ds_read_b32 v11, v0 offset:6144
    s_waitcnt lgkmcnt(0)
    v_max_u32 v10, v10, v11
    ds_read_b32 v11, v0 offset:7168
    s_waitcnt lgkmcnt(0)
    v_max_u32 v10, v10, v11
    ds_read_b32 v11, v0 offset:8192
    s_waitcnt lgkmcnt(0)
    v_max_u32 v10, v10, v11
    ds_read_b32 v11, v0 offset:9216
    s_waitcnt lgkmcnt(0)
    v_max_u32 v10, v10, v11
    v_cmp_eq_u32 vcc, -1, v10
    s_cbranch_vccnz CS1_rec
    s_branch CS1_scanned
CS1_mr:
    s_add_u32 s32, s32, 1
    s_cmp_gt_u32 s32, 0x40000
    s_cbranch_scc1 L_abort
    v_bfe_u32 v11, v0, 2, 5
    buffer_load_dword v11, v11, s[4:7], s49 offen sc1
    buffer_load_dwordx4 v0, s[4:7], s15 offen offset:0 sc1 lds
    buffer_load_dwordx4 v0, s[4:7], s15 offen offset:1024 sc1 lds
    buffer_load_dwordx4 v0, s[4:7], s15 offen offset:2048 sc1 lds
    buffer_load_dwordx4 v0, s[4:7], s15 offen offset:3072 sc1 lds
    s_waitcnt vmcnt(4)
    v_cmp_ne_u32 vcc, s39, v11
    s_cbranch_vccnz CS1_mr
    s_waitcnt vmcnt(0)
    s_branch CS1_mok
CS1_done:
    s_waitcnt vmcnt(0) lgkmcnt(0)
    s_endpgm
CS_w2:
    v_lshlrev_b32 v11, 3, v0
    s_mov_b32 s42, 65536
    buffer_load_dwordx2 v[12:13], v5, s[4:7], s42 offen sc1
    s_mov_b32 s42, 81920
    buffer_load_dwordx2 v[12:13], v5, s[4:7], s42 offen sc1
    s_mov_b32 s42, 98304
    buffer_load_dwordx2 v[12:13], v5, s[4:7], s42 offen sc1
    s_mov_b32 s42, 114688
    buffer_load_dwordx2 v[12:13], v5, s[4:7], s42 offen sc1
CS2_rec:
    s_waitcnt vmcnt(0) lgkmcnt(0)
    s_add_u32 s32, s32, 1
    s_cmp_gt_u32 s32, 0x40000
    s_cbranch_scc1 L_abort
    s_barrier
    ds_read_b128 v[40:43], v3 offset:0
    ds_read_b128 v[44:47], v3 offset:1024
    ds_read_b128 v[48:51], v3 offset:2048
    ds_read_b128 v[52:55], v3 offset:3072
    s_mov_b32 m0, 8192
    buffer_load_dwordx4 v[56:59], v0, s[4:7], s24 offen offset:2048
    buffer_load_dwordx4 v[60:63], v0, s[4:7], s24 offen offset:3072
    v_mov_b64 v[28:29], 0
    v_mov_b64 v[30:31], 0
    v_mov_b64 v[32:33], 0
    v_mov_b64 v[34:35], 0
    v_mov_b64 v[36:37], 0
    v_mov_b64 v[38:39], 0
    s_waitcnt vmcnt(0) lgkmcnt(0)
    s_branch HZ_CS2_top
.p2align 6
HZ_CS2_top:
    s_barrier
    ds_read_b128 v[12:15], v1 offset:0
    ds_read_b128 v[16:19], v1 offset:512
    ds_read_b128 v[20:23], v1 offset:1024
    ds_read_b128 v[24:27], v1 offset:1536
    v_bfe_u32 v11, v0, 2, 4
    buffer_load_dword v11, v11, s[4:7], s49 offen sc1
    buffer_load_dwordx4 v0, s[4:7], s15 offen offset:0 sc1 lds
    buffer_load_dwordx4 v0, s[4:7], s15 offen offset:1024 sc1 lds
    s_waitcnt lgkmcnt(3)
    v_smfmac_f32_16x16x64_bf16 v[28:31], v[12:15], v[40:47], v2
    v_smfmac_f32_16x16x64_bf16 v[32:35], v[12:15], v[48:55], v2
    v_smfmac_f32_16x16x64_bf16 v[36:39], v[12:15], a[240:247], v2
    s_barrier
    ds_read_b128 v[12:15], v1 offset:2048
    buffer_load_dwordx4 v[40:43], v0, s[4:7], s36 offen offset:0
    s_waitcnt lgkmcnt(3)
    v_smfmac_f32_16x16x64_bf16 v[28:31], v[16:19], a[0:7], v2
    buffer_load_dwordx4 v[44:47], v0, s[4:7], s36 offen offset:1024
    v_smfmac_f32_16x16x64_bf16 v[32:35], v[16:19], a[144:151], v2
    buffer_load_dwordx4 v[48:51], v0, s[4:7], s24 offen offset:0
    v_smfmac_f32_16x16x64_bf16 v[36:39], v[16:19], a[248:255], v2
    ds_read_b128 v[16:19], v1 offset:2560
    buffer_load_dwordx4 v[52:55], v0, s[4:7], s24 offen offset:1024
    s_waitcnt lgkmcnt(3)
    v_smfmac_f32_16x16x64_bf16 v[28:31], v[20:23], a[8:15], v2
    v_smfmac_f32_16x16x64_bf16 v[32:35], v[20:23], a[152:159], v2
    v_smfmac_f32_16x16x64_bf16 v[36:39], v[20:23], v[64:71], v2
    ds_read_b128 v[20:23], v1 offset:3072
    s_waitcnt lgkmcnt(3)
    v_smfmac_f32_16x16x64_bf16 v[28:31], v[24:27], a[16:23], v2
    s_waitcnt vmcnt(6)
    v_cmp_ne_u32 vcc, s39, v11
    v_smfmac_f32_16x16x64_bf16 v[32:35], v[24:27], a[160:167], v2
    s_cbranch_vccnz CS2_mr
CS2_mok:
    s_barrier
    v_smfmac_f32_16x16x64_bf16 v[36:39], v[24:27], v[72:79], v2
    ds_read_b128 v[24:27], v1 offset:3584
    s_waitcnt lgkmcnt(3)
    v_smfmac_f32_16x16x64_bf16 v[28:31], v[12:15], a[24:31], v2
    v_smfmac_f32_16x16x64_bf16 v[32:35], v[12:15], a[168:175], v2
    v_smfmac_f32_16x16x64_bf16 v[36:39], v[12:15], v[80:87], v2
    ds_read_b128 v[12:15], v1 offset:4096
    s_waitcnt lgkmcnt(3)
    v_smfmac_f32_16x16x64_bf16 v[28:31], v[16:19], a[32:39], v2
    v_smfmac_f32_16x16x64_bf16 v[32:35], v[16:19], a[176:183], v2
    v_smfmac_f32_16x16x64_bf16 v[36:39], v[16:19], v[88:95], v2
    ds_read_b128 v[16:19], v1 offset:4608
    s_waitcnt lgkmcnt(3)
    v_smfmac_f32_16x16x64_bf16 v[28:31], v[20:23], a[40:47], v2
    v_smfmac_f32_16x16x64_bf16 v[32:35], v[20:23], a[184:191], v2
    v_smfmac_f32_16x16x64_bf16 v[36:39], v[20:23], v[96:103], v2
    ds_read_b128 v[20:23], v1 offset:5120
    s_waitcnt lgkmcnt(3)
    v_smfmac_f32_16x16x64_bf16 v[28:31], v[24:27], a[48:55], v2
    v_smfmac_f32_16x16x64_bf16 v[32:35], v[24:27], a[192:199], v2
    v_smfmac_f32_16x16x64_bf16 v[36:39], v[24:27], v[104:111], v2
    ds_read_b128 v[24:27], v1 offset:5632
    s_waitcnt lgkmcnt(3)
    v_smfmac_f32_16x16x64_bf16 v[28:31], v[12:15], a[56:63], v2
    v_smfmac_f32_16x16x64_bf16 v[32:35], v[12:15], v[56:63], v2
    ds_read_b128 v[56:59], v3 offset:4096
    ds_read_b128 v[60:63], v3 offset:5120
    v_smfmac_f32_16x16x64_bf16 v[36:39], v[12:15], v[112:119], v2
    ds_read_b128 v[12:15], v1 offset:6144
    s_waitcnt lgkmcnt(5)
    v_smfmac_f32_16x16x64_bf16 v[28:31], v[16:19], a[64:71], v2
    v_smfmac_f32_16x16x64_bf16 v[32:35], v[16:19], a[200:207], v2
    s_waitcnt vmcnt(2)
    v_smfmac_f32_16x16x64_bf16 v[36:39], v[16:19], v[40:47], v2
    ds_read_b128 v[40:43], v3 offset:16384
    ds_read_b128 v[44:47], v3 offset:17408
    ds_read_b128 v[16:19], v1 offset:6656
    s_waitcnt lgkmcnt(7)
    v_smfmac_f32_16x16x64_bf16 v[28:31], v[20:23], a[72:79], v2
    s_waitcnt lgkmcnt(4)
    v_smfmac_f32_16x16x64_bf16 v[32:35], v[20:23], v[56:63], v2
    ds_read_b128 v[56:59], v3 offset:6144
    ds_read_b128 v[60:63], v3 offset:7168
    v_smfmac_f32_16x16x64_bf16 v[36:39], v[20:23], v[120:127], v2
    ds_read_b128 v[20:23], v1 offset:7168
    s_waitcnt vmcnt(0)
    v_smfmac_f32_16x16x64_bf16 v[28:31], v[24:27], v[48:55], v2
    ds_read_b128 v[48:51], v3 offset:8192
    ds_read_b128 v[52:55], v3 offset:9216
    v_smfmac_f32_16x16x64_bf16 v[32:35], v[24:27], a[208:215], v2
    s_waitcnt lgkmcnt(6)
    v_smfmac_f32_16x16x64_bf16 v[36:39], v[24:27], v[40:47], v2
    ds_read_b128 v[40:43], v3 offset:10240
    ds_read_b128 v[44:47], v3 offset:11264
    ds_read_b128 v[24:27], v1 offset:7680
    s_barrier
    v_smfmac_f32_16x16x64_bf16 v[28:31], v[12:15], a[80:87], v2
    s_waitcnt lgkmcnt(6)
    v_smfmac_f32_16x16x64_bf16 v[32:35], v[12:15], v[56:63], v2
    ds_read_b128 v[56:59], v3 offset:12288
    ds_read_b128 v[60:63], v3 offset:13312
    ds_read_b128 v[12:15], v1 offset:8192
    v_smfmac_f32_16x16x64_bf16 v[28:31], v[16:19], a[88:95], v2
    s_waitcnt lgkmcnt(6)
    v_smfmac_f32_16x16x64_bf16 v[32:35], v[16:19], v[48:55], v2
    ds_read_b128 v[16:19], v1 offset:8704
    v_smfmac_f32_16x16x64_bf16 v[28:31], v[20:23], a[96:103], v2
    s_waitcnt lgkmcnt(5)
    v_smfmac_f32_16x16x64_bf16 v[32:35], v[20:23], v[40:47], v2
    ds_read_b128 v[40:43], v3 offset:14336
    ds_read_b128 v[44:47], v3 offset:15360
    ds_read_b128 v[20:23], v1 offset:9216
    s_waitcnt lgkmcnt(7)
    v_smfmac_f32_16x16x64_bf16 v[28:31], v[24:27], a[104:111], v2
    s_waitcnt lgkmcnt(5)
    v_smfmac_f32_16x16x64_bf16 v[32:35], v[24:27], v[56:63], v2
    ds_read_b128 v[24:27], v1 offset:9728
    s_waitcnt lgkmcnt(5)
    v_smfmac_f32_16x16x64_bf16 v[28:31], v[12:15], a[112:119], v2
    v_smfmac_f32_16x16x64_bf16 v[32:35], v[12:15], a[216:223], v2
    s_waitcnt lgkmcnt(4)
    v_smfmac_f32_16x16x64_bf16 v[28:31], v[16:19], a[120:127], v2
    s_waitcnt lgkmcnt(2)
    v_smfmac_f32_16x16x64_bf16 v[32:35], v[16:19], v[40:47], v2
    ds_read_b128 v[56:59], v0 offset:14336
    ds_read_b128 v[60:63], v0 offset:18432
    s_waitcnt lgkmcnt(3)
    v_smfmac_f32_16x16x64_bf16 v[28:31], v[20:23], a[128:135], v2
    s_waitcnt lgkmcnt(2)
    v_smfmac_f32_16x16x64_bf16 v[28:31], v[24:27], a[136:143], v2
    ds_read_b128 v[48:51], v0 offset:15360
    ds_read_b128 v[52:55], v0 offset:19456
    v_smfmac_f32_16x16x64_bf16 v[32:35], v[20:23], a[224:231], v2
    v_smfmac_f32_16x16x64_bf16 v[32:35], v[24:27], a[232:239], v2
    s_nop 3
    v_cmp_u_f32 vcc, v28, v30
    v_cvt_pk_bf16_f32 v28, v28, v30
    v_cvt_pk_bf16_f32 v30, v29, v31
    v_smfmac_f32_16x16x64_bf16 v[36:39], v[12:15], v[160:167], v2
    ds_read_b128 v[12:15], v1 offset:6144
    v_smfmac_f32_16x16x64_bf16 v[36:39], v[16:19], v[168:175], v2
    ds_read_b128 v[16:19], v1 offset:6656
    s_cbranch_vccnz CS2_scan
CS2_scanned:
    v_cvt_pk_bf16_f32 v29, v32, v34
    v_cvt_pk_bf16_f32 v31, v33, v35
    ds_write_b64 v6, v[28:29]
    ds_write_b64 v6, v[30:31] offset:512
    v_smfmac_f32_16x16x64_bf16 v[36:39], v[20:23], v[176:183], v2
    ds_read_b128 v[20:23], v1 offset:7168
    v_smfmac_f32_16x16x64_bf16 v[36:39], v[24:27], v[184:191], v2
    ds_read_b128 v[24:27], v1 offset:7680
    s_waitcnt lgkmcnt(5)
    v_smfmac_f32_16x16x64_bf16 v[36:39], v[12:15], v[128:135], v2
    s_waitcnt lgkmcnt(4)
    v_smfmac_f32_16x16x64_bf16 v[36:39], v[16:19], v[136:143], v2
    s_waitcnt lgkmcnt(2)
    s_barrier
    ds_read_b64_tr_b16 v[28:29], v7 offset:0
    ds_read_b64_tr_b16 v[30:31], v7 offset:512
    s_waitcnt lgkmcnt(3)
    v_smfmac_f32_16x16x64_bf16 v[36:39], v[20:23], v[144:151], v2
    ds_read_b64_tr_b16 v[32:33], v7 offset:1024
    ds_read_b64_tr_b16 v[34:35], v7 offset:1536
    s_waitcnt lgkmcnt(4)
    v_smfmac_f32_16x16x64_bf16 v[36:39], v[24:27], v[152:159], v2
    s_waitcnt lgkmcnt(2)
    v_mfma_f32_16x16x32_bf16 v[12:15], v[56:59], v[28:31], 0
    ds_read_b64_tr_b16 v[40:41], v7 offset:2048
    ds_read_b64_tr_b16 v[42:43], v7 offset:2560
    v_mfma_f32_16x16x32_bf16 v[20:23], v[60:63], v[28:31], 0
    ds_read_b128 v[56:59], v0 offset:16384
    ds_read_b128 v[60:63], v0 offset:20480
    s_waitcnt lgkmcnt(4)
    v_mfma_f32_16x16x32_bf16 v[12:15], v[48:51], v[32:35], v[12:15]
    ds_read_b64_tr_b16 v[44:45], v7 offset:3072
    ds_read_b64_tr_b16 v[46:47], v7 offset:3584
    v_mfma_f32_16x16x32_bf16 v[20:23], v[52:55], v[32:35], v[20:23]
    ds_read_b128 v[48:51], v0 offset:17408
    ds_read_b128 v[52:55], v0 offset:21504
    v_mfma_f32_16x16x32_bf16 v[16:19], v[28:31], v[28:31], 0
    v_mov_b64 v[24:25], s[98:99]
    v_mov_b64 v[26:27], s[98:99]
    v_mfma_f32_16x16x32_bf16 v[16:19], v[32:35], v[32:35], v[16:19]
    s_waitcnt lgkmcnt(4)
    v_mfma_f32_16x16x32_bf16 v[12:15], v[56:59], v[40:43], v[12:15]
    v_mfma_f32_16x16x32_bf16 v[20:23], v[60:63], v[40:43], v[20:23]
    buffer_load_dwordx4 v[56:59], v0, s[4:7], s21 offen sc1
    v_cvt_pk_bf16_f32 v36, v36, v38
    s_waitcnt lgkmcnt(0)
    v_mfma_f32_16x16x32_bf16 v[12:15], v[48:51], v[44:47], v[12:15]
    v_cvt_pk_bf16_f32 v37, v37, v39
    v_mfma_f32_16x16x32_bf16 v[20:23], v[52:55], v[44:47], v[20:23]
    buffer_load_dwordx4 v[60:63], v0, s[4:7], s21 offen offset:1024 sc1
    v_mfma_f32_16x16x32_bf16 v[16:19], v[40:43], v[40:43], v[16:19]
    v_mov_b32 v53, 0
    v_mov_b32 v54, 0
    v_mfma_f32_16x16x32_bf16 v[16:19], v[44:47], v[44:47], v[16:19]
    s_nop 0
    v_max3_f32 v11, v12, v13, v14
    s_nop 0
    v_max3_f32 v10, v15, v20, v21
    v_max3_f32 v11, v11, v22, v23
    v_max_f32 v11, v11, v10
    buffer_load_dwordx4 v[28:31], v0, s[4:7], s36 offen offset:2048
    s_nop 0
    v_max3_f32 v10, v11, v18, v19
    v_max3_f32 v11, v11, v18, v19
    s_nop 1
    v_permlane32_swap_b32 v10, v11
    v_max_f32 v16, v10, v11
    v_max_f32 v10, v10, v11
    buffer_load_dwordx4 v[32:35], v0, s[4:7], s36 offen offset:3072
    s_nop 0
    v_permlane16_swap_b32 v10, v16
    v_max_f32 v10, v10, v16
    v_mul_f32 v10, s33, v10
    v_pk_fma_f32 v[12:13], v[12:13], s[96:97], v[10:11] op_sel_hi:[1,1,0] neg_lo:[0,0,1] neg_hi:[0,0,1]
    v_pk_fma_f32 v[14:15], v[14:15], s[96:97], v[10:11] op_sel_hi:[1,1,0] neg_lo:[0,0,1] neg_hi:[0,0,1]
    v_pk_fma_f32 v[20:21], v[20:21], s[96:97], v[10:11] op_sel_hi:[1,1,0] neg_lo:[0,0,1] neg_hi:[0,0,1]
    v_pk_fma_f32 v[22:23], v[22:23], s[96:97], v[10:11] op_sel_hi:[1,1,0] neg_lo:[0,0,1] neg_hi:[0,0,1]
    v_pk_fma_f32 v[18:19], v[18:19], s[96:97], v[10:11] op_sel_hi:[1,1,0] neg_lo:[0,0,1] neg_hi:[0,0,1]
    v_exp_f32 v12, v12
    v_exp_f32 v13, v13
    v_exp_f32 v14, v14
    v_cvt_pk_bf16_f32 v48, v12, v13
    v_exp_f32 v15, v15
    v_exp_f32 v20, v20
    v_cvt_pk_bf16_f32 v49, v14, v15
    v_exp_f32 v21, v21
    v_exp_f32 v22, v22
    v_cvt_pk_bf16_f32 v50, v20, v21
    v_exp_f32 v23, v23
    v_exp_f32 v18, v18
    v_cvt_pk_bf16_f32 v51, v22, v23
    v_exp_f32 v19, v19
    s_nop 0
    v_mfma_f32_16x16x32_bf16 v[20:23], v[24:27], v[48:51], 0
    v_cvt_pk_bf16_f32 v52, v18, v19
    v_cvt_pk_bf16_f32 v55, v18, v19
    s_waitcnt vmcnt(2)
    v_mfma_f32_16x16x32_bf16 v[12:15], v[60:63], v[48:51], 0
    buffer_load_dwordx4 v[40:43], v0, s[4:7], s37 offen offset:0
    s_nop 0
    v_mfma_f32_16x16x16_bf16 v[20:23], v[24:25], v[52:53], v[20:23]
    buffer_load_dwordx4 v[44:47], v0, s[4:7], s37 offen offset:1024
    v_mfma_f32_16x16x32_bf16 v[24:27], v[56:59], v[48:51], 0
    ds_read_b128 v[56:59], v3 offset:18432
    ds_read_b128 v[60:63], v3 offset:19456
    v_mfma_f32_16x16x16_bf16 v[12:15], v[36:37], v[54:55], v[12:15]
    s_nop 2
    v_rcp_f32 v10, v20
    v_mfma_f32_16x16x16_bf16 v[24:27], v[36:37], v[52:53], v[24:27]
    s_add_u32 s14, s14, 1
    s_add_u32 s21, s21, 262144
    s_add_u32 s35, s35, 262144
    s_add_u32 s20, s20, 262144
    v_pk_mul_f32 v[12:13], v[12:13], v[10:11] op_sel_hi:[1,0]
    v_pk_mul_f32 v[14:15], v[14:15], v[10:11] op_sel_hi:[1,0]
    s_nop 1
    v_pk_mul_f32 v[24:25], v[24:25], v[10:11] op_sel_hi:[1,0]
    v_cvt_pk_bf16_f32 v48, v24, v12
    v_cvt_pk_bf16_f32 v49, v25, v13
    v_pk_mul_f32 v[26:27], v[26:27], v[10:11] op_sel_hi:[1,0]
    v_cvt_pk_bf16_f32 v50, v26, v14
    v_cvt_pk_bf16_f32 v51, v27, v15
    ds_write_b128 v8, v[48:51]
    v_mov_b64 v[36:37], 0
    v_mov_b64 v[38:39], 0
    s_waitcnt lgkmcnt(0)
    buffer_load_dwordx4 v[48:51], v0, s[4:7], s37 offen offset:2048
    buffer_load_dwordx4 v[52:55], v0, s[4:7], s37 offen offset:3072
    s_barrier
    ds_read_b128 v[12:15], v1 offset:0
    ds_read_b128 v[16:19], v1 offset:512
    ds_read_b128 v[20:23], v1 offset:1024
    ds_read_b128 v[24:27], v1 offset:1536
    s_waitcnt lgkmcnt(3)
    s_waitcnt vmcnt(4)
    v_smfmac_f32_16x16x64_bf16 v[36:39], v[12:15], v[28:35], v2
    s_waitcnt lgkmcnt(2)
    s_waitcnt vmcnt(2)
    v_smfmac_f32_16x16x64_bf16 v[36:39], v[16:19], v[40:47], v2
    buffer_load_dwordx4 v[40:43], v0, s[4:7], s38 offen offset:0
    v_mov_b64 v[28:29], 0
    s_waitcnt lgkmcnt(1)
    v_smfmac_f32_16x16x64_bf16 v[36:39], v[20:23], v[56:63], v2
    ds_read_b128 v[56:59], v3 offset:20480
    ds_read_b128 v[60:63], v3 offset:21504
    v_mov_b64 v[30:31], 0
    s_waitcnt lgkmcnt(2)
    v_smfmac_f32_16x16x64_bf16 v[36:39], v[24:27], v[192:199], v2
    buffer_load_dwordx4 v[44:47], v0, s[4:7], s38 offen offset:1024
    v_mov_b64 v[32:33], 0
    v_smfmac_f32_16x16x64_bf16 v[28:31], v[12:15], v[200:207], v2
    v_mov_b64 v[34:35], 0
    v_smfmac_f32_16x16x64_bf16 v[28:31], v[16:19], v[208:215], v2
    s_nop 2
    v_cvt_pk_bf16_f32 v36, v36, v37
    s_waitcnt lgkmcnt(0)
    v_smfmac_f32_16x16x64_bf16 v[28:31], v[20:23], v[56:63], v2
    ds_read_b128 v[56:59], v3 offset:22528
    ds_read_b128 v[60:63], v3 offset:23552
    v_cvt_pk_bf16_f32 v37, v38, v39
    v_smfmac_f32_16x16x64_bf16 v[28:31], v[24:27], v[216:223], v2
    v_and_or_b32 v36, v36, -2, s18
    v_smfmac_f32_16x16x64_bf16 v[32:35], v[12:15], v[224:231], v2
    s_waitcnt vmcnt(2)
    v_smfmac_f32_16x16x64_bf16 v[32:35], v[16:19], v[48:55], v2
    ds_read_b128 v[48:51], v3 offset:24576
    ds_read_b128 v[52:55], v3 offset:25600
    s_nop 1
    v_cvt_pk_bf16_f32 v38, v28, v29
    v_cvt_pk_bf16_f32 v39, v30, v31
    buffer_store_dwordx4 v[36:39], v0, s[4:7], s25 offen sc1
    s_waitcnt lgkmcnt(2)
    v_smfmac_f32_16x16x64_bf16 v[32:35], v[20:23], v[56:63], v2
    ds_read_b128 v[56:59], v3 offset:26624
    ds_read_b128 v[60:63], v3 offset:27648
    s_mov_b32 m0, 14336
    v_mov_b64 v[36:37], 0
    v_mov_b64 v[38:39], 0
    v_smfmac_f32_16x16x64_bf16 v[32:35], v[24:27], v[232:239], v2
    buffer_load_dwordx4 v0, s[4:7], s20 offen offset:0 sc1 lds
    s_waitcnt lgkmcnt(2)
    v_smfmac_f32_16x16x64_bf16 v[36:39], v[12:15], v[48:55], v2
    ds_read_b128 v[48:51], v3 offset:28672
    ds_read_b128 v[52:55], v3 offset:29696
    buffer_load_dwordx4 v0, s[4:7], s20 offen offset:1024 sc1 lds
    v_mov_b64 v[28:29], 0
    s_waitcnt lgkmcnt(2)
    v_smfmac_f32_16x16x64_bf16 v[36:39], v[16:19], v[56:63], v2
    ds_read_b128 v[56:59], v3 offset:30720
    ds_read_b128 v[60:63], v3 offset:31744
    buffer_load_dwordx4 v0, s[4:7], s20 offen offset:2048 sc1 lds
    v_mov_b64 v[30:31], 0
    v_cvt_pk_bf16_f32 v32, v32, v33
    v_smfmac_f32_16x16x64_bf16 v[36:39], v[20:23], v[240:247], v2
    buffer_load_dwordx4 v0, s[4:7], s20 offen offset:3072 sc1 lds
    v_cvt_pk_bf16_f32 v33, v34, v35
    s_waitcnt lgkmcnt(2)
    v_smfmac_f32_16x16x64_bf16 v[36:39], v[24:27], v[48:55], v2
    ds_read_b128 v[48:51], v3 offset:32768
    ds_read_b128 v[52:55], v3 offset:33792
    s_mov_b32 m0, 8192
    v_and_or_b32 v32, v32, -2, s18
    s_waitcnt lgkmcnt(2)
    v_smfmac_f32_16x16x64_bf16 v[28:31], v[12:15], v[56:63], v2
    v_smfmac_f32_16x16x64_bf16 v[28:31], v[16:19], v[248:255], v2
    s_nop 0
    v_cvt_pk_bf16_f32 v34, v36, v37
    v_cvt_pk_bf16_f32 v35, v38, v39
    buffer_store_dwordx4 v[32:35], v0, s[4:7], s26 offen sc1
    s_waitcnt lgkmcnt(0)
    v_smfmac_f32_16x16x64_bf16 v[28:31], v[20:23], v[48:55], v2
    s_waitcnt vmcnt(6)
    v_smfmac_f32_16x16x64_bf16 v[28:31], v[24:27], v[40:47], v2
    v_and_b32 v16, 0xff, v0
    ds_read_b128 v[12:15], v16 offset:22528
    s_nop 5
    v_cvt_pk_bf16_f32 v28, v28, v29
    v_cvt_pk_bf16_f32 v29, v30, v31
    v_and_or_b32 v28, v28, -2, s18
    buffer_store_dwordx2 v[28:29], v9, s[4:7], s27 offen sc1
    v_mov_b32 v20, s14
    v_lshlrev_b32 v21, 4, v0
    v_mov_b32 v22, -1
    s_waitcnt lgkmcnt(0)
    s_waitcnt vmcnt(0)
    v_mov_b64 v[28:29], 0
    v_mov_b64 v[30:31], 0
    v_mov_b64 v[32:33], 0
    v_mov_b64 v[34:35], 0
    v_mov_b64 v[36:37], 0
    v_mov_b64 v[38:39], 0
    s_cmp_ge_u32 s46, 80
    s_cbranch_scc1 CS2_nored
    buffer_load_dwordx4 v[48:51], v4, s[4:7], s28 offen sc1
    buffer_load_dwordx4 v[52:55], v4, s[4:7], s29 offen sc1
    buffer_load_dwordx4 v[56:59], v4, s[4:7], s30 offen sc1
    buffer_load_dwordx4 v[60:63], v4, s[4:7], s31 offen sc1
CS2_red:
    s_waitcnt vmcnt(3)
    v_mfma_f32_16x16x32_bf16 v[16:19], v[12:15], v[48:51], 0
    s_waitcnt vmcnt(2)
    v_mfma_f32_16x16x32_bf16 v[16:19], v[12:15], v[52:55], v[16:19]
    v_bitop3_b32 v10, v48, v52, s19 bitop3:0x7e
    s_waitcnt vmcnt(1)
    v_mfma_f32_16x16x32_bf16 v[16:19], v[12:15], v[56:59], v[16:19]
    s_waitcnt vmcnt(0)
    v_bitop3_b32 v11, v56, v60, s19 bitop3:0x7e
    v_bitop3_b32 v10, v10, v11, 1 bitop3:0xa8
    v_cmp_ne_u32 vcc, 0, v10
    v_mfma_f32_16x16x32_bf16 v[16:19], v[12:15], v[60:63], v[16:19]
    s_cmp_eq_u32 s14, 63
    s_cbranch_vccnz CS2_redo
    s_nop 5
    v_add_f32_dpp v16, v16, v16 row_ror:8 row_mask:0xf bank_mask:0xf
    v_add_f32_dpp v17, v17, v17 row_ror:8 row_mask:0xf bank_mask:0xf
    v_add_f32_dpp v18, v18, v18 row_ror:8 row_mask:0xf bank_mask:0xf
    v_add_f32_dpp v19, v19, v19 row_ror:8 row_mask:0xf bank_mask:0xf
    v_cvt_pk_bf16_f32 v10, v16, v17
    v_cvt_pk_bf16_f32 v11, v18, v19
    v_min_u32 v10, s34, v10
    s_cbranch_scc1 CS2_last
    buffer_store_dwordx2 v[10:11], v5, s[4:7], s16 offen sc1
    buffer_store_byte v20, v21, s[8:11], s46 offen sc1
    buffer_store_dword v22, v5, s[4:7], s17 offen sc1
CS2_nored2:
    ds_read_b128 v[40:43], v3 offset:0
    ds_read_b128 v[44:47], v3 offset:1024
    ds_read_b128 v[48:51], v3 offset:2048
    ds_read_b128 v[52:55], v3 offset:3072
    s_add_u32 s15, s16, 8192
    s_add_u32 s39, s39, 0x01010101
    s_add_u32 s16, s16, 16384
    s_and_b32 s16, s16, 0xffff
    s_or_b32 s16, s16, 65536
    s_add_u32 s17, s17, 16384
    s_and_b32 s17, s17, 0xffff
    s_or_b32 s17, s17, 65536
    s_xor_b32 s18, s18, 1
    s_not_b32 s19, s19
    s_waitcnt lgkmcnt(0)
    s_barrier
    buffer_load_dwordx4 v[56:59], v0, s[4:7], s24 offen offset:2048
    buffer_load_dwordx4 v[60:63], v0, s[4:7], s24 offen offset:3072
    s_branch HZ_CS2_top
CS2_redo:
    s_mov_b64 exec, vcc
CS2_redo2:
    buffer_load_dwordx4 v[48:51], v4, s[4:7], s28 offen sc1
    buffer_load_dwordx4 v[52:55], v4, s[4:7], s29 offen sc1
    buffer_load_dwordx4 v[56:59], v4, s[4:7], s30 offen sc1
    buffer_load_dwordx4 v[60:63], v4, s[4:7], s31 offen sc1
    s_add_u32 s32, s32, 1
    s_cmp_gt_u32 s32, 0x40000
    s_cbranch_scc1 L_abort
    s_waitcnt vmcnt(0)
    v_bitop3_b32 v10, v48, v52, s19 bitop3:0x7e
    v_bitop3_b32 v11, v56, v60, s19 bitop3:0x7e
    v_bitop3_b32 v10, v10, v11, 1 bitop3:0xa8
    v_cmp_ne_u32 vcc, 0, v10
    s_cbranch_vccnz CS2_redo2
    s_mov_b64 exec, -1
    s_nop 1
    s_branch CS2_red
CS2_last:
    s_mov_b32 s42, 4855808
    buffer_store_dwordx2 v[10:11], v5, s[4:7], s42 offen sc1
    s_branch CS2_done
CS2_scan:
    v_mov_b32 v10, 0
    ds_read_b32 v11, v0 offset:0
    s_waitcnt lgkmcnt(0)
    v_max_u32 v10, v10, v11
    ds_read_b32 v11, v0 offset:1024
    s_waitcnt lgkmcnt(0)
    v_max_u32 v10, v10, v11
    ds_read_b32 v11, v0 offset:2048
    s_waitcnt lgkmcnt(0)
    v_max_u32 v10, v10, v11
    ds_read_b32 v11, v0 offset:3072
    s_waitcnt lgkmcnt(0)
    v_max_u32 v10, v10, v11
    ds_read_b32 v11, v0 offset:4096
    s_waitcnt lgkmcnt(0)
    v_max_u32 v10, v10, v11
    ds_read_b32 v11, v0 offset:5120
    s_waitcnt lgkmcnt(0)
    v_max_u32 v10, v10, v11
    ds_read_b32 v11, v0 offset:6144
    s_waitcnt lgkmcnt(0)
    v_max_u32 v10, v10, v11
    ds_read_b32 v11, v0 offset:7168
    s_waitcnt lgkmcnt(0)
    v_max_u32 v10, v10, v11
    ds_read_b32 v11, v0 offset:8192
    s_waitcnt lgkmcnt(0)
    v_max_u32 v10, v10, v11
    ds_read_b32 v11, v0 offset:9216
    s_waitcnt lgkmcnt(0)
    v_max_u32 v10, v10, v11
    v_cmp_eq_u32 vcc, -1, v10
    s_cbranch_vccnz CS2_rec
    s_branch CS2_scanned
CS2_nored:
    s_waitcnt vmcnt(0)
    s_cmp_eq_u32 s14, 63
    s_cbranch_scc1 CS2_done
    s_branch CS2_nored2
CS2_mr:
    s_add_u32 s32, s32, 1
    s_cmp_gt_u32 s32, 0x40000
    s_cbranch_scc1 L_abort
    v_bfe_u32 v11, v0, 2, 4
    buffer_load_dword v11, v11, s[4:7], s49 offen sc1
    buffer_load_dwordx4 v0, s[4:7], s15 offen offset:0 sc1 lds
    buffer_load_dwordx4 v0, s[4:7], s15 offen offset:1024 sc1 lds
    s_waitcnt vmcnt(2)
    v_cmp_ne_u32 vcc, s39, v11
    s_cbranch_vccnz CS2_mr
    s_waitcnt vmcnt(0)
    s_branch CS2_mok
CS2_done:
    s_waitcnt vmcnt(0) lgkmcnt(0)
    s_endpgm
CS_w3:
    s_cmp_eq_u32 s12, 0
    s_cselect_b32 s31, 0, 1
    v_lshlrev_b32 v11, 3, v0
    s_sub_u32 s42, s48, 262144
    buffer_load_dword v14, v11, s[4:7], s42 offen sc1
CS3_rec:
    s_waitcnt vmcnt(0) lgkmcnt(0)
    s_add_u32 s32, s32, 1
    s_cmp_gt_u32 s32, 0x40000
    s_cbranch_scc1 L_abort
    s_barrier
    ds_read_b128 v[40:43], v3 offset:0
    ds_read_b128 v[44:47], v3 offset:1024
    ds_read_b128 v[48:51], v3 offset:2048
    ds_read_b128 v[52:55], v3 offset:3072
    s_mov_b32 m0, 18432
    s_nop 0
    buffer_load_dwordx4 v0, s[4:7], s35 offen offset:0 sc1 lds
    buffer_load_dwordx4 v0, s[4:7], s35 offen offset:1024 sc1 lds
    buffer_load_dwordx4 v0, s[4:7], s35 offen offset:2048 sc1 lds
    buffer_load_dwordx4 v0, s[4:7], s35 offen offset:3072 sc1 lds
    buffer_load_dwordx4 v[56:59], v0, s[4:7], s24 offen offset:2048
    buffer_load_dwordx4 v[60:63], v0, s[4:7], s24 offen offset:3072
    v_mov_b64 v[28:29], 0
    v_mov_b64 v[30:31], 0
    v_mov_b64 v[32:33], 0
    v_mov_b64 v[34:35], 0
    v_mov_b64 v[36:37], 0
    v_mov_b64 v[38:39], 0
    s_waitcnt vmcnt(0) lgkmcnt(0)
    s_branch HZ_CS3_top
.p2align 6
HZ_CS3_top:
    s_barrier
    ds_read_b128 v[12:15], v1 offset:0
    ds_read_b128 v[16:19], v1 offset:512
    ds_read_b128 v[20:23], v1 offset:1024
    ds_read_b128 v[24:27], v1 offset:1536
    s_waitcnt lgkmcnt(3)
    v_smfmac_f32_16x16x64_bf16 v[28:31], v[12:15], v[40:47], v2
    v_smfmac_f32_16x16x64_bf16 v[32:35], v[12:15], v[48:55], v2
    v_smfmac_f32_16x16x64_bf16 v[36:39], v[12:15], a[240:247], v2
    s_barrier
    ds_read_b128 v[12:15], v1 offset:2048
    buffer_load_dwordx4 v[40:43], v0, s[4:7], s36 offen offset:0
    s_waitcnt lgkmcnt(3)
    v_smfmac_f32_16x16x64_bf16 v[28:31], v[16:19], a[0:7], v2
    buffer_load_dwordx4 v[44:47], v0, s[4:7], s36 offen offset:1024
    v_smfmac_f32_16x16x64_bf16 v[32:35], v[16:19], a[144:151], v2
    buffer_load_dwordx4 v[48:51], v0, s[4:7], s24 offen offset:0
    v_smfmac_f32_16x16x64_bf16 v[36:39], v[16:19], a[248:255], v2
    ds_read_b128 v[16:19], v1 offset:2560
    buffer_load_dwordx4 v[52:55], v0, s[4:7], s24 offen offset:1024
    s_waitcnt lgkmcnt(3)
    v_smfmac_f32_16x16x64_bf16 v[28:31], v[20:23], a[8:15], v2
    v_smfmac_f32_16x16x64_bf16 v[32:35], v[20:23], a[152:159], v2
    v_smfmac_f32_16x16x64_bf16 v[36:39], v[20:23], v[64:71], v2
    ds_read_b128 v[20:23], v1 offset:3072
    s_waitcnt lgkmcnt(3)
    v_smfmac_f32_16x16x64_bf16 v[28:31], v[24:27], a[16:23], v2
    v_smfmac_f32_16x16x64_bf16 v[32:35], v[24:27], a[160:167], v2
    s_barrier
    v_smfmac_f32_16x16x64_bf16 v[36:39], v[24:27], v[72:79], v2
    ds_read_b128 v[24:27], v1 offset:3584
    buffer_store_dwordx2 v[4:5], v9, s[8:11], s23 offen sc1
    s_mov_b32 s10, 0
    s_waitcnt lgkmcnt(3)
    v_smfmac_f32_16x16x64_bf16 v[28:31], v[12:15], a[24:31], v2
    v_smfmac_f32_16x16x64_bf16 v[32:35], v[12:15], a[168:175], v2
    v_smfmac_f32_16x16x64_bf16 v[36:39], v[12:15], v[80:87], v2
    ds_read_b128 v[12:15], v1 offset:4096
    s_waitcnt lgkmcnt(3)
    v_smfmac_f32_16x16x64_bf16 v[28:31], v[16:19], a[32:39], v2
    v_smfmac_f32_16x16x64_bf16 v[32:35], v[16:19], a[176:183], v2
    v_smfmac_f32_16x16x64_bf16 v[36:39], v[16:19], v[88:95], v2
    ds_read_b128 v[16:19], v1 offset:4608
    s_waitcnt lgkmcnt(3)
    v_smfmac_f32_16x16x64_bf16 v[28:31], v[20:23], a[40:47], v2
    v_smfmac_f32_16x16x64_bf16 v[32:35], v[20:23], a[184:191], v2
    v_smfmac_f32_16x16x64_bf16 v[36:39], v[20:23], v[96:103], v2
    ds_read_b128 v[20:23], v1 offset:5120
    s_waitcnt lgkmcnt(3)
    v_smfmac_f32_16x16x64_bf16 v[28:31], v[24:27], a[48:55], v2
    v_smfmac_f32_16x16x64_bf16 v[32:35], v[24:27], a[192:199], v2
    v_smfmac_f32_16x16x64_bf16 v[36:39], v[24:27], v[104:111], v2
    ds_read_b128 v[24:27], v1 offset:5632
    s_waitcnt lgkmcnt(3)
    v_smfmac_f32_16x16x64_bf16 v[28:31], v[12:15], a[56:63], v2
    s_waitcnt vmcnt(5)
    v_smfmac_f32_16x16x64_bf16 v[32:35], v[12:15], v[56:63], v2
    ds_read_b128 v[56:59], v3 offset:4096
    ds_read_b128 v[60:63], v3 offset:5120
    v_smfmac_f32_16x16x64_bf16 v[36:39], v[12:15], v[112:119], v2
    ds_read_b128 v[12:15], v1 offset:6144
    s_waitcnt lgkmcnt(5)
    v_smfmac_f32_16x16x64_bf16 v[28:31], v[16:19], a[64:71], v2
    v_smfmac_f32_16x16x64_bf16 v[32:35], v[16:19], a[200:207], v2
    s_waitcnt vmcnt(3)
    v_smfmac_f32_16x16x64_bf16 v[36:39], v[16:19], v[40:47], v2
    ds_read_b128 v[40:43], v3 offset:16384
    ds_read_b128 v[44:47], v3 offset:17408
    ds_read_b128 v[16:19], v1 offset:6656
    s_waitcnt lgkmcnt(7)
    v_smfmac_f32_16x16x64_bf16 v[28:31], v[20:23], a[72:79], v2
    s_waitcnt lgkmcnt(4)
    v_smfmac_f32_16x16x64_bf16 v[32:35], v[20:23], v[56:63], v2
    ds_read_b128 v[56:59], v3 offset:6144
    ds_read_b128 v[60:63], v3 offset:7168
    v_smfmac_f32_16x16x64_bf16 v[36:39], v[20:23], v[120:127], v2
    ds_read_b128 v[20:23], v1 offset:7168
    s_waitcnt vmcnt(1)
    v_smfmac_f32_16x16x64_bf16 v[28:31], v[24:27], v[48:55], v2
    ds_read_b128 v[48:51], v3 offset:8192
    ds_read_b128 v[52:55], v3 offset:9216
    v_smfmac_f32_16x16x64_bf16 v[32:35], v[24:27], a[208:215], v2
    s_waitcnt lgkmcnt(6)
    v_smfmac_f32_16x16x64_bf16 v[36:39], v[24:27], v[40:47], v2
    ds_read_b128 v[40:43], v3 offset:10240
    ds_read_b128 v[44:47], v3 offset:11264
    ds_read_b128 v[24:27], v1 offset:7680
    s_barrier
    v_smfmac_f32_16x16x64_bf16 v[28:31], v[12:15], a[80:87], v2
    s_waitcnt lgkmcnt(6)
    v_smfmac_f32_16x16x64_bf16 v[32:35], v[12:15], v[56:63], v2
    ds_read_b128 v[56:59], v3 offset:12288
    ds_read_b128 v[60:63], v3 offset:13312
    ds_read_b128 v[12:15], v1 offset:8192
    v_smfmac_f32_16x16x64_bf16 v[28:31], v[16:19], a[88:95], v2
    s_waitcnt lgkmcnt(6)
    v_smfmac_f32_16x16x64_bf16 v[32:35], v[16:19], v[48:55], v2
    ds_read_b128 v[16:19], v1 offset:8704
    v_smfmac_f32_16x16x64_bf16 v[28:31], v[20:23], a[96:103], v2
    s_waitcnt lgkmcnt(5)
    v_smfmac_f32_16x16x64_bf16 v[32:35], v[20:23], v[40:47], v2
    ds_read_b128 v[40:43], v3 offset:14336
    ds_read_b128 v[44:47], v3 offset:15360
    ds_read_b128 v[20:23], v1 offset:9216
    s_waitcnt lgkmcnt(7)
    v_smfmac_f32_16x16x64_bf16 v[28:31], v[24:27], a[104:111], v2
    s_waitcnt lgkmcnt(5)
    v_smfmac_f32_16x16x64_bf16 v[32:35], v[24:27], v[56:63], v2
    ds_read_b128 v[24:27], v1 offset:9728
    s_waitcnt lgkmcnt(5)
    v_smfmac_f32_16x16x64_bf16 v[28:31], v[12:15], a[112:119], v2
    v_smfmac_f32_16x16x64_bf16 v[32:35], v[12:15], a[216:223], v2
    s_waitcnt lgkmcnt(4)
    v_smfmac_f32_16x16x64_bf16 v[28:31], v[16:19], a[120:127], v2
    s_waitcnt lgkmcnt(2)
    v_smfmac_f32_16x16x64_bf16 v[32:35], v[16:19], v[40:47], v2
    ds_read_b128 v[56:59], v0 offset:14336
    ds_read_b128 v[60:63], v0 offset:18432
    s_waitcnt lgkmcnt(3)
    v_smfmac_f32_16x16x64_bf16 v[28:31], v[20:23], a[128:135], v2
    s_waitcnt lgkmcnt(2)
    v_smfmac_f32_16x16x64_bf16 v[28:31], v[24:27], a[136:143], v2
    ds_read_b128 v[48:51], v0 offset:15360
    ds_read_b128 v[52:55], v0 offset:19456
    v_smfmac_f32_16x16x64_bf16 v[32:35], v[20:23], a[224:231], v2
    v_smfmac_f32_16x16x64_bf16 v[32:35], v[24:27], a[232:239], v2
    s_nop 3
    v_cmp_u_f32 vcc, v28, v30
    v_cvt_pk_bf16_f32 v28, v28, v30
    v_cvt_pk_bf16_f32 v30, v29, v31
    v_smfmac_f32_16x16x64_bf16 v[36:39], v[12:15], v[160:167], v2
    ds_read_b128 v[12:15], v1 offset:6144
    v_smfmac_f32_16x16x64_bf16 v[36:39], v[16:19], v[168:175], v2
    ds_read_b128 v[16:19], v1 offset:6656
    s_cbranch_vccnz CS3_scan
CS3_scanned:
    v_cvt_pk_bf16_f32 v29, v32, v34
    v_cvt_pk_bf16_f32 v31, v33, v35
    ds_write_b64 v6, v[28:29]
    ds_write_b64 v6, v[30:31] offset:512
    v_smfmac_f32_16x16x64_bf16 v[36:39], v[20:23], v[176:183], v2
    ds_read_b128 v[20:23], v1 offset:7168
    v_smfmac_f32_16x16x64_bf16 v[36:39], v[24:27], v[184:191], v2
    ds_read_b128 v[24:27], v1 offset:7680
    s_waitcnt lgkmcnt(5)
    v_smfmac_f32_16x16x64_bf16 v[36:39], v[12:15], v[128:135], v2
    s_waitcnt lgkmcnt(4)
    v_smfmac_f32_16x16x64_bf16 v[36:39], v[16:19], v[136:143], v2
    s_cmp_ge_u32 s14, 61
    s_cbranch_scc1 CS3_pub62
CS3_pub62b:
    s_waitcnt lgkmcnt(2)
    s_barrier
    ds_read_b64_tr_b16 v[28:29], v7 offset:0
    ds_read_b64_tr_b16 v[30:31], v7 offset:512
    s_waitcnt lgkmcnt(3)
    v_smfmac_f32_16x16x64_bf16 v[36:39], v[20:23], v[144:151], v2
    ds_read_b64_tr_b16 v[32:33], v7 offset:1024
    ds_read_b64_tr_b16 v[34:35], v7 offset:1536
    s_waitcnt lgkmcnt(4)
    v_smfmac_f32_16x16x64_bf16 v[36:39], v[24:27], v[152:159], v2
    s_waitcnt lgkmcnt(2)
    v_mfma_f32_16x16x32_bf16 v[12:15], v[56:59], v[28:31], 0
    ds_read_b64_tr_b16 v[40:41], v7 offset:2048
    ds_read_b64_tr_b16 v[42:43], v7 offset:2560
    v_mfma_f32_16x16x32_bf16 v[20:23], v[60:63], v[28:31], 0
    ds_read_b128 v[56:59], v0 offset:16384
    ds_read_b128 v[60:63], v0 offset:20480
    s_waitcnt lgkmcnt(4)
    v_mfma_f32_16x16x32_bf16 v[12:15], v[48:51], v[32:35], v[12:15]
    ds_read_b64_tr_b16 v[44:45], v7 offset:3072
    ds_read_b64_tr_b16 v[46:47], v7 offset:3584
    v_mfma_f32_16x16x32_bf16 v[20:23], v[52:55], v[32:35], v[20:23]
    ds_read_b128 v[48:51], v0 offset:17408
    ds_read_b128 v[52:55], v0 offset:21504
    v_mfma_f32_16x16x32_bf16 v[16:19], v[28:31], v[28:31], 0
    v_mov_b64 v[24:25], s[98:99]
    v_mov_b64 v[26:27], s[98:99]
    v_mfma_f32_16x16x32_bf16 v[16:19], v[32:35], v[32:35], v[16:19]
    s_waitcnt lgkmcnt(4)
    v_mfma_f32_16x16x32_bf16 v[12:15], v[56:59], v[40:43], v[12:15]
    v_mfma_f32_16x16x32_bf16 v[20:23], v[60:63], v[40:43], v[20:23]
    buffer_load_dwordx4 v[56:59], v0, s[4:7], s21 offen sc1
    v_cvt_pk_bf16_f32 v36, v36, v38
    s_waitcnt lgkmcnt(0)
    v_mfma_f32_16x16x32_bf16 v[12:15], v[48:51], v[44:47], v[12:15]
    v_cvt_pk_bf16_f32 v37, v37, v39
    v_mfma_f32_16x16x32_bf16 v[20:23], v[52:55], v[44:47], v[20:23]
    buffer_load_dwordx4 v[60:63], v0, s[4:7], s21 offen offset:1024 sc1
    v_mfma_f32_16x16x32_bf16 v[16:19], v[40:43], v[40:43], v[16:19]
    v_mov_b32 v53, 0
    v_mov_b32 v54, 0
    v_mfma_f32_16x16x32_bf16 v[16:19], v[44:47], v[44:47], v[16:19]
    s_nop 0
    v_max3_f32 v11, v12, v13, v14
    s_nop 0
    v_max3_f32 v10, v15, v20, v21
    v_max3_f32 v11, v11, v22, v23
    v_max_f32 v11, v11, v10
    buffer_load_dwordx4 v[28:31], v0, s[4:7], s36 offen offset:2048
    s_nop 0
    v_max3_f32 v10, v11, v18, v19
    v_max3_f32 v11, v11, v18, v19
    s_nop 1
    v_permlane32_swap_b32 v10, v11
    v_max_f32 v16, v10, v11
    v_max_f32 v10, v10, v11
    buffer_load_dwordx4 v[32:35], v0, s[4:7], s36 offen offset:3072
    s_nop 0
    v_permlane16_swap_b32 v10, v16
    v_max_f32 v10, v10, v16
    v_mul_f32 v10, s33, v10
    v_pk_fma_f32 v[12:13], v[12:13], s[96:97], v[10:11] op_sel_hi:[1,1,0] neg_lo:[0,0,1] neg_hi:[0,0,1]
    v_pk_fma_f32 v[14:15], v[14:15], s[96:97], v[10:11] op_sel_hi:[1,1,0] neg_lo:[0,0,1] neg_hi:[0,0,1]
    v_pk_fma_f32 v[20:21], v[20:21], s[96:97], v[10:11] op_sel_hi:[1,1,0] neg_lo:[0,0,1] neg_hi:[0,0,1]
    v_pk_fma_f32 v[22:23], v[22:23], s[96:97], v[10:11] op_sel_hi:[1,1,0] neg_lo:[0,0,1] neg_hi:[0,0,1]
    v_pk_fma_f32 v[18:19], v[18:19], s[96:97], v[10:11] op_sel_hi:[1,1,0] neg_lo:[0,0,1] neg_hi:[0,0,1]
    v_exp_f32 v12, v12
    v_exp_f32 v13, v13
    v_exp_f32 v14, v14
    v_cvt_pk_bf16_f32 v48, v12, v13
    v_exp_f32 v15, v15
    v_exp_f32 v20, v20
    v_cvt_pk_bf16_f32 v49, v14, v15
    v_exp_f32 v21, v21
    v_exp_f32 v22, v22
    v_cvt_pk_bf16_f32 v50, v20, v21
    v_exp_f32 v23, v23
    v_exp_f32 v18, v18
    v_cvt_pk_bf16_f32 v51, v22, v23
    v_exp_f32 v19, v19
    s_nop 0
    v_mfma_f32_16x16x32_bf16 v[20:23], v[24:27], v[48:51], 0
    v_cvt_pk_bf16_f32 v52, v18, v19
    v_cvt_pk_bf16_f32 v55, v18, v19
    s_waitcnt vmcnt(2)
    v_mfma_f32_16x16x32_bf16 v[12:15], v[60:63], v[48:51], 0
    buffer_load_dwordx4 v[40:43], v0, s[4:7], s37 offen offset:0
    s_nop 0
    v_mfma_f32_16x16x16_bf16 v[20:23], v[24:25], v[52:53], v[20:23]
    buffer_load_dwordx4 v[44:47], v0, s[4:7], s37 offen offset:1024
    v_mfma_f32_16x16x32_bf16 v[24:27], v[56:59], v[48:51], 0
    ds_read_b128 v[56:59], v3 offset:18432
    ds_read_b128 v[60:63], v3 offset:19456
    v_mfma_f32_16x16x16_bf16 v[12:15], v[36:37], v[54:55], v[12:15]
    s_nop 2
    v_rcp_f32 v10, v20
    v_mfma_f32_16x16x16_bf16 v[24:27], v[36:37], v[52:53], v[24:27]
    s_add_u32 s14, s14, 1
    s_add_u32 s21, s21, 262144
    s_add_u32 s35, s35, 262144
    s_add_u32 s20, s20, 262144
    v_pk_mul_f32 v[12:13], v[12:13], v[10:11] op_sel_hi:[1,0]
    v_pk_mul_f32 v[14:15], v[14:15], v[10:11] op_sel_hi:[1,0]
    s_nop 1
    v_pk_mul_f32 v[24:25], v[24:25], v[10:11] op_sel_hi:[1,0]
    v_cvt_pk_bf16_f32 v48, v24, v12
    v_cvt_pk_bf16_f32 v49, v25, v13
    v_pk_mul_f32 v[26:27], v[26:27], v[10:11] op_sel_hi:[1,0]
    v_cvt_pk_bf16_f32 v50, v26, v14
    v_cvt_pk_bf16_f32 v51, v27, v15
    ds_write_b128 v8, v[48:51]
    v_mov_b64 v[36:37], 0
    v_mov_b64 v[38:39], 0
    s_waitcnt lgkmcnt(0)
    buffer_load_dwordx4 v[48:51], v0, s[4:7], s37 offen offset:2048
    buffer_load_dwordx4 v[52:55], v0, s[4:7], s37 offen offset:3072
    s_barrier
    ds_read_b128 v[12:15], v1 offset:0
    ds_read_b128 v[16:19], v1 offset:512
    ds_read_b128 v[20:23], v1 offset:1024
    ds_read_b128 v[24:27], v1 offset:1536
    s_waitcnt lgkmcnt(3)
    s_waitcnt vmcnt(4)
    v_smfmac_f32_16x16x64_bf16 v[36:39], v[12:15], v[28:35], v2
    s_waitcnt lgkmcnt(2)
    s_waitcnt vmcnt(2)
    v_smfmac_f32_16x16x64_bf16 v[36:39], v[16:19], v[40:47], v2
    buffer_load_dwordx4 v[40:43], v0, s[4:7], s38 offen offset:0
    v_mov_b64 v[28:29], 0
    s_waitcnt lgkmcnt(1)
    v_smfmac_f32_16x16x64_bf16 v[36:39], v[20:23], v[56:63], v2
    ds_read_b128 v[56:59], v3 offset:20480
    ds_read_b128 v[60:63], v3 offset:21504
    v_mov_b64 v[30:31], 0
    s_waitcnt lgkmcnt(2)
    v_smfmac_f32_16x16x64_bf16 v[36:39], v[24:27], v[192:199], v2
    buffer_load_dwordx4 v[44:47], v0, s[4:7], s38 offen offset:1024
    v_mov_b64 v[32:33], 0
    v_smfmac_f32_16x16x64_bf16 v[28:31], v[12:15], v[200:207], v2
    v_mov_b64 v[34:35], 0
    v_smfmac_f32_16x16x64_bf16 v[28:31], v[16:19], v[208:215], v2
    s_nop 2
    v_cvt_pk_bf16_f32 v36, v36, v37
    s_waitcnt lgkmcnt(0)
    v_smfmac_f32_16x16x64_bf16 v[28:31], v[20:23], v[56:63], v2
    ds_read_b128 v[56:59], v3 offset:22528
    ds_read_b128 v[60:63], v3 offset:23552
    v_cvt_pk_bf16_f32 v37, v38, v39
    v_smfmac_f32_16x16x64_bf16 v[28:31], v[24:27], v[216:223], v2
    v_and_or_b32 v36, v36, -2, s18
    v_smfmac_f32_16x16x64_bf16 v[32:35], v[12:15], v[224:231], v2
    s_waitcnt vmcnt(2)
    v_smfmac_f32_16x16x64_bf16 v[32:35], v[16:19], v[48:55], v2
    ds_read_b128 v[48:51], v3 offset:24576
    ds_read_b128 v[52:55], v3 offset:25600
    s_nop 1
    v_cvt_pk_bf16_f32 v38, v28, v29
    v_cvt_pk_bf16_f32 v39, v30, v31
    buffer_store_dwordx4 v[36:39], v0, s[4:7], s25 offen sc1
    s_waitcnt lgkmcnt(2)
    v_smfmac_f32_16x16x64_bf16 v[32:35], v[20:23], v[56:63], v2
    ds_read_b128 v[56:59], v3 offset:26624
    ds_read_b128 v[60:63], v3 offset:27648
    s_mov_b32 m0, 18432
    v_mov_b64 v[36:37], 0
    v_mov_b64 v[38:39], 0
    v_smfmac_f32_16x16x64_bf16 v[32:35], v[24:27], v[232:239], v2
    buffer_load_dwordx4 v0, s[4:7], s35 offen offset:0 sc1 lds
    s_waitcnt lgkmcnt(2)
    v_smfmac_f32_16x16x64_bf16 v[36:39], v[12:15], v[48:55], v2
    ds_read_b128 v[48:51], v3 offset:28672
    ds_read_b128 v[52:55], v3 offset:29696
    buffer_load_dwordx4 v0, s[4:7], s35 offen offset:1024 sc1 lds
    v_mov_b64 v[28:29], 0
    s_waitcnt lgkmcnt(2)
    v_smfmac_f32_16x16x64_bf16 v[36:39], v[16:19], v[56:63], v2
    ds_read_b128 v[56:59], v3 offset:30720
    ds_read_b128 v[60:63], v3 offset:31744
    buffer_load_dwordx4 v0, s[4:7], s35 offen offset:2048 sc1 lds
    v_mov_b64 v[30:31], 0
    v_cvt_pk_bf16_f32 v32, v32, v33
    v_smfmac_f32_16x16x64_bf16 v[36:39], v[20:23], v[240:247], v2
    buffer_load_dwordx4 v0, s[4:7], s35 offen offset:3072 sc1 lds
    v_cvt_pk_bf16_f32 v33, v34, v35
    s_waitcnt lgkmcnt(2)
    v_smfmac_f32_16x16x64_bf16 v[36:39], v[24:27], v[48:55], v2
    ds_read_b128 v[48:51], v3 offset:32768
    ds_read_b128 v[52:55], v3 offset:33792
    v_and_or_b32 v32, v32, -2, s18
    s_waitcnt lgkmcnt(2)
    v_smfmac_f32_16x16x64_bf16 v[28:31], v[12:15], v[56:63], v2
    v_smfmac_f32_16x16x64_bf16 v[28:31], v[16:19], v[248:255], v2
    s_nop 1
    v_cvt_pk_bf16_f32 v34, v36, v37
    v_cvt_pk_bf16_f32 v35, v38, v39
    buffer_store_dwordx4 v[32:35], v0, s[4:7], s26 offen sc1
    s_waitcnt lgkmcnt(0)
    v_smfmac_f32_16x16x64_bf16 v[28:31], v[20:23], v[48:55], v2
    s_waitcnt vmcnt(6)
    v_smfmac_f32_16x16x64_bf16 v[28:31], v[24:27], v[40:47], v2
    s_nop 7
    v_cvt_pk_bf16_f32 v28, v28, v29
    v_cvt_pk_bf16_f32 v29, v30, v31
    v_and_or_b32 v28, v28, -2, s18
    buffer_store_dwordx2 v[28:29], v9, s[4:7], s27 offen sc1
    ds_read_b128 v[40:43], v3 offset:0
    ds_read_b128 v[44:47], v3 offset:1024
    ds_read_b128 v[48:51], v3 offset:2048
    ds_read_b128 v[52:55], v3 offset:3072
    s_add_u32 s42, s15, s22
    s_sub_u32 s42, s42, 12288
    s_add_u32 s10, s42, 320
    s_cmp_lt_u32 s22, 10240
    s_cselect_b32 s10, s10, 0
    buffer_load_dwordx2 v[4:5], v9, s[8:11], s42 offen sc1
    s_add_u32 s23, s23, 10240
    s_add_u32 s10, s23, 320
    s_cmp_lt_u32 s22, 10240
    s_cselect_b32 s10, s10, 0
    s_cmp_eq_u32 s14, 63
    s_cbranch_scc1 CS3_last
    s_cmp_eq_u32 s31, 1
    s_cbranch_scc1 CS3_kvok
    s_lshl_b32 s42, s14, 7
    s_add_u32 s42, s42, 8448
    s_min_u32 s42, s42, 16256
    s_load_dword s28, s[4:5], s42 glc
    s_load_dword s29, s[4:5], 16256 glc
    s_waitcnt lgkmcnt(0)
    s_cmp_ge_u32 s29, 32
    s_cselect_b32 s31, 1, 0
    s_cmp_ge_u32 s28, 32
    s_cbranch_scc0 CS3_kvw
CS3_kvok:
    s_add_u32 s15, s16, 12288
    s_add_u32 s16, s16, 16384
    s_and_b32 s16, s16, 0xffff
    s_or_b32 s16, s16, 65536
    s_add_u32 s17, s17, 16384
    s_and_b32 s17, s17, 0xffff
    s_or_b32 s17, s17, 65536
    s_xor_b32 s18, s18, 1
    s_not_b32 s19, s19
    v_mov_b64 v[28:29], 0
    v_mov_b64 v[30:31], 0
    v_mov_b64 v[32:33], 0
    v_mov_b64 v[34:35], 0
    v_mov_b64 v[36:37], 0
    v_mov_b64 v[38:39], 0
    s_waitcnt vmcnt(0) lgkmcnt(0)
    s_barrier
    buffer_load_dwordx4 v[56:59], v0, s[4:7], s24 offen offset:2048
    buffer_load_dwordx4 v[60:63], v0, s[4:7], s24 offen offset:3072
    s_branch HZ_CS3_top
CS3_scan:
    v_mov_b32 v10, 0
    ds_read_b32 v11, v0 offset:0
    s_waitcnt lgkmcnt(0)
    v_max_u32 v10, v10, v11
    ds_read_b32 v11, v0 offset:1024
    s_waitcnt lgkmcnt(0)
    v_max_u32 v10, v10, v11
    ds_read_b32 v11, v0 offset:2048
    s_waitcnt lgkmcnt(0)
    v_max_u32 v10, v10, v11
    ds_read_b32 v11, v0 offset:3072
    s_waitcnt lgkmcnt(0)
    v_max_u32 v10, v10, v11
    ds_read_b32 v11, v0 offset:4096
    s_waitcnt lgkmcnt(0)
    v_max_u32 v10, v10, v11
    ds_read_b32 v11, v0 offset:5120
    s_waitcnt lgkmcnt(0)
    v_max_u32 v10, v10, v11
    ds_read_b32 v11, v0 offset:6144
    s_waitcnt lgkmcnt(0)
    v_max_u32 v10, v10, v11
    ds_read_b32 v11, v0 offset:7168
    s_waitcnt lgkmcnt(0)
    v_max_u32 v10, v10, v11
    ds_read_b32 v11, v0 offset:8192
    s_waitcnt lgkmcnt(0)
    v_max_u32 v10, v10, v11
    ds_read_b32 v11, v0 offset:9216
    s_waitcnt lgkmcnt(0)
    v_max_u32 v10, v10, v11
    v_cmp_eq_u32 vcc, -1, v10
    s_cbranch_vccnz CS3_rec
    s_branch CS3_scanned
CS3_kvw:
    v_mov_b32 v10, 0
CS3_kvw2:
    buffer_load_dword v11, v10, s[4:7], s42 offen sc1
    s_add_u32 s32, s32, 1
    s_cmp_gt_u32 s32, 0x40000
    s_cbranch_scc1 L_abort
    s_waitcnt vmcnt(0)
    v_cmp_gt_u32 vcc, 32, v11
    s_cbranch_vccnz CS3_kvw2
    s_branch CS3_kvok
CS3_pub62:
    v_add_u32 v11, s22, v9
    ds_read_b64 v[4:5], v11 offset:0
    s_add_u32 s42, s23, 10240
    s_add_u32 s10, s42, 320
    s_waitcnt lgkmcnt(0)
    buffer_store_dwordx2 v[4:5], v9, s[8:11], s42 offen sc1
    s_mov_b32 s10, 0
    s_branch CS3_pub62b
CS3_last:
    s_waitcnt vmcnt(0)
    s_branch CS3_done
CS3_done:
    s_waitcnt vmcnt(0) lgkmcnt(0)
    s_endpgm
L_worker:
    s_load_dwordx2 s[20:21], s[0:1], 0
    s_load_dwordx2 s[40:41], s[0:1], 16
    s_load_dwordx2 s[42:43], s[0:1], 24
    s_load_dwordx2 s[44:45], s[0:1], 32
    s_load_dwordx2 s[54:55], s[0:1], 40
    s_load_dwordx2 s[46:47], s[0:1], 64
    s_load_dwordx2 s[48:49], s[0:1], 72
    v_mov_b32 v232, v0
    v_lshlrev_b32 v233, 4, v0
    s_lshl_b32 s34, s64, 2
    s_lshr_b32 s33, 0x54321060, s34
    s_and_b32 s33, s33, 7
    s_lshl_b32 s33, s33, 5
    s_add_u32 s33, s33, s65
    s_mov_b32 s32, 0
    s_mov_b32 s37, 0xffff0000
    s_mov_b32 s22, 2621440
    s_mov_b32 s23, 0x20000
    s_mov_b32 s11, 0x20000
    s_waitcnt lgkmcnt(0)
    s_cmp_lt_u32 s33, 62
    s_cbranch_scc0 W_notp
    s_lshl_b32 s24, s33, 1
    s_add_u32 s34, s33, 48
    s_min_u32 s24, s24, s34
    s_lshr_b32 s36, s24, 5
    s_cmp_eq_u32 s36, 0
    s_cselect_b32 s8, s42, s44
    s_cselect_b32 s9, s43, s45
    s_cmp_eq_u32 s36, 2
    s_cselect_b32 s8, s40, s8
    s_cselect_b32 s9, s41, s9
    s_cmp_eq_u32 s36, 3
    s_cselect_b32 s8, s46, s8
    s_cselect_b32 s9, s47, s9
    s_mov_b32 s34, 8192
    s_cselect_b32 s30, 3456, s34
    s_mul_i32 s10, s30, 640
    v_lshrrev_b32 v242, 4, v232
    v_lshlrev_b32 v243, 1, v242
    v_and_b32 v244, 15, v232
    v_xor_b32 v243, v243, v244
    s_lshl_b32 s34, s13, 4
    v_add_u32 v242, s34, v242
    v_mul_lo_u32 v242, v242, s30
    v_lshl_add_u32 v234, v243, 4, v242
    v_xor_b32 v243, 8, v243
    v_lshl_add_u32 v235, v243, 4, v242
    s_lshl_b32 s30, s30, 2
    s_mul_i32 s27, s30, 13
    s_lshl_b32 s35, s13, 12
    v_bfe_u32 v240, v232, 2, 2
    v_bfe_u32 v241, v232, 4, 1
    v_lshl_add_u32 v241, v241, 2, v240
    v_lshrrev_b32 v242, 4, v232
    v_lshl_add_u32 v242, v242, 3, v240
    v_lshlrev_b32 v242, 8, v242
    v_and_b32 v243, 3, v232
    v_lshl_add_u32 v242, v243, 3, v242
    s_lshl_b32 s34, s13, 1
    v_xor_b32 v243, s34, v241
    v_lshl_add_u32 v248, v243, 5, v242
    v_xor_b32 v243, 1, v243
    v_lshl_add_u32 v249, v243, 5, v242
    s_and_b32 s31, s24, 31
    s_add_u32 s31, s31, 0
    s_lshl_b32 s31, s31, 8
    s_add_u32 m0, s35, 0
    s_nop 0
    buffer_load_dwordx4 v234, s[8:11], s31 offen lds
    s_add_u32 s31, s31, s30
    s_add_u32 m0, s35, 1024
    s_nop 0
    buffer_load_dwordx4 v234, s[8:11], s31 offen lds
    s_add_u32 s31, s31, s30
    s_add_u32 m0, s35, 2048
    s_nop 0
    buffer_load_dwordx4 v235, s[8:11], s31 offen lds
    s_add_u32 s31, s31, s30
    s_add_u32 m0, s35, 3072
    s_nop 0
    buffer_load_dwordx4 v235, s[8:11], s31 offen lds
    s_add_u32 s31, s31, s27
    s_add_u32 m0, s35, 16384
    s_nop 0
    buffer_load_dwordx4 v234, s[8:11], s31 offen lds
    s_add_u32 s31, s31, s30
    s_add_u32 m0, s35, 17408
    s_nop 0
    buffer_load_dwordx4 v234, s[8:11], s31 offen lds
    s_add_u32 s31, s31, s30
    s_add_u32 m0, s35, 18432
    s_nop 0
    buffer_load_dwordx4 v235, s[8:11], s31 offen lds
    s_add_u32 s31, s31, s30
    s_add_u32 m0, s35, 19456
    s_nop 0
    buffer_load_dwordx4 v235, s[8:11], s31 offen lds
    s_add_u32 s31, s31, s27
    s_add_u32 m0, s35, 32768
    s_nop 0
    buffer_load_dwordx4 v234, s[8:11], s31 offen lds
    s_add_u32 s31, s31, s30
    s_add_u32 m0, s35, 33792
    s_nop 0
    buffer_load_dwordx4 v234, s[8:11], s31 offen lds
    s_add_u32 s31, s31, s30
    s_add_u32 m0, s35, 34816
    s_nop 0
    buffer_load_dwordx4 v235, s[8:11], s31 offen lds
    s_add_u32 s31, s31, s30
    s_add_u32 m0, s35, 35840
    s_nop 0
    buffer_load_dwordx4 v235, s[8:11], s31 offen lds
    s_add_u32 s31, s31, s27
    s_add_u32 m0, s35, 49152
    s_nop 0
    buffer_load_dwordx4 v234, s[8:11], s31 offen lds
    s_add_u32 s31, s31, s30
    s_add_u32 m0, s35, 50176
    s_nop 0
    buffer_load_dwordx4 v234, s[8:11], s31 offen lds
    s_add_u32 s31, s31, s30
    s_add_u32 m0, s35, 51200
    s_nop 0
    buffer_load_dwordx4 v235, s[8:11], s31 offen lds
    s_add_u32 s31, s31, s30
    s_add_u32 m0, s35, 52224
    s_nop 0
    buffer_load_dwordx4 v235, s[8:11], s31 offen lds
    s_add_u32 s31, s31, s27
    s_add_u32 m0, s35, 65536
    s_nop 0
    buffer_load_dwordx4 v234, s[8:11], s31 offen lds
    s_add_u32 s31, s31, s30
    s_add_u32 m0, s35, 66560
    s_nop 0
    buffer_load_dwordx4 v234, s[8:11], s31 offen lds
    s_add_u32 s31, s31, s30
    s_add_u32 m0, s35, 67584
    s_nop 0
    buffer_load_dwordx4 v235, s[8:11], s31 offen lds
    s_add_u32 s31, s31, s30
    s_add_u32 m0, s35, 68608
    s_nop 0
    buffer_load_dwordx4 v235, s[8:11], s31 offen lds
    s_add_u32 s31, s31, s27
    s_add_u32 m0, s35, 81920
    s_nop 0
    buffer_load_dwordx4 v234, s[8:11], s31 offen lds
    s_add_u32 s31, s31, s30
    s_add_u32 m0, s35, 82944
    s_nop 0
    buffer_load_dwordx4 v234, s[8:11], s31 offen lds
    s_add_u32 s31, s31, s30
    s_add_u32 m0, s35, 83968
    s_nop 0
    buffer_load_dwordx4 v235, s[8:11], s31 offen lds
    s_add_u32 s31, s31, s30
    s_add_u32 m0, s35, 84992
    s_nop 0
    buffer_load_dwordx4 v235, s[8:11], s31 offen lds
    s_add_u32 s31, s31, s27
    s_add_u32 m0, s35, 98304
    s_nop 0
    buffer_load_dwordx4 v234, s[8:11], s31 offen lds
    s_add_u32 s31, s31, s30
    s_add_u32 m0, s35, 99328
    s_nop 0
    buffer_load_dwordx4 v234, s[8:11], s31 offen lds
    s_add_u32 s31, s31, s30
    s_add_u32 m0, s35, 100352
    s_nop 0
    buffer_load_dwordx4 v235, s[8:11], s31 offen lds
    s_add_u32 s31, s31, s30
    s_add_u32 m0, s35, 101376
    s_nop 0
    buffer_load_dwordx4 v235, s[8:11], s31 offen lds
    s_add_u32 s31, s31, s27
    s_add_u32 m0, s35, 114688
    s_nop 0
    buffer_load_dwordx4 v234, s[8:11], s31 offen lds
    s_add_u32 s31, s31, s30
    s_add_u32 m0, s35, 115712
    s_nop 0
    buffer_load_dwordx4 v234, s[8:11], s31 offen lds
    s_add_u32 s31, s31, s30
    s_add_u32 m0, s35, 116736
    s_nop 0
    buffer_load_dwordx4 v235, s[8:11], s31 offen lds
    s_add_u32 s31, s31, s30
    s_add_u32 m0, s35, 117760
    s_nop 0
    buffer_load_dwordx4 v235, s[8:11], s31 offen lds
    s_add_u32 s31, s31, s27
    s_add_u32 m0, s35, 131072
    s_nop 0
    buffer_load_dwordx4 v234, s[8:11], s31 offen lds
    s_add_u32 s31, s31, s30
    s_add_u32 m0, s35, 132096
    s_nop 0
    buffer_load_dwordx4 v234, s[8:11], s31 offen lds
    s_add_u32 s31, s31, s30
    s_add_u32 m0, s35, 133120
    s_nop 0
    buffer_load_dwordx4 v235, s[8:11], s31 offen lds
    s_add_u32 s31, s31, s30
    s_add_u32 m0, s35, 134144
    s_nop 0
    buffer_load_dwordx4 v235, s[8:11], s31 offen lds
    s_add_u32 s31, s31, s27
    s_add_u32 m0, s35, 147456
    s_nop 0
    buffer_load_dwordx4 v234, s[8:11], s31 offen lds
    s_add_u32 s31, s31, s30
    s_add_u32 m0, s35, 148480
    s_nop 0
    buffer_load_dwordx4 v234, s[8:11], s31 offen lds
    s_add_u32 s31, s31, s30
    s_add_u32 m0, s35, 149504
    s_nop 0
    buffer_load_dwordx4 v235, s[8:11], s31 offen lds
    s_add_u32 s31, s31, s30
    s_add_u32 m0, s35, 150528
    s_nop 0
    buffer_load_dwordx4 v235, s[8:11], s31 offen lds
    s_add_u32 s31, s31, s27
    s_waitcnt vmcnt(36)
    s_barrier
    ds_read_b64_tr_b16 a[0:1], v248 offset:0
    ds_read_b64_tr_b16 a[2:3], v248 offset:1024
    ds_read_b64_tr_b16 a[4:5], v249 offset:0
    ds_read_b64_tr_b16 a[6:7], v249 offset:1024
    ds_read_b64_tr_b16 a[8:9], v248 offset:8192
    ds_read_b64_tr_b16 a[10:11], v248 offset:9216
    ds_read_b64_tr_b16 a[12:13], v249 offset:8192
    ds_read_b64_tr_b16 a[14:15], v249 offset:9216
    s_waitcnt lgkmcnt(0)
    s_waitcnt vmcnt(32)
    s_barrier
    s_cmp_eq_u32 s36, 3
    s_cselect_b32 s10, 0, s10
    s_and_b32 s31, s24, 31
    s_add_u32 s31, s31, 1
    s_lshl_b32 s31, s31, 8
    s_add_u32 m0, s35, 0
    s_nop 0
    buffer_load_dwordx4 v234, s[8:11], s31 offen lds
    s_add_u32 s31, s31, s30
    s_add_u32 m0, s35, 1024
    s_nop 0
    buffer_load_dwordx4 v234, s[8:11], s31 offen lds
    s_add_u32 s31, s31, s30
    s_add_u32 m0, s35, 2048
    s_nop 0
    buffer_load_dwordx4 v235, s[8:11], s31 offen lds
    s_add_u32 s31, s31, s30
    s_add_u32 m0, s35, 3072
    s_nop 0
    buffer_load_dwordx4 v235, s[8:11], s31 offen lds
    s_add_u32 s31, s31, s27
    ds_read_b64_tr_b16 a[16:17], v248 offset:16384
    ds_read_b64_tr_b16 a[18:19], v248 offset:17408
    ds_read_b64_tr_b16 a[20:21], v249 offset:16384
    ds_read_b64_tr_b16 a[22:23], v249 offset:17408
    ds_read_b64_tr_b16 a[24:25], v248 offset:24576
    ds_read_b64_tr_b16 a[26:27], v248 offset:25600
    ds_read_b64_tr_b16 a[28:29], v249 offset:24576
    ds_read_b64_tr_b16 a[30:31], v249 offset:25600
    s_waitcnt lgkmcnt(0)
    s_waitcnt vmcnt(32)
    s_barrier
    s_add_u32 m0, s35, 16384
    s_nop 0
    buffer_load_dwordx4 v234, s[8:11], s31 offen lds
    s_add_u32 s31, s31, s30
    s_add_u32 m0, s35, 17408
    s_nop 0
    buffer_load_dwordx4 v234, s[8:11], s31 offen lds
    s_add_u32 s31, s31, s30
    s_add_u32 m0, s35, 18432
    s_nop 0
    buffer_load_dwordx4 v235, s[8:11], s31 offen lds
    s_add_u32 s31, s31, s30
    s_add_u32 m0, s35, 19456
    s_nop 0
    buffer_load_dwordx4 v235, s[8:11], s31 offen lds
    s_add_u32 s31, s31, s27
    ds_read_b64_tr_b16 a[32:33], v248 offset:32768
    ds_read_b64_tr_b16 a[34:35], v248 offset:33792
    ds_read_b64_tr_b16 a[36:37], v249 offset:32768
    ds_read_b64_tr_b16 a[38:39], v249 offset:33792
    ds_read_b64_tr_b16 a[40:41], v248 offset:40960
    ds_read_b64_tr_b16 a[42:43], v248 offset:41984
    ds_read_b64_tr_b16 a[44:45], v249 offset:40960
    ds_read_b64_tr_b16 a[46:47], v249 offset:41984
    s_waitcnt lgkmcnt(0)
    s_waitcnt vmcnt(32)
    s_barrier
    s_add_u32 m0, s35, 32768
    s_nop 0
    buffer_load_dwordx4 v234, s[8:11], s31 offen lds
    s_add_u32 s31, s31, s30
    s_add_u32 m0, s35, 33792
    s_nop 0
    buffer_load_dwordx4 v234, s[8:11], s31 offen lds
    s_add_u32 s31, s31, s30
    s_add_u32 m0, s35, 34816
    s_nop 0
    buffer_load_dwordx4 v235, s[8:11], s31 offen lds
    s_add_u32 s31, s31, s30
    s_add_u32 m0, s35, 35840
    s_nop 0
    buffer_load_dwordx4 v235, s[8:11], s31 offen lds
    s_add_u32 s31, s31, s27
    ds_read_b64_tr_b16 a[48:49], v248 offset:49152
    ds_read_b64_tr_b16 a[50:51], v248 offset:50176
    ds_read_b64_tr_b16 a[52:53], v249 offset:49152
    ds_read_b64_tr_b16 a[54:55], v249 offset:50176
    ds_read_b64_tr_b16 a[56:57], v248 offset:57344
    ds_read_b64_tr_b16 a[58:59], v248 offset:58368
    ds_read_b64_tr_b16 a[60:61], v249 offset:57344
    ds_read_b64_tr_b16 a[62:63], v249 offset:58368
    s_waitcnt lgkmcnt(0)
    s_waitcnt vmcnt(32)
    s_barrier
    s_add_u32 m0, s35, 49152
    s_nop 0
    buffer_load_dwordx4 v234, s[8:11], s31 offen lds
    s_add_u32 s31, s31, s30
    s_add_u32 m0, s35, 50176
    s_nop 0
    buffer_load_dwordx4 v234, s[8:11], s31 offen lds
    s_add_u32 s31, s31, s30
    s_add_u32 m0, s35, 51200
    s_nop 0
    buffer_load_dwordx4 v235, s[8:11], s31 offen lds
    s_add_u32 s31, s31, s30
    s_add_u32 m0, s35, 52224
    s_nop 0
    buffer_load_dwordx4 v235, s[8:11], s31 offen lds
    s_add_u32 s31, s31, s27
    v_add_u32 v248, 0x10000, v248
    v_add_u32 v249, 0x10000, v249
    ds_read_b64_tr_b16 a[64:65], v248 offset:0
    ds_read_b64_tr_b16 a[66:67], v248 offset:1024
    ds_read_b64_tr_b16 a[68:69], v249 offset:0
    ds_read_b64_tr_b16 a[70:71], v249 offset:1024
    ds_read_b64_tr_b16 a[72:73], v248 offset:8192
    ds_read_b64_tr_b16 a[74:75], v248 offset:9216
    ds_read_b64_tr_b16 a[76:77], v249 offset:8192
    ds_read_b64_tr_b16 a[78:79], v249 offset:9216
    s_waitcnt lgkmcnt(0)
    s_waitcnt vmcnt(32)
    s_barrier
    s_add_u32 m0, s35, 65536
    s_nop 0
    buffer_load_dwordx4 v234, s[8:11], s31 offen lds
    s_add_u32 s31, s31, s30
    s_add_u32 m0, s35, 66560
    s_nop 0
    buffer_load_dwordx4 v234, s[8:11], s31 offen lds
    s_add_u32 s31, s31, s30
    s_add_u32 m0, s35, 67584
    s_nop 0
    buffer_load_dwordx4 v235, s[8:11], s31 offen lds
    s_add_u32 s31, s31, s30
    s_add_u32 m0, s35, 68608
    s_nop 0
    buffer_load_dwordx4 v235, s[8:11], s31 offen lds
    s_add_u32 s31, s31, s27
    ds_read_b64_tr_b16 a[80:81], v248 offset:16384
    ds_read_b64_tr_b16 a[82:83], v248 offset:17408
    ds_read_b64_tr_b16 a[84:85], v249 offset:16384
    ds_read_b64_tr_b16 a[86:87], v249 offset:17408
    ds_read_b64_tr_b16 a[88:89], v248 offset:24576
    ds_read_b64_tr_b16 a[90:91], v248 offset:25600
    ds_read_b64_tr_b16 a[92:93], v249 offset:24576
    ds_read_b64_tr_b16 a[94:95], v249 offset:25600
    s_waitcnt lgkmcnt(0)
    s_waitcnt vmcnt(32)
    s_barrier
    s_add_u32 m0, s35, 81920
    s_nop 0
    buffer_load_dwordx4 v234, s[8:11], s31 offen lds
    s_add_u32 s31, s31, s30
    s_add_u32 m0, s35, 82944
    s_nop 0
    buffer_load_dwordx4 v234, s[8:11], s31 offen lds
    s_add_u32 s31, s31, s30
    s_add_u32 m0, s35, 83968
    s_nop 0
    buffer_load_dwordx4 v235, s[8:11], s31 offen lds
    s_add_u32 s31, s31, s30
    s_add_u32 m0, s35, 84992
    s_nop 0
    buffer_load_dwordx4 v235, s[8:11], s31 offen lds
    s_add_u32 s31, s31, s27
    ds_read_b64_tr_b16 a[96:97], v248 offset:32768
    ds_read_b64_tr_b16 a[98:99], v248 offset:33792
    ds_read_b64_tr_b16 a[100:101], v249 offset:32768
    ds_read_b64_tr_b16 a[102:103], v249 offset:33792
    ds_read_b64_tr_b16 a[104:105], v248 offset:40960
    ds_read_b64_tr_b16 a[106:107], v248 offset:41984
    ds_read_b64_tr_b16 a[108:109], v249 offset:40960
    ds_read_b64_tr_b16 a[110:111], v249 offset:41984
    s_waitcnt lgkmcnt(0)
    s_waitcnt vmcnt(32)
    s_barrier
    s_add_u32 m0, s35, 98304
    s_nop 0
    buffer_load_dwordx4 v234, s[8:11], s31 offen lds
    s_add_u32 s31, s31, s30
    s_add_u32 m0, s35, 99328
    s_nop 0
    buffer_load_dwordx4 v234, s[8:11], s31 offen lds
    s_add_u32 s31, s31, s30
    s_add_u32 m0, s35, 100352
    s_nop 0
    buffer_load_dwordx4 v235, s[8:11], s31 offen lds
    s_add_u32 s31, s31, s30
    s_add_u32 m0, s35, 101376
    s_nop 0
    buffer_load_dwordx4 v235, s[8:11], s31 offen lds
    s_add_u32 s31, s31, s27
    ds_read_b64_tr_b16 a[112:113], v248 offset:49152
    ds_read_b64_tr_b16 a[114:115], v248 offset:50176
    ds_read_b64_tr_b16 a[116:117], v249 offset:49152
    ds_read_b64_tr_b16 a[118:119], v249 offset:50176
    ds_read_b64_tr_b16 a[120:121], v248 offset:57344
    ds_read_b64_tr_b16 a[122:123], v248 offset:58368
    ds_read_b64_tr_b16 a[124:125], v249 offset:57344
    ds_read_b64_tr_b16 a[126:127], v249 offset:58368
    s_waitcnt lgkmcnt(0)
    s_waitcnt vmcnt(32)
    s_barrier
    s_add_u32 m0, s35, 114688
    s_nop 0
    buffer_load_dwordx4 v234, s[8:11], s31 offen lds
    s_add_u32 s31, s31, s30
    s_add_u32 m0, s35, 115712
    s_nop 0
    buffer_load_dwordx4 v234, s[8:11], s31 offen lds
    s_add_u32 s31, s31, s30
    s_add_u32 m0, s35, 116736
    s_nop 0
    buffer_load_dwordx4 v235, s[8:11], s31 offen lds
    s_add_u32 s31, s31, s30
    s_add_u32 m0, s35, 117760
    s_nop 0
    buffer_load_dwordx4 v235, s[8:11], s31 offen lds
    s_add_u32 s31, s31, s27
    v_add_u32 v248, 0x10000, v248
    v_add_u32 v249, 0x10000, v249
    ds_read_b64_tr_b16 a[128:129], v248 offset:0
    ds_read_b64_tr_b16 a[130:131], v248 offset:1024
    ds_read_b64_tr_b16 a[132:133], v249 offset:0
    ds_read_b64_tr_b16 a[134:135], v249 offset:1024
    ds_read_b64_tr_b16 a[136:137], v248 offset:8192
    ds_read_b64_tr_b16 a[138:139], v248 offset:9216
    ds_read_b64_tr_b16 a[140:141], v249 offset:8192
    ds_read_b64_tr_b16 a[142:143], v249 offset:9216
    s_waitcnt lgkmcnt(0)
    s_waitcnt vmcnt(32)
    s_barrier
    s_add_u32 m0, s35, 131072
    s_nop 0
    buffer_load_dwordx4 v234, s[8:11], s31 offen lds
    s_add_u32 s31, s31, s30
    s_add_u32 m0, s35, 132096
    s_nop 0
    buffer_load_dwordx4 v234, s[8:11], s31 offen lds
    s_add_u32 s31, s31, s30
    s_add_u32 m0, s35, 133120
    s_nop 0
    buffer_load_dwordx4 v235, s[8:11], s31 offen lds
    s_add_u32 s31, s31, s30
    s_add_u32 m0, s35, 134144
    s_nop 0
    buffer_load_dwordx4 v235, s[8:11], s31 offen lds
    s_add_u32 s31, s31, s27
    ds_read_b64_tr_b16 a[144:145], v248 offset:16384
    ds_read_b64_tr_b16 a[146:147], v248 offset:17408
    ds_read_b64_tr_b16 a[148:149], v249 offset:16384
    ds_read_b64_tr_b16 a[150:151], v249 offset:17408
    ds_read_b64_tr_b16 a[152:153], v248 offset:24576
    ds_read_b64_tr_b16 a[154:155], v248 offset:25600
    ds_read_b64_tr_b16 a[156:157], v249 offset:24576
    ds_read_b64_tr_b16 a[158:159], v249 offset:25600
    s_waitcnt lgkmcnt(0)
    s_waitcnt vmcnt(32)
    s_barrier
    s_add_u32 m0, s35, 147456
    s_nop 0
    buffer_load_dwordx4 v234, s[8:11], s31 offen lds
    s_add_u32 s31, s31, s30
    s_add_u32 m0, s35, 148480
    s_nop 0
    buffer_load_dwordx4 v234, s[8:11], s31 offen lds
    s_add_u32 s31, s31, s30
    s_add_u32 m0, s35, 149504
    s_nop 0
    buffer_load_dwordx4 v235, s[8:11], s31 offen lds
    s_add_u32 s31, s31, s30
    s_add_u32 m0, s35, 150528
    s_nop 0
    buffer_load_dwordx4 v235, s[8:11], s31 offen lds
    s_add_u32 s31, s31, s27
    v_subrev_u32 v248, 0x20000, v248
    v_subrev_u32 v249, 0x20000, v249
    ds_read_b64_tr_b16 a[160:161], v248 offset:0
    ds_read_b64_tr_b16 a[162:163], v248 offset:1024
    ds_read_b64_tr_b16 a[164:165], v249 offset:0
    ds_read_b64_tr_b16 a[166:167], v249 offset:1024
    ds_read_b64_tr_b16 a[168:169], v248 offset:8192
    ds_read_b64_tr_b16 a[170:171], v248 offset:9216
    ds_read_b64_tr_b16 a[172:173], v249 offset:8192
    ds_read_b64_tr_b16 a[174:175], v249 offset:9216
    s_waitcnt lgkmcnt(0)
    s_waitcnt vmcnt(32)
    s_barrier
    ds_read_b64_tr_b16 a[176:177], v248 offset:16384
    ds_read_b64_tr_b16 a[178:179], v248 offset:17408
    ds_read_b64_tr_b16 a[180:181], v249 offset:16384
    ds_read_b64_tr_b16 a[182:183], v249 offset:17408
    ds_read_b64_tr_b16 a[184:185], v248 offset:24576
    ds_read_b64_tr_b16 a[186:187], v248 offset:25600
    ds_read_b64_tr_b16 a[188:189], v249 offset:24576
    ds_read_b64_tr_b16 a[190:191], v249 offset:25600
    s_waitcnt lgkmcnt(0)
    s_waitcnt vmcnt(28)
    s_barrier
    ds_read_b64_tr_b16 a[192:193], v248 offset:32768
    ds_read_b64_tr_b16 a[194:195], v248 offset:33792
    ds_read_b64_tr_b16 a[196:197], v249 offset:32768
    ds_read_b64_tr_b16 a[198:199], v249 offset:33792
    ds_read_b64_tr_b16 a[200:201], v248 offset:40960
    ds_read_b64_tr_b16 a[202:203], v248 offset:41984
    ds_read_b64_tr_b16 a[204:205], v249 offset:40960
    ds_read_b64_tr_b16 a[206:207], v249 offset:41984
    s_waitcnt lgkmcnt(0)
    s_waitcnt vmcnt(24)
    s_barrier
    ds_read_b64_tr_b16 a[208:209], v248 offset:49152
    ds_read_b64_tr_b16 a[210:211], v248 offset:50176
    ds_read_b64_tr_b16 a[212:213], v249 offset:49152
    ds_read_b64_tr_b16 a[214:215], v249 offset:50176
    ds_read_b64_tr_b16 a[216:217], v248 offset:57344
    ds_read_b64_tr_b16 a[218:219], v248 offset:58368
    ds_read_b64_tr_b16 a[220:221], v249 offset:57344
    ds_read_b64_tr_b16 a[222:223], v249 offset:58368
    s_waitcnt lgkmcnt(0)
    s_waitcnt vmcnt(20)
    s_barrier
    v_add_u32 v248, 0x10000, v248
    v_add_u32 v249, 0x10000, v249
    ds_read_b64_tr_b16 a[224:225], v248 offset:0
    ds_read_b64_tr_b16 a[226:227], v248 offset:1024
    ds_read_b64_tr_b16 a[228:229], v249 offset:0
    ds_read_b64_tr_b16 a[230:231], v249 offset:1024
    ds_read_b64_tr_b16 a[232:233], v248 offset:8192
    ds_read_b64_tr_b16 a[234:235], v248 offset:9216
    ds_read_b64_tr_b16 a[236:237], v249 offset:8192
    ds_read_b64_tr_b16 a[238:239], v249 offset:9216
    s_waitcnt lgkmcnt(0)
    s_waitcnt vmcnt(16)
    s_barrier
    ds_read_b64_tr_b16 a[240:241], v248 offset:16384
    ds_read_b64_tr_b16 a[242:243], v248 offset:17408
    ds_read_b64_tr_b16 a[244:245], v249 offset:16384
    ds_read_b64_tr_b16 a[246:247], v249 offset:17408
    ds_read_b64_tr_b16 a[248:249], v248 offset:24576
    ds_read_b64_tr_b16 a[250:251], v248 offset:25600
    ds_read_b64_tr_b16 a[252:253], v249 offset:24576
    ds_read_b64_tr_b16 a[254:255], v249 offset:25600
    s_waitcnt lgkmcnt(0)
    s_waitcnt vmcnt(12)
    s_barrier
    ds_read_b64_tr_b16 v[160:161], v248 offset:32768
    ds_read_b64_tr_b16 v[162:163], v248 offset:33792
    ds_read_b64_tr_b16 v[164:165], v249 offset:32768
    ds_read_b64_tr_b16 v[166:167], v249 offset:33792
    ds_read_b64_tr_b16 v[168:169], v248 offset:40960
    ds_read_b64_tr_b16 v[170:171], v248 offset:41984
    ds_read_b64_tr_b16 v[172:173], v249 offset:40960
    ds_read_b64_tr_b16 v[174:175], v249 offset:41984
    s_waitcnt lgkmcnt(0)
    s_waitcnt vmcnt(8)
    s_barrier
    ds_read_b64_tr_b16 v[176:177], v248 offset:49152
    ds_read_b64_tr_b16 v[178:179], v248 offset:50176
    ds_read_b64_tr_b16 v[180:181], v249 offset:49152
    ds_read_b64_tr_b16 v[182:183], v249 offset:50176
    ds_read_b64_tr_b16 v[184:185], v248 offset:57344
    ds_read_b64_tr_b16 v[186:187], v248 offset:58368
    ds_read_b64_tr_b16 v[188:189], v249 offset:57344
    ds_read_b64_tr_b16 v[190:191], v249 offset:58368
    s_waitcnt lgkmcnt(0)
    s_waitcnt vmcnt(4)
    s_barrier
    v_add_u32 v248, 0x10000, v248
    v_add_u32 v249, 0x10000, v249
    ds_read_b64_tr_b16 v[192:193], v248 offset:0
    ds_read_b64_tr_b16 v[194:195], v248 offset:1024
    ds_read_b64_tr_b16 v[196:197], v249 offset:0
    ds_read_b64_tr_b16 v[198:199], v249 offset:1024
    ds_read_b64_tr_b16 v[200:201], v248 offset:8192
    ds_read_b64_tr_b16 v[202:203], v248 offset:9216
    ds_read_b64_tr_b16 v[204:205], v249 offset:8192
    ds_read_b64_tr_b16 v[206:207], v249 offset:9216
    s_waitcnt lgkmcnt(0)
    s_waitcnt vmcnt(0)
    s_barrier
    ds_read_b64_tr_b16 v[208:209], v248 offset:16384
    ds_read_b64_tr_b16 v[210:211], v248 offset:17408
    ds_read_b64_tr_b16 v[212:213], v249 offset:16384
    ds_read_b64_tr_b16 v[214:215], v249 offset:17408
    ds_read_b64_tr_b16 v[216:217], v248 offset:24576
    ds_read_b64_tr_b16 v[218:219], v248 offset:25600
    ds_read_b64_tr_b16 v[220:221], v249 offset:24576
    ds_read_b64_tr_b16 v[222:223], v249 offset:25600
    s_waitcnt lgkmcnt(0)
    v_and_b32 v240, 1, v232
    v_lshlrev_b32 v236, 10, v240
    v_lshrrev_b32 v240, 4, v232
    v_lshl_add_u32 v236, v240, 8, v236
    v_bfe_u32 v240, v232, 1, 3
    v_lshl_add_u32 v236, v240, 4, v236
    s_mov_b32 s8, s48
    s_mov_b32 s9, s49
    s_cmp_eq_u32 s36, 3
    s_cselect_b32 s10, 3456, 0
    v_lshrrev_b32 v240, 4, v232
    v_lshlrev_b32 v240, 3, v240
    s_and_b32 s34, s24, 31
    s_lshl_b32 s34, s34, 8
    s_lshl_b32 s35, s13, 6
    s_add_u32 s34, s34, s35
    buffer_load_dwordx2 v[88:89], v240, s[8:11], s34 offen offset:0
    buffer_load_dwordx2 v[90:91], v240, s[8:11], s34 offen offset:32
    buffer_load_dwordx2 v[92:93], v240, s[8:11], s34 offen offset:256
    buffer_load_dwordx2 v[94:95], v240, s[8:11], s34 offen offset:288
    v_lshlrev_b32 v246, 3, v233
W_zero2:
    v_mov_b32 v244, 4
    global_load_dword v245, v244, s[50:51] sc1
    s_add_u32 s32, s32, 1
    s_cmp_gt_u32 s32, 0x40000
    s_cbranch_scc1 L_abort
    s_waitcnt vmcnt(0)
    v_cmp_gt_u32 vcc, 32, v245
    s_cbranch_vccz W_zero2_ok
    s_sleep 1
    s_branch W_zero2
W_zero2_ok:
W_lnw:
    buffer_load_dword v247, v246, s[4:7], 0 offen sc1
    s_add_u32 s32, s32, 1
    s_cmp_gt_u32 s32, 0x40000
    s_cbranch_scc1 L_abort
    s_waitcnt vmcnt(0)
    v_cmp_gt_u32 vcc, 2, v247
    s_cbranch_vccz W_lnw_ok
    s_sleep 4
    s_branch W_lnw
W_lnw_ok:
    v_lshlrev_b32 v64, 16, v88
    v_and_b32 v65, s37, v88
    v_lshlrev_b32 v66, 16, v89
    v_and_b32 v67, s37, v89
    v_lshlrev_b32 v68, 16, v90
    v_and_b32 v69, s37, v90
    v_lshlrev_b32 v70, 16, v91
    v_and_b32 v71, s37, v91
    v_lshlrev_b32 v72, 16, v92
    v_and_b32 v73, s37, v92
    v_lshlrev_b32 v74, 16, v93
    v_and_b32 v75, s37, v93
    v_lshlrev_b32 v76, 16, v94
    v_and_b32 v77, s37, v94
    v_lshlrev_b32 v78, 16, v95
    v_and_b32 v79, s37, v95
    s_mov_b32 s39, 0xbdd2d3e8
    v_mov_b32 v80, 0xc0135761
    s_barrier
    s_cmp_eq_u32 s36, 3
    s_mov_b32 s34, 96468992
    s_cselect_b32 s34, 99090432, s34
    s_add_u32 s20, s4, s34
    s_addc_u32 s21, s5, 0
    s_mov_b32 s22, 2621440
    s_mul_i32 s38, s13, 10240
    s_mov_b32 s27, s38
    s_mov_b32 s16, 0
    v_mov_b32 v237, v233
    s_mov_b32 s19, 0
    s_and_b32 s34, s24, 31
    s_cmp_eq_u32 s36, 3
    s_cbranch_scc1 W_setH
    s_lshl_b32 s28, s34, 13
    s_lshl_b32 s34, s36, 24
    s_add_u32 s28, s28, s34
    s_add_u32 s28, s28, 20971520
    s_cmp_eq_u32 s36, 1
    s_cselect_b32 s34, 11, 10
    s_lshl_b32 s34, s13, s34
    s_add_u32 s28, s28, s34
    s_add_u32 s29, s28, 4096
    s_add_u32 s14, s28, 8192
    s_add_u32 s15, s28, 12288
    s_mov_b32 s18, 262144
    s_branch W_setD
W_setH:
    s_lshl_b32 s34, s34, 2
    s_add_u32 s34, s34, s13
    s_lshl_b32 s28, s34, 10
    s_add_u32 s28, s28, 88080384
    s_cmp_lt_u32 s34, 54
    s_cselect_b32 s28, s28, 0x7f000000
    s_add_u32 s29, s28, 55296
    s_mov_b32 s18, 110592
W_setD:
    s_cmp_lt_u32 s36, 2
    s_mov_b32 s34, 16128
    s_cselect_b32 s17, 7936, s34
    s_add_u32 m0, s38, 0
    s_nop 0
    buffer_load_dwordx4 v233, s[20:23], s27 offen offset:0 sc1 lds
    buffer_load_dwordx4 v233, s[20:23], s27 offen offset:1024 sc1 lds
    buffer_load_dwordx4 v233, s[20:23], s27 offen offset:2048 sc1 lds
    buffer_load_dwordx4 v233, s[20:23], s27 offen offset:3072 sc1 lds
    s_add_u32 m0, s38, 4096
    s_add_u32 s27, s27, 4096
    buffer_load_dwordx4 v233, s[20:23], s27 offen offset:0 sc1 lds
    buffer_load_dwordx4 v233, s[20:23], s27 offen offset:1024 sc1 lds
    buffer_load_dwordx4 v233, s[20:23], s27 offen offset:2048 sc1 lds
    buffer_load_dwordx4 v233, s[20:23], s27 offen offset:3072 sc1 lds
    s_add_u32 m0, s38, 8192
    s_add_u32 s27, s27, 4096
    buffer_load_dwordx4 v233, s[20:23], s27 offen offset:0 sc1 lds
    buffer_load_dwordx4 v233, s[20:23], s27 offen offset:1024 sc1 lds
    s_add_u32 s27, s27, 32768
    s_add_u32 s38, s38, 40960
    s_cmp_ge_u32 s38, 163840
    s_cselect_b32 s34, 163840, 0
    s_sub_u32 s38, s38, s34
    s_add_u32 m0, s38, 0
    s_nop 0
    buffer_load_dwordx4 v233, s[20:23], s27 offen offset:0 sc1 lds
    buffer_load_dwordx4 v233, s[20:23], s27 offen offset:1024 sc1 lds
    buffer_load_dwordx4 v233, s[20:23], s27 offen offset:2048 sc1 lds
    buffer_load_dwordx4 v233, s[20:23], s27 offen offset:3072 sc1 lds
    s_add_u32 m0, s38, 4096
    s_add_u32 s27, s27, 4096
    buffer_load_dwordx4 v233, s[20:23], s27 offen offset:0 sc1 lds
    buffer_load_dwordx4 v233, s[20:23], s27 offen offset:1024 sc1 lds
    buffer_load_dwordx4 v233, s[20:23], s27 offen offset:2048 sc1 lds
    buffer_load_dwordx4 v233, s[20:23], s27 offen offset:3072 sc1 lds
    s_add_u32 m0, s38, 8192
    s_add_u32 s27, s27, 4096
    buffer_load_dwordx4 v233, s[20:23], s27 offen offset:0 sc1 lds
    buffer_load_dwordx4 v233, s[20:23], s27 offen offset:1024 sc1 lds
    s_add_u32 s27, s27, 32768
    s_add_u32 s38, s38, 40960
    s_cmp_ge_u32 s38, 163840
    s_cselect_b32 s34, 163840, 0
    s_sub_u32 s38, s38, s34
    s_add_u32 m0, s38, 0
    s_nop 0
    buffer_load_dwordx4 v233, s[20:23], s27 offen offset:0 sc1 lds
    buffer_load_dwordx4 v233, s[20:23], s27 offen offset:1024 sc1 lds
    buffer_load_dwordx4 v233, s[20:23], s27 offen offset:2048 sc1 lds
    buffer_load_dwordx4 v233, s[20:23], s27 offen offset:3072 sc1 lds
    s_add_u32 m0, s38, 4096
    s_add_u32 s27, s27, 4096
    buffer_load_dwordx4 v233, s[20:23], s27 offen offset:0 sc1 lds
    buffer_load_dwordx4 v233, s[20:23], s27 offen offset:1024 sc1 lds
    buffer_load_dwordx4 v233, s[20:23], s27 offen offset:2048 sc1 lds
    buffer_load_dwordx4 v233, s[20:23], s27 offen offset:3072 sc1 lds
    s_add_u32 m0, s38, 8192
    s_add_u32 s27, s27, 4096
    buffer_load_dwordx4 v233, s[20:23], s27 offen offset:0 sc1 lds
    buffer_load_dwordx4 v233, s[20:23], s27 offen offset:1024 sc1 lds
    s_add_u32 s27, s27, 32768
    s_add_u32 s38, s38, 40960
    s_cmp_ge_u32 s38, 163840
    s_cselect_b32 s34, 163840, 0
    s_sub_u32 s38, s38, s34
    s_cmp_eq_u32 s36, 1
    s_cbranch_scc1 WV_top
    s_cmp_eq_u32 s36, 3
    s_cbranch_scc1 WH_top
WK_top:
    s_cmp_eq_u32 s19, 3
    s_cbranch_scc0 WK_late
    s_waitcnt vmcnt(0)
WK_late:
    s_waitcnt vmcnt(14)
    s_barrier
    ds_read_b128 v[0:3], v237 offset:0
    ds_read_b128 v[4:7], v237 offset:1024
    ds_read_b128 v[8:11], v237 offset:2048
    ds_read_b128 v[12:15], v237 offset:3072
    s_cmp_eq_u32 s19, 4
    s_cselect_b32 s34, 1, s13
    s_cmp_lt_u32 s19, 2
    s_cselect_b32 s34, 1, s34
    s_cmp_eq_u32 s34, 0
    s_cbranch_scc0 WK_nosig
    s_mov_b64 exec, 1
    v_mov_b32 v240, 0
    v_mov_b32 v241, 1
    buffer_atomic_add v241, v240, s[4:7], s17 offen
    s_mov_b64 exec, -1
    s_nop 3
    s_cmp_eq_u32 s19, 3
    s_cbranch_scc0 WK_nosig
    s_add_u32 s35, s17, 128
    s_mov_b64 exec, 1
    v_mov_b32 v240, 0
    v_mov_b32 v241, 1
    buffer_atomic_add v241, v240, s[4:7], s35 offen
    s_mov_b64 exec, -1
    s_nop 3
WK_nosig:
    s_waitcnt lgkmcnt(3)
    v_mfma_f32_16x16x32_bf16 v[32:35], a[0:3], v[0:3], 0
    ds_read_b128 v[16:19], v237 offset:4096
    v_mfma_f32_16x16x32_bf16 v[36:39], a[4:7], v[0:3], 0
    v_mfma_f32_16x16x32_bf16 v[48:51], a[160:163], v[0:3], 0
    v_mfma_f32_16x16x32_bf16 v[52:55], a[164:167], v[0:3], 0
    s_add_u32 m0, s38, 0
    s_nop 0
    buffer_load_dwordx4 v233, s[20:23], s27 offen offset:0 sc1 lds
    s_waitcnt lgkmcnt(3)
    v_mfma_f32_16x16x32_bf16 v[32:35], a[8:11], v[4:7], v[32:35]
    ds_read_b128 v[20:23], v237 offset:5120
    v_mfma_f32_16x16x32_bf16 v[36:39], a[12:15], v[4:7], v[36:39]
    v_mfma_f32_16x16x32_bf16 v[48:51], a[168:171], v[4:7], v[48:51]
    v_mfma_f32_16x16x32_bf16 v[52:55], a[172:175], v[4:7], v[52:55]
    s_waitcnt lgkmcnt(3)
    v_mfma_f32_16x16x32_bf16 v[32:35], a[16:19], v[8:11], v[32:35]
    ds_read_b128 v[24:27], v237 offset:6144
    v_mfma_f32_16x16x32_bf16 v[36:39], a[20:23], v[8:11], v[36:39]
    v_mfma_f32_16x16x32_bf16 v[48:51], a[176:179], v[8:11], v[48:51]
    v_mfma_f32_16x16x32_bf16 v[52:55], a[180:183], v[8:11], v[52:55]
    s_waitcnt lgkmcnt(3)
    v_mfma_f32_16x16x32_bf16 v[32:35], a[24:27], v[12:15], v[32:35]
    ds_read_b128 v[28:31], v237 offset:7168
    v_mfma_f32_16x16x32_bf16 v[36:39], a[28:31], v[12:15], v[36:39]
    v_mfma_f32_16x16x32_bf16 v[48:51], a[184:187], v[12:15], v[48:51]
    v_mfma_f32_16x16x32_bf16 v[52:55], a[188:191], v[12:15], v[52:55]
    buffer_load_dwordx4 v233, s[20:23], s27 offen offset:1024 sc1 lds
    s_waitcnt lgkmcnt(3)
    v_mfma_f32_16x16x32_bf16 v[32:35], a[32:35], v[16:19], v[32:35]
    ds_read_b128 v[0:3], v237 offset:8192
    v_mfma_f32_16x16x32_bf16 v[36:39], a[36:39], v[16:19], v[36:39]
    v_mfma_f32_16x16x32_bf16 v[48:51], a[192:195], v[16:19], v[48:51]
    v_mfma_f32_16x16x32_bf16 v[52:55], a[196:199], v[16:19], v[52:55]
    s_waitcnt lgkmcnt(3)
    v_mfma_f32_16x16x32_bf16 v[32:35], a[40:43], v[20:23], v[32:35]
    ds_read_b128 v[4:7], v237 offset:9216
    v_mfma_f32_16x16x32_bf16 v[36:39], a[44:47], v[20:23], v[36:39]
    v_mfma_f32_16x16x32_bf16 v[48:51], a[200:203], v[20:23], v[48:51]
    v_mfma_f32_16x16x32_bf16 v[52:55], a[204:207], v[20:23], v[52:55]
    s_waitcnt lgkmcnt(3)
    v_mfma_f32_16x16x32_bf16 v[32:35], a[48:51], v[24:27], v[32:35]
    ds_read_b128 v[8:11], v237 offset:10240
    v_mfma_f32_16x16x32_bf16 v[36:39], a[52:55], v[24:27], v[36:39]
    v_mfma_f32_16x16x32_bf16 v[48:51], a[208:211], v[24:27], v[48:51]
    v_mfma_f32_16x16x32_bf16 v[52:55], a[212:215], v[24:27], v[52:55]
    buffer_load_dwordx4 v233, s[20:23], s27 offen offset:2048 sc1 lds
    s_waitcnt lgkmcnt(3)
    v_mfma_f32_16x16x32_bf16 v[32:35], a[56:59], v[28:31], v[32:35]
    ds_read_b128 v[12:15], v237 offset:11264
    v_mfma_f32_16x16x32_bf16 v[36:39], a[60:63], v[28:31], v[36:39]
    v_mfma_f32_16x16x32_bf16 v[48:51], a[216:219], v[28:31], v[48:51]
    v_mfma_f32_16x16x32_bf16 v[52:55], a[220:223], v[28:31], v[52:55]
    s_waitcnt lgkmcnt(3)
    v_mfma_f32_16x16x32_bf16 v[32:35], a[64:67], v[0:3], v[32:35]
    ds_read_b128 v[16:19], v237 offset:12288
    v_mfma_f32_16x16x32_bf16 v[36:39], a[68:71], v[0:3], v[36:39]
    v_mfma_f32_16x16x32_bf16 v[48:51], a[224:227], v[0:3], v[48:51]
    v_mfma_f32_16x16x32_bf16 v[52:55], a[228:231], v[0:3], v[52:55]
    s_waitcnt lgkmcnt(3)
    v_mfma_f32_16x16x32_bf16 v[32:35], a[72:75], v[4:7], v[32:35]
    ds_read_b128 v[20:23], v237 offset:13312
    v_mfma_f32_16x16x32_bf16 v[36:39], a[76:79], v[4:7], v[36:39]
    v_mfma_f32_16x16x32_bf16 v[48:51], a[232:235], v[4:7], v[48:51]
    v_mfma_f32_16x16x32_bf16 v[52:55], a[236:239], v[4:7], v[52:55]
    buffer_load_dwordx4 v233, s[20:23], s27 offen offset:3072 sc1 lds
    s_waitcnt lgkmcnt(3)
    v_mfma_f32_16x16x32_bf16 v[32:35], a[80:83], v[8:11], v[32:35]
    ds_read_b128 v[24:27], v237 offset:14336
    v_mfma_f32_16x16x32_bf16 v[36:39], a[84:87], v[8:11], v[36:39]
    v_mfma_f32_16x16x32_bf16 v[48:51], a[240:243], v[8:11], v[48:51]
    v_mfma_f32_16x16x32_bf16 v[52:55], a[244:247], v[8:11], v[52:55]
    s_waitcnt lgkmcnt(3)
    v_mfma_f32_16x16x32_bf16 v[32:35], a[88:91], v[12:15], v[32:35]
    ds_read_b128 v[28:31], v237 offset:15360
    v_mfma_f32_16x16x32_bf16 v[36:39], a[92:95], v[12:15], v[36:39]
    v_mfma_f32_16x16x32_bf16 v[48:51], a[248:251], v[12:15], v[48:51]
    v_mfma_f32_16x16x32_bf16 v[52:55], a[252:255], v[12:15], v[52:55]
    s_waitcnt lgkmcnt(3)
    v_mfma_f32_16x16x32_bf16 v[32:35], a[96:99], v[16:19], v[32:35]
    ds_read_b128 v[0:3], v237 offset:16384
    v_mfma_f32_16x16x32_bf16 v[36:39], a[100:103], v[16:19], v[36:39]
    v_mfma_f32_16x16x32_bf16 v[48:51], v[160:163], v[16:19], v[48:51]
    v_mfma_f32_16x16x32_bf16 v[52:55], v[164:167], v[16:19], v[52:55]
    s_add_u32 m0, s38, 4096
    s_add_u32 s27, s27, 4096
    buffer_load_dwordx4 v233, s[20:23], s27 offen offset:0 sc1 lds
    s_waitcnt lgkmcnt(3)
    v_mfma_f32_16x16x32_bf16 v[32:35], a[104:107], v[20:23], v[32:35]
    ds_read_b128 v[4:7], v237 offset:17408
    v_mfma_f32_16x16x32_bf16 v[36:39], a[108:111], v[20:23], v[36:39]
    v_mfma_f32_16x16x32_bf16 v[48:51], v[168:171], v[20:23], v[48:51]
    v_mfma_f32_16x16x32_bf16 v[52:55], v[172:175], v[20:23], v[52:55]
    s_waitcnt lgkmcnt(3)
    v_mfma_f32_16x16x32_bf16 v[32:35], a[112:115], v[24:27], v[32:35]
    ds_read_b128 v[8:11], v237 offset:18432
    v_mfma_f32_16x16x32_bf16 v[36:39], a[116:119], v[24:27], v[36:39]
    v_mfma_f32_16x16x32_bf16 v[48:51], v[176:179], v[24:27], v[48:51]
    v_mfma_f32_16x16x32_bf16 v[52:55], v[180:183], v[24:27], v[52:55]
    s_waitcnt lgkmcnt(3)
    v_mfma_f32_16x16x32_bf16 v[32:35], a[120:123], v[28:31], v[32:35]
    ds_read_b128 v[12:15], v237 offset:19456
    v_mfma_f32_16x16x32_bf16 v[36:39], a[124:127], v[28:31], v[36:39]
    v_mfma_f32_16x16x32_bf16 v[48:51], v[184:187], v[28:31], v[48:51]
    v_mfma_f32_16x16x32_bf16 v[52:55], v[188:191], v[28:31], v[52:55]
    buffer_load_dwordx4 v233, s[20:23], s27 offen offset:1024 sc1 lds
    s_waitcnt lgkmcnt(3)
    v_mfma_f32_16x16x32_bf16 v[32:35], a[128:131], v[0:3], v[32:35]
    ds_read_b128 v[16:19], v237 offset:20480
    v_mfma_f32_16x16x32_bf16 v[36:39], a[132:135], v[0:3], v[36:39]
    v_mfma_f32_16x16x32_bf16 v[48:51], v[192:195], v[0:3], v[48:51]
    v_mfma_f32_16x16x32_bf16 v[52:55], v[196:199], v[0:3], v[52:55]
    s_waitcnt lgkmcnt(3)
    v_mfma_f32_16x16x32_bf16 v[32:35], a[136:139], v[4:7], v[32:35]
    ds_read_b128 v[20:23], v237 offset:21504
    v_mfma_f32_16x16x32_bf16 v[36:39], a[140:143], v[4:7], v[36:39]
    v_mfma_f32_16x16x32_bf16 v[48:51], v[200:203], v[4:7], v[48:51]
    v_mfma_f32_16x16x32_bf16 v[52:55], v[204:207], v[4:7], v[52:55]
    s_waitcnt lgkmcnt(3)
    v_mfma_f32_16x16x32_bf16 v[32:35], a[144:147], v[8:11], v[32:35]
    ds_read_b128 v[24:27], v237 offset:22528
    v_mfma_f32_16x16x32_bf16 v[36:39], a[148:151], v[8:11], v[36:39]
    v_mfma_f32_16x16x32_bf16 v[48:51], v[208:211], v[8:11], v[48:51]
    v_mfma_f32_16x16x32_bf16 v[52:55], v[212:215], v[8:11], v[52:55]
    buffer_load_dwordx4 v233, s[20:23], s27 offen offset:2048 sc1 lds
    s_waitcnt lgkmcnt(3)
    v_mfma_f32_16x16x32_bf16 v[32:35], a[152:155], v[12:15], v[32:35]
    ds_read_b128 v[28:31], v237 offset:23552
    v_mfma_f32_16x16x32_bf16 v[36:39], a[156:159], v[12:15], v[36:39]
    v_mfma_f32_16x16x32_bf16 v[48:51], v[216:219], v[12:15], v[48:51]
    v_mfma_f32_16x16x32_bf16 v[52:55], v[220:223], v[12:15], v[52:55]
    s_waitcnt lgkmcnt(3)
    v_mfma_f32_16x16x32_bf16 v[40:43], a[0:3], v[16:19], 0
    ds_read_b128 v[0:3], v237 offset:24576
    v_mfma_f32_16x16x32_bf16 v[44:47], a[4:7], v[16:19], 0
    v_mfma_f32_16x16x32_bf16 v[56:59], a[160:163], v[16:19], 0
    v_mfma_f32_16x16x32_bf16 v[60:63], a[164:167], v[16:19], 0
    s_waitcnt lgkmcnt(3)
    v_mfma_f32_16x16x32_bf16 v[40:43], a[8:11], v[20:23], v[40:43]
    ds_read_b128 v[4:7], v237 offset:25600
    v_mfma_f32_16x16x32_bf16 v[44:47], a[12:15], v[20:23], v[44:47]
    v_mfma_f32_16x16x32_bf16 v[56:59], a[168:171], v[20:23], v[56:59]
    v_mfma_f32_16x16x32_bf16 v[60:63], a[172:175], v[20:23], v[60:63]
    buffer_load_dwordx4 v233, s[20:23], s27 offen offset:3072 sc1 lds
    s_waitcnt lgkmcnt(3)
    v_mfma_f32_16x16x32_bf16 v[40:43], a[16:19], v[24:27], v[40:43]
    ds_read_b128 v[8:11], v237 offset:26624
    v_mfma_f32_16x16x32_bf16 v[44:47], a[20:23], v[24:27], v[44:47]
    v_mfma_f32_16x16x32_bf16 v[56:59], a[176:179], v[24:27], v[56:59]
    v_mfma_f32_16x16x32_bf16 v[60:63], a[180:183], v[24:27], v[60:63]
    s_waitcnt lgkmcnt(3)
    v_mfma_f32_16x16x32_bf16 v[40:43], a[24:27], v[28:31], v[40:43]
    ds_read_b128 v[12:15], v237 offset:27648
    v_mfma_f32_16x16x32_bf16 v[44:47], a[28:31], v[28:31], v[44:47]
    v_mfma_f32_16x16x32_bf16 v[56:59], a[184:187], v[28:31], v[56:59]
    v_mfma_f32_16x16x32_bf16 v[60:63], a[188:191], v[28:31], v[60:63]
    s_waitcnt lgkmcnt(3)
    v_mfma_f32_16x16x32_bf16 v[40:43], a[32:35], v[0:3], v[40:43]
    ds_read_b128 v[16:19], v237 offset:28672
    v_mfma_f32_16x16x32_bf16 v[44:47], a[36:39], v[0:3], v[44:47]
    v_mfma_f32_16x16x32_bf16 v[56:59], a[192:195], v[0:3], v[56:59]
    v_mfma_f32_16x16x32_bf16 v[60:63], a[196:199], v[0:3], v[60:63]
    s_add_u32 m0, s38, 8192
    s_add_u32 s27, s27, 4096
    buffer_load_dwordx4 v233, s[20:23], s27 offen offset:0 sc1 lds
    s_waitcnt lgkmcnt(3)
    v_mfma_f32_16x16x32_bf16 v[40:43], a[40:43], v[4:7], v[40:43]
    ds_read_b128 v[20:23], v237 offset:29696
    v_mfma_f32_16x16x32_bf16 v[44:47], a[44:47], v[4:7], v[44:47]
    v_mfma_f32_16x16x32_bf16 v[56:59], a[200:203], v[4:7], v[56:59]
    v_mfma_f32_16x16x32_bf16 v[60:63], a[204:207], v[4:7], v[60:63]
    s_waitcnt lgkmcnt(3)
    v_mfma_f32_16x16x32_bf16 v[40:43], a[48:51], v[8:11], v[40:43]
    ds_read_b128 v[24:27], v237 offset:30720
    v_mfma_f32_16x16x32_bf16 v[44:47], a[52:55], v[8:11], v[44:47]
    v_mfma_f32_16x16x32_bf16 v[56:59], a[208:211], v[8:11], v[56:59]
    v_mfma_f32_16x16x32_bf16 v[60:63], a[212:215], v[8:11], v[60:63]
    s_waitcnt lgkmcnt(3)
    v_mfma_f32_16x16x32_bf16 v[40:43], a[56:59], v[12:15], v[40:43]
    ds_read_b128 v[28:31], v237 offset:31744
    v_mfma_f32_16x16x32_bf16 v[44:47], a[60:63], v[12:15], v[44:47]
    v_mfma_f32_16x16x32_bf16 v[56:59], a[216:219], v[12:15], v[56:59]
    v_mfma_f32_16x16x32_bf16 v[60:63], a[220:223], v[12:15], v[60:63]
    buffer_load_dwordx4 v233, s[20:23], s27 offen offset:1024 sc1 lds
    s_add_u32 s27, s27, 32768
    s_add_u32 s38, s38, 40960
    s_cmp_ge_u32 s38, 163840
    s_cselect_b32 s34, 163840, 0
    s_sub_u32 s38, s38, s34
    s_waitcnt lgkmcnt(3)
    v_mfma_f32_16x16x32_bf16 v[40:43], a[64:67], v[16:19], v[40:43]
    ds_read_b128 v[0:3], v237 offset:32768
    v_mfma_f32_16x16x32_bf16 v[44:47], a[68:71], v[16:19], v[44:47]
    v_mfma_f32_16x16x32_bf16 v[56:59], a[224:227], v[16:19], v[56:59]
    v_mfma_f32_16x16x32_bf16 v[60:63], a[228:231], v[16:19], v[60:63]
    s_waitcnt lgkmcnt(3)
    v_mfma_f32_16x16x32_bf16 v[40:43], a[72:75], v[20:23], v[40:43]
    ds_read_b128 v[4:7], v237 offset:33792
    v_mfma_f32_16x16x32_bf16 v[44:47], a[76:79], v[20:23], v[44:47]
    v_mfma_f32_16x16x32_bf16 v[56:59], a[232:235], v[20:23], v[56:59]
    v_mfma_f32_16x16x32_bf16 v[60:63], a[236:239], v[20:23], v[60:63]
    s_waitcnt lgkmcnt(3)
    v_mfma_f32_16x16x32_bf16 v[40:43], a[80:83], v[24:27], v[40:43]
    ds_read_b128 v[8:11], v237 offset:34816
    v_mfma_f32_16x16x32_bf16 v[44:47], a[84:87], v[24:27], v[44:47]
    v_mfma_f32_16x16x32_bf16 v[56:59], a[240:243], v[24:27], v[56:59]
    v_mfma_f32_16x16x32_bf16 v[60:63], a[244:247], v[24:27], v[60:63]
    s_waitcnt lgkmcnt(3)
    v_mfma_f32_16x16x32_bf16 v[40:43], a[88:91], v[28:31], v[40:43]
    ds_read_b128 v[12:15], v237 offset:35840
    v_mfma_f32_16x16x32_bf16 v[44:47], a[92:95], v[28:31], v[44:47]
    v_mfma_f32_16x16x32_bf16 v[56:59], a[248:251], v[28:31], v[56:59]
    v_mfma_f32_16x16x32_bf16 v[60:63], a[252:255], v[28:31], v[60:63]
    s_waitcnt lgkmcnt(3)
    v_mfma_f32_16x16x32_bf16 v[40:43], a[96:99], v[0:3], v[40:43]
    ds_read_b128 v[16:19], v237 offset:36864
    v_mfma_f32_16x16x32_bf16 v[44:47], a[100:103], v[0:3], v[44:47]
    v_mfma_f32_16x16x32_bf16 v[56:59], v[160:163], v[0:3], v[56:59]
    v_mfma_f32_16x16x32_bf16 v[60:63], v[164:167], v[0:3], v[60:63]
    s_waitcnt lgkmcnt(3)
    v_mfma_f32_16x16x32_bf16 v[40:43], a[104:107], v[4:7], v[40:43]
    ds_read_b128 v[20:23], v237 offset:37888
    v_mfma_f32_16x16x32_bf16 v[44:47], a[108:111], v[4:7], v[44:47]
    v_mfma_f32_16x16x32_bf16 v[56:59], v[168:171], v[4:7], v[56:59]
    v_mfma_f32_16x16x32_bf16 v[60:63], v[172:175], v[4:7], v[60:63]
    s_waitcnt lgkmcnt(3)
    v_mfma_f32_16x16x32_bf16 v[40:43], a[112:115], v[8:11], v[40:43]
    ds_read_b128 v[24:27], v237 offset:38912
    v_mfma_f32_16x16x32_bf16 v[44:47], a[116:119], v[8:11], v[44:47]
    v_mfma_f32_16x16x32_bf16 v[56:59], v[176:179], v[8:11], v[56:59]
    v_mfma_f32_16x16x32_bf16 v[60:63], v[180:183], v[8:11], v[60:63]
    s_waitcnt lgkmcnt(3)
    v_mfma_f32_16x16x32_bf16 v[40:43], a[120:123], v[12:15], v[40:43]
    ds_read_b128 v[28:31], v237 offset:39936
    v_mfma_f32_16x16x32_bf16 v[44:47], a[124:127], v[12:15], v[44:47]
    v_mfma_f32_16x16x32_bf16 v[56:59], v[184:187], v[12:15], v[56:59]
    v_mfma_f32_16x16x32_bf16 v[60:63], v[188:191], v[12:15], v[60:63]
    s_waitcnt lgkmcnt(3)
    v_mfma_f32_16x16x32_bf16 v[40:43], a[128:131], v[16:19], v[40:43]
    v_mfma_f32_16x16x32_bf16 v[44:47], a[132:135], v[16:19], v[44:47]
    v_mfma_f32_16x16x32_bf16 v[56:59], v[192:195], v[16:19], v[56:59]
    v_mfma_f32_16x16x32_bf16 v[60:63], v[196:199], v[16:19], v[60:63]
    s_waitcnt lgkmcnt(2)
    v_mfma_f32_16x16x32_bf16 v[40:43], a[136:139], v[20:23], v[40:43]
    v_mfma_f32_16x16x32_bf16 v[44:47], a[140:143], v[20:23], v[44:47]
    v_mfma_f32_16x16x32_bf16 v[56:59], v[200:203], v[20:23], v[56:59]
    v_mfma_f32_16x16x32_bf16 v[60:63], v[204:207], v[20:23], v[60:63]
    s_waitcnt lgkmcnt(1)
    v_mfma_f32_16x16x32_bf16 v[40:43], a[144:147], v[24:27], v[40:43]
    v_mfma_f32_16x16x32_bf16 v[44:47], a[148:151], v[24:27], v[44:47]
    v_mfma_f32_16x16x32_bf16 v[56:59], v[208:211], v[24:27], v[56:59]
    v_mfma_f32_16x16x32_bf16 v[60:63], v[212:215], v[24:27], v[60:63]
    s_waitcnt lgkmcnt(0)
    v_mfma_f32_16x16x32_bf16 v[40:43], a[152:155], v[28:31], v[40:43]
    v_mfma_f32_16x16x32_bf16 v[44:47], a[156:159], v[28:31], v[44:47]
    v_mfma_f32_16x16x32_bf16 v[56:59], v[216:219], v[28:31], v[56:59]
    v_mfma_f32_16x16x32_bf16 v[60:63], v[220:223], v[28:31], v[60:63]
    s_add_u32 s16, s16, 40960
    s_cmp_ge_u32 s16, 163840
    s_cselect_b32 s16, 0, s16
    v_add_u32 v237, s16, v233
    v_cvt_pk_bf16_f32 v244, v32, v34
    v_cvt_pk_bf16_f32 v245, v36, v38
    v_cvt_pk_bf16_f32 v246, v33, v35
    v_cvt_pk_bf16_f32 v247, v37, v39
    buffer_store_dwordx4 v[244:247], v233, s[4:7], s28 offen sc1
    v_cvt_pk_bf16_f32 v248, v40, v42
    v_cvt_pk_bf16_f32 v249, v44, v46
    v_cvt_pk_bf16_f32 v250, v41, v43
    v_cvt_pk_bf16_f32 v251, v45, v47
    buffer_store_dwordx4 v[248:251], v233, s[4:7], s29 offen sc1
    v_cvt_pk_bf16_f32 v244, v48, v50
    v_cvt_pk_bf16_f32 v245, v52, v54
    v_cvt_pk_bf16_f32 v246, v49, v51
    v_cvt_pk_bf16_f32 v247, v53, v55
    buffer_store_dwordx4 v[244:247], v233, s[4:7], s14 offen sc1
    v_cvt_pk_bf16_f32 v248, v56, v58
    v_cvt_pk_bf16_f32 v249, v60, v62
    v_cvt_pk_bf16_f32 v250, v57, v59
    v_cvt_pk_bf16_f32 v251, v61, v63
    buffer_store_dwordx4 v[248:251], v233, s[4:7], s15 offen sc1
    s_add_u32 s28, s28, s18
    s_add_u32 s29, s29, s18
    s_add_u32 s14, s14, s18
    s_add_u32 s15, s15, s18
    s_add_u32 s17, s17, 128
    s_add_u32 s19, s19, 1
    s_cmp_lt_u32 s19, 64
    s_cbranch_scc1 WK_top
    s_branch W_tail
WV_top:
    s_cmp_eq_u32 s19, 3
    s_cbranch_scc0 WV_late
    s_waitcnt vmcnt(0)
WV_late:
    s_waitcnt vmcnt(14)
    s_barrier
    ds_read_b128 v[0:3], v237 offset:0
    ds_read_b128 v[4:7], v237 offset:1024
    ds_read_b128 v[8:11], v237 offset:2048
    ds_read_b128 v[12:15], v237 offset:3072
    s_cmp_eq_u32 s19, 4
    s_cselect_b32 s34, 1, s13
    s_cmp_lt_u32 s19, 2
    s_cselect_b32 s34, 1, s34
    s_cmp_eq_u32 s34, 0
    s_cbranch_scc0 WV_nosig
    s_mov_b64 exec, 1
    v_mov_b32 v240, 0
    v_mov_b32 v241, 1
    buffer_atomic_add v241, v240, s[4:7], s17 offen
    s_mov_b64 exec, -1
    s_nop 3
    s_cmp_eq_u32 s19, 3
    s_cbranch_scc0 WV_nosig
    s_add_u32 s35, s17, 128
    s_mov_b64 exec, 1
    v_mov_b32 v240, 0
    v_mov_b32 v241, 1
    buffer_atomic_add v241, v240, s[4:7], s35 offen
    s_mov_b64 exec, -1
    s_nop 3
WV_nosig:
    s_waitcnt lgkmcnt(3)
    v_mfma_f32_16x16x32_bf16 v[32:35], v[0:3], a[0:3], 0
    ds_read_b128 v[16:19], v237 offset:4096
    v_mfma_f32_16x16x32_bf16 v[36:39], v[0:3], a[4:7], 0
    v_mfma_f32_16x16x32_bf16 v[48:51], v[0:3], a[160:163], 0
    v_mfma_f32_16x16x32_bf16 v[52:55], v[0:3], a[164:167], 0
    s_add_u32 m0, s38, 0
    s_nop 0
    buffer_load_dwordx4 v233, s[20:23], s27 offen offset:0 sc1 lds
    s_waitcnt lgkmcnt(3)
    v_mfma_f32_16x16x32_bf16 v[32:35], v[4:7], a[8:11], v[32:35]
    ds_read_b128 v[20:23], v237 offset:5120
    v_mfma_f32_16x16x32_bf16 v[36:39], v[4:7], a[12:15], v[36:39]
    v_mfma_f32_16x16x32_bf16 v[48:51], v[4:7], a[168:171], v[48:51]
    v_mfma_f32_16x16x32_bf16 v[52:55], v[4:7], a[172:175], v[52:55]
    s_waitcnt lgkmcnt(3)
    v_mfma_f32_16x16x32_bf16 v[32:35], v[8:11], a[16:19], v[32:35]
    ds_read_b128 v[24:27], v237 offset:6144
    v_mfma_f32_16x16x32_bf16 v[36:39], v[8:11], a[20:23], v[36:39]
    v_mfma_f32_16x16x32_bf16 v[48:51], v[8:11], a[176:179], v[48:51]
    v_mfma_f32_16x16x32_bf16 v[52:55], v[8:11], a[180:183], v[52:55]
    s_waitcnt lgkmcnt(3)
    v_mfma_f32_16x16x32_bf16 v[32:35], v[12:15], a[24:27], v[32:35]
    ds_read_b128 v[28:31], v237 offset:7168
    v_mfma_f32_16x16x32_bf16 v[36:39], v[12:15], a[28:31], v[36:39]
    v_mfma_f32_16x16x32_bf16 v[48:51], v[12:15], a[184:187], v[48:51]
    v_mfma_f32_16x16x32_bf16 v[52:55], v[12:15], a[188:191], v[52:55]
    buffer_load_dwordx4 v233, s[20:23], s27 offen offset:1024 sc1 lds
    s_waitcnt lgkmcnt(3)
    v_mfma_f32_16x16x32_bf16 v[32:35], v[16:19], a[32:35], v[32:35]
    ds_read_b128 v[0:3], v237 offset:8192
    v_mfma_f32_16x16x32_bf16 v[36:39], v[16:19], a[36:39], v[36:39]
    v_mfma_f32_16x16x32_bf16 v[48:51], v[16:19], a[192:195], v[48:51]
    v_mfma_f32_16x16x32_bf16 v[52:55], v[16:19], a[196:199], v[52:55]
    s_waitcnt lgkmcnt(3)
    v_mfma_f32_16x16x32_bf16 v[32:35], v[20:23], a[40:43], v[32:35]
    ds_read_b128 v[4:7], v237 offset:9216
    v_mfma_f32_16x16x32_bf16 v[36:39], v[20:23], a[44:47], v[36:39]
    v_mfma_f32_16x16x32_bf16 v[48:51], v[20:23], a[200:203], v[48:51]
    v_mfma_f32_16x16x32_bf16 v[52:55], v[20:23], a[204:207], v[52:55]
    s_waitcnt lgkmcnt(3)
    v_mfma_f32_16x16x32_bf16 v[32:35], v[24:27], a[48:51], v[32:35]
    ds_read_b128 v[8:11], v237 offset:10240
    v_mfma_f32_16x16x32_bf16 v[36:39], v[24:27], a[52:55], v[36:39]
    v_mfma_f32_16x16x32_bf16 v[48:51], v[24:27], a[208:211], v[48:51]
    v_mfma_f32_16x16x32_bf16 v[52:55], v[24:27], a[212:215], v[52:55]
    buffer_load_dwordx4 v233, s[20:23], s27 offen offset:2048 sc1 lds
    s_waitcnt lgkmcnt(3)
    v_mfma_f32_16x16x32_bf16 v[32:35], v[28:31], a[56:59], v[32:35]
    ds_read_b128 v[12:15], v237 offset:11264
    v_mfma_f32_16x16x32_bf16 v[36:39], v[28:31], a[60:63], v[36:39]
    v_mfma_f32_16x16x32_bf16 v[48:51], v[28:31], a[216:219], v[48:51]
    v_mfma_f32_16x16x32_bf16 v[52:55], v[28:31], a[220:223], v[52:55]
    s_waitcnt lgkmcnt(3)
    v_mfma_f32_16x16x32_bf16 v[32:35], v[0:3], a[64:67], v[32:35]
    ds_read_b128 v[16:19], v237 offset:12288
    v_mfma_f32_16x16x32_bf16 v[36:39], v[0:3], a[68:71], v[36:39]
    v_mfma_f32_16x16x32_bf16 v[48:51], v[0:3], a[224:227], v[48:51]
    v_mfma_f32_16x16x32_bf16 v[52:55], v[0:3], a[228:231], v[52:55]
    s_waitcnt lgkmcnt(3)
    v_mfma_f32_16x16x32_bf16 v[32:35], v[4:7], a[72:75], v[32:35]
    ds_read_b128 v[20:23], v237 offset:13312
    v_mfma_f32_16x16x32_bf16 v[36:39], v[4:7], a[76:79], v[36:39]
    v_mfma_f32_16x16x32_bf16 v[48:51], v[4:7], a[232:235], v[48:51]
    v_mfma_f32_16x16x32_bf16 v[52:55], v[4:7], a[236:239], v[52:55]
    buffer_load_dwordx4 v233, s[20:23], s27 offen offset:3072 sc1 lds
    s_waitcnt lgkmcnt(3)
    v_mfma_f32_16x16x32_bf16 v[32:35], v[8:11], a[80:83], v[32:35]
    ds_read_b128 v[24:27], v237 offset:14336
    v_mfma_f32_16x16x32_bf16 v[36:39], v[8:11], a[84:87], v[36:39]
    v_mfma_f32_16x16x32_bf16 v[48:51], v[8:11], a[240:243], v[48:51]
    v_mfma_f32_16x16x32_bf16 v[52:55], v[8:11], a[244:247], v[52:55]
    s_waitcnt lgkmcnt(3)
    v_mfma_f32_16x16x32_bf16 v[32:35], v[12:15], a[88:91], v[32:35]
    ds_read_b128 v[28:31], v237 offset:15360
    v_mfma_f32_16x16x32_bf16 v[36:39], v[12:15], a[92:95], v[36:39]
    v_mfma_f32_16x16x32_bf16 v[48:51], v[12:15], a[248:251], v[48:51]
    v_mfma_f32_16x16x32_bf16 v[52:55], v[12:15], a[252:255], v[52:55]
    s_waitcnt lgkmcnt(3)
    v_mfma_f32_16x16x32_bf16 v[32:35], v[16:19], a[96:99], v[32:35]
    ds_read_b128 v[0:3], v237 offset:16384
    v_mfma_f32_16x16x32_bf16 v[36:39], v[16:19], a[100:103], v[36:39]
    v_mfma_f32_16x16x32_bf16 v[48:51], v[16:19], v[160:163], v[48:51]
    v_mfma_f32_16x16x32_bf16 v[52:55], v[16:19], v[164:167], v[52:55]
    s_add_u32 m0, s38, 4096
    s_add_u32 s27, s27, 4096
    buffer_load_dwordx4 v233, s[20:23], s27 offen offset:0 sc1 lds
    s_waitcnt lgkmcnt(3)
    v_mfma_f32_16x16x32_bf16 v[32:35], v[20:23], a[104:107], v[32:35]
    ds_read_b128 v[4:7], v237 offset:17408
    v_mfma_f32_16x16x32_bf16 v[36:39], v[20:23], a[108:111], v[36:39]
    v_mfma_f32_16x16x32_bf16 v[48:51], v[20:23], v[168:171], v[48:51]
    v_mfma_f32_16x16x32_bf16 v[52:55], v[20:23], v[172:175], v[52:55]
    s_waitcnt lgkmcnt(3)
    v_mfma_f32_16x16x32_bf16 v[32:35], v[24:27], a[112:115], v[32:35]
    ds_read_b128 v[8:11], v237 offset:18432
    v_mfma_f32_16x16x32_bf16 v[36:39], v[24:27], a[116:119], v[36:39]
    v_mfma_f32_16x16x32_bf16 v[48:51], v[24:27], v[176:179], v[48:51]
    v_mfma_f32_16x16x32_bf16 v[52:55], v[24:27], v[180:183], v[52:55]
    s_waitcnt lgkmcnt(3)
    v_mfma_f32_16x16x32_bf16 v[32:35], v[28:31], a[120:123], v[32:35]
    ds_read_b128 v[12:15], v237 offset:19456
    v_mfma_f32_16x16x32_bf16 v[36:39], v[28:31], a[124:127], v[36:39]
    v_mfma_f32_16x16x32_bf16 v[48:51], v[28:31], v[184:187], v[48:51]
    v_mfma_f32_16x16x32_bf16 v[52:55], v[28:31], v[188:191], v[52:55]
    buffer_load_dwordx4 v233, s[20:23], s27 offen offset:1024 sc1 lds
    s_waitcnt lgkmcnt(3)
    v_mfma_f32_16x16x32_bf16 v[32:35], v[0:3], a[128:131], v[32:35]
    ds_read_b128 v[16:19], v237 offset:20480
    v_mfma_f32_16x16x32_bf16 v[36:39], v[0:3], a[132:135], v[36:39]
    v_mfma_f32_16x16x32_bf16 v[48:51], v[0:3], v[192:195], v[48:51]
    v_mfma_f32_16x16x32_bf16 v[52:55], v[0:3], v[196:199], v[52:55]
    s_waitcnt lgkmcnt(3)
    v_mfma_f32_16x16x32_bf16 v[32:35], v[4:7], a[136:139], v[32:35]
    ds_read_b128 v[20:23], v237 offset:21504
    v_mfma_f32_16x16x32_bf16 v[36:39], v[4:7], a[140:143], v[36:39]
    v_mfma_f32_16x16x32_bf16 v[48:51], v[4:7], v[200:203], v[48:51]
    v_mfma_f32_16x16x32_bf16 v[52:55], v[4:7], v[204:207], v[52:55]
    s_waitcnt lgkmcnt(3)
    v_mfma_f32_16x16x32_bf16 v[32:35], v[8:11], a[144:147], v[32:35]
    ds_read_b128 v[24:27], v237 offset:22528
    v_mfma_f32_16x16x32_bf16 v[36:39], v[8:11], a[148:151], v[36:39]
    v_mfma_f32_16x16x32_bf16 v[48:51], v[8:11], v[208:211], v[48:51]
    v_mfma_f32_16x16x32_bf16 v[52:55], v[8:11], v[212:215], v[52:55]
    buffer_load_dwordx4 v233, s[20:23], s27 offen offset:2048 sc1 lds
    s_waitcnt lgkmcnt(3)
    v_mfma_f32_16x16x32_bf16 v[32:35], v[12:15], a[152:155], v[32:35]
    ds_read_b128 v[28:31], v237 offset:23552
    v_mfma_f32_16x16x32_bf16 v[36:39], v[12:15], a[156:159], v[36:39]
    v_mfma_f32_16x16x32_bf16 v[48:51], v[12:15], v[216:219], v[48:51]
    v_mfma_f32_16x16x32_bf16 v[52:55], v[12:15], v[220:223], v[52:55]
    s_waitcnt lgkmcnt(3)
    v_mfma_f32_16x16x32_bf16 v[40:43], v[16:19], a[0:3], 0
    ds_read_b128 v[0:3], v237 offset:24576
    v_mfma_f32_16x16x32_bf16 v[44:47], v[16:19], a[4:7], 0
    v_mfma_f32_16x16x32_bf16 v[56:59], v[16:19], a[160:163], 0
    v_mfma_f32_16x16x32_bf16 v[60:63], v[16:19], a[164:167], 0
    s_waitcnt lgkmcnt(3)
    v_mfma_f32_16x16x32_bf16 v[40:43], v[20:23], a[8:11], v[40:43]
    ds_read_b128 v[4:7], v237 offset:25600
    v_mfma_f32_16x16x32_bf16 v[44:47], v[20:23], a[12:15], v[44:47]
    v_mfma_f32_16x16x32_bf16 v[56:59], v[20:23], a[168:171], v[56:59]
    v_mfma_f32_16x16x32_bf16 v[60:63], v[20:23], a[172:175], v[60:63]
    buffer_load_dwordx4 v233, s[20:23], s27 offen offset:3072 sc1 lds
    s_waitcnt lgkmcnt(3)
    v_mfma_f32_16x16x32_bf16 v[40:43], v[24:27], a[16:19], v[40:43]
    ds_read_b128 v[8:11], v237 offset:26624
    v_mfma_f32_16x16x32_bf16 v[44:47], v[24:27], a[20:23], v[44:47]
    v_mfma_f32_16x16x32_bf16 v[56:59], v[24:27], a[176:179], v[56:59]
    v_mfma_f32_16x16x32_bf16 v[60:63], v[24:27], a[180:183], v[60:63]
    s_waitcnt lgkmcnt(3)
    v_mfma_f32_16x16x32_bf16 v[40:43], v[28:31], a[24:27], v[40:43]
    ds_read_b128 v[12:15], v237 offset:27648
    v_mfma_f32_16x16x32_bf16 v[44:47], v[28:31], a[28:31], v[44:47]
    v_mfma_f32_16x16x32_bf16 v[56:59], v[28:31], a[184:187], v[56:59]
    v_mfma_f32_16x16x32_bf16 v[60:63], v[28:31], a[188:191], v[60:63]
    s_waitcnt lgkmcnt(3)
    v_mfma_f32_16x16x32_bf16 v[40:43], v[0:3], a[32:35], v[40:43]
    ds_read_b128 v[16:19], v237 offset:28672
    v_mfma_f32_16x16x32_bf16 v[44:47], v[0:3], a[36:39], v[44:47]
    v_mfma_f32_16x16x32_bf16 v[56:59], v[0:3], a[192:195], v[56:59]
    v_mfma_f32_16x16x32_bf16 v[60:63], v[0:3], a[196:199], v[60:63]
    s_add_u32 m0, s38, 8192
    s_add_u32 s27, s27, 4096
    buffer_load_dwordx4 v233, s[20:23], s27 offen offset:0 sc1 lds
    s_waitcnt lgkmcnt(3)
    v_mfma_f32_16x16x32_bf16 v[40:43], v[4:7], a[40:43], v[40:43]
    ds_read_b128 v[20:23], v237 offset:29696
    v_mfma_f32_16x16x32_bf16 v[44:47], v[4:7], a[44:47], v[44:47]
    v_mfma_f32_16x16x32_bf16 v[56:59], v[4:7], a[200:203], v[56:59]
    v_mfma_f32_16x16x32_bf16 v[60:63], v[4:7], a[204:207], v[60:63]
    s_waitcnt lgkmcnt(3)
    v_mfma_f32_16x16x32_bf16 v[40:43], v[8:11], a[48:51], v[40:43]
    ds_read_b128 v[24:27], v237 offset:30720
    v_mfma_f32_16x16x32_bf16 v[44:47], v[8:11], a[52:55], v[44:47]
    v_mfma_f32_16x16x32_bf16 v[56:59], v[8:11], a[208:211], v[56:59]
    v_mfma_f32_16x16x32_bf16 v[60:63], v[8:11], a[212:215], v[60:63]
    s_waitcnt lgkmcnt(3)
    v_mfma_f32_16x16x32_bf16 v[40:43], v[12:15], a[56:59], v[40:43]
    ds_read_b128 v[28:31], v237 offset:31744
    v_mfma_f32_16x16x32_bf16 v[44:47], v[12:15], a[60:63], v[44:47]
    v_mfma_f32_16x16x32_bf16 v[56:59], v[12:15], a[216:219], v[56:59]
    v_mfma_f32_16x16x32_bf16 v[60:63], v[12:15], a[220:223], v[60:63]
    buffer_load_dwordx4 v233, s[20:23], s27 offen offset:1024 sc1 lds
    s_add_u32 s27, s27, 32768
    s_add_u32 s38, s38, 40960
    s_cmp_ge_u32 s38, 163840
    s_cselect_b32 s34, 163840, 0
    s_sub_u32 s38, s38, s34
    s_waitcnt lgkmcnt(3)
    v_mfma_f32_16x16x32_bf16 v[40:43], v[16:19], a[64:67], v[40:43]
    ds_read_b128 v[0:3], v237 offset:32768
    v_mfma_f32_16x16x32_bf16 v[44:47], v[16:19], a[68:71], v[44:47]
    v_mfma_f32_16x16x32_bf16 v[56:59], v[16:19], a[224:227], v[56:59]
    v_mfma_f32_16x16x32_bf16 v[60:63], v[16:19], a[228:231], v[60:63]
    s_waitcnt lgkmcnt(3)
    v_mfma_f32_16x16x32_bf16 v[40:43], v[20:23], a[72:75], v[40:43]
    ds_read_b128 v[4:7], v237 offset:33792
    v_mfma_f32_16x16x32_bf16 v[44:47], v[20:23], a[76:79], v[44:47]
    v_mfma_f32_16x16x32_bf16 v[56:59], v[20:23], a[232:235], v[56:59]
    v_mfma_f32_16x16x32_bf16 v[60:63], v[20:23], a[236:239], v[60:63]
    s_waitcnt lgkmcnt(3)
    v_mfma_f32_16x16x32_bf16 v[40:43], v[24:27], a[80:83], v[40:43]
    ds_read_b128 v[8:11], v237 offset:34816
    v_mfma_f32_16x16x32_bf16 v[44:47], v[24:27], a[84:87], v[44:47]
    v_mfma_f32_16x16x32_bf16 v[56:59], v[24:27], a[240:243], v[56:59]
    v_mfma_f32_16x16x32_bf16 v[60:63], v[24:27], a[244:247], v[60:63]
    s_waitcnt lgkmcnt(3)
    v_mfma_f32_16x16x32_bf16 v[40:43], v[28:31], a[88:91], v[40:43]
    ds_read_b128 v[12:15], v237 offset:35840
    v_mfma_f32_16x16x32_bf16 v[44:47], v[28:31], a[92:95], v[44:47]
    v_mfma_f32_16x16x32_bf16 v[56:59], v[28:31], a[248:251], v[56:59]
    v_mfma_f32_16x16x32_bf16 v[60:63], v[28:31], a[252:255], v[60:63]
    s_waitcnt lgkmcnt(3)
    v_mfma_f32_16x16x32_bf16 v[40:43], v[0:3], a[96:99], v[40:43]
    ds_read_b128 v[16:19], v237 offset:36864
    v_mfma_f32_16x16x32_bf16 v[44:47], v[0:3], a[100:103], v[44:47]
    v_mfma_f32_16x16x32_bf16 v[56:59], v[0:3], v[160:163], v[56:59]
    v_mfma_f32_16x16x32_bf16 v[60:63], v[0:3], v[164:167], v[60:63]
    s_waitcnt lgkmcnt(3)
    v_mfma_f32_16x16x32_bf16 v[40:43], v[4:7], a[104:107], v[40:43]
    ds_read_b128 v[20:23], v237 offset:37888
    v_mfma_f32_16x16x32_bf16 v[44:47], v[4:7], a[108:111], v[44:47]
    v_mfma_f32_16x16x32_bf16 v[56:59], v[4:7], v[168:171], v[56:59]
    v_mfma_f32_16x16x32_bf16 v[60:63], v[4:7], v[172:175], v[60:63]
    s_waitcnt lgkmcnt(3)
    v_mfma_f32_16x16x32_bf16 v[40:43], v[8:11], a[112:115], v[40:43]
    ds_read_b128 v[24:27], v237 offset:38912
    v_mfma_f32_16x16x32_bf16 v[44:47], v[8:11], a[116:119], v[44:47]
    v_mfma_f32_16x16x32_bf16 v[56:59], v[8:11], v[176:179], v[56:59]
    v_mfma_f32_16x16x32_bf16 v[60:63], v[8:11], v[180:183], v[60:63]
    s_waitcnt lgkmcnt(3)
    v_mfma_f32_16x16x32_bf16 v[40:43], v[12:15], a[120:123], v[40:43]
    ds_read_b128 v[28:31], v237 offset:39936
    v_mfma_f32_16x16x32_bf16 v[44:47], v[12:15], a[124:127], v[44:47]
    v_mfma_f32_16x16x32_bf16 v[56:59], v[12:15], v[184:187], v[56:59]
    v_mfma_f32_16x16x32_bf16 v[60:63], v[12:15], v[188:191], v[60:63]
    s_waitcnt lgkmcnt(3)
    v_mfma_f32_16x16x32_bf16 v[40:43], v[16:19], a[128:131], v[40:43]
    v_mfma_f32_16x16x32_bf16 v[44:47], v[16:19], a[132:135], v[44:47]
    v_mfma_f32_16x16x32_bf16 v[56:59], v[16:19], v[192:195], v[56:59]
    v_mfma_f32_16x16x32_bf16 v[60:63], v[16:19], v[196:199], v[60:63]
    s_waitcnt lgkmcnt(2)
    v_mfma_f32_16x16x32_bf16 v[40:43], v[20:23], a[136:139], v[40:43]
    v_mfma_f32_16x16x32_bf16 v[44:47], v[20:23], a[140:143], v[44:47]
    v_mfma_f32_16x16x32_bf16 v[56:59], v[20:23], v[200:203], v[56:59]
    v_mfma_f32_16x16x32_bf16 v[60:63], v[20:23], v[204:207], v[60:63]
    s_waitcnt lgkmcnt(1)
    v_mfma_f32_16x16x32_bf16 v[40:43], v[24:27], a[144:147], v[40:43]
    v_mfma_f32_16x16x32_bf16 v[44:47], v[24:27], a[148:151], v[44:47]
    v_mfma_f32_16x16x32_bf16 v[56:59], v[24:27], v[208:211], v[56:59]
    v_mfma_f32_16x16x32_bf16 v[60:63], v[24:27], v[212:215], v[60:63]
    s_waitcnt lgkmcnt(0)
    v_mfma_f32_16x16x32_bf16 v[40:43], v[28:31], a[152:155], v[40:43]
    v_mfma_f32_16x16x32_bf16 v[44:47], v[28:31], a[156:159], v[44:47]
    v_mfma_f32_16x16x32_bf16 v[56:59], v[28:31], v[216:219], v[56:59]
    v_mfma_f32_16x16x32_bf16 v[60:63], v[28:31], v[220:223], v[60:63]
    s_add_u32 s16, s16, 40960
    s_cmp_ge_u32 s16, 163840
    s_cselect_b32 s16, 0, s16
    v_add_u32 v237, s16, v233
    v_cvt_pk_bf16_f32 v244, v32, v33
    v_cvt_pk_bf16_f32 v245, v34, v35
    v_cvt_pk_bf16_f32 v246, v40, v41
    v_cvt_pk_bf16_f32 v247, v42, v43
    buffer_store_dwordx4 v[244:247], v236, s[4:7], s28 offen offset:0 sc1
    v_cvt_pk_bf16_f32 v248, v36, v37
    v_cvt_pk_bf16_f32 v249, v38, v39
    v_cvt_pk_bf16_f32 v250, v44, v45
    v_cvt_pk_bf16_f32 v251, v46, v47
    buffer_store_dwordx4 v[248:251], v236, s[4:7], s28 offen offset:128 sc1
    v_cvt_pk_bf16_f32 v244, v48, v49
    v_cvt_pk_bf16_f32 v245, v50, v51
    v_cvt_pk_bf16_f32 v246, v56, v57
    v_cvt_pk_bf16_f32 v247, v58, v59
    buffer_store_dwordx4 v[244:247], v236, s[4:7], s14 offen offset:0 sc1
    v_cvt_pk_bf16_f32 v248, v52, v53
    v_cvt_pk_bf16_f32 v249, v54, v55
    v_cvt_pk_bf16_f32 v250, v60, v61
    v_cvt_pk_bf16_f32 v251, v62, v63
    buffer_store_dwordx4 v[248:251], v236, s[4:7], s14 offen offset:128 sc1
    s_add_u32 s28, s28, s18
    s_add_u32 s29, s29, s18
    s_add_u32 s14, s14, s18
    s_add_u32 s15, s15, s18
    s_add_u32 s17, s17, 128
    s_add_u32 s19, s19, 1
    s_cmp_lt_u32 s19, 64
    s_cbranch_scc1 WV_top
    s_branch W_tail
WH_top:
    s_cmp_eq_u32 s19, 3
    s_cbranch_scc0 WH_late
    s_waitcnt vmcnt(0)
WH_late:
    s_waitcnt vmcnt(12)
    s_barrier
    ds_read_b128 v[0:3], v237 offset:0
    ds_read_b128 v[4:7], v237 offset:1024
    ds_read_b128 v[8:11], v237 offset:2048
    ds_read_b128 v[12:15], v237 offset:3072
    ds_read_b128 v[16:19], v237 offset:4096
    ds_read_b128 v[20:23], v237 offset:5120
    ds_read_b128 v[24:27], v237 offset:6144
    s_cmp_eq_u32 s19, 4
    s_cselect_b32 s34, 1, s13
    s_cmp_lt_u32 s19, 2
    s_cselect_b32 s34, 1, s34
    s_cmp_eq_u32 s34, 0
    s_cbranch_scc0 WH_nosig
    s_mov_b64 exec, 1
    v_mov_b32 v240, 0
    v_mov_b32 v241, 1
    buffer_atomic_add v241, v240, s[4:7], s17 offen
    s_mov_b64 exec, -1
    s_nop 3
    s_cmp_eq_u32 s19, 3
    s_cbranch_scc0 WH_nosig
    s_add_u32 s35, s17, 128
    s_mov_b64 exec, 1
    v_mov_b32 v240, 0
    v_mov_b32 v241, 1
    buffer_atomic_add v241, v240, s[4:7], s35 offen
    s_mov_b64 exec, -1
    s_nop 3
WH_nosig:
    s_waitcnt lgkmcnt(6)
    v_mfma_f32_16x16x32_bf16 v[32:35], a[0:3], v[0:3], 0
    ds_read_b128 v[28:31], v237 offset:7168
    v_mfma_f32_16x16x32_bf16 v[36:39], a[4:7], v[0:3], 0
    s_add_u32 m0, s38, 0
    s_nop 0
    buffer_load_dwordx4 v233, s[20:23], s27 offen offset:0 sc1 lds
    s_waitcnt lgkmcnt(6)
    v_mfma_f32_16x16x32_bf16 v[32:35], a[8:11], v[4:7], v[32:35]
    ds_read_b128 v[0:3], v237 offset:8192
    v_mfma_f32_16x16x32_bf16 v[36:39], a[12:15], v[4:7], v[36:39]
    s_waitcnt lgkmcnt(6)
    v_mfma_f32_16x16x32_bf16 v[32:35], a[16:19], v[8:11], v[32:35]
    ds_read_b128 v[4:7], v237 offset:9216
    v_mfma_f32_16x16x32_bf16 v[36:39], a[20:23], v[8:11], v[36:39]
    s_waitcnt lgkmcnt(6)
    v_mfma_f32_16x16x32_bf16 v[32:35], a[24:27], v[12:15], v[32:35]
    ds_read_b128 v[8:11], v237 offset:10240
    v_mfma_f32_16x16x32_bf16 v[36:39], a[28:31], v[12:15], v[36:39]
    buffer_load_dwordx4 v233, s[20:23], s27 offen offset:1024 sc1 lds
    s_waitcnt lgkmcnt(6)
    v_mfma_f32_16x16x32_bf16 v[32:35], a[32:35], v[16:19], v[32:35]
    ds_read_b128 v[12:15], v237 offset:11264
    v_mfma_f32_16x16x32_bf16 v[36:39], a[36:39], v[16:19], v[36:39]
    s_waitcnt lgkmcnt(6)
    v_mfma_f32_16x16x32_bf16 v[32:35], a[40:43], v[20:23], v[32:35]
    ds_read_b128 v[16:19], v237 offset:12288
    v_mfma_f32_16x16x32_bf16 v[36:39], a[44:47], v[20:23], v[36:39]
    s_waitcnt lgkmcnt(6)
    v_mfma_f32_16x16x32_bf16 v[32:35], a[48:51], v[24:27], v[32:35]
    ds_read_b128 v[20:23], v237 offset:13312
    v_mfma_f32_16x16x32_bf16 v[36:39], a[52:55], v[24:27], v[36:39]
    buffer_load_dwordx4 v233, s[20:23], s27 offen offset:2048 sc1 lds
    s_waitcnt lgkmcnt(6)
    v_mfma_f32_16x16x32_bf16 v[32:35], a[56:59], v[28:31], v[32:35]
    ds_read_b128 v[24:27], v237 offset:14336
    v_mfma_f32_16x16x32_bf16 v[36:39], a[60:63], v[28:31], v[36:39]
    s_waitcnt lgkmcnt(6)
    v_mfma_f32_16x16x32_bf16 v[32:35], a[64:67], v[0:3], v[32:35]
    ds_read_b128 v[28:31], v237 offset:15360
    v_mfma_f32_16x16x32_bf16 v[36:39], a[68:71], v[0:3], v[36:39]
    s_waitcnt lgkmcnt(6)
    v_mfma_f32_16x16x32_bf16 v[32:35], a[72:75], v[4:7], v[32:35]
    ds_read_b128 v[0:3], v237 offset:16384
    v_mfma_f32_16x16x32_bf16 v[36:39], a[76:79], v[4:7], v[36:39]
    buffer_load_dwordx4 v233, s[20:23], s27 offen offset:3072 sc1 lds
    s_waitcnt lgkmcnt(6)
    v_mfma_f32_16x16x32_bf16 v[32:35], a[80:83], v[8:11], v[32:35]
    ds_read_b128 v[4:7], v237 offset:17408
    v_mfma_f32_16x16x32_bf16 v[36:39], a[84:87], v[8:11], v[36:39]
    s_waitcnt lgkmcnt(6)
    v_mfma_f32_16x16x32_bf16 v[32:35], a[88:91], v[12:15], v[32:35]
    ds_read_b128 v[8:11], v237 offset:18432
    v_mfma_f32_16x16x32_bf16 v[36:39], a[92:95], v[12:15], v[36:39]
    s_waitcnt lgkmcnt(6)
    v_mfma_f32_16x16x32_bf16 v[32:35], a[96:99], v[16:19], v[32:35]
    ds_read_b128 v[12:15], v237 offset:19456
    v_mfma_f32_16x16x32_bf16 v[36:39], a[100:103], v[16:19], v[36:39]
    s_add_u32 m0, s38, 4096
    s_add_u32 s27, s27, 4096
    buffer_load_dwordx4 v233, s[20:23], s27 offen offset:0 sc1 lds
    s_waitcnt lgkmcnt(6)
    v_mfma_f32_16x16x32_bf16 v[32:35], a[104:107], v[20:23], v[32:35]
    ds_read_b128 v[16:19], v237 offset:20480
    v_mfma_f32_16x16x32_bf16 v[36:39], a[108:111], v[20:23], v[36:39]
    s_waitcnt lgkmcnt(6)
    v_mfma_f32_16x16x32_bf16 v[32:35], a[112:115], v[24:27], v[32:35]
    ds_read_b128 v[20:23], v237 offset:21504
    v_mfma_f32_16x16x32_bf16 v[36:39], a[116:119], v[24:27], v[36:39]
    s_waitcnt lgkmcnt(6)
    v_mfma_f32_16x16x32_bf16 v[32:35], a[120:123], v[28:31], v[32:35]
    ds_read_b128 v[24:27], v237 offset:22528
    v_mfma_f32_16x16x32_bf16 v[36:39], a[124:127], v[28:31], v[36:39]
    buffer_load_dwordx4 v233, s[20:23], s27 offen offset:1024 sc1 lds
    s_waitcnt lgkmcnt(6)
    v_mfma_f32_16x16x32_bf16 v[32:35], a[128:131], v[0:3], v[32:35]
    ds_read_b128 v[28:31], v237 offset:23552
    v_mfma_f32_16x16x32_bf16 v[36:39], a[132:135], v[0:3], v[36:39]
    s_waitcnt lgkmcnt(6)
    v_mfma_f32_16x16x32_bf16 v[32:35], a[136:139], v[4:7], v[32:35]
    ds_read_b128 v[0:3], v237 offset:24576
    v_mfma_f32_16x16x32_bf16 v[36:39], a[140:143], v[4:7], v[36:39]
    s_waitcnt lgkmcnt(6)
    v_mfma_f32_16x16x32_bf16 v[32:35], a[144:147], v[8:11], v[32:35]
    ds_read_b128 v[4:7], v237 offset:25600
    v_mfma_f32_16x16x32_bf16 v[36:39], a[148:151], v[8:11], v[36:39]
    buffer_load_dwordx4 v233, s[20:23], s27 offen offset:2048 sc1 lds
    s_waitcnt lgkmcnt(6)
    v_mfma_f32_16x16x32_bf16 v[32:35], a[152:155], v[12:15], v[32:35]
    ds_read_b128 v[8:11], v237 offset:26624
    v_mfma_f32_16x16x32_bf16 v[36:39], a[156:159], v[12:15], v[36:39]
    s_waitcnt lgkmcnt(6)
    v_mfma_f32_16x16x32_bf16 v[40:43], a[0:3], v[16:19], 0
    ds_read_b128 v[12:15], v237 offset:27648
    v_mfma_f32_16x16x32_bf16 v[44:47], a[4:7], v[16:19], 0
    s_waitcnt lgkmcnt(6)
    v_mfma_f32_16x16x32_bf16 v[40:43], a[8:11], v[20:23], v[40:43]
    ds_read_b128 v[16:19], v237 offset:28672
    v_mfma_f32_16x16x32_bf16 v[44:47], a[12:15], v[20:23], v[44:47]
    buffer_load_dwordx4 v233, s[20:23], s27 offen offset:3072 sc1 lds
    s_waitcnt lgkmcnt(6)
    v_mfma_f32_16x16x32_bf16 v[40:43], a[16:19], v[24:27], v[40:43]
    ds_read_b128 v[20:23], v237 offset:29696
    v_mfma_f32_16x16x32_bf16 v[44:47], a[20:23], v[24:27], v[44:47]
    s_waitcnt lgkmcnt(6)
    v_mfma_f32_16x16x32_bf16 v[40:43], a[24:27], v[28:31], v[40:43]
    ds_read_b128 v[24:27], v237 offset:30720
    v_mfma_f32_16x16x32_bf16 v[44:47], a[28:31], v[28:31], v[44:47]
    s_waitcnt lgkmcnt(6)
    v_mfma_f32_16x16x32_bf16 v[40:43], a[32:35], v[0:3], v[40:43]
    ds_read_b128 v[28:31], v237 offset:31744
    v_mfma_f32_16x16x32_bf16 v[44:47], a[36:39], v[0:3], v[44:47]
    s_add_u32 m0, s38, 8192
    s_add_u32 s27, s27, 4096
    buffer_load_dwordx4 v233, s[20:23], s27 offen offset:0 sc1 lds
    s_waitcnt lgkmcnt(6)
    v_mfma_f32_16x16x32_bf16 v[40:43], a[40:43], v[4:7], v[40:43]
    ds_read_b128 v[0:3], v237 offset:32768
    v_mfma_f32_16x16x32_bf16 v[44:47], a[44:47], v[4:7], v[44:47]
    s_waitcnt lgkmcnt(6)
    v_mfma_f32_16x16x32_bf16 v[40:43], a[48:51], v[8:11], v[40:43]
    ds_read_b128 v[4:7], v237 offset:33792
    v_mfma_f32_16x16x32_bf16 v[44:47], a[52:55], v[8:11], v[44:47]
    s_waitcnt lgkmcnt(6)
    v_mfma_f32_16x16x32_bf16 v[40:43], a[56:59], v[12:15], v[40:43]
    ds_read_b128 v[8:11], v237 offset:34816
    v_mfma_f32_16x16x32_bf16 v[44:47], a[60:63], v[12:15], v[44:47]
    buffer_load_dwordx4 v233, s[20:23], s27 offen offset:1024 sc1 lds
    s_add_u32 s27, s27, 32768
    s_add_u32 s38, s38, 40960
    s_cmp_ge_u32 s38, 163840
    s_cselect_b32 s34, 163840, 0
    s_sub_u32 s38, s38, s34
    s_waitcnt lgkmcnt(6)
    v_mfma_f32_16x16x32_bf16 v[40:43], a[64:67], v[16:19], v[40:43]
    ds_read_b128 v[12:15], v237 offset:35840
    v_mfma_f32_16x16x32_bf16 v[44:47], a[68:71], v[16:19], v[44:47]
    s_waitcnt lgkmcnt(6)
    v_mfma_f32_16x16x32_bf16 v[40:43], a[72:75], v[20:23], v[40:43]
    ds_read_b128 v[16:19], v237 offset:36864
    v_mfma_f32_16x16x32_bf16 v[44:47], a[76:79], v[20:23], v[44:47]
    s_waitcnt lgkmcnt(6)
    v_mfma_f32_16x16x32_bf16 v[40:43], a[80:83], v[24:27], v[40:43]
    ds_read_b128 v[20:23], v237 offset:37888
    v_mfma_f32_16x16x32_bf16 v[44:47], a[84:87], v[24:27], v[44:47]
    s_waitcnt lgkmcnt(6)
    v_mfma_f32_16x16x32_bf16 v[40:43], a[88:91], v[28:31], v[40:43]
    ds_read_b128 v[24:27], v237 offset:38912
    v_mfma_f32_16x16x32_bf16 v[44:47], a[92:95], v[28:31], v[44:47]
    s_waitcnt lgkmcnt(6)
    v_mfma_f32_16x16x32_bf16 v[40:43], a[96:99], v[0:3], v[40:43]
    ds_read_b128 v[28:31], v237 offset:39936
    v_mfma_f32_16x16x32_bf16 v[44:47], a[100:103], v[0:3], v[44:47]
    s_waitcnt lgkmcnt(6)
    v_mfma_f32_16x16x32_bf16 v[40:43], a[104:107], v[4:7], v[40:43]
    v_mfma_f32_16x16x32_bf16 v[44:47], a[108:111], v[4:7], v[44:47]
    s_waitcnt lgkmcnt(5)
    v_mfma_f32_16x16x32_bf16 v[40:43], a[112:115], v[8:11], v[40:43]
    v_mfma_f32_16x16x32_bf16 v[44:47], a[116:119], v[8:11], v[44:47]
    s_waitcnt lgkmcnt(4)
    v_mfma_f32_16x16x32_bf16 v[40:43], a[120:123], v[12:15], v[40:43]
    v_mfma_f32_16x16x32_bf16 v[44:47], a[124:127], v[12:15], v[44:47]
    s_waitcnt lgkmcnt(3)
    v_mfma_f32_16x16x32_bf16 v[40:43], a[128:131], v[16:19], v[40:43]
    v_mfma_f32_16x16x32_bf16 v[44:47], a[132:135], v[16:19], v[44:47]
    s_waitcnt lgkmcnt(2)
    v_mfma_f32_16x16x32_bf16 v[40:43], a[136:139], v[20:23], v[40:43]
    v_mfma_f32_16x16x32_bf16 v[44:47], a[140:143], v[20:23], v[44:47]
    s_waitcnt lgkmcnt(1)
    v_mfma_f32_16x16x32_bf16 v[40:43], a[144:147], v[24:27], v[40:43]
    v_mfma_f32_16x16x32_bf16 v[44:47], a[148:151], v[24:27], v[44:47]
    s_waitcnt lgkmcnt(0)
    v_mfma_f32_16x16x32_bf16 v[40:43], a[152:155], v[28:31], v[40:43]
    v_mfma_f32_16x16x32_bf16 v[44:47], a[156:159], v[28:31], v[44:47]
    s_add_u32 s16, s16, 40960
    s_cmp_ge_u32 s16, 163840
    s_cselect_b32 s16, 0, s16
    v_add_u32 v237, s16, v233
    v_add_f32 v32, v32, v64
    v_mul_f32 v84, v32, v32
    v_fma_f32 v84, v84, s39, v80
    v_mul_f32 v84, v84, v32
    v_add_f32 v33, v33, v65
    v_mul_f32 v85, v33, v33
    v_fma_f32 v85, v85, s39, v80
    v_mul_f32 v85, v85, v33
    v_add_f32 v34, v34, v66
    v_mul_f32 v86, v34, v34
    v_fma_f32 v86, v86, s39, v80
    v_mul_f32 v86, v86, v34
    v_add_f32 v35, v35, v67
    v_mul_f32 v87, v35, v35
    v_fma_f32 v87, v87, s39, v80
    v_mul_f32 v87, v87, v35
    v_exp_f32 v84, v84
    v_exp_f32 v85, v85
    v_exp_f32 v86, v86
    v_exp_f32 v87, v87
    v_add_f32 v84, 1.0, v84
    v_add_f32 v85, 1.0, v85
    v_add_f32 v86, 1.0, v86
    v_add_f32 v87, 1.0, v87
    v_rcp_f32 v84, v84
    v_rcp_f32 v85, v85
    v_rcp_f32 v86, v86
    v_rcp_f32 v87, v87
    v_mul_f32 v32, v32, v84
    v_mul_f32 v33, v33, v85
    v_mul_f32 v34, v34, v86
    v_mul_f32 v35, v35, v87
    v_add_f32 v36, v36, v68
    v_mul_f32 v84, v36, v36
    v_fma_f32 v84, v84, s39, v80
    v_mul_f32 v84, v84, v36
    v_add_f32 v37, v37, v69
    v_mul_f32 v85, v37, v37
    v_fma_f32 v85, v85, s39, v80
    v_mul_f32 v85, v85, v37
    v_add_f32 v38, v38, v70
    v_mul_f32 v86, v38, v38
    v_fma_f32 v86, v86, s39, v80
    v_mul_f32 v86, v86, v38
    v_add_f32 v39, v39, v71
    v_mul_f32 v87, v39, v39
    v_fma_f32 v87, v87, s39, v80
    v_mul_f32 v87, v87, v39
    v_exp_f32 v84, v84
    v_exp_f32 v85, v85
    v_exp_f32 v86, v86
    v_exp_f32 v87, v87
    v_add_f32 v84, 1.0, v84
    v_add_f32 v85, 1.0, v85
    v_add_f32 v86, 1.0, v86
    v_add_f32 v87, 1.0, v87
    v_rcp_f32 v84, v84
    v_rcp_f32 v85, v85
    v_rcp_f32 v86, v86
    v_rcp_f32 v87, v87
    v_mul_f32 v36, v36, v84
    v_mul_f32 v37, v37, v85
    v_mul_f32 v38, v38, v86
    v_mul_f32 v39, v39, v87
    v_cvt_pk_bf16_f32 v244, v32, v33
    v_cvt_pk_bf16_f32 v245, v34, v35
    v_cvt_pk_bf16_f32 v246, v36, v37
    v_cvt_pk_bf16_f32 v247, v38, v39
    buffer_store_dwordx4 v[244:247], v233, s[4:7], s28 offen sc1
    v_add_f32 v40, v40, v64
    v_mul_f32 v84, v40, v40
    v_fma_f32 v84, v84, s39, v80
    v_mul_f32 v84, v84, v40
    v_add_f32 v41, v41, v65
    v_mul_f32 v85, v41, v41
    v_fma_f32 v85, v85, s39, v80
    v_mul_f32 v85, v85, v41
    v_add_f32 v42, v42, v66
    v_mul_f32 v86, v42, v42
    v_fma_f32 v86, v86, s39, v80
    v_mul_f32 v86, v86, v42
    v_add_f32 v43, v43, v67
    v_mul_f32 v87, v43, v43
    v_fma_f32 v87, v87, s39, v80
    v_mul_f32 v87, v87, v43
    v_exp_f32 v84, v84
    v_exp_f32 v85, v85
    v_exp_f32 v86, v86
    v_exp_f32 v87, v87
    v_add_f32 v84, 1.0, v84
    v_add_f32 v85, 1.0, v85
    v_add_f32 v86, 1.0, v86
    v_add_f32 v87, 1.0, v87
    v_rcp_f32 v84, v84
    v_rcp_f32 v85, v85
    v_rcp_f32 v86, v86
    v_rcp_f32 v87, v87
    v_mul_f32 v40, v40, v84
    v_mul_f32 v41, v41, v85
    v_mul_f32 v42, v42, v86
    v_mul_f32 v43, v43, v87
    v_add_f32 v44, v44, v68
    v_mul_f32 v84, v44, v44
    v_fma_f32 v84, v84, s39, v80
    v_mul_f32 v84, v84, v44
    v_add_f32 v45, v45, v69
    v_mul_f32 v85, v45, v45
    v_fma_f32 v85, v85, s39, v80
    v_mul_f32 v85, v85, v45
    v_add_f32 v46, v46, v70
    v_mul_f32 v86, v46, v46
    v_fma_f32 v86, v86, s39, v80
    v_mul_f32 v86, v86, v46
    v_add_f32 v47, v47, v71
    v_mul_f32 v87, v47, v47
    v_fma_f32 v87, v87, s39, v80
    v_mul_f32 v87, v87, v47
    v_exp_f32 v84, v84
    v_exp_f32 v85, v85
    v_exp_f32 v86, v86
    v_exp_f32 v87, v87
    v_add_f32 v84, 1.0, v84
    v_add_f32 v85, 1.0, v85
    v_add_f32 v86, 1.0, v86
    v_add_f32 v87, 1.0, v87
    v_rcp_f32 v84, v84
    v_rcp_f32 v85, v85
    v_rcp_f32 v86, v86
    v_rcp_f32 v87, v87
    v_mul_f32 v44, v44, v84
    v_mul_f32 v45, v45, v85
    v_mul_f32 v46, v46, v86
    v_mul_f32 v47, v47, v87
    v_cvt_pk_bf16_f32 v248, v40, v41
    v_cvt_pk_bf16_f32 v249, v42, v43
    v_cvt_pk_bf16_f32 v250, v44, v45
    v_cvt_pk_bf16_f32 v251, v46, v47
    buffer_store_dwordx4 v[248:251], v233, s[4:7], s29 offen sc1
    s_add_u32 s28, s28, s18
    s_add_u32 s29, s29, s18
    s_add_u32 s14, s14, s18
    s_add_u32 s15, s15, s18
    s_add_u32 s17, s17, 128
    s_add_u32 s19, s19, 1
    s_cmp_lt_u32 s19, 64
    s_cbranch_scc1 WH_top
    s_branch W_tail
W_tail:
    s_waitcnt vmcnt(0)
    s_barrier
    s_cmp_eq_u32 s13, 0
    s_cbranch_scc0 W_tail2
    s_mov_b64 exec, 1
    v_mov_b32 v240, 0
    v_mov_b32 v241, 1
    buffer_atomic_add v241, v240, s[4:7], s17 offen
    s_mov_b64 exec, -1
    s_nop 3
    s_add_u32 s17, s17, 128
    s_mov_b64 exec, 1
    v_mov_b32 v240, 0
    v_mov_b32 v241, 1
    buffer_atomic_add v241, v240, s[4:7], s17 offen
    s_mov_b64 exec, -1
    s_nop 3
    s_add_u32 s17, s17, 128
W_tail2:
    s_waitcnt vmcnt(0)
    s_endpgm
W_notp:
    s_cmp_lt_u32 s33, 64
    s_cbranch_scc1 L_exit
    s_sub_u32 s25, s33, 64
    s_cmp_lt_u32 s25, 128
    s_cselect_b32 s34, s13, 1
    s_cmp_eq_u32 s34, 0
    s_cselect_b32 s36, 1, 0
    s_cbranch_scc0 W_nox
    v_and_b32 v240, 15, v232
    v_mul_u32_u24 v240, 1280, v240
    v_lshrrev_b32 v241, 4, v232
    v_lshl_add_u32 v240, v241, 4, v240
    s_mul_i32 s34, s25, 20480
    buffer_load_dwordx4 v[0:3], v240, s[20:23], s34 offen offset:0
    buffer_load_dwordx4 v[4:7], v240, s[20:23], s34 offen offset:64
    buffer_load_dwordx4 v[8:11], v240, s[20:23], s34 offen offset:128
    buffer_load_dwordx4 v[12:15], v240, s[20:23], s34 offen offset:192
    buffer_load_dwordx4 v[16:19], v240, s[20:23], s34 offen offset:256
    buffer_load_dwordx4 v[20:23], v240, s[20:23], s34 offen offset:320
    buffer_load_dwordx4 v[24:27], v240, s[20:23], s34 offen offset:384
    buffer_load_dwordx4 v[28:31], v240, s[20:23], s34 offen offset:448
    buffer_load_dwordx4 v[32:35], v240, s[20:23], s34 offen offset:512
    buffer_load_dwordx4 v[36:39], v240, s[20:23], s34 offen offset:576
    buffer_load_dwordx4 v[40:43], v240, s[20:23], s34 offen offset:640
    buffer_load_dwordx4 v[44:47], v240, s[20:23], s34 offen offset:704
    buffer_load_dwordx4 v[48:51], v240, s[20:23], s34 offen offset:768
    buffer_load_dwordx4 v[52:55], v240, s[20:23], s34 offen offset:832
    buffer_load_dwordx4 v[56:59], v240, s[20:23], s34 offen offset:896
    buffer_load_dwordx4 v[60:63], v240, s[20:23], s34 offen offset:960
    buffer_load_dwordx4 v[64:67], v240, s[20:23], s34 offen offset:1024
    buffer_load_dwordx4 v[68:71], v240, s[20:23], s34 offen offset:1088
    buffer_load_dwordx4 v[72:75], v240, s[20:23], s34 offen offset:1152
    buffer_load_dwordx4 v[76:79], v240, s[20:23], s34 offen offset:1216
W_nox:
    s_cmp_eq_u32 s36, 1
    s_cbranch_scc0 W_noln
    s_mul_i32 s34, s25, 5120
    s_add_u32 s34, s34, 4210688
    s_add_u32 s28, s34, 4096
    v_mov_b64 v[244:245], -1
    v_mov_b64 v[246:247], -1
    buffer_store_dwordx4 v[244:247], v233, s[4:7], s34 offen offset:0 sc1
    buffer_store_dwordx4 v[244:247], v233, s[4:7], s34 offen offset:1024 sc1
    buffer_store_dwordx4 v[244:247], v233, s[4:7], s34 offen offset:2048 sc1
    buffer_store_dwordx4 v[244:247], v233, s[4:7], s34 offen offset:3072 sc1
    buffer_store_dwordx4 v[244:247], v233, s[4:7], s28 offen offset:0 sc1
    v_mov_b32 v240, 0x3f803f80
    v_mov_b32 v241, 0x3f803f80
    v_mov_b32 v242, 0x3f803f80
    v_mov_b32 v243, 0x3f803f80
    v_and_b32 v252, 15, v232
    v_lshrrev_b32 v253, 2, v252
    v_lshl_add_u32 v253, v253, 4, v252
    v_lshlrev_b32 v253, 2, v253
    v_and_b32 v252, 3, v252
    s_mul_i32 s28, s25, 20480
    s_add_u32 s29, s28, 99090432
    s_add_u32 s28, s28, 96468992
    s_waitcnt vmcnt(5)
    s_mov_b32 s19, 0
W_ln:
    v_mfma_f32_16x16x32_bf16 v[244:247], v[240:243], v[0:3], 0
    v_mfma_f32_16x16x32_bf16 v[248:251], v[0:3], v[0:3], 0
    v_mfma_f32_16x16x32_bf16 v[244:247], v[240:243], v[4:7], v[244:247]
    v_mfma_f32_16x16x32_bf16 v[248:251], v[4:7], v[4:7], v[248:251]
    v_mfma_f32_16x16x32_bf16 v[244:247], v[240:243], v[8:11], v[244:247]
    v_mfma_f32_16x16x32_bf16 v[248:251], v[8:11], v[8:11], v[248:251]
    v_mfma_f32_16x16x32_bf16 v[244:247], v[240:243], v[12:15], v[244:247]
    v_mfma_f32_16x16x32_bf16 v[248:251], v[12:15], v[12:15], v[248:251]
    v_mfma_f32_16x16x32_bf16 v[244:247], v[240:243], v[16:19], v[244:247]
    v_mfma_f32_16x16x32_bf16 v[248:251], v[16:19], v[16:19], v[248:251]
    v_mfma_f32_16x16x32_bf16 v[244:247], v[240:243], v[20:23], v[244:247]
    v_mfma_f32_16x16x32_bf16 v[248:251], v[20:23], v[20:23], v[248:251]
    v_mfma_f32_16x16x32_bf16 v[244:247], v[240:243], v[24:27], v[244:247]
    v_mfma_f32_16x16x32_bf16 v[248:251], v[24:27], v[24:27], v[248:251]
    v_mfma_f32_16x16x32_bf16 v[244:247], v[240:243], v[28:31], v[244:247]
    v_mfma_f32_16x16x32_bf16 v[248:251], v[28:31], v[28:31], v[248:251]
    v_mfma_f32_16x16x32_bf16 v[244:247], v[240:243], v[32:35], v[244:247]
    v_mfma_f32_16x16x32_bf16 v[248:251], v[32:35], v[32:35], v[248:251]
    v_mfma_f32_16x16x32_bf16 v[244:247], v[240:243], v[36:39], v[244:247]
    v_mfma_f32_16x16x32_bf16 v[248:251], v[36:39], v[36:39], v[248:251]
    v_mfma_f32_16x16x32_bf16 v[244:247], v[240:243], v[40:43], v[244:247]
    v_mfma_f32_16x16x32_bf16 v[248:251], v[40:43], v[40:43], v[248:251]
    v_mfma_f32_16x16x32_bf16 v[244:247], v[240:243], v[44:47], v[244:247]
    v_mfma_f32_16x16x32_bf16 v[248:251], v[44:47], v[44:47], v[248:251]
    v_mfma_f32_16x16x32_bf16 v[244:247], v[240:243], v[48:51], v[244:247]
    v_mfma_f32_16x16x32_bf16 v[248:251], v[48:51], v[48:51], v[248:251]
    v_mfma_f32_16x16x32_bf16 v[244:247], v[240:243], v[52:55], v[244:247]
    v_mfma_f32_16x16x32_bf16 v[248:251], v[52:55], v[52:55], v[248:251]
    v_mfma_f32_16x16x32_bf16 v[244:247], v[240:243], v[56:59], v[244:247]
    v_mfma_f32_16x16x32_bf16 v[248:251], v[56:59], v[56:59], v[248:251]
    v_mfma_f32_16x16x32_bf16 v[244:247], v[240:243], v[60:63], v[244:247]
    v_mfma_f32_16x16x32_bf16 v[248:251], v[60:63], v[60:63], v[248:251]
    v_mfma_f32_16x16x32_bf16 v[244:247], v[240:243], v[64:67], v[244:247]
    v_mfma_f32_16x16x32_bf16 v[248:251], v[64:67], v[64:67], v[248:251]
    v_mfma_f32_16x16x32_bf16 v[244:247], v[240:243], v[68:71], v[244:247]
    v_mfma_f32_16x16x32_bf16 v[248:251], v[68:71], v[68:71], v[248:251]
    v_mfma_f32_16x16x32_bf16 v[244:247], v[240:243], v[72:75], v[244:247]
    v_mfma_f32_16x16x32_bf16 v[248:251], v[72:75], v[72:75], v[248:251]
    v_mfma_f32_16x16x32_bf16 v[244:247], v[240:243], v[76:79], v[244:247]
    v_mfma_f32_16x16x32_bf16 v[248:251], v[76:79], v[76:79], v[248:251]
    v_cmp_eq_u32 vcc, 1, v252
    s_nop 6
    v_cndmask_b32 v248, v248, v249, vcc
    v_cmp_eq_u32 vcc, 2, v252
    s_nop 1
    v_cndmask_b32 v248, v248, v250, vcc
    v_cmp_eq_u32 vcc, 3, v252
    s_nop 1
    v_cndmask_b32 v248, v248, v251, vcc
    ds_bpermute_b32 v248, v253, v248
    v_mul_f32 v244, 0x3acccccd, v244
    s_waitcnt lgkmcnt(0)
    v_mul_f32 v248, 0x3acccccd, v248
    v_fma_f32 v248, -v244, v244, v248
    v_max_f32 v248, 0, v248
    v_cvt_pk_bf16_f32 v244, v244, v244
    v_and_b32 v244, s37, v244
    v_cvt_pk_bf16_f32 v248, v248, v248
    v_and_b32 v248, s37, v248
    v_add_f32 v248, 0x3727c5ac, v248
    v_cvt_pk_bf16_f32 v248, v248, v248
    v_and_b32 v248, s37, v248
    v_sqrt_f32 v248, v248
    s_nop 0
    v_cvt_pk_bf16_f32 v248, v248, v248
    v_and_b32 v248, s37, v248
    v_rcp_f32 v248, v248
    s_nop 0
    v_mul_f32 v244, v244, v248
    v_lshlrev_b32 v254, 16, v0
    v_and_b32 v255, s37, v0
    v_pk_fma_f32 v[254:255], v[254:255], v[248:249], v[244:245] op_sel_hi:[1,0,0] neg_lo:[0,0,1] neg_hi:[0,0,1]
    v_cvt_pk_bf16_f32 v0, v254, v255
    v_lshlrev_b32 v254, 16, v1
    v_and_b32 v255, s37, v1
    v_pk_fma_f32 v[254:255], v[254:255], v[248:249], v[244:245] op_sel_hi:[1,0,0] neg_lo:[0,0,1] neg_hi:[0,0,1]
    v_cvt_pk_bf16_f32 v1, v254, v255
    v_lshlrev_b32 v254, 16, v2
    v_and_b32 v255, s37, v2
    v_pk_fma_f32 v[254:255], v[254:255], v[248:249], v[244:245] op_sel_hi:[1,0,0] neg_lo:[0,0,1] neg_hi:[0,0,1]
    v_cvt_pk_bf16_f32 v2, v254, v255
    v_lshlrev_b32 v254, 16, v3
    v_and_b32 v255, s37, v3
    v_pk_fma_f32 v[254:255], v[254:255], v[248:249], v[244:245] op_sel_hi:[1,0,0] neg_lo:[0,0,1] neg_hi:[0,0,1]
    v_cvt_pk_bf16_f32 v3, v254, v255
    buffer_store_dwordx4 v[0:3], v233, s[4:7], s28 offen offset:0 sc1
    v_lshlrev_b32 v254, 16, v4
    v_and_b32 v255, s37, v4
    v_pk_fma_f32 v[254:255], v[254:255], v[248:249], v[244:245] op_sel_hi:[1,0,0] neg_lo:[0,0,1] neg_hi:[0,0,1]
    v_cvt_pk_bf16_f32 v4, v254, v255
    v_lshlrev_b32 v254, 16, v5
    v_and_b32 v255, s37, v5
    v_pk_fma_f32 v[254:255], v[254:255], v[248:249], v[244:245] op_sel_hi:[1,0,0] neg_lo:[0,0,1] neg_hi:[0,0,1]
    v_cvt_pk_bf16_f32 v5, v254, v255
    v_lshlrev_b32 v254, 16, v6
    v_and_b32 v255, s37, v6
    v_pk_fma_f32 v[254:255], v[254:255], v[248:249], v[244:245] op_sel_hi:[1,0,0] neg_lo:[0,0,1] neg_hi:[0,0,1]
    v_cvt_pk_bf16_f32 v6, v254, v255
    v_lshlrev_b32 v254, 16, v7
    v_and_b32 v255, s37, v7
    v_pk_fma_f32 v[254:255], v[254:255], v[248:249], v[244:245] op_sel_hi:[1,0,0] neg_lo:[0,0,1] neg_hi:[0,0,1]
    v_cvt_pk_bf16_f32 v7, v254, v255
    buffer_store_dwordx4 v[4:7], v233, s[4:7], s28 offen offset:1024 sc1
    v_lshlrev_b32 v254, 16, v8
    v_and_b32 v255, s37, v8
    v_pk_fma_f32 v[254:255], v[254:255], v[248:249], v[244:245] op_sel_hi:[1,0,0] neg_lo:[0,0,1] neg_hi:[0,0,1]
    v_cvt_pk_bf16_f32 v8, v254, v255
    v_lshlrev_b32 v254, 16, v9
    v_and_b32 v255, s37, v9
    v_pk_fma_f32 v[254:255], v[254:255], v[248:249], v[244:245] op_sel_hi:[1,0,0] neg_lo:[0,0,1] neg_hi:[0,0,1]
    v_cvt_pk_bf16_f32 v9, v254, v255
    v_lshlrev_b32 v254, 16, v10
    v_and_b32 v255, s37, v10
    v_pk_fma_f32 v[254:255], v[254:255], v[248:249], v[244:245] op_sel_hi:[1,0,0] neg_lo:[0,0,1] neg_hi:[0,0,1]
    v_cvt_pk_bf16_f32 v10, v254, v255
    v_lshlrev_b32 v254, 16, v11
    v_and_b32 v255, s37, v11
    v_pk_fma_f32 v[254:255], v[254:255], v[248:249], v[244:245] op_sel_hi:[1,0,0] neg_lo:[0,0,1] neg_hi:[0,0,1]
    v_cvt_pk_bf16_f32 v11, v254, v255
    buffer_store_dwordx4 v[8:11], v233, s[4:7], s28 offen offset:2048 sc1
    v_lshlrev_b32 v254, 16, v12
    v_and_b32 v255, s37, v12
    v_pk_fma_f32 v[254:255], v[254:255], v[248:249], v[244:245] op_sel_hi:[1,0,0] neg_lo:[0,0,1] neg_hi:[0,0,1]
    v_cvt_pk_bf16_f32 v12, v254, v255
    v_lshlrev_b32 v254, 16, v13
    v_and_b32 v255, s37, v13
    v_pk_fma_f32 v[254:255], v[254:255], v[248:249], v[244:245] op_sel_hi:[1,0,0] neg_lo:[0,0,1] neg_hi:[0,0,1]
    v_cvt_pk_bf16_f32 v13, v254, v255
    v_lshlrev_b32 v254, 16, v14
    v_and_b32 v255, s37, v14
    v_pk_fma_f32 v[254:255], v[254:255], v[248:249], v[244:245] op_sel_hi:[1,0,0] neg_lo:[0,0,1] neg_hi:[0,0,1]
    v_cvt_pk_bf16_f32 v14, v254, v255
    v_lshlrev_b32 v254, 16, v15
    v_and_b32 v255, s37, v15
    v_pk_fma_f32 v[254:255], v[254:255], v[248:249], v[244:245] op_sel_hi:[1,0,0] neg_lo:[0,0,1] neg_hi:[0,0,1]
    v_cvt_pk_bf16_f32 v15, v254, v255
    buffer_store_dwordx4 v[12:15], v233, s[4:7], s28 offen offset:3072 sc1
    s_add_u32 s28, s28, 4096
    v_lshlrev_b32 v254, 16, v16
    v_and_b32 v255, s37, v16
    v_pk_fma_f32 v[254:255], v[254:255], v[248:249], v[244:245] op_sel_hi:[1,0,0] neg_lo:[0,0,1] neg_hi:[0,0,1]
    v_cvt_pk_bf16_f32 v16, v254, v255
    v_lshlrev_b32 v254, 16, v17
    v_and_b32 v255, s37, v17
    v_pk_fma_f32 v[254:255], v[254:255], v[248:249], v[244:245] op_sel_hi:[1,0,0] neg_lo:[0,0,1] neg_hi:[0,0,1]
    v_cvt_pk_bf16_f32 v17, v254, v255
    v_lshlrev_b32 v254, 16, v18
    v_and_b32 v255, s37, v18
    v_pk_fma_f32 v[254:255], v[254:255], v[248:249], v[244:245] op_sel_hi:[1,0,0] neg_lo:[0,0,1] neg_hi:[0,0,1]
    v_cvt_pk_bf16_f32 v18, v254, v255
    v_lshlrev_b32 v254, 16, v19
    v_and_b32 v255, s37, v19
    v_pk_fma_f32 v[254:255], v[254:255], v[248:249], v[244:245] op_sel_hi:[1,0,0] neg_lo:[0,0,1] neg_hi:[0,0,1]
    v_cvt_pk_bf16_f32 v19, v254, v255
    buffer_store_dwordx4 v[16:19], v233, s[4:7], s28 offen offset:0 sc1
    v_lshlrev_b32 v254, 16, v20
    v_and_b32 v255, s37, v20
    v_pk_fma_f32 v[254:255], v[254:255], v[248:249], v[244:245] op_sel_hi:[1,0,0] neg_lo:[0,0,1] neg_hi:[0,0,1]
    v_cvt_pk_bf16_f32 v20, v254, v255
    v_lshlrev_b32 v254, 16, v21
    v_and_b32 v255, s37, v21
    v_pk_fma_f32 v[254:255], v[254:255], v[248:249], v[244:245] op_sel_hi:[1,0,0] neg_lo:[0,0,1] neg_hi:[0,0,1]
    v_cvt_pk_bf16_f32 v21, v254, v255
    v_lshlrev_b32 v254, 16, v22
    v_and_b32 v255, s37, v22
    v_pk_fma_f32 v[254:255], v[254:255], v[248:249], v[244:245] op_sel_hi:[1,0,0] neg_lo:[0,0,1] neg_hi:[0,0,1]
    v_cvt_pk_bf16_f32 v22, v254, v255
    v_lshlrev_b32 v254, 16, v23
    v_and_b32 v255, s37, v23
    v_pk_fma_f32 v[254:255], v[254:255], v[248:249], v[244:245] op_sel_hi:[1,0,0] neg_lo:[0,0,1] neg_hi:[0,0,1]
    v_cvt_pk_bf16_f32 v23, v254, v255
    buffer_store_dwordx4 v[20:23], v233, s[4:7], s28 offen offset:1024 sc1
    v_lshlrev_b32 v254, 16, v24
    v_and_b32 v255, s37, v24
    v_pk_fma_f32 v[254:255], v[254:255], v[248:249], v[244:245] op_sel_hi:[1,0,0] neg_lo:[0,0,1] neg_hi:[0,0,1]
    v_cvt_pk_bf16_f32 v24, v254, v255
    v_lshlrev_b32 v254, 16, v25
    v_and_b32 v255, s37, v25
    v_pk_fma_f32 v[254:255], v[254:255], v[248:249], v[244:245] op_sel_hi:[1,0,0] neg_lo:[0,0,1] neg_hi:[0,0,1]
    v_cvt_pk_bf16_f32 v25, v254, v255
    v_lshlrev_b32 v254, 16, v26
    v_and_b32 v255, s37, v26
    v_pk_fma_f32 v[254:255], v[254:255], v[248:249], v[244:245] op_sel_hi:[1,0,0] neg_lo:[0,0,1] neg_hi:[0,0,1]
    v_cvt_pk_bf16_f32 v26, v254, v255
    v_lshlrev_b32 v254, 16, v27
    v_and_b32 v255, s37, v27
    v_pk_fma_f32 v[254:255], v[254:255], v[248:249], v[244:245] op_sel_hi:[1,0,0] neg_lo:[0,0,1] neg_hi:[0,0,1]
    v_cvt_pk_bf16_f32 v27, v254, v255
    buffer_store_dwordx4 v[24:27], v233, s[4:7], s28 offen offset:2048 sc1
    v_lshlrev_b32 v254, 16, v28
    v_and_b32 v255, s37, v28
    v_pk_fma_f32 v[254:255], v[254:255], v[248:249], v[244:245] op_sel_hi:[1,0,0] neg_lo:[0,0,1] neg_hi:[0,0,1]
    v_cvt_pk_bf16_f32 v28, v254, v255
    v_lshlrev_b32 v254, 16, v29
    v_and_b32 v255, s37, v29
    v_pk_fma_f32 v[254:255], v[254:255], v[248:249], v[244:245] op_sel_hi:[1,0,0] neg_lo:[0,0,1] neg_hi:[0,0,1]
    v_cvt_pk_bf16_f32 v29, v254, v255
    v_lshlrev_b32 v254, 16, v30
    v_and_b32 v255, s37, v30
    v_pk_fma_f32 v[254:255], v[254:255], v[248:249], v[244:245] op_sel_hi:[1,0,0] neg_lo:[0,0,1] neg_hi:[0,0,1]
    v_cvt_pk_bf16_f32 v30, v254, v255
    v_lshlrev_b32 v254, 16, v31
    v_and_b32 v255, s37, v31
    v_pk_fma_f32 v[254:255], v[254:255], v[248:249], v[244:245] op_sel_hi:[1,0,0] neg_lo:[0,0,1] neg_hi:[0,0,1]
    v_cvt_pk_bf16_f32 v31, v254, v255
    buffer_store_dwordx4 v[28:31], v233, s[4:7], s28 offen offset:3072 sc1
    s_add_u32 s28, s28, 4096
    v_lshlrev_b32 v254, 16, v32
    v_and_b32 v255, s37, v32
    v_pk_fma_f32 v[254:255], v[254:255], v[248:249], v[244:245] op_sel_hi:[1,0,0] neg_lo:[0,0,1] neg_hi:[0,0,1]
    v_cvt_pk_bf16_f32 v32, v254, v255
    v_lshlrev_b32 v254, 16, v33
    v_and_b32 v255, s37, v33
    v_pk_fma_f32 v[254:255], v[254:255], v[248:249], v[244:245] op_sel_hi:[1,0,0] neg_lo:[0,0,1] neg_hi:[0,0,1]
    v_cvt_pk_bf16_f32 v33, v254, v255
    v_lshlrev_b32 v254, 16, v34
    v_and_b32 v255, s37, v34
    v_pk_fma_f32 v[254:255], v[254:255], v[248:249], v[244:245] op_sel_hi:[1,0,0] neg_lo:[0,0,1] neg_hi:[0,0,1]
    v_cvt_pk_bf16_f32 v34, v254, v255
    v_lshlrev_b32 v254, 16, v35
    v_and_b32 v255, s37, v35
    v_pk_fma_f32 v[254:255], v[254:255], v[248:249], v[244:245] op_sel_hi:[1,0,0] neg_lo:[0,0,1] neg_hi:[0,0,1]
    v_cvt_pk_bf16_f32 v35, v254, v255
    buffer_store_dwordx4 v[32:35], v233, s[4:7], s28 offen offset:0 sc1
    v_lshlrev_b32 v254, 16, v36
    v_and_b32 v255, s37, v36
    v_pk_fma_f32 v[254:255], v[254:255], v[248:249], v[244:245] op_sel_hi:[1,0,0] neg_lo:[0,0,1] neg_hi:[0,0,1]
    v_cvt_pk_bf16_f32 v36, v254, v255
    v_lshlrev_b32 v254, 16, v37
    v_and_b32 v255, s37, v37
    v_pk_fma_f32 v[254:255], v[254:255], v[248:249], v[244:245] op_sel_hi:[1,0,0] neg_lo:[0,0,1] neg_hi:[0,0,1]
    v_cvt_pk_bf16_f32 v37, v254, v255
    v_lshlrev_b32 v254, 16, v38
    v_and_b32 v255, s37, v38
    v_pk_fma_f32 v[254:255], v[254:255], v[248:249], v[244:245] op_sel_hi:[1,0,0] neg_lo:[0,0,1] neg_hi:[0,0,1]
    v_cvt_pk_bf16_f32 v38, v254, v255
    v_lshlrev_b32 v254, 16, v39
    v_and_b32 v255, s37, v39
    v_pk_fma_f32 v[254:255], v[254:255], v[248:249], v[244:245] op_sel_hi:[1,0,0] neg_lo:[0,0,1] neg_hi:[0,0,1]
    v_cvt_pk_bf16_f32 v39, v254, v255
    buffer_store_dwordx4 v[36:39], v233, s[4:7], s28 offen offset:1024 sc1
    v_lshlrev_b32 v254, 16, v40
    v_and_b32 v255, s37, v40
    v_pk_fma_f32 v[254:255], v[254:255], v[248:249], v[244:245] op_sel_hi:[1,0,0] neg_lo:[0,0,1] neg_hi:[0,0,1]
    v_cvt_pk_bf16_f32 v40, v254, v255
    v_lshlrev_b32 v254, 16, v41
    v_and_b32 v255, s37, v41
    v_pk_fma_f32 v[254:255], v[254:255], v[248:249], v[244:245] op_sel_hi:[1,0,0] neg_lo:[0,0,1] neg_hi:[0,0,1]
    v_cvt_pk_bf16_f32 v41, v254, v255
    v_lshlrev_b32 v254, 16, v42
    v_and_b32 v255, s37, v42
    v_pk_fma_f32 v[254:255], v[254:255], v[248:249], v[244:245] op_sel_hi:[1,0,0] neg_lo:[0,0,1] neg_hi:[0,0,1]
    v_cvt_pk_bf16_f32 v42, v254, v255
    v_lshlrev_b32 v254, 16, v43
    v_and_b32 v255, s37, v43
    v_pk_fma_f32 v[254:255], v[254:255], v[248:249], v[244:245] op_sel_hi:[1,0,0] neg_lo:[0,0,1] neg_hi:[0,0,1]
    v_cvt_pk_bf16_f32 v43, v254, v255
    buffer_store_dwordx4 v[40:43], v233, s[4:7], s28 offen offset:2048 sc1
    v_lshlrev_b32 v254, 16, v44
    v_and_b32 v255, s37, v44
    v_pk_fma_f32 v[254:255], v[254:255], v[248:249], v[244:245] op_sel_hi:[1,0,0] neg_lo:[0,0,1] neg_hi:[0,0,1]
    v_cvt_pk_bf16_f32 v44, v254, v255
    v_lshlrev_b32 v254, 16, v45
    v_and_b32 v255, s37, v45
    v_pk_fma_f32 v[254:255], v[254:255], v[248:249], v[244:245] op_sel_hi:[1,0,0] neg_lo:[0,0,1] neg_hi:[0,0,1]
    v_cvt_pk_bf16_f32 v45, v254, v255
    v_lshlrev_b32 v254, 16, v46
    v_and_b32 v255, s37, v46
    v_pk_fma_f32 v[254:255], v[254:255], v[248:249], v[244:245] op_sel_hi:[1,0,0] neg_lo:[0,0,1] neg_hi:[0,0,1]
    v_cvt_pk_bf16_f32 v46, v254, v255
    v_lshlrev_b32 v254, 16, v47
    v_and_b32 v255, s37, v47
    v_pk_fma_f32 v[254:255], v[254:255], v[248:249], v[244:245] op_sel_hi:[1,0,0] neg_lo:[0,0,1] neg_hi:[0,0,1]
    v_cvt_pk_bf16_f32 v47, v254, v255
    buffer_store_dwordx4 v[44:47], v233, s[4:7], s28 offen offset:3072 sc1
    s_add_u32 s28, s28, 4096
    v_lshlrev_b32 v254, 16, v48
    v_and_b32 v255, s37, v48
    v_pk_fma_f32 v[254:255], v[254:255], v[248:249], v[244:245] op_sel_hi:[1,0,0] neg_lo:[0,0,1] neg_hi:[0,0,1]
    v_cvt_pk_bf16_f32 v48, v254, v255
    v_lshlrev_b32 v254, 16, v49
    v_and_b32 v255, s37, v49
    v_pk_fma_f32 v[254:255], v[254:255], v[248:249], v[244:245] op_sel_hi:[1,0,0] neg_lo:[0,0,1] neg_hi:[0,0,1]
    v_cvt_pk_bf16_f32 v49, v254, v255
    v_lshlrev_b32 v254, 16, v50
    v_and_b32 v255, s37, v50
    v_pk_fma_f32 v[254:255], v[254:255], v[248:249], v[244:245] op_sel_hi:[1,0,0] neg_lo:[0,0,1] neg_hi:[0,0,1]
    v_cvt_pk_bf16_f32 v50, v254, v255
    v_lshlrev_b32 v254, 16, v51
    v_and_b32 v255, s37, v51
    v_pk_fma_f32 v[254:255], v[254:255], v[248:249], v[244:245] op_sel_hi:[1,0,0] neg_lo:[0,0,1] neg_hi:[0,0,1]
    v_cvt_pk_bf16_f32 v51, v254, v255
    buffer_store_dwordx4 v[48:51], v233, s[4:7], s28 offen offset:0 sc1
    v_lshlrev_b32 v254, 16, v52
    v_and_b32 v255, s37, v52
    v_pk_fma_f32 v[254:255], v[254:255], v[248:249], v[244:245] op_sel_hi:[1,0,0] neg_lo:[0,0,1] neg_hi:[0,0,1]
    v_cvt_pk_bf16_f32 v52, v254, v255
    v_lshlrev_b32 v254, 16, v53
    v_and_b32 v255, s37, v53
    v_pk_fma_f32 v[254:255], v[254:255], v[248:249], v[244:245] op_sel_hi:[1,0,0] neg_lo:[0,0,1] neg_hi:[0,0,1]
    v_cvt_pk_bf16_f32 v53, v254, v255
    v_lshlrev_b32 v254, 16, v54
    v_and_b32 v255, s37, v54
    v_pk_fma_f32 v[254:255], v[254:255], v[248:249], v[244:245] op_sel_hi:[1,0,0] neg_lo:[0,0,1] neg_hi:[0,0,1]
    v_cvt_pk_bf16_f32 v54, v254, v255
    v_lshlrev_b32 v254, 16, v55
    v_and_b32 v255, s37, v55
    v_pk_fma_f32 v[254:255], v[254:255], v[248:249], v[244:245] op_sel_hi:[1,0,0] neg_lo:[0,0,1] neg_hi:[0,0,1]
    v_cvt_pk_bf16_f32 v55, v254, v255
    buffer_store_dwordx4 v[52:55], v233, s[4:7], s28 offen offset:1024 sc1
    v_lshlrev_b32 v254, 16, v56
    v_and_b32 v255, s37, v56
    v_pk_fma_f32 v[254:255], v[254:255], v[248:249], v[244:245] op_sel_hi:[1,0,0] neg_lo:[0,0,1] neg_hi:[0,0,1]
    v_cvt_pk_bf16_f32 v56, v254, v255
    v_lshlrev_b32 v254, 16, v57
    v_and_b32 v255, s37, v57
    v_pk_fma_f32 v[254:255], v[254:255], v[248:249], v[244:245] op_sel_hi:[1,0,0] neg_lo:[0,0,1] neg_hi:[0,0,1]
    v_cvt_pk_bf16_f32 v57, v254, v255
    v_lshlrev_b32 v254, 16, v58
    v_and_b32 v255, s37, v58
    v_pk_fma_f32 v[254:255], v[254:255], v[248:249], v[244:245] op_sel_hi:[1,0,0] neg_lo:[0,0,1] neg_hi:[0,0,1]
    v_cvt_pk_bf16_f32 v58, v254, v255
    v_lshlrev_b32 v254, 16, v59
    v_and_b32 v255, s37, v59
    v_pk_fma_f32 v[254:255], v[254:255], v[248:249], v[244:245] op_sel_hi:[1,0,0] neg_lo:[0,0,1] neg_hi:[0,0,1]
    v_cvt_pk_bf16_f32 v59, v254, v255
    buffer_store_dwordx4 v[56:59], v233, s[4:7], s28 offen offset:2048 sc1
    v_lshlrev_b32 v254, 16, v60
    v_and_b32 v255, s37, v60
    v_pk_fma_f32 v[254:255], v[254:255], v[248:249], v[244:245] op_sel_hi:[1,0,0] neg_lo:[0,0,1] neg_hi:[0,0,1]
    v_cvt_pk_bf16_f32 v60, v254, v255
    v_lshlrev_b32 v254, 16, v61
    v_and_b32 v255, s37, v61
    v_pk_fma_f32 v[254:255], v[254:255], v[248:249], v[244:245] op_sel_hi:[1,0,0] neg_lo:[0,0,1] neg_hi:[0,0,1]
    v_cvt_pk_bf16_f32 v61, v254, v255
    v_lshlrev_b32 v254, 16, v62
    v_and_b32 v255, s37, v62
    v_pk_fma_f32 v[254:255], v[254:255], v[248:249], v[244:245] op_sel_hi:[1,0,0] neg_lo:[0,0,1] neg_hi:[0,0,1]
    v_cvt_pk_bf16_f32 v62, v254, v255
    v_lshlrev_b32 v254, 16, v63
    v_and_b32 v255, s37, v63
    v_pk_fma_f32 v[254:255], v[254:255], v[248:249], v[244:245] op_sel_hi:[1,0,0] neg_lo:[0,0,1] neg_hi:[0,0,1]
    v_cvt_pk_bf16_f32 v63, v254, v255
    buffer_store_dwordx4 v[60:63], v233, s[4:7], s28 offen offset:3072 sc1
    s_add_u32 s28, s28, 4096
    v_lshlrev_b32 v254, 16, v64
    v_and_b32 v255, s37, v64
    v_pk_fma_f32 v[254:255], v[254:255], v[248:249], v[244:245] op_sel_hi:[1,0,0] neg_lo:[0,0,1] neg_hi:[0,0,1]
    v_cvt_pk_bf16_f32 v64, v254, v255
    v_lshlrev_b32 v254, 16, v65
    v_and_b32 v255, s37, v65
    v_pk_fma_f32 v[254:255], v[254:255], v[248:249], v[244:245] op_sel_hi:[1,0,0] neg_lo:[0,0,1] neg_hi:[0,0,1]
    v_cvt_pk_bf16_f32 v65, v254, v255
    v_lshlrev_b32 v254, 16, v66
    v_and_b32 v255, s37, v66
    v_pk_fma_f32 v[254:255], v[254:255], v[248:249], v[244:245] op_sel_hi:[1,0,0] neg_lo:[0,0,1] neg_hi:[0,0,1]
    v_cvt_pk_bf16_f32 v66, v254, v255
    v_lshlrev_b32 v254, 16, v67
    v_and_b32 v255, s37, v67
    v_pk_fma_f32 v[254:255], v[254:255], v[248:249], v[244:245] op_sel_hi:[1,0,0] neg_lo:[0,0,1] neg_hi:[0,0,1]
    v_cvt_pk_bf16_f32 v67, v254, v255
    buffer_store_dwordx4 v[64:67], v233, s[4:7], s28 offen offset:0 sc1
    v_lshlrev_b32 v254, 16, v68
    v_and_b32 v255, s37, v68
    v_pk_fma_f32 v[254:255], v[254:255], v[248:249], v[244:245] op_sel_hi:[1,0,0] neg_lo:[0,0,1] neg_hi:[0,0,1]
    v_cvt_pk_bf16_f32 v68, v254, v255
    v_lshlrev_b32 v254, 16, v69
    v_and_b32 v255, s37, v69
    v_pk_fma_f32 v[254:255], v[254:255], v[248:249], v[244:245] op_sel_hi:[1,0,0] neg_lo:[0,0,1] neg_hi:[0,0,1]
    v_cvt_pk_bf16_f32 v69, v254, v255
    v_lshlrev_b32 v254, 16, v70
    v_and_b32 v255, s37, v70
    v_pk_fma_f32 v[254:255], v[254:255], v[248:249], v[244:245] op_sel_hi:[1,0,0] neg_lo:[0,0,1] neg_hi:[0,0,1]
    v_cvt_pk_bf16_f32 v70, v254, v255
    v_lshlrev_b32 v254, 16, v71
    v_and_b32 v255, s37, v71
    v_pk_fma_f32 v[254:255], v[254:255], v[248:249], v[244:245] op_sel_hi:[1,0,0] neg_lo:[0,0,1] neg_hi:[0,0,1]
    v_cvt_pk_bf16_f32 v71, v254, v255
    buffer_store_dwordx4 v[68:71], v233, s[4:7], s28 offen offset:1024 sc1
    v_lshlrev_b32 v254, 16, v72
    v_and_b32 v255, s37, v72
    v_pk_fma_f32 v[254:255], v[254:255], v[248:249], v[244:245] op_sel_hi:[1,0,0] neg_lo:[0,0,1] neg_hi:[0,0,1]
    v_cvt_pk_bf16_f32 v72, v254, v255
    v_lshlrev_b32 v254, 16, v73
    v_and_b32 v255, s37, v73
    v_pk_fma_f32 v[254:255], v[254:255], v[248:249], v[244:245] op_sel_hi:[1,0,0] neg_lo:[0,0,1] neg_hi:[0,0,1]
    v_cvt_pk_bf16_f32 v73, v254, v255
    v_lshlrev_b32 v254, 16, v74
    v_and_b32 v255, s37, v74
    v_pk_fma_f32 v[254:255], v[254:255], v[248:249], v[244:245] op_sel_hi:[1,0,0] neg_lo:[0,0,1] neg_hi:[0,0,1]
    v_cvt_pk_bf16_f32 v74, v254, v255
    v_lshlrev_b32 v254, 16, v75
    v_and_b32 v255, s37, v75
    v_pk_fma_f32 v[254:255], v[254:255], v[248:249], v[244:245] op_sel_hi:[1,0,0] neg_lo:[0,0,1] neg_hi:[0,0,1]
    v_cvt_pk_bf16_f32 v75, v254, v255
    buffer_store_dwordx4 v[72:75], v233, s[4:7], s28 offen offset:2048 sc1
    v_lshlrev_b32 v254, 16, v76
    v_and_b32 v255, s37, v76
    v_pk_fma_f32 v[254:255], v[254:255], v[248:249], v[244:245] op_sel_hi:[1,0,0] neg_lo:[0,0,1] neg_hi:[0,0,1]
    v_cvt_pk_bf16_f32 v76, v254, v255
    v_lshlrev_b32 v254, 16, v77
    v_and_b32 v255, s37, v77
    v_pk_fma_f32 v[254:255], v[254:255], v[248:249], v[244:245] op_sel_hi:[1,0,0] neg_lo:[0,0,1] neg_hi:[0,0,1]
    v_cvt_pk_bf16_f32 v77, v254, v255
    v_lshlrev_b32 v254, 16, v78
    v_and_b32 v255, s37, v78
    v_pk_fma_f32 v[254:255], v[254:255], v[248:249], v[244:245] op_sel_hi:[1,0,0] neg_lo:[0,0,1] neg_hi:[0,0,1]
    v_cvt_pk_bf16_f32 v78, v254, v255
    v_lshlrev_b32 v254, 16, v79
    v_and_b32 v255, s37, v79
    v_pk_fma_f32 v[254:255], v[254:255], v[248:249], v[244:245] op_sel_hi:[1,0,0] neg_lo:[0,0,1] neg_hi:[0,0,1]
    v_cvt_pk_bf16_f32 v79, v254, v255
    buffer_store_dwordx4 v[76:79], v233, s[4:7], s28 offen offset:3072 sc1
    s_mov_b32 s28, s29
    s_add_u32 s19, s19, 1
    s_cmp_lt_u32 s19, 2
    s_cbranch_scc1 W_ln
W_zero:
    v_mov_b32 v244, 4
    global_load_dword v245, v244, s[50:51] sc1
    s_add_u32 s32, s32, 1
    s_cmp_gt_u32 s32, 0x40000
    s_cbranch_scc1 L_abort
    s_waitcnt vmcnt(0)
    v_cmp_gt_u32 vcc, 32, v245
    s_cbranch_vccz W_zero_ok
    s_sleep 1
    s_branch W_zero
W_zero_ok:
    s_lshr_b32 s34, s25, 1
    s_lshl_b32 s34, s34, 7
    s_add_u32 s34, s34, 0
    s_mov_b64 exec, 1
    v_mov_b32 v240, 0
    v_mov_b32 v241, 1
    buffer_atomic_add v241, v240, s[4:7], s34 offen
    s_mov_b64 exec, -1
    s_nop 3
W_noln:
    s_cmp_ge_u32 s33, 208
    s_cbranch_scc1 L_exit
W_zero3:
    v_mov_b32 v244, 4
    global_load_dword v245, v244, s[50:51] sc1
    s_add_u32 s32, s32, 1
    s_cmp_gt_u32 s32, 0x40000
    s_cbranch_scc1 L_abort
    s_waitcnt vmcnt(0)
    v_cmp_gt_u32 vcc, 32, v245
    s_cbranch_vccz W_zero3_ok
    s_sleep 1
    s_branch W_zero3
W_zero3_ok:
    s_barrier
    s_cmp_lt_u32 s33, 128
    s_cbranch_scc0 W_stageB
    s_and_b32 s24, s33, 31
    s_lshr_b32 s25, s33, 5
    s_sub_u32 s25, s25, 2
    v_mov_b32 v15, v232
    v_lshrrev_b32 v4, 5, v15
    v_lshlrev_b32 v4, 4, v4
    v_bfe_u32 v5, v15, 4, 1
    v_lshl_add_u32 v4, v5, 2, v4
    v_and_b32 v5, 15, v15
    v_lshlrev_b32 v5, 2, v5
    s_lshl_b32 s34, s24, 8
    s_lshl_b32 s35, s13, 6
    s_add_u32 s34, s34, s35
    v_lshl_add_u32 v1, v4, 13, v5
    v_add_u32 v1, s34, v1
    s_mov_b32 s10, 5242880
    s_mov_b32 s38, 0x05040100
    s_mov_b32 s39, 0x07060302
    s_mov_b32 s8, s42
    s_mov_b32 s9, s43
    s_mov_b32 s34, 0
    buffer_load_dword v16, v1, s[8:11], s34 offen
    s_mov_b32 s34, 8192
    buffer_load_dword v17, v1, s[8:11], s34 offen
    s_mov_b32 s34, 65536
    buffer_load_dword v18, v1, s[8:11], s34 offen
    s_mov_b32 s34, 73728
    buffer_load_dword v19, v1, s[8:11], s34 offen
    s_mov_b32 s34, 16384
    buffer_load_dword v20, v1, s[8:11], s34 offen
    s_mov_b32 s34, 24576
    buffer_load_dword v21, v1, s[8:11], s34 offen
    s_mov_b32 s34, 81920
    buffer_load_dword v22, v1, s[8:11], s34 offen
    s_mov_b32 s34, 90112
    buffer_load_dword v23, v1, s[8:11], s34 offen
    s_mov_b32 s34, 262144
    buffer_load_dword v24, v1, s[8:11], s34 offen
    s_mov_b32 s34, 270336
    buffer_load_dword v25, v1, s[8:11], s34 offen
    s_mov_b32 s34, 327680
    buffer_load_dword v26, v1, s[8:11], s34 offen
    s_mov_b32 s34, 335872
    buffer_load_dword v27, v1, s[8:11], s34 offen
    s_mov_b32 s34, 278528
    buffer_load_dword v28, v1, s[8:11], s34 offen
    s_mov_b32 s34, 286720
    buffer_load_dword v29, v1, s[8:11], s34 offen
    s_mov_b32 s34, 344064
    buffer_load_dword v30, v1, s[8:11], s34 offen
    s_mov_b32 s34, 352256
    buffer_load_dword v31, v1, s[8:11], s34 offen
    s_mov_b32 s34, 524288
    buffer_load_dword v32, v1, s[8:11], s34 offen
    s_mov_b32 s34, 532480
    buffer_load_dword v33, v1, s[8:11], s34 offen
    s_mov_b32 s34, 589824
    buffer_load_dword v34, v1, s[8:11], s34 offen
    s_mov_b32 s34, 598016
    buffer_load_dword v35, v1, s[8:11], s34 offen
    s_mov_b32 s34, 540672
    buffer_load_dword v36, v1, s[8:11], s34 offen
    s_mov_b32 s34, 548864
    buffer_load_dword v37, v1, s[8:11], s34 offen
    s_mov_b32 s34, 606208
    buffer_load_dword v38, v1, s[8:11], s34 offen
    s_mov_b32 s34, 614400
    buffer_load_dword v39, v1, s[8:11], s34 offen
    s_mov_b32 s34, 786432
    buffer_load_dword v40, v1, s[8:11], s34 offen
    s_mov_b32 s34, 794624
    buffer_load_dword v41, v1, s[8:11], s34 offen
    s_mov_b32 s34, 851968
    buffer_load_dword v42, v1, s[8:11], s34 offen
    s_mov_b32 s34, 860160
    buffer_load_dword v43, v1, s[8:11], s34 offen
    s_mov_b32 s34, 802816
    buffer_load_dword v44, v1, s[8:11], s34 offen
    s_mov_b32 s34, 811008
    buffer_load_dword v45, v1, s[8:11], s34 offen
    s_mov_b32 s34, 868352
    buffer_load_dword v46, v1, s[8:11], s34 offen
    s_mov_b32 s34, 876544
    buffer_load_dword v47, v1, s[8:11], s34 offen
    s_mov_b32 s34, 1048576
    buffer_load_dword v48, v1, s[8:11], s34 offen
    s_mov_b32 s34, 1056768
    buffer_load_dword v49, v1, s[8:11], s34 offen
    s_mov_b32 s34, 1114112
    buffer_load_dword v50, v1, s[8:11], s34 offen
    s_mov_b32 s34, 1122304
    buffer_load_dword v51, v1, s[8:11], s34 offen
    s_mov_b32 s34, 1064960
    buffer_load_dword v52, v1, s[8:11], s34 offen
    s_mov_b32 s34, 1073152
    buffer_load_dword v53, v1, s[8:11], s34 offen
    s_mov_b32 s34, 1130496
    buffer_load_dword v54, v1, s[8:11], s34 offen
    s_mov_b32 s34, 1138688
    buffer_load_dword v55, v1, s[8:11], s34 offen
    s_mov_b32 s34, 1310720
    buffer_load_dword v56, v1, s[8:11], s34 offen
    s_mov_b32 s34, 1318912
    buffer_load_dword v57, v1, s[8:11], s34 offen
    s_mov_b32 s34, 1376256
    buffer_load_dword v58, v1, s[8:11], s34 offen
    s_mov_b32 s34, 1384448
    buffer_load_dword v59, v1, s[8:11], s34 offen
    s_mov_b32 s34, 1327104
    buffer_load_dword v60, v1, s[8:11], s34 offen
    s_mov_b32 s34, 1335296
    buffer_load_dword v61, v1, s[8:11], s34 offen
    s_mov_b32 s34, 1392640
    buffer_load_dword v62, v1, s[8:11], s34 offen
    s_mov_b32 s34, 1400832
    buffer_load_dword v63, v1, s[8:11], s34 offen
    s_waitcnt vmcnt(32)
    s_barrier
    v_perm_b32 v4, v17, v16, s38
    v_accvgpr_write_b32 a0, v4
    v_perm_b32 v5, v19, v18, s38
    v_accvgpr_write_b32 a1, v5
    v_perm_b32 v6, v21, v20, s38
    v_accvgpr_write_b32 a2, v6
    v_perm_b32 v7, v23, v22, s38
    v_accvgpr_write_b32 a3, v7
    v_perm_b32 v4, v25, v24, s38
    v_accvgpr_write_b32 a4, v4
    v_perm_b32 v5, v27, v26, s38
    v_accvgpr_write_b32 a5, v5
    v_perm_b32 v6, v29, v28, s38
    v_accvgpr_write_b32 a6, v6
    v_perm_b32 v7, v31, v30, s38
    v_accvgpr_write_b32 a7, v7
    v_perm_b32 v4, v17, v16, s39
    v_accvgpr_write_b32 a8, v4
    v_perm_b32 v5, v19, v18, s39
    v_accvgpr_write_b32 a9, v5
    v_perm_b32 v6, v21, v20, s39
    v_accvgpr_write_b32 a10, v6
    v_perm_b32 v7, v23, v22, s39
    v_accvgpr_write_b32 a11, v7
    v_perm_b32 v4, v25, v24, s39
    v_accvgpr_write_b32 a12, v4
    v_perm_b32 v5, v27, v26, s39
    v_accvgpr_write_b32 a13, v5
    v_perm_b32 v6, v29, v28, s39
    v_accvgpr_write_b32 a14, v6
    v_perm_b32 v7, v31, v30, s39
    v_accvgpr_write_b32 a15, v7
    s_mov_b32 s34, 1572864
    buffer_load_dword v16, v1, s[8:11], s34 offen
    s_mov_b32 s34, 1581056
    buffer_load_dword v17, v1, s[8:11], s34 offen
    s_mov_b32 s34, 1638400
    buffer_load_dword v18, v1, s[8:11], s34 offen
    s_mov_b32 s34, 1646592
    buffer_load_dword v19, v1, s[8:11], s34 offen
    s_mov_b32 s34, 1589248
    buffer_load_dword v20, v1, s[8:11], s34 offen
    s_mov_b32 s34, 1597440
    buffer_load_dword v21, v1, s[8:11], s34 offen
    s_mov_b32 s34, 1654784
    buffer_load_dword v22, v1, s[8:11], s34 offen
    s_mov_b32 s34, 1662976
    buffer_load_dword v23, v1, s[8:11], s34 offen
    s_mov_b32 s34, 1835008
    buffer_load_dword v24, v1, s[8:11], s34 offen
    s_mov_b32 s34, 1843200
    buffer_load_dword v25, v1, s[8:11], s34 offen
    s_mov_b32 s34, 1900544
    buffer_load_dword v26, v1, s[8:11], s34 offen
    s_mov_b32 s34, 1908736
    buffer_load_dword v27, v1, s[8:11], s34 offen
    s_mov_b32 s34, 1851392
    buffer_load_dword v28, v1, s[8:11], s34 offen
    s_mov_b32 s34, 1859584
    buffer_load_dword v29, v1, s[8:11], s34 offen
    s_mov_b32 s34, 1916928
    buffer_load_dword v30, v1, s[8:11], s34 offen
    s_mov_b32 s34, 1925120
    buffer_load_dword v31, v1, s[8:11], s34 offen
    s_waitcnt vmcnt(32)
    s_barrier
    v_perm_b32 v4, v33, v32, s38
    v_accvgpr_write_b32 a16, v4
    v_perm_b32 v5, v35, v34, s38
    v_accvgpr_write_b32 a17, v5
    v_perm_b32 v6, v37, v36, s38
    v_accvgpr_write_b32 a18, v6
    v_perm_b32 v7, v39, v38, s38
    v_accvgpr_write_b32 a19, v7
    v_perm_b32 v4, v41, v40, s38
    v_accvgpr_write_b32 a20, v4
    v_perm_b32 v5, v43, v42, s38
    v_accvgpr_write_b32 a21, v5
    v_perm_b32 v6, v45, v44, s38
    v_accvgpr_write_b32 a22, v6
    v_perm_b32 v7, v47, v46, s38
    v_accvgpr_write_b32 a23, v7
    v_perm_b32 v4, v33, v32, s39
    v_accvgpr_write_b32 a24, v4
    v_perm_b32 v5, v35, v34, s39
    v_accvgpr_write_b32 a25, v5
    v_perm_b32 v6, v37, v36, s39
    v_accvgpr_write_b32 a26, v6
    v_perm_b32 v7, v39, v38, s39
    v_accvgpr_write_b32 a27, v7
    v_perm_b32 v4, v41, v40, s39
    v_accvgpr_write_b32 a28, v4
    v_perm_b32 v5, v43, v42, s39
    v_accvgpr_write_b32 a29, v5
    v_perm_b32 v6, v45, v44, s39
    v_accvgpr_write_b32 a30, v6
    v_perm_b32 v7, v47, v46, s39
    v_accvgpr_write_b32 a31, v7
    s_mov_b32 s34, 2097152
    buffer_load_dword v32, v1, s[8:11], s34 offen
    s_mov_b32 s34, 2105344
    buffer_load_dword v33, v1, s[8:11], s34 offen
    s_mov_b32 s34, 2162688
    buffer_load_dword v34, v1, s[8:11], s34 offen
    s_mov_b32 s34, 2170880
    buffer_load_dword v35, v1, s[8:11], s34 offen
    s_mov_b32 s34, 2113536
    buffer_load_dword v36, v1, s[8:11], s34 offen
    s_mov_b32 s34, 2121728
    buffer_load_dword v37, v1, s[8:11], s34 offen
    s_mov_b32 s34, 2179072
    buffer_load_dword v38, v1, s[8:11], s34 offen
    s_mov_b32 s34, 2187264
    buffer_load_dword v39, v1, s[8:11], s34 offen
    s_mov_b32 s34, 2359296
    buffer_load_dword v40, v1, s[8:11], s34 offen
    s_mov_b32 s34, 2367488
    buffer_load_dword v41, v1, s[8:11], s34 offen
    s_mov_b32 s34, 2424832
    buffer_load_dword v42, v1, s[8:11], s34 offen
    s_mov_b32 s34, 2433024
    buffer_load_dword v43, v1, s[8:11], s34 offen
    s_mov_b32 s34, 2375680
    buffer_load_dword v44, v1, s[8:11], s34 offen
    s_mov_b32 s34, 2383872
    buffer_load_dword v45, v1, s[8:11], s34 offen
    s_mov_b32 s34, 2441216
    buffer_load_dword v46, v1, s[8:11], s34 offen
    s_mov_b32 s34, 2449408
    buffer_load_dword v47, v1, s[8:11], s34 offen
    s_waitcnt vmcnt(32)
    s_barrier
    v_perm_b32 v4, v49, v48, s38
    v_accvgpr_write_b32 a32, v4
    v_perm_b32 v5, v51, v50, s38
    v_accvgpr_write_b32 a33, v5
    v_perm_b32 v6, v53, v52, s38
    v_accvgpr_write_b32 a34, v6
    v_perm_b32 v7, v55, v54, s38
    v_accvgpr_write_b32 a35, v7
    v_perm_b32 v4, v57, v56, s38
    v_accvgpr_write_b32 a36, v4
    v_perm_b32 v5, v59, v58, s38
    v_accvgpr_write_b32 a37, v5
    v_perm_b32 v6, v61, v60, s38
    v_accvgpr_write_b32 a38, v6
    v_perm_b32 v7, v63, v62, s38
    v_accvgpr_write_b32 a39, v7
    v_perm_b32 v4, v49, v48, s39
    v_accvgpr_write_b32 a40, v4
    v_perm_b32 v5, v51, v50, s39
    v_accvgpr_write_b32 a41, v5
    v_perm_b32 v6, v53, v52, s39
    v_accvgpr_write_b32 a42, v6
    v_perm_b32 v7, v55, v54, s39
    v_accvgpr_write_b32 a43, v7
    v_perm_b32 v4, v57, v56, s39
    v_accvgpr_write_b32 a44, v4
    v_perm_b32 v5, v59, v58, s39
    v_accvgpr_write_b32 a45, v5
    v_perm_b32 v6, v61, v60, s39
    v_accvgpr_write_b32 a46, v6
    v_perm_b32 v7, v63, v62, s39
    v_accvgpr_write_b32 a47, v7
    s_mov_b32 s34, 2621440
    buffer_load_dword v48, v1, s[8:11], s34 offen
    s_mov_b32 s34, 2629632
    buffer_load_dword v49, v1, s[8:11], s34 offen
    s_mov_b32 s34, 2686976
    buffer_load_dword v50, v1, s[8:11], s34 offen
    s_mov_b32 s34, 2695168
    buffer_load_dword v51, v1, s[8:11], s34 offen
    s_mov_b32 s34, 2637824
    buffer_load_dword v52, v1, s[8:11], s34 offen
    s_mov_b32 s34, 2646016
    buffer_load_dword v53, v1, s[8:11], s34 offen
    s_mov_b32 s34, 2703360
    buffer_load_dword v54, v1, s[8:11], s34 offen
    s_mov_b32 s34, 2711552
    buffer_load_dword v55, v1, s[8:11], s34 offen
    s_mov_b32 s34, 2883584
    buffer_load_dword v56, v1, s[8:11], s34 offen
    s_mov_b32 s34, 2891776
    buffer_load_dword v57, v1, s[8:11], s34 offen
    s_mov_b32 s34, 2949120
    buffer_load_dword v58, v1, s[8:11], s34 offen
    s_mov_b32 s34, 2957312
    buffer_load_dword v59, v1, s[8:11], s34 offen
    s_mov_b32 s34, 2899968
    buffer_load_dword v60, v1, s[8:11], s34 offen
    s_mov_b32 s34, 2908160
    buffer_load_dword v61, v1, s[8:11], s34 offen
    s_mov_b32 s34, 2965504
    buffer_load_dword v62, v1, s[8:11], s34 offen
    s_mov_b32 s34, 2973696
    buffer_load_dword v63, v1, s[8:11], s34 offen
    s_waitcnt vmcnt(32)
    s_barrier
    v_perm_b32 v4, v17, v16, s38
    v_accvgpr_write_b32 a48, v4
    v_perm_b32 v5, v19, v18, s38
    v_accvgpr_write_b32 a49, v5
    v_perm_b32 v6, v21, v20, s38
    v_accvgpr_write_b32 a50, v6
    v_perm_b32 v7, v23, v22, s38
    v_accvgpr_write_b32 a51, v7
    v_perm_b32 v4, v25, v24, s38
    v_accvgpr_write_b32 a52, v4
    v_perm_b32 v5, v27, v26, s38
    v_accvgpr_write_b32 a53, v5
    v_perm_b32 v6, v29, v28, s38
    v_accvgpr_write_b32 a54, v6
    v_perm_b32 v7, v31, v30, s38
    v_accvgpr_write_b32 a55, v7
    v_perm_b32 v4, v17, v16, s39
    v_accvgpr_write_b32 a56, v4
    v_perm_b32 v5, v19, v18, s39
    v_accvgpr_write_b32 a57, v5
    v_perm_b32 v6, v21, v20, s39
    v_accvgpr_write_b32 a58, v6
    v_perm_b32 v7, v23, v22, s39
    v_accvgpr_write_b32 a59, v7
    v_perm_b32 v4, v25, v24, s39
    v_accvgpr_write_b32 a60, v4
    v_perm_b32 v5, v27, v26, s39
    v_accvgpr_write_b32 a61, v5
    v_perm_b32 v6, v29, v28, s39
    v_accvgpr_write_b32 a62, v6
    v_perm_b32 v7, v31, v30, s39
    v_accvgpr_write_b32 a63, v7
    s_mov_b32 s34, 3145728
    buffer_load_dword v16, v1, s[8:11], s34 offen
    s_mov_b32 s34, 3153920
    buffer_load_dword v17, v1, s[8:11], s34 offen
    s_mov_b32 s34, 3211264
    buffer_load_dword v18, v1, s[8:11], s34 offen
    s_mov_b32 s34, 3219456
    buffer_load_dword v19, v1, s[8:11], s34 offen
    s_mov_b32 s34, 3162112
    buffer_load_dword v20, v1, s[8:11], s34 offen
    s_mov_b32 s34, 3170304
    buffer_load_dword v21, v1, s[8:11], s34 offen
    s_mov_b32 s34, 3227648
    buffer_load_dword v22, v1, s[8:11], s34 offen
    s_mov_b32 s34, 3235840
    buffer_load_dword v23, v1, s[8:11], s34 offen
    s_mov_b32 s34, 3407872
    buffer_load_dword v24, v1, s[8:11], s34 offen
    s_mov_b32 s34, 3416064
    buffer_load_dword v25, v1, s[8:11], s34 offen
    s_mov_b32 s34, 3473408
    buffer_load_dword v26, v1, s[8:11], s34 offen
    s_mov_b32 s34, 3481600
    buffer_load_dword v27, v1, s[8:11], s34 offen
    s_mov_b32 s34, 3424256
    buffer_load_dword v28, v1, s[8:11], s34 offen
    s_mov_b32 s34, 3432448
    buffer_load_dword v29, v1, s[8:11], s34 offen
    s_mov_b32 s34, 3489792
    buffer_load_dword v30, v1, s[8:11], s34 offen
    s_mov_b32 s34, 3497984
    buffer_load_dword v31, v1, s[8:11], s34 offen
    s_waitcnt vmcnt(32)
    s_barrier
    v_perm_b32 v4, v33, v32, s38
    v_accvgpr_write_b32 a64, v4
    v_perm_b32 v5, v35, v34, s38
    v_accvgpr_write_b32 a65, v5
    v_perm_b32 v6, v37, v36, s38
    v_accvgpr_write_b32 a66, v6
    v_perm_b32 v7, v39, v38, s38
    v_accvgpr_write_b32 a67, v7
    v_perm_b32 v4, v41, v40, s38
    v_accvgpr_write_b32 a68, v4
    v_perm_b32 v5, v43, v42, s38
    v_accvgpr_write_b32 a69, v5
    v_perm_b32 v6, v45, v44, s38
    v_accvgpr_write_b32 a70, v6
    v_perm_b32 v7, v47, v46, s38
    v_accvgpr_write_b32 a71, v7
    v_perm_b32 v4, v33, v32, s39
    v_accvgpr_write_b32 a72, v4
    v_perm_b32 v5, v35, v34, s39
    v_accvgpr_write_b32 a73, v5
    v_perm_b32 v6, v37, v36, s39
    v_accvgpr_write_b32 a74, v6
    v_perm_b32 v7, v39, v38, s39
    v_accvgpr_write_b32 a75, v7
    v_perm_b32 v4, v41, v40, s39
    v_accvgpr_write_b32 a76, v4
    v_perm_b32 v5, v43, v42, s39
    v_accvgpr_write_b32 a77, v5
    v_perm_b32 v6, v45, v44, s39
    v_accvgpr_write_b32 a78, v6
    v_perm_b32 v7, v47, v46, s39
    v_accvgpr_write_b32 a79, v7
    s_mov_b32 s34, 3670016
    buffer_load_dword v32, v1, s[8:11], s34 offen
    s_mov_b32 s34, 3678208
    buffer_load_dword v33, v1, s[8:11], s34 offen
    s_mov_b32 s34, 3735552
    buffer_load_dword v34, v1, s[8:11], s34 offen
    s_mov_b32 s34, 3743744
    buffer_load_dword v35, v1, s[8:11], s34 offen
    s_mov_b32 s34, 3686400
    buffer_load_dword v36, v1, s[8:11], s34 offen
    s_mov_b32 s34, 3694592
    buffer_load_dword v37, v1, s[8:11], s34 offen
    s_mov_b32 s34, 3751936
    buffer_load_dword v38, v1, s[8:11], s34 offen
    s_mov_b32 s34, 3760128
    buffer_load_dword v39, v1, s[8:11], s34 offen
    s_mov_b32 s34, 3932160
    buffer_load_dword v40, v1, s[8:11], s34 offen
    s_mov_b32 s34, 3940352
    buffer_load_dword v41, v1, s[8:11], s34 offen
    s_mov_b32 s34, 3997696
    buffer_load_dword v42, v1, s[8:11], s34 offen
    s_mov_b32 s34, 4005888
    buffer_load_dword v43, v1, s[8:11], s34 offen
    s_mov_b32 s34, 3948544
    buffer_load_dword v44, v1, s[8:11], s34 offen
    s_mov_b32 s34, 3956736
    buffer_load_dword v45, v1, s[8:11], s34 offen
    s_mov_b32 s34, 4014080
    buffer_load_dword v46, v1, s[8:11], s34 offen
    s_mov_b32 s34, 4022272
    buffer_load_dword v47, v1, s[8:11], s34 offen
    s_waitcnt vmcnt(32)
    s_barrier
    v_perm_b32 v4, v49, v48, s38
    v_accvgpr_write_b32 a80, v4
    v_perm_b32 v5, v51, v50, s38
    v_accvgpr_write_b32 a81, v5
    v_perm_b32 v6, v53, v52, s38
    v_accvgpr_write_b32 a82, v6
    v_perm_b32 v7, v55, v54, s38
    v_accvgpr_write_b32 a83, v7
    v_perm_b32 v4, v57, v56, s38
    v_accvgpr_write_b32 a84, v4
    v_perm_b32 v5, v59, v58, s38
    v_accvgpr_write_b32 a85, v5
    v_perm_b32 v6, v61, v60, s38
    v_accvgpr_write_b32 a86, v6
    v_perm_b32 v7, v63, v62, s38
    v_accvgpr_write_b32 a87, v7
    v_perm_b32 v4, v49, v48, s39
    v_accvgpr_write_b32 a88, v4
    v_perm_b32 v5, v51, v50, s39
    v_accvgpr_write_b32 a89, v5
    v_perm_b32 v6, v53, v52, s39
    v_accvgpr_write_b32 a90, v6
    v_perm_b32 v7, v55, v54, s39
    v_accvgpr_write_b32 a91, v7
    v_perm_b32 v4, v57, v56, s39
    v_accvgpr_write_b32 a92, v4
    v_perm_b32 v5, v59, v58, s39
    v_accvgpr_write_b32 a93, v5
    v_perm_b32 v6, v61, v60, s39
    v_accvgpr_write_b32 a94, v6
    v_perm_b32 v7, v63, v62, s39
    v_accvgpr_write_b32 a95, v7
    s_mov_b32 s34, 4194304
    buffer_load_dword v48, v1, s[8:11], s34 offen
    s_mov_b32 s34, 4202496
    buffer_load_dword v49, v1, s[8:11], s34 offen
    s_mov_b32 s34, 4259840
    buffer_load_dword v50, v1, s[8:11], s34 offen
    s_mov_b32 s34, 4268032
    buffer_load_dword v51, v1, s[8:11], s34 offen
    s_mov_b32 s34, 4210688
    buffer_load_dword v52, v1, s[8:11], s34 offen
    s_mov_b32 s34, 4218880
    buffer_load_dword v53, v1, s[8:11], s34 offen
    s_mov_b32 s34, 4276224
    buffer_load_dword v54, v1, s[8:11], s34 offen
    s_mov_b32 s34, 4284416
    buffer_load_dword v55, v1, s[8:11], s34 offen
    s_mov_b32 s34, 4456448
    buffer_load_dword v56, v1, s[8:11], s34 offen
    s_mov_b32 s34, 4464640
    buffer_load_dword v57, v1, s[8:11], s34 offen
    s_mov_b32 s34, 4521984
    buffer_load_dword v58, v1, s[8:11], s34 offen
    s_mov_b32 s34, 4530176
    buffer_load_dword v59, v1, s[8:11], s34 offen
    s_mov_b32 s34, 4472832
    buffer_load_dword v60, v1, s[8:11], s34 offen
    s_mov_b32 s34, 4481024
    buffer_load_dword v61, v1, s[8:11], s34 offen
    s_mov_b32 s34, 4538368
    buffer_load_dword v62, v1, s[8:11], s34 offen
    s_mov_b32 s34, 4546560
    buffer_load_dword v63, v1, s[8:11], s34 offen
    s_waitcnt vmcnt(32)
    s_barrier
    v_perm_b32 v4, v17, v16, s38
    v_accvgpr_write_b32 a96, v4
    v_perm_b32 v5, v19, v18, s38
    v_accvgpr_write_b32 a97, v5
    v_perm_b32 v6, v21, v20, s38
    v_accvgpr_write_b32 a98, v6
    v_perm_b32 v7, v23, v22, s38
    v_accvgpr_write_b32 a99, v7
    v_perm_b32 v4, v25, v24, s38
    v_accvgpr_write_b32 a100, v4
    v_perm_b32 v5, v27, v26, s38
    v_accvgpr_write_b32 a101, v5
    v_perm_b32 v6, v29, v28, s38
    v_accvgpr_write_b32 a102, v6
    v_perm_b32 v7, v31, v30, s38
    v_accvgpr_write_b32 a103, v7
    v_perm_b32 v4, v17, v16, s39
    v_accvgpr_write_b32 a104, v4
    v_perm_b32 v5, v19, v18, s39
    v_accvgpr_write_b32 a105, v5
    v_perm_b32 v6, v21, v20, s39
    v_accvgpr_write_b32 a106, v6
    v_perm_b32 v7, v23, v22, s39
    v_accvgpr_write_b32 a107, v7
    v_perm_b32 v4, v25, v24, s39
    v_accvgpr_write_b32 a108, v4
    v_perm_b32 v5, v27, v26, s39
    v_accvgpr_write_b32 a109, v5
    v_perm_b32 v6, v29, v28, s39
    v_accvgpr_write_b32 a110, v6
    v_perm_b32 v7, v31, v30, s39
    v_accvgpr_write_b32 a111, v7
    s_mov_b32 s34, 4718592
    buffer_load_dword v16, v1, s[8:11], s34 offen
    s_mov_b32 s34, 4726784
    buffer_load_dword v17, v1, s[8:11], s34 offen
    s_mov_b32 s34, 4784128
    buffer_load_dword v18, v1, s[8:11], s34 offen
    s_mov_b32 s34, 4792320
    buffer_load_dword v19, v1, s[8:11], s34 offen
    s_mov_b32 s34, 4734976
    buffer_load_dword v20, v1, s[8:11], s34 offen
    s_mov_b32 s34, 4743168
    buffer_load_dword v21, v1, s[8:11], s34 offen
    s_mov_b32 s34, 4800512
    buffer_load_dword v22, v1, s[8:11], s34 offen
    s_mov_b32 s34, 4808704
    buffer_load_dword v23, v1, s[8:11], s34 offen
    s_mov_b32 s34, 4980736
    buffer_load_dword v24, v1, s[8:11], s34 offen
    s_mov_b32 s34, 4988928
    buffer_load_dword v25, v1, s[8:11], s34 offen
    s_mov_b32 s34, 5046272
    buffer_load_dword v26, v1, s[8:11], s34 offen
    s_mov_b32 s34, 5054464
    buffer_load_dword v27, v1, s[8:11], s34 offen
    s_mov_b32 s34, 4997120
    buffer_load_dword v28, v1, s[8:11], s34 offen
    s_mov_b32 s34, 5005312
    buffer_load_dword v29, v1, s[8:11], s34 offen
    s_mov_b32 s34, 5062656
    buffer_load_dword v30, v1, s[8:11], s34 offen
    s_mov_b32 s34, 5070848
    buffer_load_dword v31, v1, s[8:11], s34 offen
    s_waitcnt vmcnt(32)
    s_barrier
    v_perm_b32 v4, v33, v32, s38
    v_accvgpr_write_b32 a112, v4
    v_perm_b32 v5, v35, v34, s38
    v_accvgpr_write_b32 a113, v5
    v_perm_b32 v6, v37, v36, s38
    v_accvgpr_write_b32 a114, v6
    v_perm_b32 v7, v39, v38, s38
    v_accvgpr_write_b32 a115, v7
    v_perm_b32 v4, v41, v40, s38
    v_accvgpr_write_b32 a116, v4
    v_perm_b32 v5, v43, v42, s38
    v_accvgpr_write_b32 a117, v5
    v_perm_b32 v6, v45, v44, s38
    v_accvgpr_write_b32 a118, v6
    v_perm_b32 v7, v47, v46, s38
    v_accvgpr_write_b32 a119, v7
    v_perm_b32 v4, v33, v32, s39
    v_accvgpr_write_b32 a120, v4
    v_perm_b32 v5, v35, v34, s39
    v_accvgpr_write_b32 a121, v5
    v_perm_b32 v6, v37, v36, s39
    v_accvgpr_write_b32 a122, v6
    v_perm_b32 v7, v39, v38, s39
    v_accvgpr_write_b32 a123, v7
    v_perm_b32 v4, v41, v40, s39
    v_accvgpr_write_b32 a124, v4
    v_perm_b32 v5, v43, v42, s39
    v_accvgpr_write_b32 a125, v5
    v_perm_b32 v6, v45, v44, s39
    v_accvgpr_write_b32 a126, v6
    v_perm_b32 v7, v47, v46, s39
    v_accvgpr_write_b32 a127, v7
    s_mov_b32 s8, s44
    s_mov_b32 s9, s45
    s_mov_b32 s34, 0
    buffer_load_dword v32, v1, s[8:11], s34 offen
    s_mov_b32 s34, 8192
    buffer_load_dword v33, v1, s[8:11], s34 offen
    s_mov_b32 s34, 65536
    buffer_load_dword v34, v1, s[8:11], s34 offen
    s_mov_b32 s34, 73728
    buffer_load_dword v35, v1, s[8:11], s34 offen
    s_mov_b32 s34, 16384
    buffer_load_dword v36, v1, s[8:11], s34 offen
    s_mov_b32 s34, 24576
    buffer_load_dword v37, v1, s[8:11], s34 offen
    s_mov_b32 s34, 81920
    buffer_load_dword v38, v1, s[8:11], s34 offen
    s_mov_b32 s34, 90112
    buffer_load_dword v39, v1, s[8:11], s34 offen
    s_mov_b32 s34, 262144
    buffer_load_dword v40, v1, s[8:11], s34 offen
    s_mov_b32 s34, 270336
    buffer_load_dword v41, v1, s[8:11], s34 offen
    s_mov_b32 s34, 327680
    buffer_load_dword v42, v1, s[8:11], s34 offen
    s_mov_b32 s34, 335872
    buffer_load_dword v43, v1, s[8:11], s34 offen
    s_mov_b32 s34, 278528
    buffer_load_dword v44, v1, s[8:11], s34 offen
    s_mov_b32 s34, 286720
    buffer_load_dword v45, v1, s[8:11], s34 offen
    s_mov_b32 s34, 344064
    buffer_load_dword v46, v1, s[8:11], s34 offen
    s_mov_b32 s34, 352256
    buffer_load_dword v47, v1, s[8:11], s34 offen
    s_waitcnt vmcnt(32)
    s_barrier
    v_perm_b32 v4, v49, v48, s38
    v_accvgpr_write_b32 a128, v4
    v_perm_b32 v5, v51, v50, s38
    v_accvgpr_write_b32 a129, v5
    v_perm_b32 v6, v53, v52, s38
    v_accvgpr_write_b32 a130, v6
    v_perm_b32 v7, v55, v54, s38
    v_accvgpr_write_b32 a131, v7
    v_perm_b32 v4, v57, v56, s38
    v_accvgpr_write_b32 a132, v4
    v_perm_b32 v5, v59, v58, s38
    v_accvgpr_write_b32 a133, v5
    v_perm_b32 v6, v61, v60, s38
    v_accvgpr_write_b32 a134, v6
    v_perm_b32 v7, v63, v62, s38
    v_accvgpr_write_b32 a135, v7
    v_perm_b32 v4, v49, v48, s39
    v_accvgpr_write_b32 a136, v4
    v_perm_b32 v5, v51, v50, s39
    v_accvgpr_write_b32 a137, v5
    v_perm_b32 v6, v53, v52, s39
    v_accvgpr_write_b32 a138, v6
    v_perm_b32 v7, v55, v54, s39
    v_accvgpr_write_b32 a139, v7
    v_perm_b32 v4, v57, v56, s39
    v_accvgpr_write_b32 a140, v4
    v_perm_b32 v5, v59, v58, s39
    v_accvgpr_write_b32 a141, v5
    v_perm_b32 v6, v61, v60, s39
    v_accvgpr_write_b32 a142, v6
    v_perm_b32 v7, v63, v62, s39
    v_accvgpr_write_b32 a143, v7
    s_mov_b32 s34, 524288
    buffer_load_dword v48, v1, s[8:11], s34 offen
    s_mov_b32 s34, 532480
    buffer_load_dword v49, v1, s[8:11], s34 offen
    s_mov_b32 s34, 589824
    buffer_load_dword v50, v1, s[8:11], s34 offen
    s_mov_b32 s34, 598016
    buffer_load_dword v51, v1, s[8:11], s34 offen
    s_mov_b32 s34, 540672
    buffer_load_dword v52, v1, s[8:11], s34 offen
    s_mov_b32 s34, 548864
    buffer_load_dword v53, v1, s[8:11], s34 offen
    s_mov_b32 s34, 606208
    buffer_load_dword v54, v1, s[8:11], s34 offen
    s_mov_b32 s34, 614400
    buffer_load_dword v55, v1, s[8:11], s34 offen
    s_mov_b32 s34, 786432
    buffer_load_dword v56, v1, s[8:11], s34 offen
    s_mov_b32 s34, 794624
    buffer_load_dword v57, v1, s[8:11], s34 offen
    s_mov_b32 s34, 851968
    buffer_load_dword v58, v1, s[8:11], s34 offen
    s_mov_b32 s34, 860160
    buffer_load_dword v59, v1, s[8:11], s34 offen
    s_mov_b32 s34, 802816
    buffer_load_dword v60, v1, s[8:11], s34 offen
    s_mov_b32 s34, 811008
    buffer_load_dword v61, v1, s[8:11], s34 offen
    s_mov_b32 s34, 868352
    buffer_load_dword v62, v1, s[8:11], s34 offen
    s_mov_b32 s34, 876544
    buffer_load_dword v63, v1, s[8:11], s34 offen
    s_waitcnt vmcnt(32)
    s_barrier
    v_perm_b32 v4, v17, v16, s38
    v_accvgpr_write_b32 a144, v4
    v_perm_b32 v5, v19, v18, s38
    v_accvgpr_write_b32 a145, v5
    v_perm_b32 v6, v21, v20, s38
    v_accvgpr_write_b32 a146, v6
    v_perm_b32 v7, v23, v22, s38
    v_accvgpr_write_b32 a147, v7
    v_perm_b32 v4, v25, v24, s38
    v_accvgpr_write_b32 a148, v4
    v_perm_b32 v5, v27, v26, s38
    v_accvgpr_write_b32 a149, v5
    v_perm_b32 v6, v29, v28, s38
    v_accvgpr_write_b32 a150, v6
    v_perm_b32 v7, v31, v30, s38
    v_accvgpr_write_b32 a151, v7
    v_perm_b32 v4, v17, v16, s39
    v_accvgpr_write_b32 a152, v4
    v_perm_b32 v5, v19, v18, s39
    v_accvgpr_write_b32 a153, v5
    v_perm_b32 v6, v21, v20, s39
    v_accvgpr_write_b32 a154, v6
    v_perm_b32 v7, v23, v22, s39
    v_accvgpr_write_b32 a155, v7
    v_perm_b32 v4, v25, v24, s39
    v_accvgpr_write_b32 a156, v4
    v_perm_b32 v5, v27, v26, s39
    v_accvgpr_write_b32 a157, v5
    v_perm_b32 v6, v29, v28, s39
    v_accvgpr_write_b32 a158, v6
    v_perm_b32 v7, v31, v30, s39
    v_accvgpr_write_b32 a159, v7
    s_mov_b32 s34, 1048576
    buffer_load_dword v16, v1, s[8:11], s34 offen
    s_mov_b32 s34, 1056768
    buffer_load_dword v17, v1, s[8:11], s34 offen
    s_mov_b32 s34, 1114112
    buffer_load_dword v18, v1, s[8:11], s34 offen
    s_mov_b32 s34, 1122304
    buffer_load_dword v19, v1, s[8:11], s34 offen
    s_mov_b32 s34, 1064960
    buffer_load_dword v20, v1, s[8:11], s34 offen
    s_mov_b32 s34, 1073152
    buffer_load_dword v21, v1, s[8:11], s34 offen
    s_mov_b32 s34, 1130496
    buffer_load_dword v22, v1, s[8:11], s34 offen
    s_mov_b32 s34, 1138688
    buffer_load_dword v23, v1, s[8:11], s34 offen
    s_mov_b32 s34, 1310720
    buffer_load_dword v24, v1, s[8:11], s34 offen
    s_mov_b32 s34, 1318912
    buffer_load_dword v25, v1, s[8:11], s34 offen
    s_mov_b32 s34, 1376256
    buffer_load_dword v26, v1, s[8:11], s34 offen
    s_mov_b32 s34, 1384448
    buffer_load_dword v27, v1, s[8:11], s34 offen
    s_mov_b32 s34, 1327104
    buffer_load_dword v28, v1, s[8:11], s34 offen
    s_mov_b32 s34, 1335296
    buffer_load_dword v29, v1, s[8:11], s34 offen
    s_mov_b32 s34, 1392640
    buffer_load_dword v30, v1, s[8:11], s34 offen
    s_mov_b32 s34, 1400832
    buffer_load_dword v31, v1, s[8:11], s34 offen
    s_waitcnt vmcnt(32)
    s_barrier
    v_perm_b32 v4, v33, v32, s38
    v_accvgpr_write_b32 a160, v4
    v_perm_b32 v5, v35, v34, s38
    v_accvgpr_write_b32 a161, v5
    v_perm_b32 v6, v37, v36, s38
    v_accvgpr_write_b32 a162, v6
    v_perm_b32 v7, v39, v38, s38
    v_accvgpr_write_b32 a163, v7
    v_perm_b32 v4, v41, v40, s38
    v_accvgpr_write_b32 a164, v4
    v_perm_b32 v5, v43, v42, s38
    v_accvgpr_write_b32 a165, v5
    v_perm_b32 v6, v45, v44, s38
    v_accvgpr_write_b32 a166, v6
    v_perm_b32 v7, v47, v46, s38
    v_accvgpr_write_b32 a167, v7
    v_perm_b32 v4, v33, v32, s39
    v_accvgpr_write_b32 a168, v4
    v_perm_b32 v5, v35, v34, s39
    v_accvgpr_write_b32 a169, v5
    v_perm_b32 v6, v37, v36, s39
    v_accvgpr_write_b32 a170, v6
    v_perm_b32 v7, v39, v38, s39
    v_accvgpr_write_b32 a171, v7
    v_perm_b32 v4, v41, v40, s39
    v_accvgpr_write_b32 a172, v4
    v_perm_b32 v5, v43, v42, s39
    v_accvgpr_write_b32 a173, v5
    v_perm_b32 v6, v45, v44, s39
    v_accvgpr_write_b32 a174, v6
    v_perm_b32 v7, v47, v46, s39
    v_accvgpr_write_b32 a175, v7
    s_mov_b32 s34, 1572864
    buffer_load_dword v32, v1, s[8:11], s34 offen
    s_mov_b32 s34, 1581056
    buffer_load_dword v33, v1, s[8:11], s34 offen
    s_mov_b32 s34, 1638400
    buffer_load_dword v34, v1, s[8:11], s34 offen
    s_mov_b32 s34, 1646592
    buffer_load_dword v35, v1, s[8:11], s34 offen
    s_mov_b32 s34, 1589248
    buffer_load_dword v36, v1, s[8:11], s34 offen
    s_mov_b32 s34, 1597440
    buffer_load_dword v37, v1, s[8:11], s34 offen
    s_mov_b32 s34, 1654784
    buffer_load_dword v38, v1, s[8:11], s34 offen
    s_mov_b32 s34, 1662976
    buffer_load_dword v39, v1, s[8:11], s34 offen
    s_mov_b32 s34, 1835008
    buffer_load_dword v40, v1, s[8:11], s34 offen
    s_mov_b32 s34, 1843200
    buffer_load_dword v41, v1, s[8:11], s34 offen
    s_mov_b32 s34, 1900544
    buffer_load_dword v42, v1, s[8:11], s34 offen
    s_mov_b32 s34, 1908736
    buffer_load_dword v43, v1, s[8:11], s34 offen
    s_mov_b32 s34, 1851392
    buffer_load_dword v44, v1, s[8:11], s34 offen
    s_mov_b32 s34, 1859584
    buffer_load_dword v45, v1, s[8:11], s34 offen
    s_mov_b32 s34, 1916928
    buffer_load_dword v46, v1, s[8:11], s34 offen
    s_mov_b32 s34, 1925120
    buffer_load_dword v47, v1, s[8:11], s34 offen
    s_waitcnt vmcnt(32)
    s_barrier
    v_perm_b32 v4, v49, v48, s38
    v_accvgpr_write_b32 a176, v4
    v_perm_b32 v5, v51, v50, s38
    v_accvgpr_write_b32 a177, v5
    v_perm_b32 v6, v53, v52, s38
    v_accvgpr_write_b32 a178, v6
    v_perm_b32 v7, v55, v54, s38
    v_accvgpr_write_b32 a179, v7
    v_perm_b32 v4, v57, v56, s38
    v_accvgpr_write_b32 a180, v4
    v_perm_b32 v5, v59, v58, s38
    v_accvgpr_write_b32 a181, v5
    v_perm_b32 v6, v61, v60, s38
    v_accvgpr_write_b32 a182, v6
    v_perm_b32 v7, v63, v62, s38
    v_accvgpr_write_b32 a183, v7
    v_perm_b32 v4, v49, v48, s39
    v_accvgpr_write_b32 a184, v4
    v_perm_b32 v5, v51, v50, s39
    v_accvgpr_write_b32 a185, v5
    v_perm_b32 v6, v53, v52, s39
    v_accvgpr_write_b32 a186, v6
    v_perm_b32 v7, v55, v54, s39
    v_accvgpr_write_b32 a187, v7
    v_perm_b32 v4, v57, v56, s39
    v_accvgpr_write_b32 a188, v4
    v_perm_b32 v5, v59, v58, s39
    v_accvgpr_write_b32 a189, v5
    v_perm_b32 v6, v61, v60, s39
    v_accvgpr_write_b32 a190, v6
    v_perm_b32 v7, v63, v62, s39
    v_accvgpr_write_b32 a191, v7
    s_mov_b32 s34, 2097152
    buffer_load_dword v48, v1, s[8:11], s34 offen
    s_mov_b32 s34, 2105344
    buffer_load_dword v49, v1, s[8:11], s34 offen
    s_mov_b32 s34, 2162688
    buffer_load_dword v50, v1, s[8:11], s34 offen
    s_mov_b32 s34, 2170880
    buffer_load_dword v51, v1, s[8:11], s34 offen
    s_mov_b32 s34, 2113536
    buffer_load_dword v52, v1, s[8:11], s34 offen
    s_mov_b32 s34, 2121728
    buffer_load_dword v53, v1, s[8:11], s34 offen
    s_mov_b32 s34, 2179072
    buffer_load_dword v54, v1, s[8:11], s34 offen
    s_mov_b32 s34, 2187264
    buffer_load_dword v55, v1, s[8:11], s34 offen
    s_mov_b32 s34, 2359296
    buffer_load_dword v56, v1, s[8:11], s34 offen
    s_mov_b32 s34, 2367488
    buffer_load_dword v57, v1, s[8:11], s34 offen
    s_mov_b32 s34, 2424832
    buffer_load_dword v58, v1, s[8:11], s34 offen
    s_mov_b32 s34, 2433024
    buffer_load_dword v59, v1, s[8:11], s34 offen
    s_mov_b32 s34, 2375680
    buffer_load_dword v60, v1, s[8:11], s34 offen
    s_mov_b32 s34, 2383872
    buffer_load_dword v61, v1, s[8:11], s34 offen
    s_mov_b32 s34, 2441216
    buffer_load_dword v62, v1, s[8:11], s34 offen
    s_mov_b32 s34, 2449408
    buffer_load_dword v63, v1, s[8:11], s34 offen
    s_waitcnt vmcnt(32)
    s_barrier
    v_perm_b32 v4, v17, v16, s38
    v_accvgpr_write_b32 a192, v4
    v_perm_b32 v5, v19, v18, s38
    v_accvgpr_write_b32 a193, v5
    v_perm_b32 v6, v21, v20, s38
    v_accvgpr_write_b32 a194, v6
    v_perm_b32 v7, v23, v22, s38
    v_accvgpr_write_b32 a195, v7
    v_perm_b32 v4, v25, v24, s38
    v_accvgpr_write_b32 a196, v4
    v_perm_b32 v5, v27, v26, s38
    v_accvgpr_write_b32 a197, v5
    v_perm_b32 v6, v29, v28, s38
    v_accvgpr_write_b32 a198, v6
    v_perm_b32 v7, v31, v30, s38
    v_accvgpr_write_b32 a199, v7
    v_perm_b32 v4, v17, v16, s39
    v_accvgpr_write_b32 a200, v4
    v_perm_b32 v5, v19, v18, s39
    v_accvgpr_write_b32 a201, v5
    v_perm_b32 v6, v21, v20, s39
    v_accvgpr_write_b32 a202, v6
    v_perm_b32 v7, v23, v22, s39
    v_accvgpr_write_b32 a203, v7
    v_perm_b32 v4, v25, v24, s39
    v_accvgpr_write_b32 a204, v4
    v_perm_b32 v5, v27, v26, s39
    v_accvgpr_write_b32 a205, v5
    v_perm_b32 v6, v29, v28, s39
    v_accvgpr_write_b32 a206, v6
    v_perm_b32 v7, v31, v30, s39
    v_accvgpr_write_b32 a207, v7
    s_mov_b32 s34, 2621440
    buffer_load_dword v16, v1, s[8:11], s34 offen
    s_mov_b32 s34, 2629632
    buffer_load_dword v17, v1, s[8:11], s34 offen
    s_mov_b32 s34, 2686976
    buffer_load_dword v18, v1, s[8:11], s34 offen
    s_mov_b32 s34, 2695168
    buffer_load_dword v19, v1, s[8:11], s34 offen
    s_mov_b32 s34, 2637824
    buffer_load_dword v20, v1, s[8:11], s34 offen
    s_mov_b32 s34, 2646016
    buffer_load_dword v21, v1, s[8:11], s34 offen
    s_mov_b32 s34, 2703360
    buffer_load_dword v22, v1, s[8:11], s34 offen
    s_mov_b32 s34, 2711552
    buffer_load_dword v23, v1, s[8:11], s34 offen
    s_mov_b32 s34, 2883584
    buffer_load_dword v24, v1, s[8:11], s34 offen
    s_mov_b32 s34, 2891776
    buffer_load_dword v25, v1, s[8:11], s34 offen
    s_mov_b32 s34, 2949120
    buffer_load_dword v26, v1, s[8:11], s34 offen
    s_mov_b32 s34, 2957312
    buffer_load_dword v27, v1, s[8:11], s34 offen
    s_mov_b32 s34, 2899968
    buffer_load_dword v28, v1, s[8:11], s34 offen
    s_mov_b32 s34, 2908160
    buffer_load_dword v29, v1, s[8:11], s34 offen
    s_mov_b32 s34, 2965504
    buffer_load_dword v30, v1, s[8:11], s34 offen
    s_mov_b32 s34, 2973696
    buffer_load_dword v31, v1, s[8:11], s34 offen
    s_waitcnt vmcnt(32)
    s_barrier
    v_perm_b32 v4, v33, v32, s38
    v_accvgpr_write_b32 a208, v4
    v_perm_b32 v5, v35, v34, s38
    v_accvgpr_write_b32 a209, v5
    v_perm_b32 v6, v37, v36, s38
    v_accvgpr_write_b32 a210, v6
    v_perm_b32 v7, v39, v38, s38
    v_accvgpr_write_b32 a211, v7
    v_perm_b32 v4, v41, v40, s38
    v_accvgpr_write_b32 a212, v4
    v_perm_b32 v5, v43, v42, s38
    v_accvgpr_write_b32 a213, v5
    v_perm_b32 v6, v45, v44, s38
    v_accvgpr_write_b32 a214, v6
    v_perm_b32 v7, v47, v46, s38
    v_accvgpr_write_b32 a215, v7
    v_perm_b32 v4, v33, v32, s39
    v_accvgpr_write_b32 a216, v4
    v_perm_b32 v5, v35, v34, s39
    v_accvgpr_write_b32 a217, v5
    v_perm_b32 v6, v37, v36, s39
    v_accvgpr_write_b32 a218, v6
    v_perm_b32 v7, v39, v38, s39
    v_accvgpr_write_b32 a219, v7
    v_perm_b32 v4, v41, v40, s39
    v_accvgpr_write_b32 a220, v4
    v_perm_b32 v5, v43, v42, s39
    v_accvgpr_write_b32 a221, v5
    v_perm_b32 v6, v45, v44, s39
    v_accvgpr_write_b32 a222, v6
    v_perm_b32 v7, v47, v46, s39
    v_accvgpr_write_b32 a223, v7
    s_mov_b32 s34, 3145728
    buffer_load_dword v32, v1, s[8:11], s34 offen
    s_mov_b32 s34, 3153920
    buffer_load_dword v33, v1, s[8:11], s34 offen
    s_mov_b32 s34, 3211264
    buffer_load_dword v34, v1, s[8:11], s34 offen
    s_mov_b32 s34, 3219456
    buffer_load_dword v35, v1, s[8:11], s34 offen
    s_mov_b32 s34, 3162112
    buffer_load_dword v36, v1, s[8:11], s34 offen
    s_mov_b32 s34, 3170304
    buffer_load_dword v37, v1, s[8:11], s34 offen
    s_mov_b32 s34, 3227648
    buffer_load_dword v38, v1, s[8:11], s34 offen
    s_mov_b32 s34, 3235840
    buffer_load_dword v39, v1, s[8:11], s34 offen
    s_mov_b32 s34, 3407872
    buffer_load_dword v40, v1, s[8:11], s34 offen
    s_mov_b32 s34, 3416064
    buffer_load_dword v41, v1, s[8:11], s34 offen
    s_mov_b32 s34, 3473408
    buffer_load_dword v42, v1, s[8:11], s34 offen
    s_mov_b32 s34, 3481600
    buffer_load_dword v43, v1, s[8:11], s34 offen
    s_mov_b32 s34, 3424256
    buffer_load_dword v44, v1, s[8:11], s34 offen
    s_mov_b32 s34, 3432448
    buffer_load_dword v45, v1, s[8:11], s34 offen
    s_mov_b32 s34, 3489792
    buffer_load_dword v46, v1, s[8:11], s34 offen
    s_mov_b32 s34, 3497984
    buffer_load_dword v47, v1, s[8:11], s34 offen
    s_waitcnt vmcnt(32)
    s_barrier
    v_perm_b32 v4, v49, v48, s38
    v_accvgpr_write_b32 a224, v4
    v_perm_b32 v5, v51, v50, s38
    v_accvgpr_write_b32 a225, v5
    v_perm_b32 v6, v53, v52, s38
    v_accvgpr_write_b32 a226, v6
    v_perm_b32 v7, v55, v54, s38
    v_accvgpr_write_b32 a227, v7
    v_perm_b32 v4, v57, v56, s38
    v_accvgpr_write_b32 a228, v4
    v_perm_b32 v5, v59, v58, s38
    v_accvgpr_write_b32 a229, v5
    v_perm_b32 v6, v61, v60, s38
    v_accvgpr_write_b32 a230, v6
    v_perm_b32 v7, v63, v62, s38
    v_accvgpr_write_b32 a231, v7
    v_perm_b32 v4, v49, v48, s39
    v_accvgpr_write_b32 a232, v4
    v_perm_b32 v5, v51, v50, s39
    v_accvgpr_write_b32 a233, v5
    v_perm_b32 v6, v53, v52, s39
    v_accvgpr_write_b32 a234, v6
    v_perm_b32 v7, v55, v54, s39
    v_accvgpr_write_b32 a235, v7
    v_perm_b32 v4, v57, v56, s39
    v_accvgpr_write_b32 a236, v4
    v_perm_b32 v5, v59, v58, s39
    v_accvgpr_write_b32 a237, v5
    v_perm_b32 v6, v61, v60, s39
    v_accvgpr_write_b32 a238, v6
    v_perm_b32 v7, v63, v62, s39
    v_accvgpr_write_b32 a239, v7
    s_mov_b32 s34, 3670016
    buffer_load_dword v48, v1, s[8:11], s34 offen
    s_mov_b32 s34, 3678208
    buffer_load_dword v49, v1, s[8:11], s34 offen
    s_mov_b32 s34, 3735552
    buffer_load_dword v50, v1, s[8:11], s34 offen
    s_mov_b32 s34, 3743744
    buffer_load_dword v51, v1, s[8:11], s34 offen
    s_mov_b32 s34, 3686400
    buffer_load_dword v52, v1, s[8:11], s34 offen
    s_mov_b32 s34, 3694592
    buffer_load_dword v53, v1, s[8:11], s34 offen
    s_mov_b32 s34, 3751936
    buffer_load_dword v54, v1, s[8:11], s34 offen
    s_mov_b32 s34, 3760128
    buffer_load_dword v55, v1, s[8:11], s34 offen
    s_mov_b32 s34, 3932160
    buffer_load_dword v56, v1, s[8:11], s34 offen
    s_mov_b32 s34, 3940352
    buffer_load_dword v57, v1, s[8:11], s34 offen
    s_mov_b32 s34, 3997696
    buffer_load_dword v58, v1, s[8:11], s34 offen
    s_mov_b32 s34, 4005888
    buffer_load_dword v59, v1, s[8:11], s34 offen
    s_mov_b32 s34, 3948544
    buffer_load_dword v60, v1, s[8:11], s34 offen
    s_mov_b32 s34, 3956736
    buffer_load_dword v61, v1, s[8:11], s34 offen
    s_mov_b32 s34, 4014080
    buffer_load_dword v62, v1, s[8:11], s34 offen
    s_mov_b32 s34, 4022272
    buffer_load_dword v63, v1, s[8:11], s34 offen
    s_waitcnt vmcnt(32)
    s_barrier
    v_perm_b32 v4, v17, v16, s38
    v_accvgpr_write_b32 a240, v4
    v_perm_b32 v5, v19, v18, s38
    v_accvgpr_write_b32 a241, v5
    v_perm_b32 v6, v21, v20, s38
    v_accvgpr_write_b32 a242, v6
    v_perm_b32 v7, v23, v22, s38
    v_accvgpr_write_b32 a243, v7
    v_perm_b32 v4, v25, v24, s38
    v_accvgpr_write_b32 a244, v4
    v_perm_b32 v5, v27, v26, s38
    v_accvgpr_write_b32 a245, v5
    v_perm_b32 v6, v29, v28, s38
    v_accvgpr_write_b32 a246, v6
    v_perm_b32 v7, v31, v30, s38
    v_accvgpr_write_b32 a247, v7
    v_perm_b32 v4, v17, v16, s39
    v_accvgpr_write_b32 a248, v4
    v_perm_b32 v5, v19, v18, s39
    v_accvgpr_write_b32 a249, v5
    v_perm_b32 v6, v21, v20, s39
    v_accvgpr_write_b32 a250, v6
    v_perm_b32 v7, v23, v22, s39
    v_accvgpr_write_b32 a251, v7
    v_perm_b32 v4, v25, v24, s39
    v_accvgpr_write_b32 a252, v4
    v_perm_b32 v5, v27, v26, s39
    v_accvgpr_write_b32 a253, v5
    v_perm_b32 v6, v29, v28, s39
    v_accvgpr_write_b32 a254, v6
    v_perm_b32 v7, v31, v30, s39
    v_accvgpr_write_b32 a255, v7
    s_mov_b32 s34, 4194304
    buffer_load_dword v16, v1, s[8:11], s34 offen
    s_mov_b32 s34, 4202496
    buffer_load_dword v17, v1, s[8:11], s34 offen
    s_mov_b32 s34, 4259840
    buffer_load_dword v18, v1, s[8:11], s34 offen
    s_mov_b32 s34, 4268032
    buffer_load_dword v19, v1, s[8:11], s34 offen
    s_mov_b32 s34, 4210688
    buffer_load_dword v20, v1, s[8:11], s34 offen
    s_mov_b32 s34, 4218880
    buffer_load_dword v21, v1, s[8:11], s34 offen
    s_mov_b32 s34, 4276224
    buffer_load_dword v22, v1, s[8:11], s34 offen
    s_mov_b32 s34, 4284416
    buffer_load_dword v23, v1, s[8:11], s34 offen
    s_mov_b32 s34, 4456448
    buffer_load_dword v24, v1, s[8:11], s34 offen
    s_mov_b32 s34, 4464640
    buffer_load_dword v25, v1, s[8:11], s34 offen
    s_mov_b32 s34, 4521984
    buffer_load_dword v26, v1, s[8:11], s34 offen
    s_mov_b32 s34, 4530176
    buffer_load_dword v27, v1, s[8:11], s34 offen
    s_mov_b32 s34, 4472832
    buffer_load_dword v28, v1, s[8:11], s34 offen
    s_mov_b32 s34, 4481024
    buffer_load_dword v29, v1, s[8:11], s34 offen
    s_mov_b32 s34, 4538368
    buffer_load_dword v30, v1, s[8:11], s34 offen
    s_mov_b32 s34, 4546560
    buffer_load_dword v31, v1, s[8:11], s34 offen
    s_waitcnt vmcnt(32)
    s_barrier
    v_perm_b32 v192, v33, v32, s38
    v_perm_b32 v193, v35, v34, s38
    v_perm_b32 v194, v37, v36, s38
    v_perm_b32 v195, v39, v38, s38
    v_perm_b32 v196, v41, v40, s38
    v_perm_b32 v197, v43, v42, s38
    v_perm_b32 v198, v45, v44, s38
    v_perm_b32 v199, v47, v46, s38
    v_perm_b32 v200, v33, v32, s39
    v_perm_b32 v201, v35, v34, s39
    v_perm_b32 v202, v37, v36, s39
    v_perm_b32 v203, v39, v38, s39
    v_perm_b32 v204, v41, v40, s39
    v_perm_b32 v205, v43, v42, s39
    v_perm_b32 v206, v45, v44, s39
    v_perm_b32 v207, v47, v46, s39
    s_mov_b32 s34, 4718592
    buffer_load_dword v32, v1, s[8:11], s34 offen
    s_mov_b32 s34, 4726784
    buffer_load_dword v33, v1, s[8:11], s34 offen
    s_mov_b32 s34, 4784128
    buffer_load_dword v34, v1, s[8:11], s34 offen
    s_mov_b32 s34, 4792320
    buffer_load_dword v35, v1, s[8:11], s34 offen
    s_mov_b32 s34, 4734976
    buffer_load_dword v36, v1, s[8:11], s34 offen
    s_mov_b32 s34, 4743168
    buffer_load_dword v37, v1, s[8:11], s34 offen
    s_mov_b32 s34, 4800512
    buffer_load_dword v38, v1, s[8:11], s34 offen
    s_mov_b32 s34, 4808704
    buffer_load_dword v39, v1, s[8:11], s34 offen
    s_mov_b32 s34, 4980736
    buffer_load_dword v40, v1, s[8:11], s34 offen
    s_mov_b32 s34, 4988928
    buffer_load_dword v41, v1, s[8:11], s34 offen
    s_mov_b32 s34, 5046272
    buffer_load_dword v42, v1, s[8:11], s34 offen
    s_mov_b32 s34, 5054464
    buffer_load_dword v43, v1, s[8:11], s34 offen
    s_mov_b32 s34, 4997120
    buffer_load_dword v44, v1, s[8:11], s34 offen
    s_mov_b32 s34, 5005312
    buffer_load_dword v45, v1, s[8:11], s34 offen
    s_mov_b32 s34, 5062656
    buffer_load_dword v46, v1, s[8:11], s34 offen
    s_mov_b32 s34, 5070848
    buffer_load_dword v47, v1, s[8:11], s34 offen
    s_waitcnt vmcnt(32)
    s_barrier
    v_perm_b32 v208, v49, v48, s38
    v_perm_b32 v209, v51, v50, s38
    v_perm_b32 v210, v53, v52, s38
    v_perm_b32 v211, v55, v54, s38
    v_perm_b32 v212, v57, v56, s38
    v_perm_b32 v213, v59, v58, s38
    v_perm_b32 v214, v61, v60, s38
    v_perm_b32 v215, v63, v62, s38
    v_perm_b32 v216, v49, v48, s39
    v_perm_b32 v217, v51, v50, s39
    v_perm_b32 v218, v53, v52, s39
    v_perm_b32 v219, v55, v54, s39
    v_perm_b32 v220, v57, v56, s39
    v_perm_b32 v221, v59, v58, s39
    v_perm_b32 v222, v61, v60, s39
    v_perm_b32 v223, v63, v62, s39
    s_waitcnt vmcnt(16)
    s_barrier
    v_perm_b32 v224, v17, v16, s38
    v_perm_b32 v225, v19, v18, s38
    v_perm_b32 v226, v21, v20, s38
    v_perm_b32 v227, v23, v22, s38
    v_perm_b32 v228, v25, v24, s38
    v_perm_b32 v229, v27, v26, s38
    v_perm_b32 v230, v29, v28, s38
    v_perm_b32 v231, v31, v30, s38
    v_perm_b32 v232, v17, v16, s39
    v_perm_b32 v233, v19, v18, s39
    v_perm_b32 v234, v21, v20, s39
    v_perm_b32 v235, v23, v22, s39
    v_perm_b32 v236, v25, v24, s39
    v_perm_b32 v237, v27, v26, s39
    v_perm_b32 v238, v29, v28, s39
    v_perm_b32 v239, v31, v30, s39
    s_waitcnt vmcnt(0)
    s_barrier
    v_perm_b32 v240, v33, v32, s38
    v_perm_b32 v241, v35, v34, s38
    v_perm_b32 v242, v37, v36, s38
    v_perm_b32 v243, v39, v38, s38
    v_perm_b32 v244, v41, v40, s38
    v_perm_b32 v245, v43, v42, s38
    v_perm_b32 v246, v45, v44, s38
    v_perm_b32 v247, v47, v46, s38
    v_perm_b32 v248, v33, v32, s39
    v_perm_b32 v249, v35, v34, s39
    v_perm_b32 v250, v37, v36, s39
    v_perm_b32 v251, v39, v38, s39
    v_perm_b32 v252, v41, v40, s39
    v_perm_b32 v253, v43, v42, s39
    v_perm_b32 v254, v45, v44, s39
    v_perm_b32 v255, v47, v46, s39
    v_lshlrev_b32 v0, 4, v15
    v_lshrrev_b32 v12, 5, v15
    v_lshlrev_b32 v1, 9, v12
    v_bfe_u32 v12, v15, 1, 3
    v_lshl_add_u32 v1, v12, 6, v1
    v_bfe_u32 v12, v15, 4, 1
    v_lshl_add_u32 v1, v12, 5, v1
    v_and_b32 v12, 1, v15
    v_lshl_add_u32 v1, v12, 4, v1
    v_mov_b32 v13, 0xaaaa
    v_mul_u32_u24 v2, v12, v13
    v_add_u32 v2, 0x4444, v2
    v_lshrrev_b32 v12, 5, v15
    v_lshlrev_b32 v12, 2, v12
    v_and_b32 v13, 15, v15
    v_xor_b32 v12, v12, v13
    v_lshlrev_b32 v6, 3, v12
    v_lshrrev_b32 v12, 4, v15
    v_lshl_add_u32 v6, v12, 7, v6
    s_lshl_b32 s34, s13, 10
    s_add_u32 s34, s34, 10240
    v_add_u32 v6, s34, v6
    v_bfe_u32 v12, v15, 3, 1
    v_lshlrev_b32 v7, 3, v12
    v_lshrrev_b32 v12, 4, v15
    v_lshl_add_u32 v7, v12, 1, v7
    v_bfe_u32 v12, v15, 2, 1
    v_add_u32 v7, v7, v12
    v_bfe_u32 v12, v15, 1, 1
    v_lshlrev_b32 v12, 2, v12
    v_xor_b32 v7, v7, v12
    v_lshlrev_b32 v7, 3, v7
    v_and_b32 v12, 3, v15
    v_lshl_add_u32 v7, v12, 7, v7
    v_add_u32 v7, 10240, v7
    s_mul_i32 s34, s13, 2560
    v_add_u32 v8, s34, v0
    v_and_b32 v9, 0x1ff, v0
    v_add_u32 v9, s34, v9
    v_lshrrev_b32 v12, 4, v15
    v_lshlrev_b32 v12, 2, v12
    v_and_b32 v13, 15, v15
    v_sub_u32 v3, v13, v12
    s_mov_b32 s96, 0x3e0293ee
    s_mov_b32 s97, 0x3e0293ee
    s_mov_b32 s98, 0x3f803f80
    s_mov_b32 s99, 0x3f803f80
    s_mov_b32 s100, 0x3f003f00
    s_mov_b32 s101, 0x3f003f00
A_seg:
    s_lshl_b32 s34, s25, 7
    s_add_u32 s34, s34, 8192
    v_lshrrev_b32 v12, 9, v0
    v_lshlrev_b32 v10, 13, v12
    v_mul_u32_u24 v12, 2, v12
    v_sub_u32 v12, 32, v12
A_qh:
    buffer_load_dword v11, v10, s[4:7], s34 offen sc1
    s_add_u32 s32, s32, 1
    s_cmp_gt_u32 s32, 0x40000
    s_cbranch_scc1 L_abort
    s_waitcnt vmcnt(0)
    v_cmp_gt_u32 vcc, v12, v11
    s_cbranch_vccz A_qh_ok
    s_sleep 8
    s_branch A_qh
A_qh_ok:
    s_lshl_b32 s34, s25, 5
    s_add_u32 s34, s34, s24
    s_lshl_b32 s34, s34, 13
    s_add_u32 s26, s34, 54525952
    s_add_u32 s36, s26, 4096
    s_add_u32 s27, s34, 20971520
    s_add_u32 s37, s27, 4096
    s_lshl_b32 s35, s13, 11
    s_add_u32 s28, s34, s35
    s_add_u32 s28, s28, 37748736
    buffer_load_dwordx4 v[16:19], v0, s[4:7], s26 offen offset:0 sc1
    buffer_load_dwordx4 v[20:23], v0, s[4:7], s26 offen offset:1024 sc1
    buffer_load_dwordx4 v[24:27], v0, s[4:7], s26 offen offset:2048 sc1
    buffer_load_dwordx4 v[28:31], v0, s[4:7], s26 offen offset:3072 sc1
    buffer_load_dwordx4 v[48:51], v0, s[4:7], s27 offen offset:0 sc1
    buffer_load_dwordx4 v[52:55], v0, s[4:7], s27 offen offset:1024 sc1
    buffer_load_dwordx4 v[56:59], v0, s[4:7], s27 offen offset:2048 sc1
    buffer_load_dwordx4 v[60:63], v0, s[4:7], s27 offen offset:3072 sc1
    buffer_load_dwordx4 v[32:35], v0, s[4:7], s36 offen offset:0 sc1
    buffer_load_dwordx4 v[36:39], v0, s[4:7], s36 offen offset:1024 sc1
    buffer_load_dwordx4 v[40:43], v0, s[4:7], s36 offen offset:2048 sc1
    buffer_load_dwordx4 v[44:47], v0, s[4:7], s36 offen offset:3072 sc1
    buffer_load_dwordx4 v[64:67], v0, s[4:7], s37 offen offset:0 sc1
    buffer_load_dwordx4 v[68:71], v0, s[4:7], s37 offen offset:1024 sc1
    buffer_load_dwordx4 v[72:75], v0, s[4:7], s37 offen offset:2048 sc1
    buffer_load_dwordx4 v[76:79], v0, s[4:7], s37 offen offset:3072 sc1
    buffer_load_dwordx4 v[80:83], v0, s[4:7], s28 offen offset:0 sc1
    buffer_load_dwordx4 v[84:87], v0, s[4:7], s28 offen offset:1024 sc1
    s_mul_i32 s29, s25, 10240
    s_add_u32 s29, s29, 4210688
    s_lshl_b32 s30, s25, 6
    s_add_u32 s30, s30, s24
    s_lshl_b32 s30, s30, 2
    s_add_u32 s30, s30, s13
    s_lshl_b32 s30, s30, 10
    s_add_u32 s30, s30, 71303168
    s_lshl_b32 s31, s25, 2
    s_lshr_b32 s34, s24, 3
    s_add_u32 s31, s31, s34
    s_lshl_b32 s31, s31, 7
    s_add_u32 s31, s31, 3145728
    s_waitcnt vmcnt(10)
    v_mfma_f32_16x16x32_bf16 v[88:91], v[48:51], v[16:19], 0
    v_mfma_f32_16x16x32_bf16 v[88:91], v[52:55], v[20:23], v[88:91]
    v_mfma_f32_16x16x32_bf16 v[88:91], v[56:59], v[24:27], v[88:91]
    v_mfma_f32_16x16x32_bf16 v[88:91], v[60:63], v[28:31], v[88:91]
    s_waitcnt vmcnt(6)
    v_mfma_f32_16x16x32_bf16 v[92:95], v[48:51], v[32:35], 0
    v_mfma_f32_16x16x32_bf16 v[92:95], v[52:55], v[36:39], v[92:95]
    v_mfma_f32_16x16x32_bf16 v[92:95], v[56:59], v[40:43], v[92:95]
    v_mfma_f32_16x16x32_bf16 v[92:95], v[60:63], v[44:47], v[92:95]
    s_waitcnt vmcnt(2)
    v_mfma_f32_16x16x32_bf16 v[96:99], v[64:67], v[32:35], 0
    v_mfma_f32_16x16x32_bf16 v[96:99], v[68:71], v[36:39], v[96:99]
    v_mfma_f32_16x16x32_bf16 v[96:99], v[72:75], v[40:43], v[96:99]
    v_mfma_f32_16x16x32_bf16 v[96:99], v[76:79], v[44:47], v[96:99]
    v_mov_b64 v[148:149], 0
    v_mov_b64 v[150:151], 0
    v_mov_b64 v[152:153], 0
    v_mov_b64 v[154:155], 0
    v_mov_b64 v[156:157], 0
    v_mov_b64 v[158:159], 0
    v_mov_b64 v[160:161], 0
    v_mov_b64 v[162:163], 0
    v_mov_b32 v11, 0xff800000
    v_cmp_gt_i32 vcc, 0, v3
    s_nop 1
    v_cndmask_b32 v88, v88, v11, vcc
    v_cndmask_b32 v96, v96, v11, vcc
    v_cmp_gt_i32 vcc, 1, v3
    s_nop 1
    v_cndmask_b32 v89, v89, v11, vcc
    v_cndmask_b32 v97, v97, v11, vcc
    v_cmp_gt_i32 vcc, 2, v3
    s_nop 1
    v_cndmask_b32 v90, v90, v11, vcc
    v_cndmask_b32 v98, v98, v11, vcc
    v_cmp_gt_i32 vcc, 3, v3
    s_nop 1
    v_cndmask_b32 v91, v91, v11, vcc
    v_cndmask_b32 v99, v99, v11, vcc
A_mem:
    buffer_load_dwordx4 v[108:111], v8, s[4:7], s29 offen sc1
    buffer_load_dwordx4 v[112:115], v8, s[4:7], s29 offen offset:1024 sc1
    buffer_load_dwordx4 v[116:119], v9, s[4:7], s29 offen offset:2048 sc1
    s_add_u32 s32, s32, 1
    s_cmp_gt_u32 s32, 0x40000
    s_cbranch_scc1 L_abort
    s_waitcnt vmcnt(0)
    v_max3_u32 v10, v108, v110, v112
    v_max3_u32 v10, v10, v114, v116
    v_max_u32 v10, v10, v118
    v_cmp_eq_u32 vcc, -1, v10
    s_cbranch_vccz A_mem_ok
    s_sleep 1
    s_branch A_mem
A_mem_ok:
    ds_write_b128 v8, v[108:111]
    ds_write_b128 v8, v[112:115] offset:1024
    ds_write_b128 v9, v[116:119] offset:2048
    s_waitcnt lgkmcnt(0)
    s_barrier
    ds_read_b128 v[108:111], v1 offset:0
    ds_read_b128 v[112:115], v1 offset:1024
    ds_read_b128 v[116:119], v1 offset:2048
    ds_read_b128 v[120:123], v1 offset:3072
    ds_read_b128 v[124:127], v1 offset:4096
    ds_read_b128 v[128:131], v1 offset:5120
    ds_read_b128 v[132:135], v1 offset:6144
    ds_read_b128 v[136:139], v1 offset:7168
    ds_read_b128 v[140:143], v1 offset:8192
    ds_read_b128 v[144:147], v1 offset:9216
    s_waitcnt lgkmcnt(9)
    v_smfmac_f32_16x16x64_bf16 v[148:151], v[108:111], a[0:7], v2
    v_smfmac_f32_16x16x64_bf16 v[152:155], v[108:111], a[8:15], v2
    s_waitcnt lgkmcnt(8)
    v_smfmac_f32_16x16x64_bf16 v[148:151], v[112:115], a[16:23], v2
    v_smfmac_f32_16x16x64_bf16 v[152:155], v[112:115], a[24:31], v2
    s_waitcnt lgkmcnt(7)
    v_smfmac_f32_16x16x64_bf16 v[148:151], v[116:119], a[32:39], v2
    v_smfmac_f32_16x16x64_bf16 v[152:155], v[116:119], a[40:47], v2
    s_waitcnt lgkmcnt(6)
    v_smfmac_f32_16x16x64_bf16 v[148:151], v[120:123], a[48:55], v2
    v_smfmac_f32_16x16x64_bf16 v[152:155], v[120:123], a[56:63], v2
    s_waitcnt lgkmcnt(5)
    v_smfmac_f32_16x16x64_bf16 v[148:151], v[124:127], a[64:71], v2
    v_smfmac_f32_16x16x64_bf16 v[152:155], v[124:127], a[72:79], v2
    s_waitcnt lgkmcnt(4)
    v_smfmac_f32_16x16x64_bf16 v[148:151], v[128:131], a[80:87], v2
    v_smfmac_f32_16x16x64_bf16 v[152:155], v[128:131], a[88:95], v2
    s_waitcnt lgkmcnt(3)
    v_smfmac_f32_16x16x64_bf16 v[148:151], v[132:135], a[96:103], v2
    v_smfmac_f32_16x16x64_bf16 v[152:155], v[132:135], a[104:111], v2
    s_waitcnt lgkmcnt(2)
    v_smfmac_f32_16x16x64_bf16 v[148:151], v[136:139], a[112:119], v2
    v_smfmac_f32_16x16x64_bf16 v[152:155], v[136:139], a[120:127], v2
    s_waitcnt lgkmcnt(1)
    v_smfmac_f32_16x16x64_bf16 v[148:151], v[140:143], a[128:135], v2
    v_smfmac_f32_16x16x64_bf16 v[152:155], v[140:143], a[136:143], v2
    s_waitcnt lgkmcnt(0)
    v_smfmac_f32_16x16x64_bf16 v[148:151], v[144:147], a[144:151], v2
    v_smfmac_f32_16x16x64_bf16 v[152:155], v[144:147], a[152:159], v2
    v_smfmac_f32_16x16x64_bf16 v[156:159], v[108:111], a[160:167], v2
    v_smfmac_f32_16x16x64_bf16 v[160:163], v[108:111], a[168:175], v2
    s_nop 4
    v_add_f32 v148, v148, v149
    v_add_f32 v150, v150, v151
    v_cvt_pk_bf16_f32 v149, v148, v150
    v_mov_b32 v148, 0
    ds_write_b64 v6, v[148:149] offset:0
    v_add_f32 v152, v152, v153
    v_add_f32 v154, v154, v155
    v_cvt_pk_bf16_f32 v153, v152, v154
    v_mov_b32 v152, 0
    ds_write_b64 v6, v[152:153] offset:512
    v_smfmac_f32_16x16x64_bf16 v[156:159], v[112:115], a[176:183], v2
    v_smfmac_f32_16x16x64_bf16 v[160:163], v[112:115], a[184:191], v2
    v_smfmac_f32_16x16x64_bf16 v[156:159], v[116:119], a[192:199], v2
    v_smfmac_f32_16x16x64_bf16 v[160:163], v[116:119], a[200:207], v2
    v_smfmac_f32_16x16x64_bf16 v[156:159], v[120:123], a[208:215], v2
    v_smfmac_f32_16x16x64_bf16 v[160:163], v[120:123], a[216:223], v2
    s_waitcnt lgkmcnt(0)
    s_barrier
    ds_read_b64_tr_b16 v[164:165], v7 offset:0
    ds_read_b64_tr_b16 v[166:167], v7 offset:512
    ds_read_b64_tr_b16 v[168:169], v7 offset:1024
    ds_read_b64_tr_b16 v[170:171], v7 offset:1536
    ds_read_b64_tr_b16 v[172:173], v7 offset:2048
    ds_read_b64_tr_b16 v[174:175], v7 offset:2560
    ds_read_b64_tr_b16 v[176:177], v7 offset:3072
    ds_read_b64_tr_b16 v[178:179], v7 offset:3584
    v_smfmac_f32_16x16x64_bf16 v[156:159], v[124:127], a[224:231], v2
    v_smfmac_f32_16x16x64_bf16 v[160:163], v[124:127], a[232:239], v2
    v_smfmac_f32_16x16x64_bf16 v[156:159], v[128:131], a[240:247], v2
    v_smfmac_f32_16x16x64_bf16 v[160:163], v[128:131], a[248:255], v2
    v_smfmac_f32_16x16x64_bf16 v[156:159], v[132:135], v[192:199], v2
    v_smfmac_f32_16x16x64_bf16 v[160:163], v[132:135], v[200:207], v2
    v_smfmac_f32_16x16x64_bf16 v[156:159], v[136:139], v[208:215], v2
    v_smfmac_f32_16x16x64_bf16 v[160:163], v[136:139], v[216:223], v2
    v_smfmac_f32_16x16x64_bf16 v[156:159], v[140:143], v[224:231], v2
    v_smfmac_f32_16x16x64_bf16 v[160:163], v[140:143], v[232:239], v2
    v_smfmac_f32_16x16x64_bf16 v[156:159], v[144:147], v[240:247], v2
    v_smfmac_f32_16x16x64_bf16 v[160:163], v[144:147], v[248:255], v2
    s_waitcnt lgkmcnt(6)
    v_mfma_f32_16x16x32_bf16 v[100:103], v[164:167], v[16:19], 0
    v_mfma_f32_16x16x32_bf16 v[104:107], v[164:167], v[32:35], 0
    s_waitcnt lgkmcnt(4)
    v_mfma_f32_16x16x32_bf16 v[100:103], v[168:171], v[20:23], v[100:103]
    v_mfma_f32_16x16x32_bf16 v[104:107], v[168:171], v[36:39], v[104:107]
    s_waitcnt lgkmcnt(2)
    v_mfma_f32_16x16x32_bf16 v[100:103], v[172:175], v[24:27], v[100:103]
    v_mfma_f32_16x16x32_bf16 v[104:107], v[172:175], v[40:43], v[104:107]
    s_waitcnt lgkmcnt(0)
    v_mfma_f32_16x16x32_bf16 v[100:103], v[176:179], v[28:31], v[100:103]
    v_mfma_f32_16x16x32_bf16 v[104:107], v[176:179], v[44:47], v[104:107]
    v_cvt_pk_bf16_f32 v156, v156, v157
    v_cvt_pk_bf16_f32 v157, v158, v159
    v_cvt_pk_bf16_f32 v158, v160, v161
    v_cvt_pk_bf16_f32 v159, v162, v163
    v_mov_b64 v[48:49], s[98:99]
    v_mov_b64 v[50:51], s[98:99]
    v_mov_b64 v[148:149], s[100:101]
    v_max3_f32 v10, v88, v89, v90
    v_max3_f32 v10, v10, v91, v102
    v_max_f32 v11, v10, v103
    v_max_f32 v10, v10, v103
    s_nop 1
    v_permlane32_swap_b32 v10, v11
    v_max_f32 v12, v10, v11
    v_max_f32 v10, v10, v11
    s_nop 1
    v_permlane16_swap_b32 v10, v12
    v_max_f32 v10, v10, v12
    v_mul_f32 v10, s96, v10
    v_pk_fma_f32 v[88:89], v[88:89], s[96:97], v[10:11] op_sel_hi:[1,1,0] neg_lo:[0,0,1] neg_hi:[0,0,1]
    v_pk_fma_f32 v[90:91], v[90:91], s[96:97], v[10:11] op_sel_hi:[1,1,0] neg_lo:[0,0,1] neg_hi:[0,0,1]
    v_pk_fma_f32 v[102:103], v[102:103], s[96:97], v[10:11] op_sel_hi:[1,1,0] neg_lo:[0,0,1] neg_hi:[0,0,1]
    v_exp_f32 v88, v88
    v_exp_f32 v89, v89
    v_exp_f32 v90, v90
    v_exp_f32 v91, v91
    v_exp_f32 v102, v102
    v_exp_f32 v103, v103
    v_cvt_pk_bf16_f32 v16, v88, v89
    v_cvt_pk_bf16_f32 v17, v90, v91
    v_mov_b64 v[18:19], 0
    v_cvt_pk_bf16_f32 v20, v102, v102
    v_cvt_pk_bf16_f32 v21, v103, v103
    v_mfma_f32_16x16x32_bf16 v[52:55], v[48:51], v[16:19], 0
    v_mfma_f32_16x16x32_bf16 v[32:35], v[80:83], v[16:19], 0
    v_mfma_f32_16x16x32_bf16 v[36:39], v[84:87], v[16:19], 0
    s_nop 3
    v_mfma_f32_16x16x16_bf16 v[52:55], v[148:149], v[20:21], v[52:55]
    v_mfma_f32_16x16x16_bf16 v[32:35], v[156:157], v[20:21], v[32:35]
    v_mfma_f32_16x16x16_bf16 v[36:39], v[158:159], v[20:21], v[36:39]
    s_nop 5
    v_rcp_f32 v10, v52
    s_nop 0
    v_pk_mul_f32 v[32:33], v[32:33], v[10:11] op_sel_hi:[1,0]
    v_pk_mul_f32 v[36:37], v[36:37], v[10:11] op_sel_hi:[1,0]
    v_cvt_pk_bf16_f32 v56, v32, v36
    v_cvt_pk_bf16_f32 v57, v33, v37
    v_pk_mul_f32 v[34:35], v[34:35], v[10:11] op_sel_hi:[1,0]
    v_pk_mul_f32 v[38:39], v[38:39], v[10:11] op_sel_hi:[1,0]
    v_cvt_pk_bf16_f32 v58, v34, v38
    v_cvt_pk_bf16_f32 v59, v35, v39
    buffer_store_dwordx4 v[56:59], v0, s[4:7], s30 offen sc1
    v_max3_f32 v10, v92, v93, v94
    v_max3_f32 v10, v10, v95, v96
    v_max3_f32 v10, v10, v97, v98
    v_max3_f32 v10, v10, v99, v106
    v_max_f32 v11, v10, v107
    v_max_f32 v10, v10, v107
    s_nop 1
    v_permlane32_swap_b32 v10, v11
    v_max_f32 v12, v10, v11
    v_max_f32 v10, v10, v11
    s_nop 1
    v_permlane16_swap_b32 v10, v12
    v_max_f32 v10, v10, v12
    v_mul_f32 v10, s96, v10
    v_pk_fma_f32 v[92:93], v[92:93], s[96:97], v[10:11] op_sel_hi:[1,1,0] neg_lo:[0,0,1] neg_hi:[0,0,1]
    v_pk_fma_f32 v[94:95], v[94:95], s[96:97], v[10:11] op_sel_hi:[1,1,0] neg_lo:[0,0,1] neg_hi:[0,0,1]
    v_pk_fma_f32 v[96:97], v[96:97], s[96:97], v[10:11] op_sel_hi:[1,1,0] neg_lo:[0,0,1] neg_hi:[0,0,1]
    v_pk_fma_f32 v[98:99], v[98:99], s[96:97], v[10:11] op_sel_hi:[1,1,0] neg_lo:[0,0,1] neg_hi:[0,0,1]
    v_pk_fma_f32 v[106:107], v[106:107], s[96:97], v[10:11] op_sel_hi:[1,1,0] neg_lo:[0,0,1] neg_hi:[0,0,1]
    v_exp_f32 v92, v92
    v_exp_f32 v93, v93
    v_exp_f32 v94, v94
    v_exp_f32 v95, v95
    v_exp_f32 v96, v96
    v_exp_f32 v97, v97
    v_exp_f32 v98, v98
    v_exp_f32 v99, v99
    v_exp_f32 v106, v106
    v_exp_f32 v107, v107
    v_cvt_pk_bf16_f32 v24, v92, v93
    v_cvt_pk_bf16_f32 v25, v94, v95
    v_cvt_pk_bf16_f32 v26, v96, v97
    v_cvt_pk_bf16_f32 v27, v98, v99
    v_cvt_pk_bf16_f32 v28, v106, v106
    v_cvt_pk_bf16_f32 v29, v107, v107
    v_mfma_f32_16x16x32_bf16 v[52:55], v[48:51], v[24:27], 0
    v_mfma_f32_16x16x32_bf16 v[40:43], v[80:83], v[24:27], 0
    v_mfma_f32_16x16x32_bf16 v[44:47], v[84:87], v[24:27], 0
    s_nop 3
    v_mfma_f32_16x16x16_bf16 v[52:55], v[148:149], v[28:29], v[52:55]
    v_mfma_f32_16x16x16_bf16 v[40:43], v[156:157], v[28:29], v[40:43]
    v_mfma_f32_16x16x16_bf16 v[44:47], v[158:159], v[28:29], v[44:47]
    s_nop 5
    v_rcp_f32 v10, v52
    s_nop 0
    v_pk_mul_f32 v[40:41], v[40:41], v[10:11] op_sel_hi:[1,0]
    v_pk_mul_f32 v[44:45], v[44:45], v[10:11] op_sel_hi:[1,0]
    v_cvt_pk_bf16_f32 v60, v40, v44
    v_cvt_pk_bf16_f32 v61, v41, v45
    v_pk_mul_f32 v[42:43], v[42:43], v[10:11] op_sel_hi:[1,0]
    v_pk_mul_f32 v[46:47], v[46:47], v[10:11] op_sel_hi:[1,0]
    v_cvt_pk_bf16_f32 v62, v42, v46
    v_cvt_pk_bf16_f32 v63, v43, v47
    s_add_u32 s30, s30, 131072
    buffer_store_dwordx4 v[60:63], v0, s[4:7], s30 offen sc1
    s_waitcnt vmcnt(0)
    s_barrier
    s_cmp_eq_u32 s13, 0
    s_cbranch_scc0 A_nosig
    s_mov_b64 exec, 1
    v_mov_b32 v10, 0
    v_mov_b32 v11, 1
    buffer_atomic_add v11, v10, s[4:7], s31 offen
    s_mov_b64 exec, -1
    s_nop 3
A_nosig:
    s_add_u32 s25, s25, 2
    s_cmp_lt_u32 s25, 64
    s_cbranch_scc1 A_seg
    s_waitcnt vmcnt(0)
    s_endpgm
W_stageB:
    s_load_dwordx2 s[40:41], s[0:1], 40
    s_load_dwordx2 s[42:43], s[0:1], 80
    s_load_dwordx2 s[44:45], s[0:1], 88
    s_load_dwordx2 s[16:17], s[0:1], 96
    s_load_dwordx2 s[20:21], s[0:1], 0
    s_sub_u32 s34, s33, 128
    s_mul_i32 s25, s34, 1639
    s_lshr_b32 s25, s25, 16
    s_mul_i32 s35, s25, 40
    s_sub_u32 s34, s34, s35
    s_cmp_ge_u32 s34, 20
    s_cselect_b32 s26, 1, 0
    s_mul_i32 s35, s26, 20
    s_sub_u32 s24, s34, s35
    v_mov_b32 v15, v232
    v_lshrrev_b32 v4, 4, v15
    v_and_b32 v5, 15, v15
    v_lshlrev_b32 v5, 2, v5
    s_lshl_b32 s34, s24, 6
    v_add_u32 v5, s34, v5
    v_mul_u32_u24 v1, 10240, v4
    v_add_u32 v1, v1, v5
    s_mul_i32 s34, s13, 1310720
    v_add_u32 v1, s34, v1
    v_mul_u32_u24 v2, 5120, v4
    v_add_u32 v2, v2, v5
    s_mul_i32 s34, s13, 573440
    v_add_u32 v2, s34, v2
    s_mov_b32 s18, 2621440
    s_mov_b32 s19, 0x20000
    s_mov_b32 s22, 2621440
    s_mov_b32 s23, 0x20000
    s_waitcnt lgkmcnt(0)
    s_mov_b32 s38, 0x05040100
    s_mov_b32 s39, 0x07060302
    s_mov_b32 s8, s40
    s_mov_b32 s9, s41
    s_mov_b32 s10, 5242880
    s_mov_b32 s34, 0
    buffer_load_dword v16, v1, s[8:11], s34 offen
    s_mov_b32 s34, 1280
    buffer_load_dword v17, v1, s[8:11], s34 offen
    s_mov_b32 s34, 2560
    buffer_load_dword v18, v1, s[8:11], s34 offen
    s_mov_b32 s34, 3840
    buffer_load_dword v19, v1, s[8:11], s34 offen
    s_mov_b32 s34, 5120
    buffer_load_dword v20, v1, s[8:11], s34 offen
    s_mov_b32 s34, 6400
    buffer_load_dword v21, v1, s[8:11], s34 offen
    s_mov_b32 s34, 7680
    buffer_load_dword v22, v1, s[8:11], s34 offen
    s_mov_b32 s34, 8960
    buffer_load_dword v23, v1, s[8:11], s34 offen
    s_mov_b32 s34, 40960
    buffer_load_dword v24, v1, s[8:11], s34 offen
    s_mov_b32 s34, 42240
    buffer_load_dword v25, v1, s[8:11], s34 offen
    s_mov_b32 s34, 43520
    buffer_load_dword v26, v1, s[8:11], s34 offen
    s_mov_b32 s34, 44800
    buffer_load_dword v27, v1, s[8:11], s34 offen
    s_mov_b32 s34, 46080
    buffer_load_dword v28, v1, s[8:11], s34 offen
    s_mov_b32 s34, 47360
    buffer_load_dword v29, v1, s[8:11], s34 offen
    s_mov_b32 s34, 48640
    buffer_load_dword v30, v1, s[8:11], s34 offen
    s_mov_b32 s34, 49920
    buffer_load_dword v31, v1, s[8:11], s34 offen
    s_mov_b32 s34, 81920
    buffer_load_dword v32, v1, s[8:11], s34 offen
    s_mov_b32 s34, 83200
    buffer_load_dword v33, v1, s[8:11], s34 offen
    s_mov_b32 s34, 84480
    buffer_load_dword v34, v1, s[8:11], s34 offen
    s_mov_b32 s34, 85760
    buffer_load_dword v35, v1, s[8:11], s34 offen
    s_mov_b32 s34, 87040
    buffer_load_dword v36, v1, s[8:11], s34 offen
    s_mov_b32 s34, 88320
    buffer_load_dword v37, v1, s[8:11], s34 offen
    s_mov_b32 s34, 89600
    buffer_load_dword v38, v1, s[8:11], s34 offen
    s_mov_b32 s34, 90880
    buffer_load_dword v39, v1, s[8:11], s34 offen
    s_mov_b32 s34, 122880
    buffer_load_dword v40, v1, s[8:11], s34 offen
    s_mov_b32 s34, 124160
    buffer_load_dword v41, v1, s[8:11], s34 offen
    s_mov_b32 s34, 125440
    buffer_load_dword v42, v1, s[8:11], s34 offen
    s_mov_b32 s34, 126720
    buffer_load_dword v43, v1, s[8:11], s34 offen
    s_mov_b32 s34, 128000
    buffer_load_dword v44, v1, s[8:11], s34 offen
    s_mov_b32 s34, 129280
    buffer_load_dword v45, v1, s[8:11], s34 offen
    s_mov_b32 s34, 130560
    buffer_load_dword v46, v1, s[8:11], s34 offen
    s_mov_b32 s34, 131840
    buffer_load_dword v47, v1, s[8:11], s34 offen
    s_mov_b32 s34, 163840
    buffer_load_dword v48, v1, s[8:11], s34 offen
    s_mov_b32 s34, 165120
    buffer_load_dword v49, v1, s[8:11], s34 offen
    s_mov_b32 s34, 166400
    buffer_load_dword v50, v1, s[8:11], s34 offen
    s_mov_b32 s34, 167680
    buffer_load_dword v51, v1, s[8:11], s34 offen
    s_mov_b32 s34, 168960
    buffer_load_dword v52, v1, s[8:11], s34 offen
    s_mov_b32 s34, 170240
    buffer_load_dword v53, v1, s[8:11], s34 offen
    s_mov_b32 s34, 171520
    buffer_load_dword v54, v1, s[8:11], s34 offen
    s_mov_b32 s34, 172800
    buffer_load_dword v55, v1, s[8:11], s34 offen
    s_mov_b32 s34, 204800
    buffer_load_dword v56, v1, s[8:11], s34 offen
    s_mov_b32 s34, 206080
    buffer_load_dword v57, v1, s[8:11], s34 offen
    s_mov_b32 s34, 207360
    buffer_load_dword v58, v1, s[8:11], s34 offen
    s_mov_b32 s34, 208640
    buffer_load_dword v59, v1, s[8:11], s34 offen
    s_mov_b32 s34, 209920
    buffer_load_dword v60, v1, s[8:11], s34 offen
    s_mov_b32 s34, 211200
    buffer_load_dword v61, v1, s[8:11], s34 offen
    s_mov_b32 s34, 212480
    buffer_load_dword v62, v1, s[8:11], s34 offen
    s_mov_b32 s34, 213760
    buffer_load_dword v63, v1, s[8:11], s34 offen
    s_waitcnt vmcnt(32)
    v_perm_b32 v4, v17, v16, s38
    v_accvgpr_write_b32 a0, v4
    v_perm_b32 v5, v19, v18, s38
    v_accvgpr_write_b32 a1, v5
    v_perm_b32 v6, v21, v20, s38
    v_accvgpr_write_b32 a2, v6
    v_perm_b32 v7, v23, v22, s38
    v_accvgpr_write_b32 a3, v7
    v_perm_b32 v4, v25, v24, s38
    v_accvgpr_write_b32 a8, v4
    v_perm_b32 v5, v27, v26, s38
    v_accvgpr_write_b32 a9, v5
    v_perm_b32 v6, v29, v28, s38
    v_accvgpr_write_b32 a10, v6
    v_perm_b32 v7, v31, v30, s38
    v_accvgpr_write_b32 a11, v7
    v_perm_b32 v4, v17, v16, s39
    v_accvgpr_write_b32 a4, v4
    v_perm_b32 v5, v19, v18, s39
    v_accvgpr_write_b32 a5, v5
    v_perm_b32 v6, v21, v20, s39
    v_accvgpr_write_b32 a6, v6
    v_perm_b32 v7, v23, v22, s39
    v_accvgpr_write_b32 a7, v7
    v_perm_b32 v4, v25, v24, s39
    v_accvgpr_write_b32 a12, v4
    v_perm_b32 v5, v27, v26, s39
    v_accvgpr_write_b32 a13, v5
    v_perm_b32 v6, v29, v28, s39
    v_accvgpr_write_b32 a14, v6
    v_perm_b32 v7, v31, v30, s39
    v_accvgpr_write_b32 a15, v7
    s_mov_b32 s34, 245760
    buffer_load_dword v16, v1, s[8:11], s34 offen
    s_mov_b32 s34, 247040
    buffer_load_dword v17, v1, s[8:11], s34 offen
    s_mov_b32 s34, 248320
    buffer_load_dword v18, v1, s[8:11], s34 offen
    s_mov_b32 s34, 249600
    buffer_load_dword v19, v1, s[8:11], s34 offen
    s_mov_b32 s34, 250880
    buffer_load_dword v20, v1, s[8:11], s34 offen
    s_mov_b32 s34, 252160
    buffer_load_dword v21, v1, s[8:11], s34 offen
    s_mov_b32 s34, 253440
    buffer_load_dword v22, v1, s[8:11], s34 offen
    s_mov_b32 s34, 254720
    buffer_load_dword v23, v1, s[8:11], s34 offen
    s_mov_b32 s34, 286720
    buffer_load_dword v24, v1, s[8:11], s34 offen
    s_mov_b32 s34, 288000
    buffer_load_dword v25, v1, s[8:11], s34 offen
    s_mov_b32 s34, 289280
    buffer_load_dword v26, v1, s[8:11], s34 offen
    s_mov_b32 s34, 290560
    buffer_load_dword v27, v1, s[8:11], s34 offen
    s_mov_b32 s34, 291840
    buffer_load_dword v28, v1, s[8:11], s34 offen
    s_mov_b32 s34, 293120
    buffer_load_dword v29, v1, s[8:11], s34 offen
    s_mov_b32 s34, 294400
    buffer_load_dword v30, v1, s[8:11], s34 offen
    s_mov_b32 s34, 295680
    buffer_load_dword v31, v1, s[8:11], s34 offen
    s_waitcnt vmcnt(32)
    v_perm_b32 v4, v33, v32, s38
    v_accvgpr_write_b32 a16, v4
    v_perm_b32 v5, v35, v34, s38
    v_accvgpr_write_b32 a17, v5
    v_perm_b32 v6, v37, v36, s38
    v_accvgpr_write_b32 a18, v6
    v_perm_b32 v7, v39, v38, s38
    v_accvgpr_write_b32 a19, v7
    v_perm_b32 v4, v41, v40, s38
    v_accvgpr_write_b32 a24, v4
    v_perm_b32 v5, v43, v42, s38
    v_accvgpr_write_b32 a25, v5
    v_perm_b32 v6, v45, v44, s38
    v_accvgpr_write_b32 a26, v6
    v_perm_b32 v7, v47, v46, s38
    v_accvgpr_write_b32 a27, v7
    v_perm_b32 v4, v33, v32, s39
    v_accvgpr_write_b32 a20, v4
    v_perm_b32 v5, v35, v34, s39
    v_accvgpr_write_b32 a21, v5
    v_perm_b32 v6, v37, v36, s39
    v_accvgpr_write_b32 a22, v6
    v_perm_b32 v7, v39, v38, s39
    v_accvgpr_write_b32 a23, v7
    v_perm_b32 v4, v41, v40, s39
    v_accvgpr_write_b32 a28, v4
    v_perm_b32 v5, v43, v42, s39
    v_accvgpr_write_b32 a29, v5
    v_perm_b32 v6, v45, v44, s39
    v_accvgpr_write_b32 a30, v6
    v_perm_b32 v7, v47, v46, s39
    v_accvgpr_write_b32 a31, v7
    s_mov_b32 s34, 327680
    buffer_load_dword v32, v1, s[8:11], s34 offen
    s_mov_b32 s34, 328960
    buffer_load_dword v33, v1, s[8:11], s34 offen
    s_mov_b32 s34, 330240
    buffer_load_dword v34, v1, s[8:11], s34 offen
    s_mov_b32 s34, 331520
    buffer_load_dword v35, v1, s[8:11], s34 offen
    s_mov_b32 s34, 332800
    buffer_load_dword v36, v1, s[8:11], s34 offen
    s_mov_b32 s34, 334080
    buffer_load_dword v37, v1, s[8:11], s34 offen
    s_mov_b32 s34, 335360
    buffer_load_dword v38, v1, s[8:11], s34 offen
    s_mov_b32 s34, 336640
    buffer_load_dword v39, v1, s[8:11], s34 offen
    s_mov_b32 s34, 368640
    buffer_load_dword v40, v1, s[8:11], s34 offen
    s_mov_b32 s34, 369920
    buffer_load_dword v41, v1, s[8:11], s34 offen
    s_mov_b32 s34, 371200
    buffer_load_dword v42, v1, s[8:11], s34 offen
    s_mov_b32 s34, 372480
    buffer_load_dword v43, v1, s[8:11], s34 offen
    s_mov_b32 s34, 373760
    buffer_load_dword v44, v1, s[8:11], s34 offen
    s_mov_b32 s34, 375040
    buffer_load_dword v45, v1, s[8:11], s34 offen
    s_mov_b32 s34, 376320
    buffer_load_dword v46, v1, s[8:11], s34 offen
    s_mov_b32 s34, 377600
    buffer_load_dword v47, v1, s[8:11], s34 offen
    s_waitcnt vmcnt(32)
    v_perm_b32 v4, v49, v48, s38
    v_accvgpr_write_b32 a32, v4
    v_perm_b32 v5, v51, v50, s38
    v_accvgpr_write_b32 a33, v5
    v_perm_b32 v6, v53, v52, s38
    v_accvgpr_write_b32 a34, v6
    v_perm_b32 v7, v55, v54, s38
    v_accvgpr_write_b32 a35, v7
    v_perm_b32 v4, v57, v56, s38
    v_accvgpr_write_b32 a40, v4
    v_perm_b32 v5, v59, v58, s38
    v_accvgpr_write_b32 a41, v5
    v_perm_b32 v6, v61, v60, s38
    v_accvgpr_write_b32 a42, v6
    v_perm_b32 v7, v63, v62, s38
    v_accvgpr_write_b32 a43, v7
    v_perm_b32 v4, v49, v48, s39
    v_accvgpr_write_b32 a36, v4
    v_perm_b32 v5, v51, v50, s39
    v_accvgpr_write_b32 a37, v5
    v_perm_b32 v6, v53, v52, s39
    v_accvgpr_write_b32 a38, v6
    v_perm_b32 v7, v55, v54, s39
    v_accvgpr_write_b32 a39, v7
    v_perm_b32 v4, v57, v56, s39
    v_accvgpr_write_b32 a44, v4
    v_perm_b32 v5, v59, v58, s39
    v_accvgpr_write_b32 a45, v5
    v_perm_b32 v6, v61, v60, s39
    v_accvgpr_write_b32 a46, v6
    v_perm_b32 v7, v63, v62, s39
    v_accvgpr_write_b32 a47, v7
    s_mov_b32 s34, 409600
    buffer_load_dword v48, v1, s[8:11], s34 offen
    s_mov_b32 s34, 410880
    buffer_load_dword v49, v1, s[8:11], s34 offen
    s_mov_b32 s34, 412160
    buffer_load_dword v50, v1, s[8:11], s34 offen
    s_mov_b32 s34, 413440
    buffer_load_dword v51, v1, s[8:11], s34 offen
    s_mov_b32 s34, 414720
    buffer_load_dword v52, v1, s[8:11], s34 offen
    s_mov_b32 s34, 416000
    buffer_load_dword v53, v1, s[8:11], s34 offen
    s_mov_b32 s34, 417280
    buffer_load_dword v54, v1, s[8:11], s34 offen
    s_mov_b32 s34, 418560
    buffer_load_dword v55, v1, s[8:11], s34 offen
    s_mov_b32 s34, 450560
    buffer_load_dword v56, v1, s[8:11], s34 offen
    s_mov_b32 s34, 451840
    buffer_load_dword v57, v1, s[8:11], s34 offen
    s_mov_b32 s34, 453120
    buffer_load_dword v58, v1, s[8:11], s34 offen
    s_mov_b32 s34, 454400
    buffer_load_dword v59, v1, s[8:11], s34 offen
    s_mov_b32 s34, 455680
    buffer_load_dword v60, v1, s[8:11], s34 offen
    s_mov_b32 s34, 456960
    buffer_load_dword v61, v1, s[8:11], s34 offen
    s_mov_b32 s34, 458240
    buffer_load_dword v62, v1, s[8:11], s34 offen
    s_mov_b32 s34, 459520
    buffer_load_dword v63, v1, s[8:11], s34 offen
    s_waitcnt vmcnt(32)
    v_perm_b32 v4, v17, v16, s38
    v_accvgpr_write_b32 a48, v4
    v_perm_b32 v5, v19, v18, s38
    v_accvgpr_write_b32 a49, v5
    v_perm_b32 v6, v21, v20, s38
    v_accvgpr_write_b32 a50, v6
    v_perm_b32 v7, v23, v22, s38
    v_accvgpr_write_b32 a51, v7
    v_perm_b32 v4, v25, v24, s38
    v_accvgpr_write_b32 a56, v4
    v_perm_b32 v5, v27, v26, s38
    v_accvgpr_write_b32 a57, v5
    v_perm_b32 v6, v29, v28, s38
    v_accvgpr_write_b32 a58, v6
    v_perm_b32 v7, v31, v30, s38
    v_accvgpr_write_b32 a59, v7
    v_perm_b32 v4, v17, v16, s39
    v_accvgpr_write_b32 a52, v4
    v_perm_b32 v5, v19, v18, s39
    v_accvgpr_write_b32 a53, v5
    v_perm_b32 v6, v21, v20, s39
    v_accvgpr_write_b32 a54, v6
    v_perm_b32 v7, v23, v22, s39
    v_accvgpr_write_b32 a55, v7
    v_perm_b32 v4, v25, v24, s39
    v_accvgpr_write_b32 a60, v4
    v_perm_b32 v5, v27, v26, s39
    v_accvgpr_write_b32 a61, v5
    v_perm_b32 v6, v29, v28, s39
    v_accvgpr_write_b32 a62, v6
    v_perm_b32 v7, v31, v30, s39
    v_accvgpr_write_b32 a63, v7
    s_mov_b32 s34, 491520
    buffer_load_dword v16, v1, s[8:11], s34 offen
    s_mov_b32 s34, 492800
    buffer_load_dword v17, v1, s[8:11], s34 offen
    s_mov_b32 s34, 494080
    buffer_load_dword v18, v1, s[8:11], s34 offen
    s_mov_b32 s34, 495360
    buffer_load_dword v19, v1, s[8:11], s34 offen
    s_mov_b32 s34, 496640
    buffer_load_dword v20, v1, s[8:11], s34 offen
    s_mov_b32 s34, 497920
    buffer_load_dword v21, v1, s[8:11], s34 offen
    s_mov_b32 s34, 499200
    buffer_load_dword v22, v1, s[8:11], s34 offen
    s_mov_b32 s34, 500480
    buffer_load_dword v23, v1, s[8:11], s34 offen
    s_mov_b32 s34, 532480
    buffer_load_dword v24, v1, s[8:11], s34 offen
    s_mov_b32 s34, 533760
    buffer_load_dword v25, v1, s[8:11], s34 offen
    s_mov_b32 s34, 535040
    buffer_load_dword v26, v1, s[8:11], s34 offen
    s_mov_b32 s34, 536320
    buffer_load_dword v27, v1, s[8:11], s34 offen
    s_mov_b32 s34, 537600
    buffer_load_dword v28, v1, s[8:11], s34 offen
    s_mov_b32 s34, 538880
    buffer_load_dword v29, v1, s[8:11], s34 offen
    s_mov_b32 s34, 540160
    buffer_load_dword v30, v1, s[8:11], s34 offen
    s_mov_b32 s34, 541440
    buffer_load_dword v31, v1, s[8:11], s34 offen
    s_waitcnt vmcnt(32)
    v_perm_b32 v4, v33, v32, s38
    v_accvgpr_write_b32 a64, v4
    v_perm_b32 v5, v35, v34, s38
    v_accvgpr_write_b32 a65, v5
    v_perm_b32 v6, v37, v36, s38
    v_accvgpr_write_b32 a66, v6
    v_perm_b32 v7, v39, v38, s38
    v_accvgpr_write_b32 a67, v7
    v_perm_b32 v4, v41, v40, s38
    v_accvgpr_write_b32 a72, v4
    v_perm_b32 v5, v43, v42, s38
    v_accvgpr_write_b32 a73, v5
    v_perm_b32 v6, v45, v44, s38
    v_accvgpr_write_b32 a74, v6
    v_perm_b32 v7, v47, v46, s38
    v_accvgpr_write_b32 a75, v7
    v_perm_b32 v4, v33, v32, s39
    v_accvgpr_write_b32 a68, v4
    v_perm_b32 v5, v35, v34, s39
    v_accvgpr_write_b32 a69, v5
    v_perm_b32 v6, v37, v36, s39
    v_accvgpr_write_b32 a70, v6
    v_perm_b32 v7, v39, v38, s39
    v_accvgpr_write_b32 a71, v7
    v_perm_b32 v4, v41, v40, s39
    v_accvgpr_write_b32 a76, v4
    v_perm_b32 v5, v43, v42, s39
    v_accvgpr_write_b32 a77, v5
    v_perm_b32 v6, v45, v44, s39
    v_accvgpr_write_b32 a78, v6
    v_perm_b32 v7, v47, v46, s39
    v_accvgpr_write_b32 a79, v7
    s_mov_b32 s34, 573440
    buffer_load_dword v32, v1, s[8:11], s34 offen
    s_mov_b32 s34, 574720
    buffer_load_dword v33, v1, s[8:11], s34 offen
    s_mov_b32 s34, 576000
    buffer_load_dword v34, v1, s[8:11], s34 offen
    s_mov_b32 s34, 577280
    buffer_load_dword v35, v1, s[8:11], s34 offen
    s_mov_b32 s34, 578560
    buffer_load_dword v36, v1, s[8:11], s34 offen
    s_mov_b32 s34, 579840
    buffer_load_dword v37, v1, s[8:11], s34 offen
    s_mov_b32 s34, 581120
    buffer_load_dword v38, v1, s[8:11], s34 offen
    s_mov_b32 s34, 582400
    buffer_load_dword v39, v1, s[8:11], s34 offen
    s_mov_b32 s34, 614400
    buffer_load_dword v40, v1, s[8:11], s34 offen
    s_mov_b32 s34, 615680
    buffer_load_dword v41, v1, s[8:11], s34 offen
    s_mov_b32 s34, 616960
    buffer_load_dword v42, v1, s[8:11], s34 offen
    s_mov_b32 s34, 618240
    buffer_load_dword v43, v1, s[8:11], s34 offen
    s_mov_b32 s34, 619520
    buffer_load_dword v44, v1, s[8:11], s34 offen
    s_mov_b32 s34, 620800
    buffer_load_dword v45, v1, s[8:11], s34 offen
    s_mov_b32 s34, 622080
    buffer_load_dword v46, v1, s[8:11], s34 offen
    s_mov_b32 s34, 623360
    buffer_load_dword v47, v1, s[8:11], s34 offen
    s_waitcnt vmcnt(32)
    v_perm_b32 v4, v49, v48, s38
    v_accvgpr_write_b32 a80, v4
    v_perm_b32 v5, v51, v50, s38
    v_accvgpr_write_b32 a81, v5
    v_perm_b32 v6, v53, v52, s38
    v_accvgpr_write_b32 a82, v6
    v_perm_b32 v7, v55, v54, s38
    v_accvgpr_write_b32 a83, v7
    v_perm_b32 v4, v57, v56, s38
    v_accvgpr_write_b32 a88, v4
    v_perm_b32 v5, v59, v58, s38
    v_accvgpr_write_b32 a89, v5
    v_perm_b32 v6, v61, v60, s38
    v_accvgpr_write_b32 a90, v6
    v_perm_b32 v7, v63, v62, s38
    v_accvgpr_write_b32 a91, v7
    v_perm_b32 v4, v49, v48, s39
    v_accvgpr_write_b32 a84, v4
    v_perm_b32 v5, v51, v50, s39
    v_accvgpr_write_b32 a85, v5
    v_perm_b32 v6, v53, v52, s39
    v_accvgpr_write_b32 a86, v6
    v_perm_b32 v7, v55, v54, s39
    v_accvgpr_write_b32 a87, v7
    v_perm_b32 v4, v57, v56, s39
    v_accvgpr_write_b32 a92, v4
    v_perm_b32 v5, v59, v58, s39
    v_accvgpr_write_b32 a93, v5
    v_perm_b32 v6, v61, v60, s39
    v_accvgpr_write_b32 a94, v6
    v_perm_b32 v7, v63, v62, s39
    v_accvgpr_write_b32 a95, v7
    s_mov_b32 s34, 655360
    buffer_load_dword v48, v1, s[8:11], s34 offen
    s_mov_b32 s34, 656640
    buffer_load_dword v49, v1, s[8:11], s34 offen
    s_mov_b32 s34, 657920
    buffer_load_dword v50, v1, s[8:11], s34 offen
    s_mov_b32 s34, 659200
    buffer_load_dword v51, v1, s[8:11], s34 offen
    s_mov_b32 s34, 660480
    buffer_load_dword v52, v1, s[8:11], s34 offen
    s_mov_b32 s34, 661760
    buffer_load_dword v53, v1, s[8:11], s34 offen
    s_mov_b32 s34, 663040
    buffer_load_dword v54, v1, s[8:11], s34 offen
    s_mov_b32 s34, 664320
    buffer_load_dword v55, v1, s[8:11], s34 offen
    s_mov_b32 s34, 696320
    buffer_load_dword v56, v1, s[8:11], s34 offen
    s_mov_b32 s34, 697600
    buffer_load_dword v57, v1, s[8:11], s34 offen
    s_mov_b32 s34, 698880
    buffer_load_dword v58, v1, s[8:11], s34 offen
    s_mov_b32 s34, 700160
    buffer_load_dword v59, v1, s[8:11], s34 offen
    s_mov_b32 s34, 701440
    buffer_load_dword v60, v1, s[8:11], s34 offen
    s_mov_b32 s34, 702720
    buffer_load_dword v61, v1, s[8:11], s34 offen
    s_mov_b32 s34, 704000
    buffer_load_dword v62, v1, s[8:11], s34 offen
    s_mov_b32 s34, 705280
    buffer_load_dword v63, v1, s[8:11], s34 offen
    s_waitcnt vmcnt(32)
    v_perm_b32 v4, v17, v16, s38
    v_accvgpr_write_b32 a96, v4
    v_perm_b32 v5, v19, v18, s38
    v_accvgpr_write_b32 a97, v5
    v_perm_b32 v6, v21, v20, s38
    v_accvgpr_write_b32 a98, v6
    v_perm_b32 v7, v23, v22, s38
    v_accvgpr_write_b32 a99, v7
    v_perm_b32 v4, v25, v24, s38
    v_accvgpr_write_b32 a104, v4
    v_perm_b32 v5, v27, v26, s38
    v_accvgpr_write_b32 a105, v5
    v_perm_b32 v6, v29, v28, s38
    v_accvgpr_write_b32 a106, v6
    v_perm_b32 v7, v31, v30, s38
    v_accvgpr_write_b32 a107, v7
    v_perm_b32 v4, v17, v16, s39
    v_accvgpr_write_b32 a100, v4
    v_perm_b32 v5, v19, v18, s39
    v_accvgpr_write_b32 a101, v5
    v_perm_b32 v6, v21, v20, s39
    v_accvgpr_write_b32 a102, v6
    v_perm_b32 v7, v23, v22, s39
    v_accvgpr_write_b32 a103, v7
    v_perm_b32 v4, v25, v24, s39
    v_accvgpr_write_b32 a108, v4
    v_perm_b32 v5, v27, v26, s39
    v_accvgpr_write_b32 a109, v5
    v_perm_b32 v6, v29, v28, s39
    v_accvgpr_write_b32 a110, v6
    v_perm_b32 v7, v31, v30, s39
    v_accvgpr_write_b32 a111, v7
    s_mov_b32 s34, 737280
    buffer_load_dword v16, v1, s[8:11], s34 offen
    s_mov_b32 s34, 738560
    buffer_load_dword v17, v1, s[8:11], s34 offen
    s_mov_b32 s34, 739840
    buffer_load_dword v18, v1, s[8:11], s34 offen
    s_mov_b32 s34, 741120
    buffer_load_dword v19, v1, s[8:11], s34 offen
    s_mov_b32 s34, 742400
    buffer_load_dword v20, v1, s[8:11], s34 offen
    s_mov_b32 s34, 743680
    buffer_load_dword v21, v1, s[8:11], s34 offen
    s_mov_b32 s34, 744960
    buffer_load_dword v22, v1, s[8:11], s34 offen
    s_mov_b32 s34, 746240
    buffer_load_dword v23, v1, s[8:11], s34 offen
    s_mov_b32 s34, 778240
    buffer_load_dword v24, v1, s[8:11], s34 offen
    s_mov_b32 s34, 779520
    buffer_load_dword v25, v1, s[8:11], s34 offen
    s_mov_b32 s34, 780800
    buffer_load_dword v26, v1, s[8:11], s34 offen
    s_mov_b32 s34, 782080
    buffer_load_dword v27, v1, s[8:11], s34 offen
    s_mov_b32 s34, 783360
    buffer_load_dword v28, v1, s[8:11], s34 offen
    s_mov_b32 s34, 784640
    buffer_load_dword v29, v1, s[8:11], s34 offen
    s_mov_b32 s34, 785920
    buffer_load_dword v30, v1, s[8:11], s34 offen
    s_mov_b32 s34, 787200
    buffer_load_dword v31, v1, s[8:11], s34 offen
    s_waitcnt vmcnt(32)
    v_perm_b32 v4, v33, v32, s38
    v_accvgpr_write_b32 a112, v4
    v_perm_b32 v5, v35, v34, s38
    v_accvgpr_write_b32 a113, v5
    v_perm_b32 v6, v37, v36, s38
    v_accvgpr_write_b32 a114, v6
    v_perm_b32 v7, v39, v38, s38
    v_accvgpr_write_b32 a115, v7
    v_perm_b32 v4, v41, v40, s38
    v_accvgpr_write_b32 a120, v4
    v_perm_b32 v5, v43, v42, s38
    v_accvgpr_write_b32 a121, v5
    v_perm_b32 v6, v45, v44, s38
    v_accvgpr_write_b32 a122, v6
    v_perm_b32 v7, v47, v46, s38
    v_accvgpr_write_b32 a123, v7
    v_perm_b32 v4, v33, v32, s39
    v_accvgpr_write_b32 a116, v4
    v_perm_b32 v5, v35, v34, s39
    v_accvgpr_write_b32 a117, v5
    v_perm_b32 v6, v37, v36, s39
    v_accvgpr_write_b32 a118, v6
    v_perm_b32 v7, v39, v38, s39
    v_accvgpr_write_b32 a119, v7
    v_perm_b32 v4, v41, v40, s39
    v_accvgpr_write_b32 a124, v4
    v_perm_b32 v5, v43, v42, s39
    v_accvgpr_write_b32 a125, v5
    v_perm_b32 v6, v45, v44, s39
    v_accvgpr_write_b32 a126, v6
    v_perm_b32 v7, v47, v46, s39
    v_accvgpr_write_b32 a127, v7
    s_mov_b32 s34, 819200
    buffer_load_dword v32, v1, s[8:11], s34 offen
    s_mov_b32 s34, 820480
    buffer_load_dword v33, v1, s[8:11], s34 offen
    s_mov_b32 s34, 821760
    buffer_load_dword v34, v1, s[8:11], s34 offen
    s_mov_b32 s34, 823040
    buffer_load_dword v35, v1, s[8:11], s34 offen
    s_mov_b32 s34, 824320
    buffer_load_dword v36, v1, s[8:11], s34 offen
    s_mov_b32 s34, 825600
    buffer_load_dword v37, v1, s[8:11], s34 offen
    s_mov_b32 s34, 826880
    buffer_load_dword v38, v1, s[8:11], s34 offen
    s_mov_b32 s34, 828160
    buffer_load_dword v39, v1, s[8:11], s34 offen
    s_mov_b32 s34, 860160
    buffer_load_dword v40, v1, s[8:11], s34 offen
    s_mov_b32 s34, 861440
    buffer_load_dword v41, v1, s[8:11], s34 offen
    s_mov_b32 s34, 862720
    buffer_load_dword v42, v1, s[8:11], s34 offen
    s_mov_b32 s34, 864000
    buffer_load_dword v43, v1, s[8:11], s34 offen
    s_mov_b32 s34, 865280
    buffer_load_dword v44, v1, s[8:11], s34 offen
    s_mov_b32 s34, 866560
    buffer_load_dword v45, v1, s[8:11], s34 offen
    s_mov_b32 s34, 867840
    buffer_load_dword v46, v1, s[8:11], s34 offen
    s_mov_b32 s34, 869120
    buffer_load_dword v47, v1, s[8:11], s34 offen
    s_waitcnt vmcnt(32)
    v_perm_b32 v4, v49, v48, s38
    v_accvgpr_write_b32 a128, v4
    v_perm_b32 v5, v51, v50, s38
    v_accvgpr_write_b32 a129, v5
    v_perm_b32 v6, v53, v52, s38
    v_accvgpr_write_b32 a130, v6
    v_perm_b32 v7, v55, v54, s38
    v_accvgpr_write_b32 a131, v7
    v_perm_b32 v4, v57, v56, s38
    v_accvgpr_write_b32 a136, v4
    v_perm_b32 v5, v59, v58, s38
    v_accvgpr_write_b32 a137, v5
    v_perm_b32 v6, v61, v60, s38
    v_accvgpr_write_b32 a138, v6
    v_perm_b32 v7, v63, v62, s38
    v_accvgpr_write_b32 a139, v7
    v_perm_b32 v4, v49, v48, s39
    v_accvgpr_write_b32 a132, v4
    v_perm_b32 v5, v51, v50, s39
    v_accvgpr_write_b32 a133, v5
    v_perm_b32 v6, v53, v52, s39
    v_accvgpr_write_b32 a134, v6
    v_perm_b32 v7, v55, v54, s39
    v_accvgpr_write_b32 a135, v7
    v_perm_b32 v4, v57, v56, s39
    v_accvgpr_write_b32 a140, v4
    v_perm_b32 v5, v59, v58, s39
    v_accvgpr_write_b32 a141, v5
    v_perm_b32 v6, v61, v60, s39
    v_accvgpr_write_b32 a142, v6
    v_perm_b32 v7, v63, v62, s39
    v_accvgpr_write_b32 a143, v7
    s_mov_b32 s34, 901120
    buffer_load_dword v48, v1, s[8:11], s34 offen
    s_mov_b32 s34, 902400
    buffer_load_dword v49, v1, s[8:11], s34 offen
    s_mov_b32 s34, 903680
    buffer_load_dword v50, v1, s[8:11], s34 offen
    s_mov_b32 s34, 904960
    buffer_load_dword v51, v1, s[8:11], s34 offen
    s_mov_b32 s34, 906240
    buffer_load_dword v52, v1, s[8:11], s34 offen
    s_mov_b32 s34, 907520
    buffer_load_dword v53, v1, s[8:11], s34 offen
    s_mov_b32 s34, 908800
    buffer_load_dword v54, v1, s[8:11], s34 offen
    s_mov_b32 s34, 910080
    buffer_load_dword v55, v1, s[8:11], s34 offen
    s_mov_b32 s34, 942080
    buffer_load_dword v56, v1, s[8:11], s34 offen
    s_mov_b32 s34, 943360
    buffer_load_dword v57, v1, s[8:11], s34 offen
    s_mov_b32 s34, 944640
    buffer_load_dword v58, v1, s[8:11], s34 offen
    s_mov_b32 s34, 945920
    buffer_load_dword v59, v1, s[8:11], s34 offen
    s_mov_b32 s34, 947200
    buffer_load_dword v60, v1, s[8:11], s34 offen
    s_mov_b32 s34, 948480
    buffer_load_dword v61, v1, s[8:11], s34 offen
    s_mov_b32 s34, 949760
    buffer_load_dword v62, v1, s[8:11], s34 offen
    s_mov_b32 s34, 951040
    buffer_load_dword v63, v1, s[8:11], s34 offen
    s_waitcnt vmcnt(32)
    v_perm_b32 v4, v17, v16, s38
    v_accvgpr_write_b32 a144, v4
    v_perm_b32 v5, v19, v18, s38
    v_accvgpr_write_b32 a145, v5
    v_perm_b32 v6, v21, v20, s38
    v_accvgpr_write_b32 a146, v6
    v_perm_b32 v7, v23, v22, s38
    v_accvgpr_write_b32 a147, v7
    v_perm_b32 v4, v25, v24, s38
    v_accvgpr_write_b32 a152, v4
    v_perm_b32 v5, v27, v26, s38
    v_accvgpr_write_b32 a153, v5
    v_perm_b32 v6, v29, v28, s38
    v_accvgpr_write_b32 a154, v6
    v_perm_b32 v7, v31, v30, s38
    v_accvgpr_write_b32 a155, v7
    v_perm_b32 v4, v17, v16, s39
    v_accvgpr_write_b32 a148, v4
    v_perm_b32 v5, v19, v18, s39
    v_accvgpr_write_b32 a149, v5
    v_perm_b32 v6, v21, v20, s39
    v_accvgpr_write_b32 a150, v6
    v_perm_b32 v7, v23, v22, s39
    v_accvgpr_write_b32 a151, v7
    v_perm_b32 v4, v25, v24, s39
    v_accvgpr_write_b32 a156, v4
    v_perm_b32 v5, v27, v26, s39
    v_accvgpr_write_b32 a157, v5
    v_perm_b32 v6, v29, v28, s39
    v_accvgpr_write_b32 a158, v6
    v_perm_b32 v7, v31, v30, s39
    v_accvgpr_write_b32 a159, v7
    s_mov_b32 s34, 983040
    buffer_load_dword v16, v1, s[8:11], s34 offen
    s_mov_b32 s34, 984320
    buffer_load_dword v17, v1, s[8:11], s34 offen
    s_mov_b32 s34, 985600
    buffer_load_dword v18, v1, s[8:11], s34 offen
    s_mov_b32 s34, 986880
    buffer_load_dword v19, v1, s[8:11], s34 offen
    s_mov_b32 s34, 988160
    buffer_load_dword v20, v1, s[8:11], s34 offen
    s_mov_b32 s34, 989440
    buffer_load_dword v21, v1, s[8:11], s34 offen
    s_mov_b32 s34, 990720
    buffer_load_dword v22, v1, s[8:11], s34 offen
    s_mov_b32 s34, 992000
    buffer_load_dword v23, v1, s[8:11], s34 offen
    s_mov_b32 s34, 1024000
    buffer_load_dword v24, v1, s[8:11], s34 offen
    s_mov_b32 s34, 1025280
    buffer_load_dword v25, v1, s[8:11], s34 offen
    s_mov_b32 s34, 1026560
    buffer_load_dword v26, v1, s[8:11], s34 offen
    s_mov_b32 s34, 1027840
    buffer_load_dword v27, v1, s[8:11], s34 offen
    s_mov_b32 s34, 1029120
    buffer_load_dword v28, v1, s[8:11], s34 offen
    s_mov_b32 s34, 1030400
    buffer_load_dword v29, v1, s[8:11], s34 offen
    s_mov_b32 s34, 1031680
    buffer_load_dword v30, v1, s[8:11], s34 offen
    s_mov_b32 s34, 1032960
    buffer_load_dword v31, v1, s[8:11], s34 offen
    s_waitcnt vmcnt(32)
    v_perm_b32 v4, v33, v32, s38
    v_accvgpr_write_b32 a160, v4
    v_perm_b32 v5, v35, v34, s38
    v_accvgpr_write_b32 a161, v5
    v_perm_b32 v6, v37, v36, s38
    v_accvgpr_write_b32 a162, v6
    v_perm_b32 v7, v39, v38, s38
    v_accvgpr_write_b32 a163, v7
    v_perm_b32 v4, v41, v40, s38
    v_accvgpr_write_b32 a168, v4
    v_perm_b32 v5, v43, v42, s38
    v_accvgpr_write_b32 a169, v5
    v_perm_b32 v6, v45, v44, s38
    v_accvgpr_write_b32 a170, v6
    v_perm_b32 v7, v47, v46, s38
    v_accvgpr_write_b32 a171, v7
    v_perm_b32 v4, v33, v32, s39
    v_accvgpr_write_b32 a164, v4
    v_perm_b32 v5, v35, v34, s39
    v_accvgpr_write_b32 a165, v5
    v_perm_b32 v6, v37, v36, s39
    v_accvgpr_write_b32 a166, v6
    v_perm_b32 v7, v39, v38, s39
    v_accvgpr_write_b32 a167, v7
    v_perm_b32 v4, v41, v40, s39
    v_accvgpr_write_b32 a172, v4
    v_perm_b32 v5, v43, v42, s39
    v_accvgpr_write_b32 a173, v5
    v_perm_b32 v6, v45, v44, s39
    v_accvgpr_write_b32 a174, v6
    v_perm_b32 v7, v47, v46, s39
    v_accvgpr_write_b32 a175, v7
    s_mov_b32 s34, 1064960
    buffer_load_dword v32, v1, s[8:11], s34 offen
    s_mov_b32 s34, 1066240
    buffer_load_dword v33, v1, s[8:11], s34 offen
    s_mov_b32 s34, 1067520
    buffer_load_dword v34, v1, s[8:11], s34 offen
    s_mov_b32 s34, 1068800
    buffer_load_dword v35, v1, s[8:11], s34 offen
    s_mov_b32 s34, 1070080
    buffer_load_dword v36, v1, s[8:11], s34 offen
    s_mov_b32 s34, 1071360
    buffer_load_dword v37, v1, s[8:11], s34 offen
    s_mov_b32 s34, 1072640
    buffer_load_dword v38, v1, s[8:11], s34 offen
    s_mov_b32 s34, 1073920
    buffer_load_dword v39, v1, s[8:11], s34 offen
    s_mov_b32 s34, 1105920
    buffer_load_dword v40, v1, s[8:11], s34 offen
    s_mov_b32 s34, 1107200
    buffer_load_dword v41, v1, s[8:11], s34 offen
    s_mov_b32 s34, 1108480
    buffer_load_dword v42, v1, s[8:11], s34 offen
    s_mov_b32 s34, 1109760
    buffer_load_dword v43, v1, s[8:11], s34 offen
    s_mov_b32 s34, 1111040
    buffer_load_dword v44, v1, s[8:11], s34 offen
    s_mov_b32 s34, 1112320
    buffer_load_dword v45, v1, s[8:11], s34 offen
    s_mov_b32 s34, 1113600
    buffer_load_dword v46, v1, s[8:11], s34 offen
    s_mov_b32 s34, 1114880
    buffer_load_dword v47, v1, s[8:11], s34 offen
    s_waitcnt vmcnt(32)
    v_perm_b32 v4, v49, v48, s38
    v_accvgpr_write_b32 a176, v4
    v_perm_b32 v5, v51, v50, s38
    v_accvgpr_write_b32 a177, v5
    v_perm_b32 v6, v53, v52, s38
    v_accvgpr_write_b32 a178, v6
    v_perm_b32 v7, v55, v54, s38
    v_accvgpr_write_b32 a179, v7
    v_perm_b32 v4, v57, v56, s38
    v_accvgpr_write_b32 a184, v4
    v_perm_b32 v5, v59, v58, s38
    v_accvgpr_write_b32 a185, v5
    v_perm_b32 v6, v61, v60, s38
    v_accvgpr_write_b32 a186, v6
    v_perm_b32 v7, v63, v62, s38
    v_accvgpr_write_b32 a187, v7
    v_perm_b32 v4, v49, v48, s39
    v_accvgpr_write_b32 a180, v4
    v_perm_b32 v5, v51, v50, s39
    v_accvgpr_write_b32 a181, v5
    v_perm_b32 v6, v53, v52, s39
    v_accvgpr_write_b32 a182, v6
    v_perm_b32 v7, v55, v54, s39
    v_accvgpr_write_b32 a183, v7
    v_perm_b32 v4, v57, v56, s39
    v_accvgpr_write_b32 a188, v4
    v_perm_b32 v5, v59, v58, s39
    v_accvgpr_write_b32 a189, v5
    v_perm_b32 v6, v61, v60, s39
    v_accvgpr_write_b32 a190, v6
    v_perm_b32 v7, v63, v62, s39
    v_accvgpr_write_b32 a191, v7
    s_mov_b32 s34, 1146880
    buffer_load_dword v48, v1, s[8:11], s34 offen
    s_mov_b32 s34, 1148160
    buffer_load_dword v49, v1, s[8:11], s34 offen
    s_mov_b32 s34, 1149440
    buffer_load_dword v50, v1, s[8:11], s34 offen
    s_mov_b32 s34, 1150720
    buffer_load_dword v51, v1, s[8:11], s34 offen
    s_mov_b32 s34, 1152000
    buffer_load_dword v52, v1, s[8:11], s34 offen
    s_mov_b32 s34, 1153280
    buffer_load_dword v53, v1, s[8:11], s34 offen
    s_mov_b32 s34, 1154560
    buffer_load_dword v54, v1, s[8:11], s34 offen
    s_mov_b32 s34, 1155840
    buffer_load_dword v55, v1, s[8:11], s34 offen
    s_mov_b32 s34, 1187840
    buffer_load_dword v56, v1, s[8:11], s34 offen
    s_mov_b32 s34, 1189120
    buffer_load_dword v57, v1, s[8:11], s34 offen
    s_mov_b32 s34, 1190400
    buffer_load_dword v58, v1, s[8:11], s34 offen
    s_mov_b32 s34, 1191680
    buffer_load_dword v59, v1, s[8:11], s34 offen
    s_mov_b32 s34, 1192960
    buffer_load_dword v60, v1, s[8:11], s34 offen
    s_mov_b32 s34, 1194240
    buffer_load_dword v61, v1, s[8:11], s34 offen
    s_mov_b32 s34, 1195520
    buffer_load_dword v62, v1, s[8:11], s34 offen
    s_mov_b32 s34, 1196800
    buffer_load_dword v63, v1, s[8:11], s34 offen
    s_waitcnt vmcnt(32)
    v_perm_b32 v4, v17, v16, s38
    v_accvgpr_write_b32 a192, v4
    v_perm_b32 v5, v19, v18, s38
    v_accvgpr_write_b32 a193, v5
    v_perm_b32 v6, v21, v20, s38
    v_accvgpr_write_b32 a194, v6
    v_perm_b32 v7, v23, v22, s38
    v_accvgpr_write_b32 a195, v7
    v_perm_b32 v4, v25, v24, s38
    v_accvgpr_write_b32 a200, v4
    v_perm_b32 v5, v27, v26, s38
    v_accvgpr_write_b32 a201, v5
    v_perm_b32 v6, v29, v28, s38
    v_accvgpr_write_b32 a202, v6
    v_perm_b32 v7, v31, v30, s38
    v_accvgpr_write_b32 a203, v7
    v_perm_b32 v4, v17, v16, s39
    v_accvgpr_write_b32 a196, v4
    v_perm_b32 v5, v19, v18, s39
    v_accvgpr_write_b32 a197, v5
    v_perm_b32 v6, v21, v20, s39
    v_accvgpr_write_b32 a198, v6
    v_perm_b32 v7, v23, v22, s39
    v_accvgpr_write_b32 a199, v7
    v_perm_b32 v4, v25, v24, s39
    v_accvgpr_write_b32 a204, v4
    v_perm_b32 v5, v27, v26, s39
    v_accvgpr_write_b32 a205, v5
    v_perm_b32 v6, v29, v28, s39
    v_accvgpr_write_b32 a206, v6
    v_perm_b32 v7, v31, v30, s39
    v_accvgpr_write_b32 a207, v7
    s_mov_b32 s34, 1228800
    buffer_load_dword v16, v1, s[8:11], s34 offen
    s_mov_b32 s34, 1230080
    buffer_load_dword v17, v1, s[8:11], s34 offen
    s_mov_b32 s34, 1231360
    buffer_load_dword v18, v1, s[8:11], s34 offen
    s_mov_b32 s34, 1232640
    buffer_load_dword v19, v1, s[8:11], s34 offen
    s_mov_b32 s34, 1233920
    buffer_load_dword v20, v1, s[8:11], s34 offen
    s_mov_b32 s34, 1235200
    buffer_load_dword v21, v1, s[8:11], s34 offen
    s_mov_b32 s34, 1236480
    buffer_load_dword v22, v1, s[8:11], s34 offen
    s_mov_b32 s34, 1237760
    buffer_load_dword v23, v1, s[8:11], s34 offen
    s_mov_b32 s34, 1269760
    buffer_load_dword v24, v1, s[8:11], s34 offen
    s_mov_b32 s34, 1271040
    buffer_load_dword v25, v1, s[8:11], s34 offen
    s_mov_b32 s34, 1272320
    buffer_load_dword v26, v1, s[8:11], s34 offen
    s_mov_b32 s34, 1273600
    buffer_load_dword v27, v1, s[8:11], s34 offen
    s_mov_b32 s34, 1274880
    buffer_load_dword v28, v1, s[8:11], s34 offen
    s_mov_b32 s34, 1276160
    buffer_load_dword v29, v1, s[8:11], s34 offen
    s_mov_b32 s34, 1277440
    buffer_load_dword v30, v1, s[8:11], s34 offen
    s_mov_b32 s34, 1278720
    buffer_load_dword v31, v1, s[8:11], s34 offen
    s_waitcnt vmcnt(32)
    v_perm_b32 v4, v33, v32, s38
    v_accvgpr_write_b32 a208, v4
    v_perm_b32 v5, v35, v34, s38
    v_accvgpr_write_b32 a209, v5
    v_perm_b32 v6, v37, v36, s38
    v_accvgpr_write_b32 a210, v6
    v_perm_b32 v7, v39, v38, s38
    v_accvgpr_write_b32 a211, v7
    v_perm_b32 v4, v41, v40, s38
    v_accvgpr_write_b32 a216, v4
    v_perm_b32 v5, v43, v42, s38
    v_accvgpr_write_b32 a217, v5
    v_perm_b32 v6, v45, v44, s38
    v_accvgpr_write_b32 a218, v6
    v_perm_b32 v7, v47, v46, s38
    v_accvgpr_write_b32 a219, v7
    v_perm_b32 v4, v33, v32, s39
    v_accvgpr_write_b32 a212, v4
    v_perm_b32 v5, v35, v34, s39
    v_accvgpr_write_b32 a213, v5
    v_perm_b32 v6, v37, v36, s39
    v_accvgpr_write_b32 a214, v6
    v_perm_b32 v7, v39, v38, s39
    v_accvgpr_write_b32 a215, v7
    v_perm_b32 v4, v41, v40, s39
    v_accvgpr_write_b32 a220, v4
    v_perm_b32 v5, v43, v42, s39
    v_accvgpr_write_b32 a221, v5
    v_perm_b32 v6, v45, v44, s39
    v_accvgpr_write_b32 a222, v6
    v_perm_b32 v7, v47, v46, s39
    v_accvgpr_write_b32 a223, v7
    s_mov_b32 s8, s42
    s_mov_b32 s9, s43
    s_mov_b32 s10, 2211840
    s_mov_b32 s34, 0
    buffer_load_dword v32, v2, s[8:11], s34 offen
    s_mov_b32 s34, 1280
    buffer_load_dword v33, v2, s[8:11], s34 offen
    s_mov_b32 s34, 2560
    buffer_load_dword v34, v2, s[8:11], s34 offen
    s_mov_b32 s34, 3840
    buffer_load_dword v35, v2, s[8:11], s34 offen
    s_mov_b32 s34, 20480
    buffer_load_dword v36, v2, s[8:11], s34 offen
    s_mov_b32 s34, 21760
    buffer_load_dword v37, v2, s[8:11], s34 offen
    s_mov_b32 s34, 23040
    buffer_load_dword v38, v2, s[8:11], s34 offen
    s_mov_b32 s34, 24320
    buffer_load_dword v39, v2, s[8:11], s34 offen
    s_mov_b32 s34, 40960
    buffer_load_dword v40, v2, s[8:11], s34 offen
    s_mov_b32 s34, 42240
    buffer_load_dword v41, v2, s[8:11], s34 offen
    s_mov_b32 s34, 43520
    buffer_load_dword v42, v2, s[8:11], s34 offen
    s_mov_b32 s34, 44800
    buffer_load_dword v43, v2, s[8:11], s34 offen
    s_mov_b32 s34, 61440
    buffer_load_dword v44, v2, s[8:11], s34 offen
    s_mov_b32 s34, 62720
    buffer_load_dword v45, v2, s[8:11], s34 offen
    s_mov_b32 s34, 64000
    buffer_load_dword v46, v2, s[8:11], s34 offen
    s_mov_b32 s34, 65280
    buffer_load_dword v47, v2, s[8:11], s34 offen
    s_waitcnt vmcnt(32)
    v_perm_b32 v4, v49, v48, s38
    v_accvgpr_write_b32 a224, v4
    v_perm_b32 v5, v51, v50, s38
    v_accvgpr_write_b32 a225, v5
    v_perm_b32 v6, v53, v52, s38
    v_accvgpr_write_b32 a226, v6
    v_perm_b32 v7, v55, v54, s38
    v_accvgpr_write_b32 a227, v7
    v_perm_b32 v4, v57, v56, s38
    v_accvgpr_write_b32 a232, v4
    v_perm_b32 v5, v59, v58, s38
    v_accvgpr_write_b32 a233, v5
    v_perm_b32 v6, v61, v60, s38
    v_accvgpr_write_b32 a234, v6
    v_perm_b32 v7, v63, v62, s38
    v_accvgpr_write_b32 a235, v7
    v_perm_b32 v4, v49, v48, s39
    v_accvgpr_write_b32 a228, v4
    v_perm_b32 v5, v51, v50, s39
    v_accvgpr_write_b32 a229, v5
    v_perm_b32 v6, v53, v52, s39
    v_accvgpr_write_b32 a230, v6
    v_perm_b32 v7, v55, v54, s39
    v_accvgpr_write_b32 a231, v7
    v_perm_b32 v4, v57, v56, s39
    v_accvgpr_write_b32 a236, v4
    v_perm_b32 v5, v59, v58, s39
    v_accvgpr_write_b32 a237, v5
    v_perm_b32 v6, v61, v60, s39
    v_accvgpr_write_b32 a238, v6
    v_perm_b32 v7, v63, v62, s39
    v_accvgpr_write_b32 a239, v7
    s_mov_b32 s34, 81920
    buffer_load_dword v48, v2, s[8:11], s34 offen
    s_mov_b32 s34, 83200
    buffer_load_dword v49, v2, s[8:11], s34 offen
    s_mov_b32 s34, 84480
    buffer_load_dword v50, v2, s[8:11], s34 offen
    s_mov_b32 s34, 85760
    buffer_load_dword v51, v2, s[8:11], s34 offen
    s_mov_b32 s34, 102400
    buffer_load_dword v52, v2, s[8:11], s34 offen
    s_mov_b32 s34, 103680
    buffer_load_dword v53, v2, s[8:11], s34 offen
    s_mov_b32 s34, 104960
    buffer_load_dword v54, v2, s[8:11], s34 offen
    s_mov_b32 s34, 106240
    buffer_load_dword v55, v2, s[8:11], s34 offen
    s_mov_b32 s34, 122880
    buffer_load_dword v56, v2, s[8:11], s34 offen
    s_mov_b32 s34, 124160
    buffer_load_dword v57, v2, s[8:11], s34 offen
    s_mov_b32 s34, 125440
    buffer_load_dword v58, v2, s[8:11], s34 offen
    s_mov_b32 s34, 126720
    buffer_load_dword v59, v2, s[8:11], s34 offen
    s_mov_b32 s34, 143360
    buffer_load_dword v60, v2, s[8:11], s34 offen
    s_mov_b32 s34, 144640
    buffer_load_dword v61, v2, s[8:11], s34 offen
    s_mov_b32 s34, 145920
    buffer_load_dword v62, v2, s[8:11], s34 offen
    s_mov_b32 s34, 147200
    buffer_load_dword v63, v2, s[8:11], s34 offen
    s_waitcnt vmcnt(32)
    v_perm_b32 v4, v17, v16, s38
    v_accvgpr_write_b32 a240, v4
    v_perm_b32 v5, v19, v18, s38
    v_accvgpr_write_b32 a241, v5
    v_perm_b32 v6, v21, v20, s38
    v_accvgpr_write_b32 a242, v6
    v_perm_b32 v7, v23, v22, s38
    v_accvgpr_write_b32 a243, v7
    v_perm_b32 v4, v25, v24, s38
    v_accvgpr_write_b32 a248, v4
    v_perm_b32 v5, v27, v26, s38
    v_accvgpr_write_b32 a249, v5
    v_perm_b32 v6, v29, v28, s38
    v_accvgpr_write_b32 a250, v6
    v_perm_b32 v7, v31, v30, s38
    v_accvgpr_write_b32 a251, v7
    v_perm_b32 v4, v17, v16, s39
    v_accvgpr_write_b32 a244, v4
    v_perm_b32 v5, v19, v18, s39
    v_accvgpr_write_b32 a245, v5
    v_perm_b32 v6, v21, v20, s39
    v_accvgpr_write_b32 a246, v6
    v_perm_b32 v7, v23, v22, s39
    v_accvgpr_write_b32 a247, v7
    v_perm_b32 v4, v25, v24, s39
    v_accvgpr_write_b32 a252, v4
    v_perm_b32 v5, v27, v26, s39
    v_accvgpr_write_b32 a253, v5
    v_perm_b32 v6, v29, v28, s39
    v_accvgpr_write_b32 a254, v6
    v_perm_b32 v7, v31, v30, s39
    v_accvgpr_write_b32 a255, v7
    s_mov_b32 s34, 163840
    buffer_load_dword v16, v2, s[8:11], s34 offen
    s_mov_b32 s34, 165120
    buffer_load_dword v17, v2, s[8:11], s34 offen
    s_mov_b32 s34, 166400
    buffer_load_dword v18, v2, s[8:11], s34 offen
    s_mov_b32 s34, 167680
    buffer_load_dword v19, v2, s[8:11], s34 offen
    s_mov_b32 s34, 184320
    buffer_load_dword v20, v2, s[8:11], s34 offen
    s_mov_b32 s34, 185600
    buffer_load_dword v21, v2, s[8:11], s34 offen
    s_mov_b32 s34, 186880
    buffer_load_dword v22, v2, s[8:11], s34 offen
    s_mov_b32 s34, 188160
    buffer_load_dword v23, v2, s[8:11], s34 offen
    s_mov_b32 s34, 204800
    buffer_load_dword v24, v2, s[8:11], s34 offen
    s_mov_b32 s34, 206080
    buffer_load_dword v25, v2, s[8:11], s34 offen
    s_mov_b32 s34, 207360
    buffer_load_dword v26, v2, s[8:11], s34 offen
    s_mov_b32 s34, 208640
    buffer_load_dword v27, v2, s[8:11], s34 offen
    s_mov_b32 s34, 225280
    buffer_load_dword v28, v2, s[8:11], s34 offen
    s_mov_b32 s34, 226560
    buffer_load_dword v29, v2, s[8:11], s34 offen
    s_mov_b32 s34, 227840
    buffer_load_dword v30, v2, s[8:11], s34 offen
    s_mov_b32 s34, 229120
    buffer_load_dword v31, v2, s[8:11], s34 offen
    s_waitcnt vmcnt(32)
    v_perm_b32 v144, v33, v32, s38
    v_perm_b32 v145, v35, v34, s38
    v_perm_b32 v146, v37, v36, s38
    v_perm_b32 v147, v39, v38, s38
    v_perm_b32 v152, v41, v40, s38
    v_perm_b32 v153, v43, v42, s38
    v_perm_b32 v154, v45, v44, s38
    v_perm_b32 v155, v47, v46, s38
    v_perm_b32 v148, v33, v32, s39
    v_perm_b32 v149, v35, v34, s39
    v_perm_b32 v150, v37, v36, s39
    v_perm_b32 v151, v39, v38, s39
    v_perm_b32 v156, v41, v40, s39
    v_perm_b32 v157, v43, v42, s39
    v_perm_b32 v158, v45, v44, s39
    v_perm_b32 v159, v47, v46, s39
    s_mov_b32 s34, 245760
    buffer_load_dword v32, v2, s[8:11], s34 offen
    s_mov_b32 s34, 247040
    buffer_load_dword v33, v2, s[8:11], s34 offen
    s_mov_b32 s34, 248320
    buffer_load_dword v34, v2, s[8:11], s34 offen
    s_mov_b32 s34, 249600
    buffer_load_dword v35, v2, s[8:11], s34 offen
    s_mov_b32 s34, 266240
    buffer_load_dword v36, v2, s[8:11], s34 offen
    s_mov_b32 s34, 267520
    buffer_load_dword v37, v2, s[8:11], s34 offen
    s_mov_b32 s34, 268800
    buffer_load_dword v38, v2, s[8:11], s34 offen
    s_mov_b32 s34, 270080
    buffer_load_dword v39, v2, s[8:11], s34 offen
    s_mov_b32 s34, 286720
    buffer_load_dword v40, v2, s[8:11], s34 offen
    s_mov_b32 s34, 288000
    buffer_load_dword v41, v2, s[8:11], s34 offen
    s_mov_b32 s34, 289280
    buffer_load_dword v42, v2, s[8:11], s34 offen
    s_mov_b32 s34, 290560
    buffer_load_dword v43, v2, s[8:11], s34 offen
    s_mov_b32 s34, 307200
    buffer_load_dword v44, v2, s[8:11], s34 offen
    s_mov_b32 s34, 308480
    buffer_load_dword v45, v2, s[8:11], s34 offen
    s_mov_b32 s34, 309760
    buffer_load_dword v46, v2, s[8:11], s34 offen
    s_mov_b32 s34, 311040
    buffer_load_dword v47, v2, s[8:11], s34 offen
    s_waitcnt vmcnt(32)
    v_perm_b32 v160, v49, v48, s38
    v_perm_b32 v161, v51, v50, s38
    v_perm_b32 v162, v53, v52, s38
    v_perm_b32 v163, v55, v54, s38
    v_perm_b32 v168, v57, v56, s38
    v_perm_b32 v169, v59, v58, s38
    v_perm_b32 v170, v61, v60, s38
    v_perm_b32 v171, v63, v62, s38
    v_perm_b32 v164, v49, v48, s39
    v_perm_b32 v165, v51, v50, s39
    v_perm_b32 v166, v53, v52, s39
    v_perm_b32 v167, v55, v54, s39
    v_perm_b32 v172, v57, v56, s39
    v_perm_b32 v173, v59, v58, s39
    v_perm_b32 v174, v61, v60, s39
    v_perm_b32 v175, v63, v62, s39
    s_mov_b32 s34, 327680
    buffer_load_dword v48, v2, s[8:11], s34 offen
    s_mov_b32 s34, 328960
    buffer_load_dword v49, v2, s[8:11], s34 offen
    s_mov_b32 s34, 330240
    buffer_load_dword v50, v2, s[8:11], s34 offen
    s_mov_b32 s34, 331520
    buffer_load_dword v51, v2, s[8:11], s34 offen
    s_mov_b32 s34, 348160
    buffer_load_dword v52, v2, s[8:11], s34 offen
    s_mov_b32 s34, 349440
    buffer_load_dword v53, v2, s[8:11], s34 offen
    s_mov_b32 s34, 350720
    buffer_load_dword v54, v2, s[8:11], s34 offen
    s_mov_b32 s34, 352000
    buffer_load_dword v55, v2, s[8:11], s34 offen
    s_mov_b32 s34, 368640
    buffer_load_dword v56, v2, s[8:11], s34 offen
    s_mov_b32 s34, 369920
    buffer_load_dword v57, v2, s[8:11], s34 offen
    s_mov_b32 s34, 371200
    buffer_load_dword v58, v2, s[8:11], s34 offen
    s_mov_b32 s34, 372480
    buffer_load_dword v59, v2, s[8:11], s34 offen
    s_mov_b32 s34, 389120
    buffer_load_dword v60, v2, s[8:11], s34 offen
    s_mov_b32 s34, 390400
    buffer_load_dword v61, v2, s[8:11], s34 offen
    s_mov_b32 s34, 391680
    buffer_load_dword v62, v2, s[8:11], s34 offen
    s_mov_b32 s34, 392960
    buffer_load_dword v63, v2, s[8:11], s34 offen
    s_waitcnt vmcnt(32)
    v_perm_b32 v176, v17, v16, s38
    v_perm_b32 v177, v19, v18, s38
    v_perm_b32 v178, v21, v20, s38
    v_perm_b32 v179, v23, v22, s38
    v_perm_b32 v184, v25, v24, s38
    v_perm_b32 v185, v27, v26, s38
    v_perm_b32 v186, v29, v28, s38
    v_perm_b32 v187, v31, v30, s38
    v_perm_b32 v180, v17, v16, s39
    v_perm_b32 v181, v19, v18, s39
    v_perm_b32 v182, v21, v20, s39
    v_perm_b32 v183, v23, v22, s39
    v_perm_b32 v188, v25, v24, s39
    v_perm_b32 v189, v27, v26, s39
    v_perm_b32 v190, v29, v28, s39
    v_perm_b32 v191, v31, v30, s39
    s_mov_b32 s34, 409600
    buffer_load_dword v16, v2, s[8:11], s34 offen
    s_mov_b32 s34, 410880
    buffer_load_dword v17, v2, s[8:11], s34 offen
    s_mov_b32 s34, 412160
    buffer_load_dword v18, v2, s[8:11], s34 offen
    s_mov_b32 s34, 413440
    buffer_load_dword v19, v2, s[8:11], s34 offen
    s_mov_b32 s34, 430080
    buffer_load_dword v20, v2, s[8:11], s34 offen
    s_mov_b32 s34, 431360
    buffer_load_dword v21, v2, s[8:11], s34 offen
    s_mov_b32 s34, 432640
    buffer_load_dword v22, v2, s[8:11], s34 offen
    s_mov_b32 s34, 433920
    buffer_load_dword v23, v2, s[8:11], s34 offen
    s_mov_b32 s34, 450560
    buffer_load_dword v24, v2, s[8:11], s34 offen
    s_mov_b32 s34, 451840
    buffer_load_dword v25, v2, s[8:11], s34 offen
    s_mov_b32 s34, 453120
    buffer_load_dword v26, v2, s[8:11], s34 offen
    s_mov_b32 s34, 454400
    buffer_load_dword v27, v2, s[8:11], s34 offen
    s_mov_b32 s34, 471040
    buffer_load_dword v28, v2, s[8:11], s34 offen
    s_mov_b32 s34, 472320
    buffer_load_dword v29, v2, s[8:11], s34 offen
    s_mov_b32 s34, 473600
    buffer_load_dword v30, v2, s[8:11], s34 offen
    s_mov_b32 s34, 474880
    buffer_load_dword v31, v2, s[8:11], s34 offen
    s_waitcnt vmcnt(32)
    v_perm_b32 v192, v33, v32, s38
    v_perm_b32 v193, v35, v34, s38
    v_perm_b32 v194, v37, v36, s38
    v_perm_b32 v195, v39, v38, s38
    v_perm_b32 v200, v41, v40, s38
    v_perm_b32 v201, v43, v42, s38
    v_perm_b32 v202, v45, v44, s38
    v_perm_b32 v203, v47, v46, s38
    v_perm_b32 v196, v33, v32, s39
    v_perm_b32 v197, v35, v34, s39
    v_perm_b32 v198, v37, v36, s39
    v_perm_b32 v199, v39, v38, s39
    v_perm_b32 v204, v41, v40, s39
    v_perm_b32 v205, v43, v42, s39
    v_perm_b32 v206, v45, v44, s39
    v_perm_b32 v207, v47, v46, s39
    s_mov_b32 s34, 491520
    buffer_load_dword v32, v2, s[8:11], s34 offen
    s_mov_b32 s34, 492800
    buffer_load_dword v33, v2, s[8:11], s34 offen
    s_mov_b32 s34, 494080
    buffer_load_dword v34, v2, s[8:11], s34 offen
    s_mov_b32 s34, 495360
    buffer_load_dword v35, v2, s[8:11], s34 offen
    s_mov_b32 s34, 512000
    buffer_load_dword v36, v2, s[8:11], s34 offen
    s_mov_b32 s34, 513280
    buffer_load_dword v37, v2, s[8:11], s34 offen
    s_mov_b32 s34, 514560
    buffer_load_dword v38, v2, s[8:11], s34 offen
    s_mov_b32 s34, 515840
    buffer_load_dword v39, v2, s[8:11], s34 offen
    s_mov_b32 s34, 532480
    buffer_load_dword v40, v2, s[8:11], s34 offen
    s_mov_b32 s34, 533760
    buffer_load_dword v41, v2, s[8:11], s34 offen
    s_mov_b32 s34, 535040
    buffer_load_dword v42, v2, s[8:11], s34 offen
    s_mov_b32 s34, 536320
    buffer_load_dword v43, v2, s[8:11], s34 offen
    s_mov_b32 s34, 552960
    buffer_load_dword v44, v2, s[8:11], s34 offen
    s_mov_b32 s34, 554240
    buffer_load_dword v45, v2, s[8:11], s34 offen
    s_mov_b32 s34, 555520
    buffer_load_dword v46, v2, s[8:11], s34 offen
    s_mov_b32 s34, 556800
    buffer_load_dword v47, v2, s[8:11], s34 offen
    s_waitcnt vmcnt(32)
    v_perm_b32 v208, v49, v48, s38
    v_perm_b32 v209, v51, v50, s38
    v_perm_b32 v210, v53, v52, s38
    v_perm_b32 v211, v55, v54, s38
    v_perm_b32 v216, v57, v56, s38
    v_perm_b32 v217, v59, v58, s38
    v_perm_b32 v218, v61, v60, s38
    v_perm_b32 v219, v63, v62, s38
    v_perm_b32 v212, v49, v48, s39
    v_perm_b32 v213, v51, v50, s39
    v_perm_b32 v214, v53, v52, s39
    v_perm_b32 v215, v55, v54, s39
    v_perm_b32 v220, v57, v56, s39
    v_perm_b32 v221, v59, v58, s39
    v_perm_b32 v222, v61, v60, s39
    v_perm_b32 v223, v63, v62, s39
    s_waitcnt vmcnt(16)
    v_perm_b32 v224, v17, v16, s38
    v_perm_b32 v225, v19, v18, s38
    v_perm_b32 v226, v21, v20, s38
    v_perm_b32 v227, v23, v22, s38
    v_perm_b32 v232, v25, v24, s38
    v_perm_b32 v233, v27, v26, s38
    v_perm_b32 v234, v29, v28, s38
    v_perm_b32 v235, v31, v30, s38
    v_perm_b32 v228, v17, v16, s39
    v_perm_b32 v229, v19, v18, s39
    v_perm_b32 v230, v21, v20, s39
    v_perm_b32 v231, v23, v22, s39
    v_perm_b32 v236, v25, v24, s39
    v_perm_b32 v237, v27, v26, s39
    v_perm_b32 v238, v29, v28, s39
    v_perm_b32 v239, v31, v30, s39
    s_waitcnt vmcnt(0)
    v_perm_b32 v240, v33, v32, s38
    v_perm_b32 v241, v35, v34, s38
    v_perm_b32 v242, v37, v36, s38
    v_perm_b32 v243, v39, v38, s38
    v_perm_b32 v248, v41, v40, s38
    v_perm_b32 v249, v43, v42, s38
    v_perm_b32 v250, v45, v44, s38
    v_perm_b32 v251, v47, v46, s38
    v_perm_b32 v244, v33, v32, s39
    v_perm_b32 v245, v35, v34, s39
    v_perm_b32 v246, v37, v36, s39
    v_perm_b32 v247, v39, v38, s39
    v_perm_b32 v252, v41, v40, s39
    v_perm_b32 v253, v43, v42, s39
    v_perm_b32 v254, v45, v44, s39
    v_perm_b32 v255, v47, v46, s39
    v_lshlrev_b32 v0, 4, v15
    v_and_b32 v12, 15, v15
    v_mul_u32_u24 v1, 1280, v12
    v_lshrrev_b32 v12, 4, v15
    v_lshlrev_b32 v12, 4, v12
    s_lshl_b32 s34, s24, 6
    v_add_u32 v12, s34, v12
    v_add_u32 v1, v1, v12
    s_lshl_b32 s34, s13, 11
    v_add_u32 v2, s34, v0
    s_mov_b32 s8, s44
    s_mov_b32 s9, s45
    s_mov_b32 s10, 1280
    buffer_load_dwordx4 v[16:19], v12, s[8:11], 0 offen
    s_mov_b32 s37, 0xffff0000
    s_waitcnt vmcnt(0)
    v_lshlrev_b32 v4, 16, v16
    v_and_b32 v8, s37, v16
    v_lshlrev_b32 v5, 16, v17
    v_and_b32 v9, s37, v17
    v_lshlrev_b32 v6, 16, v18
    v_and_b32 v10, s37, v18
    v_lshlrev_b32 v7, 16, v19
    v_and_b32 v11, s37, v19
    s_mov_b32 s31, 0
    v_mov_b32 v28, v0
    v_mov_b32 v29, v1
    s_mov_b32 s39, s25
B_unit:
    s_lshl_b32 s34, s25, 7
    s_add_u32 s34, s34, 16384
    v_mov_b32 v24, 0
B_qh:
    buffer_load_dword v25, v24, s[4:7], s34 offen sc1
    s_add_u32 s32, s32, 1
    s_cmp_gt_u32 s32, 0x40000
    s_cbranch_scc1 L_abort
    s_waitcnt vmcnt(0)
    v_cmp_gt_u32 vcc, 30, v25
    s_cbranch_vccz B_qh_ok
    s_sleep 8
    s_branch B_qh
B_qh_ok:
    s_lshl_b32 s27, s25, 1
    s_add_u32 s27, s27, s26
    s_mul_i32 s28, s27, 55296
    s_mul_i32 s34, s13, 14336
    s_add_u32 s28, s28, s34
    s_add_u32 s28, s28, 88080384
    s_lshl_b32 s29, s27, 17
    s_lshl_b32 s34, s13, 15
    s_add_u32 s29, s29, s34
    s_add_u32 s29, s29, 71303168
    s_mul_i32 s30, s27, 20480
    buffer_load_dwordx4 v[32:35], v28, s[4:7], s28 offen offset:0 sc1
    buffer_load_dwordx4 v[36:39], v28, s[4:7], s28 offen offset:1024 sc1
    buffer_load_dwordx4 v[40:43], v28, s[4:7], s28 offen offset:2048 sc1
    buffer_load_dwordx4 v[44:47], v28, s[4:7], s28 offen offset:3072 sc1
    s_add_u32 s28, s28, 4096
    buffer_load_dwordx4 v[48:51], v28, s[4:7], s28 offen offset:0 sc1
    buffer_load_dwordx4 v[52:55], v28, s[4:7], s28 offen offset:1024 sc1
    buffer_load_dwordx4 v[56:59], v28, s[4:7], s28 offen offset:2048 sc1
    buffer_load_dwordx4 v[60:63], v28, s[4:7], s28 offen offset:3072 sc1
    s_add_u32 s28, s28, 4096
    buffer_load_dwordx4 v[64:67], v28, s[4:7], s28 offen offset:0 sc1
    buffer_load_dwordx4 v[68:71], v28, s[4:7], s28 offen offset:1024 sc1
    buffer_load_dwordx4 v[72:75], v28, s[4:7], s28 offen offset:2048 sc1
    buffer_load_dwordx4 v[76:79], v28, s[4:7], s28 offen offset:3072 sc1
    s_cmp_eq_u32 s13, 3
    s_cselect_b32 s28, 0x7ff00000, s28
    s_add_u32 s28, s28, 4096
    buffer_load_dwordx4 v[80:83], v28, s[4:7], s28 offen offset:0 sc1
    buffer_load_dwordx4 v[84:87], v28, s[4:7], s28 offen offset:1024 sc1
    buffer_load_dwordx4 v[20:23], v1, s[20:23], s30 offen
    s_waitcnt vmcnt(14)
    v_mfma_f32_16x16x32_bf16 v[12:15], v[144:147], v[32:35], 0
    v_mfma_f32_16x16x32_bf16 v[16:19], v[148:151], v[32:35], 0
    s_waitcnt vmcnt(13)
    v_mfma_f32_16x16x32_bf16 v[12:15], v[152:155], v[36:39], v[12:15]
    v_mfma_f32_16x16x32_bf16 v[16:19], v[156:159], v[36:39], v[16:19]
    s_waitcnt vmcnt(12)
    v_mfma_f32_16x16x32_bf16 v[12:15], v[160:163], v[40:43], v[12:15]
    v_mfma_f32_16x16x32_bf16 v[16:19], v[164:167], v[40:43], v[16:19]
    s_waitcnt vmcnt(11)
    v_mfma_f32_16x16x32_bf16 v[12:15], v[168:171], v[44:47], v[12:15]
    v_mfma_f32_16x16x32_bf16 v[16:19], v[172:175], v[44:47], v[16:19]
    s_waitcnt vmcnt(10)
    v_mfma_f32_16x16x32_bf16 v[12:15], v[176:179], v[48:51], v[12:15]
    v_mfma_f32_16x16x32_bf16 v[16:19], v[180:183], v[48:51], v[16:19]
    s_waitcnt vmcnt(9)
    v_mfma_f32_16x16x32_bf16 v[12:15], v[184:187], v[52:55], v[12:15]
    v_mfma_f32_16x16x32_bf16 v[16:19], v[188:191], v[52:55], v[16:19]
    s_waitcnt vmcnt(8)
    v_mfma_f32_16x16x32_bf16 v[12:15], v[192:195], v[56:59], v[12:15]
    v_mfma_f32_16x16x32_bf16 v[16:19], v[196:199], v[56:59], v[16:19]
    s_waitcnt vmcnt(7)
    v_mfma_f32_16x16x32_bf16 v[12:15], v[200:203], v[60:63], v[12:15]
    v_mfma_f32_16x16x32_bf16 v[16:19], v[204:207], v[60:63], v[16:19]
    s_waitcnt vmcnt(6)
    v_mfma_f32_16x16x32_bf16 v[12:15], v[208:211], v[64:67], v[12:15]
    v_mfma_f32_16x16x32_bf16 v[16:19], v[212:215], v[64:67], v[16:19]
    s_waitcnt vmcnt(5)
    v_mfma_f32_16x16x32_bf16 v[12:15], v[216:219], v[68:71], v[12:15]
    v_mfma_f32_16x16x32_bf16 v[16:19], v[220:223], v[68:71], v[16:19]
    s_waitcnt vmcnt(4)
    v_mfma_f32_16x16x32_bf16 v[12:15], v[224:227], v[72:75], v[12:15]
    v_mfma_f32_16x16x32_bf16 v[16:19], v[228:231], v[72:75], v[16:19]
    s_waitcnt vmcnt(3)
    v_mfma_f32_16x16x32_bf16 v[12:15], v[232:235], v[76:79], v[12:15]
    v_mfma_f32_16x16x32_bf16 v[16:19], v[236:239], v[76:79], v[16:19]
    s_waitcnt vmcnt(2)
    v_mfma_f32_16x16x32_bf16 v[12:15], v[240:243], v[80:83], v[12:15]
    v_mfma_f32_16x16x32_bf16 v[16:19], v[244:247], v[80:83], v[16:19]
    s_waitcnt vmcnt(1)
    v_mfma_f32_16x16x32_bf16 v[12:15], v[248:251], v[84:87], v[12:15]
    v_mfma_f32_16x16x32_bf16 v[16:19], v[252:255], v[84:87], v[16:19]
    s_lshl_b32 s34, s25, 2
    s_add_u32 s34, s34, s13
    s_lshl_b32 s34, s34, 7
    s_add_u32 s34, s34, 3145728
B_o:
    buffer_load_dword v25, v24, s[4:7], s34 offen sc1
    s_add_u32 s32, s32, 1
    s_cmp_gt_u32 s32, 0x40000
    s_cbranch_scc1 L_abort
    s_waitcnt vmcnt(0)
    v_cmp_gt_u32 vcc, 8, v25
    s_cbranch_vccz B_o_ok
    s_sleep 1
    s_branch B_o
B_o_ok:
    buffer_load_dwordx4 v[32:35], v28, s[4:7], s29 offen offset:0 sc1
    buffer_load_dwordx4 v[36:39], v28, s[4:7], s29 offen offset:1024 sc1
    buffer_load_dwordx4 v[40:43], v28, s[4:7], s29 offen offset:2048 sc1
    buffer_load_dwordx4 v[44:47], v28, s[4:7], s29 offen offset:3072 sc1
    s_add_u32 s29, s29, 4096
    buffer_load_dwordx4 v[48:51], v28, s[4:7], s29 offen offset:0 sc1
    buffer_load_dwordx4 v[52:55], v28, s[4:7], s29 offen offset:1024 sc1
    buffer_load_dwordx4 v[56:59], v28, s[4:7], s29 offen offset:2048 sc1
    buffer_load_dwordx4 v[60:63], v28, s[4:7], s29 offen offset:3072 sc1
    s_add_u32 s29, s29, 4096
    buffer_load_dwordx4 v[64:67], v28, s[4:7], s29 offen offset:0 sc1
    buffer_load_dwordx4 v[68:71], v28, s[4:7], s29 offen offset:1024 sc1
    buffer_load_dwordx4 v[72:75], v28, s[4:7], s29 offen offset:2048 sc1
    buffer_load_dwordx4 v[76:79], v28, s[4:7], s29 offen offset:3072 sc1
    s_add_u32 s29, s29, 4096
    buffer_load_dwordx4 v[80:83], v28, s[4:7], s29 offen offset:0 sc1
    buffer_load_dwordx4 v[84:87], v28, s[4:7], s29 offen offset:1024 sc1
    buffer_load_dwordx4 v[88:91], v28, s[4:7], s29 offen offset:2048 sc1
    buffer_load_dwordx4 v[92:95], v28, s[4:7], s29 offen offset:3072 sc1
    s_add_u32 s29, s29, 4096
    buffer_load_dwordx4 v[96:99], v28, s[4:7], s29 offen offset:0 sc1
    buffer_load_dwordx4 v[100:103], v28, s[4:7], s29 offen offset:1024 sc1
    buffer_load_dwordx4 v[104:107], v28, s[4:7], s29 offen offset:2048 sc1
    buffer_load_dwordx4 v[108:111], v28, s[4:7], s29 offen offset:3072 sc1
    s_add_u32 s29, s29, 4096
    buffer_load_dwordx4 v[112:115], v28, s[4:7], s29 offen offset:0 sc1
    buffer_load_dwordx4 v[116:119], v28, s[4:7], s29 offen offset:1024 sc1
    buffer_load_dwordx4 v[120:123], v28, s[4:7], s29 offen offset:2048 sc1
    buffer_load_dwordx4 v[124:127], v28, s[4:7], s29 offen offset:3072 sc1
    s_waitcnt vmcnt(23)
    v_mfma_f32_16x16x32_bf16 v[12:15], a[0:3], v[32:35], v[12:15]
    v_mfma_f32_16x16x32_bf16 v[16:19], a[4:7], v[32:35], v[16:19]
    s_add_u32 s29, s29, 4096
    buffer_load_dwordx4 v[32:35], v28, s[4:7], s29 offen offset:0 sc1
    s_waitcnt vmcnt(23)
    v_mfma_f32_16x16x32_bf16 v[12:15], a[8:11], v[36:39], v[12:15]
    v_mfma_f32_16x16x32_bf16 v[16:19], a[12:15], v[36:39], v[16:19]
    buffer_load_dwordx4 v[36:39], v28, s[4:7], s29 offen offset:1024 sc1
    s_waitcnt vmcnt(23)
    v_mfma_f32_16x16x32_bf16 v[12:15], a[16:19], v[40:43], v[12:15]
    v_mfma_f32_16x16x32_bf16 v[16:19], a[20:23], v[40:43], v[16:19]
    buffer_load_dwordx4 v[40:43], v28, s[4:7], s29 offen offset:2048 sc1
    s_waitcnt vmcnt(23)
    v_mfma_f32_16x16x32_bf16 v[12:15], a[24:27], v[44:47], v[12:15]
    v_mfma_f32_16x16x32_bf16 v[16:19], a[28:31], v[44:47], v[16:19]
    buffer_load_dwordx4 v[44:47], v28, s[4:7], s29 offen offset:3072 sc1
    s_waitcnt vmcnt(23)
    v_mfma_f32_16x16x32_bf16 v[12:15], a[32:35], v[48:51], v[12:15]
    v_mfma_f32_16x16x32_bf16 v[16:19], a[36:39], v[48:51], v[16:19]
    s_add_u32 s29, s29, 4096
    buffer_load_dwordx4 v[48:51], v28, s[4:7], s29 offen offset:0 sc1
    s_waitcnt vmcnt(23)
    v_mfma_f32_16x16x32_bf16 v[12:15], a[40:43], v[52:55], v[12:15]
    v_mfma_f32_16x16x32_bf16 v[16:19], a[44:47], v[52:55], v[16:19]
    buffer_load_dwordx4 v[52:55], v28, s[4:7], s29 offen offset:1024 sc1
    s_waitcnt vmcnt(23)
    v_mfma_f32_16x16x32_bf16 v[12:15], a[48:51], v[56:59], v[12:15]
    v_mfma_f32_16x16x32_bf16 v[16:19], a[52:55], v[56:59], v[16:19]
    buffer_load_dwordx4 v[56:59], v28, s[4:7], s29 offen offset:2048 sc1
    s_waitcnt vmcnt(23)
    v_mfma_f32_16x16x32_bf16 v[12:15], a[56:59], v[60:63], v[12:15]
    v_mfma_f32_16x16x32_bf16 v[16:19], a[60:63], v[60:63], v[16:19]
    buffer_load_dwordx4 v[60:63], v28, s[4:7], s29 offen offset:3072 sc1
    s_waitcnt vmcnt(23)
    v_mfma_f32_16x16x32_bf16 v[12:15], a[64:67], v[64:67], v[12:15]
    v_mfma_f32_16x16x32_bf16 v[16:19], a[68:71], v[64:67], v[16:19]
    s_waitcnt vmcnt(22)
    v_mfma_f32_16x16x32_bf16 v[12:15], a[72:75], v[68:71], v[12:15]
    v_mfma_f32_16x16x32_bf16 v[16:19], a[76:79], v[68:71], v[16:19]
    s_waitcnt vmcnt(21)
    v_mfma_f32_16x16x32_bf16 v[12:15], a[80:83], v[72:75], v[12:15]
    v_mfma_f32_16x16x32_bf16 v[16:19], a[84:87], v[72:75], v[16:19]
    s_waitcnt vmcnt(20)
    v_mfma_f32_16x16x32_bf16 v[12:15], a[88:91], v[76:79], v[12:15]
    v_mfma_f32_16x16x32_bf16 v[16:19], a[92:95], v[76:79], v[16:19]
    s_waitcnt vmcnt(19)
    v_mfma_f32_16x16x32_bf16 v[12:15], a[96:99], v[80:83], v[12:15]
    v_mfma_f32_16x16x32_bf16 v[16:19], a[100:103], v[80:83], v[16:19]
    s_waitcnt vmcnt(18)
    v_mfma_f32_16x16x32_bf16 v[12:15], a[104:107], v[84:87], v[12:15]
    v_mfma_f32_16x16x32_bf16 v[16:19], a[108:111], v[84:87], v[16:19]
    s_waitcnt vmcnt(17)
    v_mfma_f32_16x16x32_bf16 v[12:15], a[112:115], v[88:91], v[12:15]
    v_mfma_f32_16x16x32_bf16 v[16:19], a[116:119], v[88:91], v[16:19]
    s_waitcnt vmcnt(16)
    v_mfma_f32_16x16x32_bf16 v[12:15], a[120:123], v[92:95], v[12:15]
    v_mfma_f32_16x16x32_bf16 v[16:19], a[124:127], v[92:95], v[16:19]
    s_waitcnt vmcnt(15)
    v_mfma_f32_16x16x32_bf16 v[12:15], a[128:131], v[96:99], v[12:15]
    v_mfma_f32_16x16x32_bf16 v[16:19], a[132:135], v[96:99], v[16:19]
    s_waitcnt vmcnt(14)
    v_mfma_f32_16x16x32_bf16 v[12:15], a[136:139], v[100:103], v[12:15]
    v_mfma_f32_16x16x32_bf16 v[16:19], a[140:143], v[100:103], v[16:19]
    s_waitcnt vmcnt(13)
    v_mfma_f32_16x16x32_bf16 v[12:15], a[144:147], v[104:107], v[12:15]
    v_mfma_f32_16x16x32_bf16 v[16:19], a[148:151], v[104:107], v[16:19]
    s_waitcnt vmcnt(12)
    v_mfma_f32_16x16x32_bf16 v[12:15], a[152:155], v[108:111], v[12:15]
    v_mfma_f32_16x16x32_bf16 v[16:19], a[156:159], v[108:111], v[16:19]
    s_waitcnt vmcnt(11)
    v_mfma_f32_16x16x32_bf16 v[12:15], a[160:163], v[112:115], v[12:15]
    v_mfma_f32_16x16x32_bf16 v[16:19], a[164:167], v[112:115], v[16:19]
    s_waitcnt vmcnt(10)
    v_mfma_f32_16x16x32_bf16 v[12:15], a[168:171], v[116:119], v[12:15]
    v_mfma_f32_16x16x32_bf16 v[16:19], a[172:175], v[116:119], v[16:19]
    s_waitcnt vmcnt(9)
    v_mfma_f32_16x16x32_bf16 v[12:15], a[176:179], v[120:123], v[12:15]
    v_mfma_f32_16x16x32_bf16 v[16:19], a[180:183], v[120:123], v[16:19]
    s_waitcnt vmcnt(8)
    v_mfma_f32_16x16x32_bf16 v[12:15], a[184:187], v[124:127], v[12:15]
    v_mfma_f32_16x16x32_bf16 v[16:19], a[188:191], v[124:127], v[16:19]
    s_waitcnt vmcnt(7)
    v_mfma_f32_16x16x32_bf16 v[12:15], a[192:195], v[32:35], v[12:15]
    v_mfma_f32_16x16x32_bf16 v[16:19], a[196:199], v[32:35], v[16:19]
    s_waitcnt vmcnt(6)
    v_mfma_f32_16x16x32_bf16 v[12:15], a[200:203], v[36:39], v[12:15]
    v_mfma_f32_16x16x32_bf16 v[16:19], a[204:207], v[36:39], v[16:19]
    s_waitcnt vmcnt(5)
    v_mfma_f32_16x16x32_bf16 v[12:15], a[208:211], v[40:43], v[12:15]
    v_mfma_f32_16x16x32_bf16 v[16:19], a[212:215], v[40:43], v[16:19]
    s_waitcnt vmcnt(4)
    v_mfma_f32_16x16x32_bf16 v[12:15], a[216:219], v[44:47], v[12:15]
    v_mfma_f32_16x16x32_bf16 v[16:19], a[220:223], v[44:47], v[16:19]
    s_waitcnt vmcnt(3)
    v_mfma_f32_16x16x32_bf16 v[12:15], a[224:227], v[48:51], v[12:15]
    v_mfma_f32_16x16x32_bf16 v[16:19], a[228:231], v[48:51], v[16:19]
    s_waitcnt vmcnt(2)
    v_mfma_f32_16x16x32_bf16 v[12:15], a[232:235], v[52:55], v[12:15]
    v_mfma_f32_16x16x32_bf16 v[16:19], a[236:239], v[52:55], v[16:19]
    s_waitcnt vmcnt(1)
    v_mfma_f32_16x16x32_bf16 v[12:15], a[240:243], v[56:59], v[12:15]
    v_mfma_f32_16x16x32_bf16 v[16:19], a[244:247], v[56:59], v[16:19]
    s_waitcnt vmcnt(0)
    v_mfma_f32_16x16x32_bf16 v[12:15], a[248:251], v[60:63], v[12:15]
    v_mfma_f32_16x16x32_bf16 v[16:19], a[252:255], v[60:63], v[16:19]
    v_add_u32 v26, s31, v2
    v_add_u32 v27, s31, v0
    s_nop 4
    ds_write_b128 v26, v[12:15]
    ds_write_b128 v26, v[16:19] offset:1024
    s_waitcnt lgkmcnt(0)
    s_barrier
    s_cmp_eq_u32 s13, 0
    s_cbranch_scc0 B_next
    ds_read_b128 v[32:35], v27 offset:2048
    ds_read_b128 v[36:39], v27 offset:3072
    ds_read_b128 v[40:43], v27 offset:4096
    ds_read_b128 v[44:47], v27 offset:5120
    ds_read_b128 v[48:51], v27 offset:6144
    ds_read_b128 v[52:55], v27 offset:7168
    v_lshlrev_b32 v56, 16, v20
    v_and_b32 v60, s37, v20
    v_lshlrev_b32 v57, 16, v21
    v_and_b32 v61, s37, v21
    v_lshlrev_b32 v58, 16, v22
    v_and_b32 v62, s37, v22
    v_lshlrev_b32 v59, 16, v23
    v_and_b32 v63, s37, v23
    v_add_f32 v56, v56, v4
    v_add_f32 v57, v57, v5
    v_add_f32 v58, v58, v6
    v_add_f32 v59, v59, v7
    v_add_f32 v60, v60, v8
    v_add_f32 v61, v61, v9
    v_add_f32 v62, v62, v10
    v_add_f32 v63, v63, v11
    v_add_f32 v12, v12, v56
    v_add_f32 v13, v13, v57
    v_add_f32 v14, v14, v58
    v_add_f32 v15, v15, v59
    v_add_f32 v16, v16, v60
    v_add_f32 v17, v17, v61
    v_add_f32 v18, v18, v62
    v_add_f32 v19, v19, v63
    s_waitcnt lgkmcnt(4)
    v_add_f32 v12, v12, v32
    v_add_f32 v13, v13, v33
    v_add_f32 v14, v14, v34
    v_add_f32 v15, v15, v35
    v_add_f32 v16, v16, v36
    v_add_f32 v17, v17, v37
    v_add_f32 v18, v18, v38
    v_add_f32 v19, v19, v39
    s_waitcnt lgkmcnt(2)
    v_add_f32 v12, v12, v40
    v_add_f32 v13, v13, v41
    v_add_f32 v14, v14, v42
    v_add_f32 v15, v15, v43
    v_add_f32 v16, v16, v44
    v_add_f32 v17, v17, v45
    v_add_f32 v18, v18, v46
    v_add_f32 v19, v19, v47
    s_waitcnt lgkmcnt(0)
    v_add_f32 v12, v12, v48
    v_add_f32 v13, v13, v49
    v_add_f32 v14, v14, v50
    v_add_f32 v15, v15, v51
    v_add_f32 v16, v16, v52
    v_add_f32 v17, v17, v53
    v_add_f32 v18, v18, v54
    v_add_f32 v19, v19, v55
    v_cvt_pk_bf16_f32 v20, v12, v16
    v_cvt_pk_bf16_f32 v21, v13, v17
    v_cvt_pk_bf16_f32 v22, v14, v18
    v_cvt_pk_bf16_f32 v23, v15, v19
    buffer_store_dwordx4 v[20:23], v29, s[16:19], s30 offen sc1
B_next:
    s_xor_b32 s31, s31, 8192
    s_add_u32 s25, s25, 2
    s_cmp_lt_u32 s25, 64
    s_cbranch_scc1 B_unit
    s_waitcnt vmcnt(0)
    s_endpgm
L_abort:
L_exit:
    s_endpgm
.section .rodata,"a"
.p2align 6
.amdhsa_kernel parallel_sum__memory_aug_recurrent_mem_tr__mixer_channel_mlp__prompt_kernel
  .amdhsa_next_free_vgpr 512
  .amdhsa_next_free_sgpr 102
  .amdhsa_accum_offset 256
  .amdhsa_group_segment_fixed_size 0
  .amdhsa_kernarg_size 120
  .amdhsa_user_sgpr_count 2
  .amdhsa_user_sgpr_kernarg_segment_ptr 1
  .amdhsa_system_sgpr_workgroup_id_x 1
  .amdhsa_float_denorm_mode_32 3
.end_amdhsa_kernel
```
